```python
import torch

def _softmax(x, axis=-1):
    return torch.softmax(x, dim=axis)
def _gelu(x):
    return torch.nn.functional.gelu(x, approximate="tanh")
def _silu(x):
    return torch.nn.functional.silu(x)
def _sigmoid(x):
    return torch.sigmoid(x)
def _layernorm(x, axis=-1, eps=1e-5):
    m = x.mean(dim=axis, keepdim=True)
    v = x.var(dim=axis, keepdim=True, unbiased=False)
    return (x - m) / torch.sqrt(v + eps)
def _scatter_add(tgt, idx, src, axis=0):
    return tgt.clone().index_add_(axis, idx, src)
def _segment_sum(src, seg, n):
    out = torch.zeros((n,) + src.shape[1:], dtype=src.dtype)
    return out.index_add_(0, seg, src)
def _pad(x, pw):
    flat = tuple(v for pair in reversed(pw) for v in pair)
    return torch.nn.functional.pad(x, flat)

kernel_name = 'parallel_sum__compressed_kv_cla__glu_gated_bilinear__prompt'

def setup_inputs():

    _w = (lambda a: (lambda t: t.to(torch.bfloat16) if t.is_floating_point() else t)(torch.as_tensor(a)))
    def _A_setup():
        B, H, Sq, Sk, D, M = 1, 16, 2048, 2048, 256, 448
        Dc = 4 * D
        return {
            "x": _w((lambda *s: torch.randn(*s, dtype=torch.bfloat16) * 0.05)(B, Sq, M)),
            "c_kv": _w((lambda *s: torch.randn(*s, dtype=torch.bfloat16) * 0.2)(B, Sk, Dc)),
            "w_q": _w((lambda *s: torch.randn(*s, dtype=torch.bfloat16) * 6.4)(M, H, D) * (M ** -0.5)),
            "w_uk": _w((lambda *s: torch.randn(*s, dtype=torch.bfloat16) * 6.4)(Dc, H, D) * (Dc ** -0.5)),
            "w_uv": _w((lambda *s: torch.randn(*s, dtype=torch.bfloat16) * 0.2)(Dc, H, D) * (Dc ** -0.5)),
            "w_o": _w((lambda *s: torch.randn(*s, dtype=torch.bfloat16) * 0.2)(H, D, M) * ((H * D) ** -0.5)),
        }
    _A_in = _A_setup()

    def _B_setup():
        B, S, D, F = 1, 2048, 448, 1792
        return {
            "x": _w((lambda *s: torch.randn(*s, dtype=torch.bfloat16) * 0.05)(B, S, D)),
            "w_gate": _w((lambda *s: torch.randn(*s, dtype=torch.bfloat16) * 0.2)(D, F) * (D ** -0.5)),
            "w_up": _w((lambda *s: torch.randn(*s, dtype=torch.bfloat16) * 0.2)(D, F) * (D ** -0.5)),
            "w_down": _w((lambda *s: torch.randn(*s, dtype=torch.bfloat16) * 0.2)(F, D) * (F ** -0.5)),
        }
    _B_in = _B_setup()

    return {
        "A_x": _A_in["x"],
        "A_c_kv": _A_in["c_kv"],
        "A_w_q": _A_in["w_q"],
        "A_w_uk": _A_in["w_uk"],
        "A_w_uv": _A_in["w_uv"],
        "A_w_o": _A_in["w_o"],
        "B_x": _B_in["x"],
        "B_w_gate": _B_in["w_gate"],
        "B_w_up": _B_in["w_up"],
        "B_w_down": _B_in["w_down"],
    }

def reference(A_x, A_c_kv, A_w_q, A_w_uk, A_w_uv, A_w_o, B_x, B_w_gate, B_w_up, B_w_down):
    def _A_ref(x, c_kv, w_q, w_uk, w_uv, w_o):
        B, Sq, M = x.shape[0], x.shape[1], x.shape[2]
        Sk = c_kv.shape[1]
        H, D = w_q.shape[1], w_q.shape[2]
        q = torch.einsum("bqm,mhd->bhqd", x, w_q)
        k = torch.einsum("bkc,chd->bhkd", c_kv, w_uk)
        v = torch.einsum("bkc,chd->bhkd", c_kv, w_uv)
        scores = torch.einsum("bhqd,bhkd->bhqk", q, k) * (D ** -0.5)
        off = Sk - Sq
        qi = torch.arange(Sq)[:, None]
        kj = torch.arange(Sk)[None, :]
        cmask = kj <= (qi + off)
        scores = torch.where(cmask[None, None], scores, -1e9)
        p = _softmax(scores, axis=-1)
        ctx = torch.einsum("bhqk,bhkd->bhqd", p, v)
        return torch.einsum("bhqd,hdm->bqm", ctx, w_o)

    def _B_ref(x, w_gate, w_up, w_down):
        g = torch.einsum("bsd,df->bsf", x, w_gate)
        u = torch.einsum("bsd,df->bsf", x, w_up)
        h = g * u
        return torch.einsum("bsf,fd->bsd", h, w_down)

    x = A_x
    xn = _layernorm(x, axis=-1)
    return x + _A_ref(xn, A_c_kv, A_w_q, A_w_uk, A_w_uv, A_w_o) + _B_ref(xn, B_w_gate, B_w_up, B_w_down)
```

```asm
; @launch grid=(256,1,1) block=(256,1,1) lds=163840
.amdgcn_target "amdgcn-amd-amdhsa--gfx950"
.text
.globl parallel_sum__compressed_kv_cla__glu_gated_bilinear__prompt_kernel
.p2align 8
.type parallel_sum__compressed_kv_cla__glu_gated_bilinear__prompt_kernel,@function
parallel_sum__compressed_kv_cla__glu_gated_bilinear__prompt_kernel:
s_cmp_ge_u32 s2, 256
s_cbranch_scc1 KF_END
s_memrealtime s[100:101]
s_getpc_b64 s[4:5]
KF_PC0:
s_lshr_b32 s3, s2, 3
v_lshrrev_b32 v1, 6, v0
s_cmp_ge_u32 s3, 14
v_readfirstlane_b32 s6, v1
s_cbranch_scc1 KF_NOPF
s_cmp_eq_u32 s6, 3
s_cbranch_scc0 KF_NOPF
v_and_b32 v1, 63, v0
v_lshlrev_b32 v1, 7, v1
s_lshl_b32 s3, s3, 13
v_add_u32 v1, s3, v1
s_mov_b32 s7, KF_END-KF_PC0
v_min_u32 v1, s7, v1
global_load_dword v223, v1, s[4:5]
KF_NOPF:
s_load_dwordx4 s[24:27], s[0:1], 0
s_load_dwordx4 s[48:51], s[0:1], 24
s_load_dwordx2 s[28:29], s[0:1], 96
s_load_dwordx2 s[76:77], s[0:1], 16
s_load_dwordx2 s[78:79], s[0:1], 40
s_load_dwordx4 s[80:83], s[0:1], 56
s_load_dwordx2 s[84:85], s[0:1], 72
s_load_dwordx2 s[88:89], s[0:1], 88
v_lshrrev_b32 v1, 6, v0
v_and_b32 v2, 63, v0
v_readfirstlane_b32 s30, v1
s_and_b32 s3, s2, 7
s_lshr_b32 s41, s2, 3
s_and_b32 s42, s41, 1
s_lshl_b32 s31, s3, 1
s_add_u32 s31, s31, s42
s_bfe_u32 s33, s41, 0x10001
s_lshr_b32 s32, s41, 2
s_and_b32 s44, s30, 1
s_lshr_b32 s45, s30, 1
v_lshrrev_b32 v3, 5, v2
v_and_b32 v4, 31, v2
v_lshrrev_b32 v11, 3, v2
v_lshlrev_b32 v11, 11, v11
v_and_b32 v12, 7, v2
v_lshrrev_b32 v13, 4, v2
v_xor_b32 v12, v12, v13
v_xor_b32 v13, 4, v12
v_lshl_add_u32 v12, v12, 4, v11
v_lshl_add_u32 v13, v13, 4, v11
v_add_u32 v144, 0, v12
v_add_u32 v145, 15360, v13
v_add_u32 v146, 30720, v12
v_add_u32 v147, 46080, v13
v_add_u32 v148, 65536, v12
v_add_u32 v149, 80896, v13
v_add_u32 v150, 96256, v12
v_add_u32 v151, 111616, v13
s_lshl_b32 s41, s44, 3
v_add_u32 v11, 0, v3
v_and_b32 v12, 3, v11
v_lshlrev_b32 v12, 1, v12
v_or_b32 v12, s41, v12
v_xor_b32 v12, v12, v4
v_lshlrev_b32 v12, 4, v12
v_lshl_add_u32 v12, v11, 13, v12
v_subrev_u32 v152, 0, v12
v_add_u32 v11, 2, v3
v_and_b32 v12, 3, v11
v_lshlrev_b32 v12, 1, v12
v_or_b32 v12, s41, v12
v_xor_b32 v12, v12, v4
v_lshlrev_b32 v12, 4, v12
v_lshl_add_u32 v12, v11, 13, v12
v_subrev_u32 v153, 1024, v12
v_add_u32 v11, 4, v3
v_and_b32 v12, 3, v11
v_lshlrev_b32 v12, 1, v12
v_or_b32 v12, s41, v12
v_xor_b32 v12, v12, v4
v_lshlrev_b32 v12, 4, v12
v_lshl_add_u32 v12, v11, 13, v12
v_subrev_u32 v154, 2048, v12
v_add_u32 v11, 6, v3
v_and_b32 v12, 3, v11
v_lshlrev_b32 v12, 1, v12
v_or_b32 v12, s41, v12
v_xor_b32 v12, v12, v4
v_lshlrev_b32 v12, 4, v12
v_lshl_add_u32 v12, v11, 13, v12
v_subrev_u32 v155, 3072, v12
s_lshl_b32 s34, s32, 8
s_lshl_b32 s41, s30, 6
s_add_u32 s34, s34, s41
s_lshl_b32 s34, s34, 11
s_lshl_b32 s35, s30, 16
s_lshl_b32 s41, s31, 9
s_add_u32 s35, s35, s41
s_lshl_b32 s36, s30, 13
s_lshl_b32 s37, s30, 12
s_lshl_b32 s41, s2, 3
s_lshl_b32 s42, s30, 1
s_add_u32 s41, s41, s42
v_add_u32 v5, s41, v3
v_mul_u32_u24 v6, 896, v5
v_lshl_add_u32 v6, v4, 4, v6
v_add_u32 v7, 512, v6
v_cmp_gt_u32 vcc, 24, v4
v_mov_b32 v8, 0x7ffffff0
s_waitcnt lgkmcnt(0)
v_cndmask_b32 v7, v8, v7, vcc
s_mov_b32 s4, s26
s_and_b32 s5, s27, 0xffff
s_mov_b32 s6, 4194304
s_mov_b32 s7, 0x20000
s_cmp_eq_u32 s33, 0
s_cselect_b32 s52, s48, s50
s_cselect_b32 s53, s49, s51
s_mov_b32 s8, s52
s_and_b32 s9, s53, 0xffff
s_mov_b32 s10, 8388608
s_mov_b32 s11, 0x20000
s_mov_b32 s16, s24
s_and_b32 s17, s25, 0xffff
s_mov_b32 s18, 1835008
s_mov_b32 s19, 0x20000
buffer_load_dwordx4 v[168:171], v6, s[16:19], 0 offen
buffer_load_dwordx4 v[172:175], v7, s[16:19], 0 offen
s_add_u32 s60, s36, 65536
s_add_u32 s61, s36, 98304
s_add_u32 s62, s36, 131072
s_mov_b32 s63, s34
s_add_u32 s64, s34, 128
s_add_u32 s65, s34, 256
s_mov_b32 s54, s37
s_add_u32 s55, s37, 16384
s_add_u32 s56, s35, 262144
s_add_u32 s71, s37, 32768
s_add_u32 s72, s37, 49152
s_add_u32 s73, s35, 524288
s_add_u32 s86, s35, 786432
s_add_u32 m0, s60, 0
s_nop 0
buffer_load_dwordx4 v144, s[4:7], s63 offen offset:0 lds
v_lshrrev_b32 v9, 4, v5
v_mul_u32_u24 v9, 14, v9
v_lshrrev_b32 v10, 2, v4
v_add_u32 v9, v9, v10
v_lshlrev_b32 v9, 6, v9
v_and_b32 v10, 15, v5
v_add_u32 v9, v9, v10
v_and_b32 v10, 3, v4
v_lshl_add_u32 v9, v10, 4, v9
v_lshlrev_b32 v9, 4, v9
buffer_load_dwordx4 v145, s[4:7], s63 offen offset:1024 lds
v_add_u32 v10, 8192, v9
v_cndmask_b32 v10, v8, v10, vcc
v_and_b32 v11, 15, v2
v_lshrrev_b32 v14, 4, v2
v_bfe_u32 v13, v2, 1, 3
s_lshl_b32 s42, s44, 14
s_add_u32 s42, s42, 65536
v_lshlrev_b32 v12, 7, v11
v_add_u32 v12, s42, v12
v_add_u32 v15, 0, v14
buffer_load_dwordx4 v146, s[4:7], s63 offen offset:2048 lds
v_xor_b32 v15, v15, v13
v_lshl_add_u32 v156, v15, 4, v12
v_add_u32 v15, 4, v14
v_xor_b32 v15, v15, v13
v_lshl_add_u32 v157, v15, 4, v12
v_bfe_u32 v12, v2, 2, 2
v_lshl_add_u32 v13, v14, 3, v12
v_lshlrev_b32 v13, 9, v13
v_and_b32 v15, 1, v2
v_lshl_add_u32 v13, v15, 3, v13
buffer_load_dwordx4 v147, s[4:7], s63 offen offset:3072 lds
v_bfe_u32 v15, v2, 4, 1
v_lshl_add_u32 v12, v15, 2, v12
v_lshlrev_b32 v12, 1, v12
v_bfe_u32 v15, v2, 1, 1
s_lshl_b32 s42, s45, 4
v_add_u32 v15, s42, v15
v_add_u32 v11, 0, v15
v_xor_b32 v11, v11, v12
v_lshl_add_u32 v158, v11, 4, v13
v_add_u32 v11, 2, v15
s_add_u32 m0, s60, 4096
s_nop 0
buffer_load_dwordx4 v148, s[4:7], s63 offen offset:0 lds
v_xor_b32 v11, v11, v12
v_lshl_add_u32 v159, v11, 4, v13
v_add_u32 v11, 4, v15
v_xor_b32 v11, v11, v12
v_lshl_add_u32 v160, v11, 4, v13
v_add_u32 v11, 6, v15
v_xor_b32 v11, v11, v12
v_lshl_add_u32 v161, v11, 4, v13
v_add_u32 v11, 8, v15
v_xor_b32 v11, v11, v12
buffer_load_dwordx4 v149, s[4:7], s63 offen offset:1024 lds
v_lshl_add_u32 v162, v11, 4, v13
v_add_u32 v11, 10, v15
v_xor_b32 v11, v11, v12
v_lshl_add_u32 v163, v11, 4, v13
v_add_u32 v11, 12, v15
v_xor_b32 v11, v11, v12
v_lshl_add_u32 v164, v11, 4, v13
v_add_u32 v11, 14, v15
v_xor_b32 v11, v11, v12
v_lshl_add_u32 v165, v11, 4, v13
buffer_load_dwordx4 v150, s[4:7], s63 offen offset:2048 lds
v_lshrrev_b32 v11, 4, v2
v_and_b32 v12, 15, v2
v_or_b32 v13, 0, v11
v_lshlrev_b32 v13, 1, v13
v_xor_b32 v13, v13, v12
v_lshlrev_b32 v13, 4, v13
v_add_u32 v216, 0, v11
v_lshlrev_b32 v216, 13, v216
v_add_u32 v216, v216, v13
v_subrev_u32 v216, 0, v216
buffer_load_dwordx4 v151, s[4:7], s63 offen offset:3072 lds
v_or_b32 v13, 0, v11
v_lshlrev_b32 v13, 1, v13
v_xor_b32 v13, v13, v12
v_lshlrev_b32 v13, 4, v13
v_add_u32 v217, 4, v11
v_lshlrev_b32 v217, 13, v217
v_add_u32 v217, v217, v13
v_subrev_u32 v217, 1024, v217
v_or_b32 v13, 4, v11
v_lshlrev_b32 v13, 1, v13
s_mov_b32 m0, s54
s_nop 0
buffer_load_dwordx4 v152, s[8:11], s35 offen offset:0 lds
v_xor_b32 v13, v13, v12
v_lshlrev_b32 v13, 4, v13
v_add_u32 v218, 8, v11
v_lshlrev_b32 v218, 13, v218
v_add_u32 v218, v218, v13
v_subrev_u32 v218, 2048, v218
v_or_b32 v13, 4, v11
v_lshlrev_b32 v13, 1, v13
v_xor_b32 v13, v13, v12
v_lshlrev_b32 v13, 4, v13
buffer_load_dwordx4 v153, s[8:11], s35 offen offset:1024 lds
v_add_u32 v219, 12, v11
v_lshlrev_b32 v219, 13, v219
v_add_u32 v219, v219, v13
v_subrev_u32 v219, 3072, v219
v_accvgpr_write_b32 a0, 0
v_accvgpr_write_b32 a1, 0
v_accvgpr_write_b32 a2, 0
v_accvgpr_write_b32 a3, 0
v_accvgpr_write_b32 a4, 0
v_accvgpr_write_b32 a5, 0
buffer_load_dwordx4 v154, s[8:11], s35 offen offset:2048 lds
v_accvgpr_write_b32 a6, 0
v_accvgpr_write_b32 a7, 0
v_accvgpr_write_b32 a8, 0
v_accvgpr_write_b32 a9, 0
v_accvgpr_write_b32 a10, 0
v_accvgpr_write_b32 a11, 0
v_accvgpr_write_b32 a12, 0
v_accvgpr_write_b32 a13, 0
v_accvgpr_write_b32 a14, 0
v_accvgpr_write_b32 a15, 0
buffer_load_dwordx4 v155, s[8:11], s35 offen offset:3072 lds
v_accvgpr_write_b32 a16, 0
v_accvgpr_write_b32 a17, 0
v_accvgpr_write_b32 a18, 0
v_accvgpr_write_b32 a19, 0
v_accvgpr_write_b32 a20, 0
v_accvgpr_write_b32 a21, 0
v_accvgpr_write_b32 a22, 0
v_accvgpr_write_b32 a23, 0
v_accvgpr_write_b32 a24, 0
v_accvgpr_write_b32 a25, 0
s_mov_b32 m0, s55
s_nop 0
buffer_load_dwordx4 v152, s[8:11], s56 offen offset:0 lds
v_accvgpr_write_b32 a26, 0
v_accvgpr_write_b32 a27, 0
v_accvgpr_write_b32 a28, 0
v_accvgpr_write_b32 a29, 0
v_accvgpr_write_b32 a30, 0
v_accvgpr_write_b32 a31, 0
v_accvgpr_write_b32 a32, 0
v_accvgpr_write_b32 a33, 0
v_accvgpr_write_b32 a34, 0
v_accvgpr_write_b32 a35, 0
buffer_load_dwordx4 v153, s[8:11], s56 offen offset:1024 lds
v_accvgpr_write_b32 a36, 0
v_accvgpr_write_b32 a37, 0
v_accvgpr_write_b32 a38, 0
v_accvgpr_write_b32 a39, 0
v_accvgpr_write_b32 a40, 0
v_accvgpr_write_b32 a41, 0
v_accvgpr_write_b32 a42, 0
v_accvgpr_write_b32 a43, 0
v_accvgpr_write_b32 a44, 0
v_accvgpr_write_b32 a45, 0
buffer_load_dwordx4 v154, s[8:11], s56 offen offset:2048 lds
v_accvgpr_write_b32 a46, 0
v_accvgpr_write_b32 a47, 0
v_accvgpr_write_b32 a48, 0
v_accvgpr_write_b32 a49, 0
v_accvgpr_write_b32 a50, 0
v_accvgpr_write_b32 a51, 0
v_accvgpr_write_b32 a52, 0
v_accvgpr_write_b32 a53, 0
v_accvgpr_write_b32 a54, 0
v_accvgpr_write_b32 a55, 0
buffer_load_dwordx4 v155, s[8:11], s56 offen offset:3072 lds
v_accvgpr_write_b32 a56, 0
v_accvgpr_write_b32 a57, 0
v_accvgpr_write_b32 a58, 0
v_accvgpr_write_b32 a59, 0
v_accvgpr_write_b32 a60, 0
v_accvgpr_write_b32 a61, 0
v_accvgpr_write_b32 a62, 0
v_accvgpr_write_b32 a63, 0
v_accvgpr_write_b32 a64, 0
v_accvgpr_write_b32 a65, 0
s_add_u32 m0, s61, 0
s_nop 0
buffer_load_dwordx4 v144, s[4:7], s64 offen offset:0 lds
v_accvgpr_write_b32 a66, 0
v_accvgpr_write_b32 a67, 0
v_accvgpr_write_b32 a68, 0
v_accvgpr_write_b32 a69, 0
v_accvgpr_write_b32 a70, 0
v_accvgpr_write_b32 a71, 0
v_accvgpr_write_b32 a72, 0
v_accvgpr_write_b32 a73, 0
v_accvgpr_write_b32 a74, 0
v_accvgpr_write_b32 a75, 0
buffer_load_dwordx4 v145, s[4:7], s64 offen offset:1024 lds
v_accvgpr_write_b32 a76, 0
v_accvgpr_write_b32 a77, 0
v_accvgpr_write_b32 a78, 0
v_accvgpr_write_b32 a79, 0
v_accvgpr_write_b32 a80, 0
v_accvgpr_write_b32 a81, 0
v_accvgpr_write_b32 a82, 0
v_accvgpr_write_b32 a83, 0
v_accvgpr_write_b32 a84, 0
v_accvgpr_write_b32 a85, 0
buffer_load_dwordx4 v146, s[4:7], s64 offen offset:2048 lds
v_accvgpr_write_b32 a86, 0
v_accvgpr_write_b32 a87, 0
v_accvgpr_write_b32 a88, 0
v_accvgpr_write_b32 a89, 0
v_accvgpr_write_b32 a90, 0
v_accvgpr_write_b32 a91, 0
v_accvgpr_write_b32 a92, 0
v_accvgpr_write_b32 a93, 0
v_accvgpr_write_b32 a94, 0
v_accvgpr_write_b32 a95, 0
buffer_load_dwordx4 v147, s[4:7], s64 offen offset:3072 lds
v_accvgpr_write_b32 a96, 0
v_accvgpr_write_b32 a97, 0
v_accvgpr_write_b32 a98, 0
v_accvgpr_write_b32 a99, 0
v_accvgpr_write_b32 a100, 0
v_accvgpr_write_b32 a101, 0
v_accvgpr_write_b32 a102, 0
v_accvgpr_write_b32 a103, 0
v_accvgpr_write_b32 a104, 0
v_accvgpr_write_b32 a105, 0
s_add_u32 m0, s61, 4096
s_nop 0
buffer_load_dwordx4 v148, s[4:7], s64 offen offset:0 lds
v_accvgpr_write_b32 a106, 0
v_accvgpr_write_b32 a107, 0
v_accvgpr_write_b32 a108, 0
v_accvgpr_write_b32 a109, 0
v_accvgpr_write_b32 a110, 0
v_accvgpr_write_b32 a111, 0
v_accvgpr_write_b32 a112, 0
v_accvgpr_write_b32 a113, 0
v_accvgpr_write_b32 a114, 0
v_accvgpr_write_b32 a115, 0
buffer_load_dwordx4 v149, s[4:7], s64 offen offset:1024 lds
v_accvgpr_write_b32 a116, 0
v_accvgpr_write_b32 a117, 0
v_accvgpr_write_b32 a118, 0
v_accvgpr_write_b32 a119, 0
v_accvgpr_write_b32 a120, 0
v_accvgpr_write_b32 a121, 0
v_accvgpr_write_b32 a122, 0
v_accvgpr_write_b32 a123, 0
v_accvgpr_write_b32 a124, 0
v_accvgpr_write_b32 a125, 0
buffer_load_dwordx4 v150, s[4:7], s64 offen offset:2048 lds
v_accvgpr_write_b32 a126, 0
v_accvgpr_write_b32 a127, 0
v_accvgpr_write_b32 a128, 0
v_accvgpr_write_b32 a129, 0
v_accvgpr_write_b32 a130, 0
v_accvgpr_write_b32 a131, 0
v_accvgpr_write_b32 a132, 0
v_accvgpr_write_b32 a133, 0
v_accvgpr_write_b32 a134, 0
v_accvgpr_write_b32 a135, 0
buffer_load_dwordx4 v151, s[4:7], s64 offen offset:3072 lds
v_accvgpr_write_b32 a136, 0
v_accvgpr_write_b32 a137, 0
v_accvgpr_write_b32 a138, 0
v_accvgpr_write_b32 a139, 0
v_accvgpr_write_b32 a140, 0
v_accvgpr_write_b32 a141, 0
v_accvgpr_write_b32 a142, 0
v_accvgpr_write_b32 a143, 0
v_accvgpr_write_b32 a144, 0
v_accvgpr_write_b32 a145, 0
s_mov_b32 m0, s71
s_nop 0
buffer_load_dwordx4 v152, s[8:11], s73 offen offset:0 lds
v_accvgpr_write_b32 a146, 0
v_accvgpr_write_b32 a147, 0
v_accvgpr_write_b32 a148, 0
v_accvgpr_write_b32 a149, 0
v_accvgpr_write_b32 a150, 0
v_accvgpr_write_b32 a151, 0
v_accvgpr_write_b32 a152, 0
v_accvgpr_write_b32 a153, 0
v_accvgpr_write_b32 a154, 0
v_accvgpr_write_b32 a155, 0
buffer_load_dwordx4 v153, s[8:11], s73 offen offset:1024 lds
v_accvgpr_write_b32 a156, 0
v_accvgpr_write_b32 a157, 0
v_accvgpr_write_b32 a158, 0
v_accvgpr_write_b32 a159, 0
v_accvgpr_write_b32 a160, 0
v_accvgpr_write_b32 a161, 0
v_accvgpr_write_b32 a162, 0
v_accvgpr_write_b32 a163, 0
v_accvgpr_write_b32 a164, 0
v_accvgpr_write_b32 a165, 0
buffer_load_dwordx4 v154, s[8:11], s73 offen offset:2048 lds
v_accvgpr_write_b32 a166, 0
v_accvgpr_write_b32 a167, 0
v_accvgpr_write_b32 a168, 0
v_accvgpr_write_b32 a169, 0
v_accvgpr_write_b32 a170, 0
v_accvgpr_write_b32 a171, 0
v_accvgpr_write_b32 a172, 0
v_accvgpr_write_b32 a173, 0
v_accvgpr_write_b32 a174, 0
v_accvgpr_write_b32 a175, 0
buffer_load_dwordx4 v155, s[8:11], s73 offen offset:3072 lds
v_accvgpr_write_b32 a176, 0
v_accvgpr_write_b32 a177, 0
v_accvgpr_write_b32 a178, 0
v_accvgpr_write_b32 a179, 0
v_accvgpr_write_b32 a180, 0
v_accvgpr_write_b32 a181, 0
v_accvgpr_write_b32 a182, 0
v_accvgpr_write_b32 a183, 0
v_accvgpr_write_b32 a184, 0
v_accvgpr_write_b32 a185, 0
s_mov_b32 m0, s72
s_nop 0
buffer_load_dwordx4 v152, s[8:11], s86 offen offset:0 lds
v_accvgpr_write_b32 a186, 0
v_accvgpr_write_b32 a187, 0
v_accvgpr_write_b32 a188, 0
v_accvgpr_write_b32 a189, 0
v_accvgpr_write_b32 a190, 0
v_accvgpr_write_b32 a191, 0
v_accvgpr_write_b32 a192, 0
v_accvgpr_write_b32 a193, 0
v_accvgpr_write_b32 a194, 0
v_accvgpr_write_b32 a195, 0
buffer_load_dwordx4 v153, s[8:11], s86 offen offset:1024 lds
v_accvgpr_write_b32 a196, 0
v_accvgpr_write_b32 a197, 0
v_accvgpr_write_b32 a198, 0
v_accvgpr_write_b32 a199, 0
v_accvgpr_write_b32 a200, 0
v_accvgpr_write_b32 a201, 0
v_accvgpr_write_b32 a202, 0
v_accvgpr_write_b32 a203, 0
v_accvgpr_write_b32 a204, 0
v_accvgpr_write_b32 a205, 0
buffer_load_dwordx4 v154, s[8:11], s86 offen offset:2048 lds
v_accvgpr_write_b32 a206, 0
v_accvgpr_write_b32 a207, 0
v_accvgpr_write_b32 a208, 0
v_accvgpr_write_b32 a209, 0
v_accvgpr_write_b32 a210, 0
v_accvgpr_write_b32 a211, 0
v_accvgpr_write_b32 a212, 0
v_accvgpr_write_b32 a213, 0
v_accvgpr_write_b32 a214, 0
v_accvgpr_write_b32 a215, 0
buffer_load_dwordx4 v155, s[8:11], s86 offen offset:3072 lds
v_accvgpr_write_b32 a216, 0
v_accvgpr_write_b32 a217, 0
v_accvgpr_write_b32 a218, 0
v_accvgpr_write_b32 a219, 0
v_accvgpr_write_b32 a220, 0
v_accvgpr_write_b32 a221, 0
v_accvgpr_write_b32 a222, 0
v_accvgpr_write_b32 a223, 0
v_accvgpr_write_b32 a224, 0
v_accvgpr_write_b32 a225, 0
s_add_u32 m0, s62, 0
s_nop 0
buffer_load_dwordx4 v144, s[4:7], s65 offen offset:0 lds
v_accvgpr_write_b32 a226, 0
v_accvgpr_write_b32 a227, 0
v_accvgpr_write_b32 a228, 0
v_accvgpr_write_b32 a229, 0
v_accvgpr_write_b32 a230, 0
v_accvgpr_write_b32 a231, 0
v_accvgpr_write_b32 a232, 0
v_accvgpr_write_b32 a233, 0
v_accvgpr_write_b32 a234, 0
v_accvgpr_write_b32 a235, 0
buffer_load_dwordx4 v145, s[4:7], s65 offen offset:1024 lds
v_accvgpr_write_b32 a236, 0
v_accvgpr_write_b32 a237, 0
v_accvgpr_write_b32 a238, 0
v_accvgpr_write_b32 a239, 0
v_accvgpr_write_b32 a240, 0
v_accvgpr_write_b32 a241, 0
v_accvgpr_write_b32 a242, 0
v_accvgpr_write_b32 a243, 0
v_accvgpr_write_b32 a244, 0
v_accvgpr_write_b32 a245, 0
buffer_load_dwordx4 v146, s[4:7], s65 offen offset:2048 lds
v_accvgpr_write_b32 a246, 0
v_accvgpr_write_b32 a247, 0
v_accvgpr_write_b32 a248, 0
v_accvgpr_write_b32 a249, 0
v_accvgpr_write_b32 a250, 0
v_accvgpr_write_b32 a251, 0
v_accvgpr_write_b32 a252, 0
v_accvgpr_write_b32 a253, 0
v_accvgpr_write_b32 a254, 0
v_accvgpr_write_b32 a255, 0
buffer_load_dwordx4 v147, s[4:7], s65 offen offset:3072 lds
s_lshl_b32 s41, s2, 2
s_add_u32 s41, s41, s30
s_lshl_b32 s41, s41, 13
v_lshlrev_b32 v11, 7, v2
buffer_load_dword v224, v11, s[4:7], s41 offen
s_mul_i32 s41, s33, 16777216
s_add_u32 s41, s41, 2097152
s_add_u32 s12, s28, s41
s_addc_u32 s13, s29, 0
s_and_b32 s13, s13, 0xffff
s_mov_b32 s14, 16777216
s_mov_b32 s15, 0x20000
s_mov_b32 s20, s28
s_and_b32 s21, s29, 0xffff
s_mov_b32 s22, 1835008
s_mov_b32 s23, 0x20000
s_add_u32 s60, s28, 100663296
s_addc_u32 s61, s29, 0
s_and_b32 s61, s61, 0xffff
s_mov_b32 s62, 131072
s_mov_b32 s63, 0x20000
s_cmp_eq_u32 s30, 0
s_cbranch_scc0 K1_NOZ
v_lshlrev_b32 v11, 3, v2
s_lshl_b32 s64, s2, 9
v_mov_b32 v12, 0
v_mov_b32 v13, 0
buffer_store_dwordx2 v[12:13], v11, s[60:63], s64 offen sc1
s_cmp_eq_u32 s2, 0
s_cbranch_scc0 K1_NOZ
s_mov_b32 s60, s88
s_and_b32 s61, s89, 0xffff
s_mov_b32 s62, 256
s_mov_b32 s63, 0x20000
s_or_b32 s64, s100, 1
v_mov_b32 v12, s64
v_mov_b32 v11, 4
buffer_store_dword v12, v11, s[60:63], 0 offen sc1
K1_NOZ:
s_add_u32 s35, s35, 1048576
s_add_u32 s56, s35, 262144
s_add_u32 s66, s36, 131072
s_add_u32 s67, s34, 256
s_add_u32 s68, s36, 65536
s_add_u32 s69, s34, 384
s_add_u32 s70, s36, 163840
s_waitcnt vmcnt(37)
v_mov_b32 v178, 0x3f803f80
v_mov_b32 v176, 0
v_mov_b32 v177, 0
v_dot2_f32_bf16 v176, v168, v178, v176
v_dot2_f32_bf16 v177, v168, v168, v177
v_dot2_f32_bf16 v176, v169, v178, v176
v_dot2_f32_bf16 v177, v169, v169, v177
v_dot2_f32_bf16 v176, v170, v178, v176
v_dot2_f32_bf16 v177, v170, v170, v177
v_dot2_f32_bf16 v176, v171, v178, v176
v_dot2_f32_bf16 v177, v171, v171, v177
v_dot2_f32_bf16 v176, v172, v178, v176
v_dot2_f32_bf16 v177, v172, v172, v177
v_dot2_f32_bf16 v176, v173, v178, v176
v_dot2_f32_bf16 v177, v173, v173, v177
v_dot2_f32_bf16 v176, v174, v178, v176
v_dot2_f32_bf16 v177, v174, v174, v177
v_dot2_f32_bf16 v176, v175, v178, v176
v_dot2_f32_bf16 v177, v175, v175, v177
s_nop 2
ds_swizzle_b32 v179, v176 offset:1055
ds_swizzle_b32 v180, v177 offset:1055
s_waitcnt lgkmcnt(0)
v_add_f32 v176, v176, v179
v_add_f32 v177, v177, v180
ds_swizzle_b32 v179, v176 offset:2079
ds_swizzle_b32 v180, v177 offset:2079
s_waitcnt lgkmcnt(0)
v_add_f32 v176, v176, v179
v_add_f32 v177, v177, v180
ds_swizzle_b32 v179, v176 offset:4127
ds_swizzle_b32 v180, v177 offset:4127
s_waitcnt lgkmcnt(0)
v_add_f32 v176, v176, v179
v_add_f32 v177, v177, v180
ds_swizzle_b32 v179, v176 offset:8223
ds_swizzle_b32 v180, v177 offset:8223
s_waitcnt lgkmcnt(0)
v_add_f32 v176, v176, v179
v_add_f32 v177, v177, v180
ds_swizzle_b32 v179, v176 offset:16415
ds_swizzle_b32 v180, v177 offset:16415
s_waitcnt lgkmcnt(0)
v_add_f32 v176, v176, v179
v_add_f32 v177, v177, v180
v_mul_f32 v176, 0x3b124925, v176
v_mul_f32 v177, 0x3b124925, v177
v_fma_f32 v177, -v176, v176, v177
v_max_f32 v177, 0, v177
v_add_f32 v177, 0x3727c5ac, v177
v_rsq_f32 v177, v177
s_nop 0
v_lshlrev_b32 v179, 16, v168
v_and_b32 v180, 0xffff0000, v168
v_sub_f32 v179, v179, v176
v_sub_f32 v180, v180, v176
v_mul_f32 v179, v179, v177
v_mul_f32 v180, v180, v177
v_cvt_pk_bf16_f32 v168, v179, v180
v_lshlrev_b32 v179, 16, v169
v_and_b32 v180, 0xffff0000, v169
v_sub_f32 v179, v179, v176
v_sub_f32 v180, v180, v176
v_mul_f32 v179, v179, v177
v_mul_f32 v180, v180, v177
v_cvt_pk_bf16_f32 v169, v179, v180
v_lshlrev_b32 v179, 16, v170
v_and_b32 v180, 0xffff0000, v170
v_sub_f32 v179, v179, v176
v_sub_f32 v180, v180, v176
v_mul_f32 v179, v179, v177
v_mul_f32 v180, v180, v177
v_cvt_pk_bf16_f32 v170, v179, v180
v_lshlrev_b32 v179, 16, v171
v_and_b32 v180, 0xffff0000, v171
v_sub_f32 v179, v179, v176
v_sub_f32 v180, v180, v176
v_mul_f32 v179, v179, v177
v_mul_f32 v180, v180, v177
v_cvt_pk_bf16_f32 v171, v179, v180
v_lshlrev_b32 v179, 16, v172
v_and_b32 v180, 0xffff0000, v172
v_sub_f32 v179, v179, v176
v_sub_f32 v180, v180, v176
v_mul_f32 v179, v179, v177
v_mul_f32 v180, v180, v177
v_cvt_pk_bf16_f32 v172, v179, v180
v_lshlrev_b32 v179, 16, v173
v_and_b32 v180, 0xffff0000, v173
v_sub_f32 v179, v179, v176
v_sub_f32 v180, v180, v176
v_mul_f32 v179, v179, v177
v_mul_f32 v180, v180, v177
v_cvt_pk_bf16_f32 v173, v179, v180
v_lshlrev_b32 v179, 16, v174
v_and_b32 v180, 0xffff0000, v174
v_sub_f32 v179, v179, v176
v_sub_f32 v180, v180, v176
v_mul_f32 v179, v179, v177
v_mul_f32 v180, v180, v177
v_cvt_pk_bf16_f32 v174, v179, v180
v_lshlrev_b32 v179, 16, v175
v_and_b32 v180, 0xffff0000, v175
v_sub_f32 v179, v179, v176
v_sub_f32 v180, v180, v176
v_mul_f32 v179, v179, v177
v_mul_f32 v180, v180, v177
v_cvt_pk_bf16_f32 v175, v179, v180
buffer_store_dwordx4 v[168:171], v9, s[20:23], 0 offen sc1
buffer_store_dwordx4 v[172:175], v10, s[20:23], 0 offen sc1
s_waitcnt vmcnt(27)
s_barrier
ds_read_b128 v[16:19], v156 offset:0
ds_read_b64_tr_b16 v[80:81], v158 offset:0
ds_read_b64_tr_b16 v[82:83], v158 offset:2048
ds_read_b64_tr_b16 v[84:85], v159 offset:0
ds_read_b64_tr_b16 v[86:87], v159 offset:2048
ds_read_b64_tr_b16 v[88:89], v160 offset:0
ds_read_b64_tr_b16 v[90:91], v160 offset:2048
ds_read_b64_tr_b16 v[92:93], v161 offset:0
ds_read_b64_tr_b16 v[94:95], v161 offset:2048
ds_read_b64_tr_b16 v[96:97], v162 offset:0
ds_read_b64_tr_b16 v[98:99], v162 offset:2048
ds_read_b64_tr_b16 v[100:101], v163 offset:0
ds_read_b64_tr_b16 v[102:103], v163 offset:2048
ds_read_b64_tr_b16 v[104:105], v164 offset:0
ds_read_b64_tr_b16 v[106:107], v164 offset:2048
ds_read_b64_tr_b16 v[108:109], v165 offset:0
ds_read_b64_tr_b16 v[110:111], v165 offset:2048
ds_read_b128 v[20:23], v156 offset:2048
ds_read_b128 v[24:27], v156 offset:4096
ds_read_b128 v[28:31], v156 offset:6144
ds_read_b128 v[32:35], v156 offset:8192
ds_read_b128 v[36:39], v156 offset:10240
ds_read_b128 v[40:43], v156 offset:12288
ds_read_b128 v[44:47], v156 offset:14336
s_mov_b32 s38, 0
s_mov_b32 s39, 32768
s_mov_b32 s57, 0
s_mov_b32 s58, 32768
s_mov_b32 s59, 0xffff0000
s_mov_b32 s40, 2
s_cmp_eq_u32 s33, 0
s_cbranch_scc0 K1_LOOP_V
.p2align 6
K1_LOOP_K:
s_waitcnt vmcnt(20) lgkmcnt(0)
s_barrier
v_mfma_f32_16x16x32_bf16 a[0:3], v[80:83], v[16:19], a[0:3]
s_cmp_eq_u32 s38, s40
ds_read_b128 v[48:51], v157 offset:0
v_mfma_f32_16x16x32_bf16 a[4:7], v[84:87], v[16:19], a[4:7]
s_cbranch_scc1 K1_HOOK_K
K1_BACK_K:
v_mfma_f32_16x16x32_bf16 a[8:11], v[88:91], v[16:19], a[8:11]
s_add_u32 m0, s66, 4096
ds_read_b64_tr_b16 v[112:113], v158 offset:16384
ds_read_b64_tr_b16 v[114:115], v158 offset:18432
v_mfma_f32_16x16x32_bf16 a[12:15], v[92:95], v[16:19], a[12:15]
v_mfma_f32_16x16x32_bf16 a[16:19], v[96:99], v[16:19], a[16:19]
ds_read_b64_tr_b16 v[116:117], v159 offset:16384
ds_read_b64_tr_b16 v[118:119], v159 offset:18432
v_mfma_f32_16x16x32_bf16 a[20:23], v[100:103], v[16:19], a[20:23]
buffer_load_dwordx4 v148, s[4:7], s67 offen offset:0 lds
v_mfma_f32_16x16x32_bf16 a[24:27], v[104:107], v[16:19], a[24:27]
ds_read_b64_tr_b16 v[120:121], v160 offset:16384
ds_read_b64_tr_b16 v[122:123], v160 offset:18432
v_mfma_f32_16x16x32_bf16 a[28:31], v[108:111], v[16:19], a[28:31]
v_mfma_f32_16x16x32_bf16 a[32:35], v[80:83], v[20:23], a[32:35]
ds_read_b64_tr_b16 v[124:125], v161 offset:16384
ds_read_b64_tr_b16 v[126:127], v161 offset:18432
v_mfma_f32_16x16x32_bf16 a[36:39], v[84:87], v[20:23], a[36:39]
v_mfma_f32_16x16x32_bf16 a[40:43], v[88:91], v[20:23], a[40:43]
ds_read_b64_tr_b16 v[128:129], v162 offset:16384
ds_read_b64_tr_b16 v[130:131], v162 offset:18432
v_mfma_f32_16x16x32_bf16 a[44:47], v[92:95], v[20:23], a[44:47]
buffer_load_dwordx4 v149, s[4:7], s67 offen offset:1024 lds
v_mfma_f32_16x16x32_bf16 a[48:51], v[96:99], v[20:23], a[48:51]
ds_read_b64_tr_b16 v[132:133], v163 offset:16384
ds_read_b64_tr_b16 v[134:135], v163 offset:18432
v_mfma_f32_16x16x32_bf16 a[52:55], v[100:103], v[20:23], a[52:55]
v_mfma_f32_16x16x32_bf16 a[56:59], v[104:107], v[20:23], a[56:59]
ds_read_b64_tr_b16 v[136:137], v164 offset:16384
ds_read_b64_tr_b16 v[138:139], v164 offset:18432
v_mfma_f32_16x16x32_bf16 a[60:63], v[108:111], v[20:23], a[60:63]
v_mfma_f32_16x16x32_bf16 a[64:67], v[80:83], v[24:27], a[64:67]
ds_read_b64_tr_b16 v[140:141], v165 offset:16384
ds_read_b64_tr_b16 v[142:143], v165 offset:18432
v_mfma_f32_16x16x32_bf16 a[68:71], v[84:87], v[24:27], a[68:71]
buffer_load_dwordx4 v150, s[4:7], s67 offen offset:2048 lds
v_mfma_f32_16x16x32_bf16 a[72:75], v[88:91], v[24:27], a[72:75]
ds_read_b128 v[52:55], v157 offset:2048
v_mfma_f32_16x16x32_bf16 a[76:79], v[92:95], v[24:27], a[76:79]
v_mfma_f32_16x16x32_bf16 a[80:83], v[96:99], v[24:27], a[80:83]
ds_read_b128 v[56:59], v157 offset:4096
v_mfma_f32_16x16x32_bf16 a[84:87], v[100:103], v[24:27], a[84:87]
v_mfma_f32_16x16x32_bf16 a[88:91], v[104:107], v[24:27], a[88:91]
ds_read_b128 v[60:63], v157 offset:6144
v_mfma_f32_16x16x32_bf16 a[92:95], v[108:111], v[24:27], a[92:95]
buffer_load_dwordx4 v151, s[4:7], s67 offen offset:3072 lds
v_mfma_f32_16x16x32_bf16 a[96:99], v[80:83], v[28:31], a[96:99]
ds_read_b128 v[64:67], v157 offset:8192
v_mfma_f32_16x16x32_bf16 a[100:103], v[84:87], v[28:31], a[100:103]
v_mfma_f32_16x16x32_bf16 a[104:107], v[88:91], v[28:31], a[104:107]
s_cmp_ge_u32 s38, 13
ds_read_b128 v[68:71], v157 offset:10240
v_mfma_f32_16x16x32_bf16 a[108:111], v[92:95], v[28:31], a[108:111]
s_cselect_b32 s6, 0, 4194304
v_mfma_f32_16x16x32_bf16 a[112:115], v[96:99], v[28:31], a[112:115]
ds_read_b128 v[72:75], v157 offset:12288
v_mfma_f32_16x16x32_bf16 a[116:119], v[100:103], v[28:31], a[116:119]
v_mfma_f32_16x16x32_bf16 a[120:123], v[104:107], v[28:31], a[120:123]
s_mov_b32 m0, s54
ds_read_b128 v[76:79], v157 offset:14336
v_mfma_f32_16x16x32_bf16 a[124:127], v[108:111], v[28:31], a[124:127]
v_mfma_f32_16x16x32_bf16 a[128:131], v[80:83], v[32:35], a[128:131]
s_add_u32 s66, s66, 32768
v_mfma_f32_16x16x32_bf16 a[132:135], v[84:87], v[32:35], a[132:135]
buffer_load_dwordx4 v152, s[8:11], s35 offen offset:0 lds
v_mfma_f32_16x16x32_bf16 a[136:139], v[88:91], v[32:35], a[136:139]
v_mfma_f32_16x16x32_bf16 a[140:143], v[92:95], v[32:35], a[140:143]
s_cmp_eq_u32 s66, s70
s_cselect_b32 s42, 98304, 0
s_sub_u32 s66, s66, s42
v_mfma_f32_16x16x32_bf16 a[144:147], v[96:99], v[32:35], a[144:147]
s_add_u32 s67, s67, 128
v_mfma_f32_16x16x32_bf16 a[148:151], v[100:103], v[32:35], a[148:151]
v_mfma_f32_16x16x32_bf16 a[152:155], v[104:107], v[32:35], a[152:155]
s_add_u32 s57, s57, 1
v_mfma_f32_16x16x32_bf16 a[156:159], v[108:111], v[32:35], a[156:159]
buffer_load_dwordx4 v153, s[8:11], s35 offen offset:1024 lds
v_mfma_f32_16x16x32_bf16 a[160:163], v[80:83], v[36:39], a[160:163]
v_mfma_f32_16x16x32_bf16 a[164:167], v[84:87], v[36:39], a[164:167]
s_cmp_eq_u32 s57, 3
s_cselect_b32 s39, s59, s58
s_cselect_b32 s57, 0, s57
v_mfma_f32_16x16x32_bf16 a[168:171], v[88:91], v[36:39], a[168:171]
v_mfma_f32_16x16x32_bf16 a[172:175], v[92:95], v[36:39], a[172:175]
v_mfma_f32_16x16x32_bf16 a[176:179], v[96:99], v[36:39], a[176:179]
v_mfma_f32_16x16x32_bf16 a[180:183], v[100:103], v[36:39], a[180:183]
buffer_load_dwordx4 v154, s[8:11], s35 offen offset:2048 lds
v_mfma_f32_16x16x32_bf16 a[184:187], v[104:107], v[36:39], a[184:187]
v_mfma_f32_16x16x32_bf16 a[188:191], v[108:111], v[36:39], a[188:191]
v_mfma_f32_16x16x32_bf16 a[192:195], v[80:83], v[40:43], a[192:195]
v_mfma_f32_16x16x32_bf16 a[196:199], v[84:87], v[40:43], a[196:199]
v_mfma_f32_16x16x32_bf16 a[200:203], v[88:91], v[40:43], a[200:203]
v_mfma_f32_16x16x32_bf16 a[204:207], v[92:95], v[40:43], a[204:207]
buffer_load_dwordx4 v155, s[8:11], s35 offen offset:3072 lds
v_mfma_f32_16x16x32_bf16 a[208:211], v[96:99], v[40:43], a[208:211]
v_mfma_f32_16x16x32_bf16 a[212:215], v[100:103], v[40:43], a[212:215]
v_mfma_f32_16x16x32_bf16 a[216:219], v[104:107], v[40:43], a[216:219]
s_add_u32 s35, s35, 524288
v_mfma_f32_16x16x32_bf16 a[220:223], v[108:111], v[40:43], a[220:223]
v_mfma_f32_16x16x32_bf16 a[224:227], v[80:83], v[44:47], a[224:227]
s_xor_b32 s54, s54, 0x8000
v_mfma_f32_16x16x32_bf16 a[228:231], v[84:87], v[44:47], a[228:231]
v_mfma_f32_16x16x32_bf16 a[232:235], v[88:91], v[44:47], a[232:235]
v_mfma_f32_16x16x32_bf16 a[236:239], v[92:95], v[44:47], a[236:239]
v_mfma_f32_16x16x32_bf16 a[240:243], v[96:99], v[44:47], a[240:243]
v_mfma_f32_16x16x32_bf16 a[244:247], v[100:103], v[44:47], a[244:247]
v_mfma_f32_16x16x32_bf16 a[248:251], v[104:107], v[44:47], a[248:251]
v_mfma_f32_16x16x32_bf16 a[252:255], v[108:111], v[44:47], a[252:255]
s_waitcnt vmcnt(16) lgkmcnt(0)
s_barrier
v_mfma_f32_16x16x32_bf16 a[0:3], v[112:115], v[48:51], a[0:3]
v_add_u32 v156, s39, v156
v_add_u32 v157, s39, v157
v_mfma_f32_16x16x32_bf16 a[4:7], v[116:119], v[48:51], a[4:7]
v_xor_b32 v158, 0x8000, v158
v_xor_b32 v159, 0x8000, v159
v_mfma_f32_16x16x32_bf16 a[8:11], v[120:123], v[48:51], a[8:11]
s_mov_b32 m0, s55
v_xor_b32 v160, 0x8000, v160
v_xor_b32 v161, 0x8000, v161
v_mfma_f32_16x16x32_bf16 a[12:15], v[124:127], v[48:51], a[12:15]
v_xor_b32 v162, 0x8000, v162
v_xor_b32 v163, 0x8000, v163
v_mfma_f32_16x16x32_bf16 a[16:19], v[128:131], v[48:51], a[16:19]
v_xor_b32 v164, 0x8000, v164
v_xor_b32 v165, 0x8000, v165
v_mfma_f32_16x16x32_bf16 a[20:23], v[132:135], v[48:51], a[20:23]
buffer_load_dwordx4 v152, s[8:11], s56 offen offset:0 lds
v_mfma_f32_16x16x32_bf16 a[24:27], v[136:139], v[48:51], a[24:27]
ds_read_b128 v[16:19], v156 offset:0
v_mfma_f32_16x16x32_bf16 a[28:31], v[140:143], v[48:51], a[28:31]
v_mfma_f32_16x16x32_bf16 a[32:35], v[112:115], v[52:55], a[32:35]
ds_read_b64_tr_b16 v[80:81], v158 offset:0
ds_read_b64_tr_b16 v[82:83], v158 offset:2048
v_mfma_f32_16x16x32_bf16 a[36:39], v[116:119], v[52:55], a[36:39]
v_mfma_f32_16x16x32_bf16 a[40:43], v[120:123], v[52:55], a[40:43]
ds_read_b64_tr_b16 v[84:85], v159 offset:0
ds_read_b64_tr_b16 v[86:87], v159 offset:2048
v_mfma_f32_16x16x32_bf16 a[44:47], v[124:127], v[52:55], a[44:47]
buffer_load_dwordx4 v153, s[8:11], s56 offen offset:1024 lds
v_mfma_f32_16x16x32_bf16 a[48:51], v[128:131], v[52:55], a[48:51]
ds_read_b64_tr_b16 v[88:89], v160 offset:0
ds_read_b64_tr_b16 v[90:91], v160 offset:2048
v_mfma_f32_16x16x32_bf16 a[52:55], v[132:135], v[52:55], a[52:55]
v_mfma_f32_16x16x32_bf16 a[56:59], v[136:139], v[52:55], a[56:59]
ds_read_b64_tr_b16 v[92:93], v161 offset:0
ds_read_b64_tr_b16 v[94:95], v161 offset:2048
v_mfma_f32_16x16x32_bf16 a[60:63], v[140:143], v[52:55], a[60:63]
v_mfma_f32_16x16x32_bf16 a[64:67], v[112:115], v[56:59], a[64:67]
ds_read_b64_tr_b16 v[96:97], v162 offset:0
ds_read_b64_tr_b16 v[98:99], v162 offset:2048
v_mfma_f32_16x16x32_bf16 a[68:71], v[116:119], v[56:59], a[68:71]
buffer_load_dwordx4 v154, s[8:11], s56 offen offset:2048 lds
v_mfma_f32_16x16x32_bf16 a[72:75], v[120:123], v[56:59], a[72:75]
ds_read_b64_tr_b16 v[100:101], v163 offset:0
ds_read_b64_tr_b16 v[102:103], v163 offset:2048
v_mfma_f32_16x16x32_bf16 a[76:79], v[124:127], v[56:59], a[76:79]
v_mfma_f32_16x16x32_bf16 a[80:83], v[128:131], v[56:59], a[80:83]
ds_read_b64_tr_b16 v[104:105], v164 offset:0
ds_read_b64_tr_b16 v[106:107], v164 offset:2048
v_mfma_f32_16x16x32_bf16 a[84:87], v[132:135], v[56:59], a[84:87]
v_mfma_f32_16x16x32_bf16 a[88:91], v[136:139], v[56:59], a[88:91]
ds_read_b64_tr_b16 v[108:109], v165 offset:0
ds_read_b64_tr_b16 v[110:111], v165 offset:2048
v_mfma_f32_16x16x32_bf16 a[92:95], v[140:143], v[56:59], a[92:95]
buffer_load_dwordx4 v155, s[8:11], s56 offen offset:3072 lds
v_mfma_f32_16x16x32_bf16 a[96:99], v[112:115], v[60:63], a[96:99]
ds_read_b128 v[20:23], v156 offset:2048
v_mfma_f32_16x16x32_bf16 a[100:103], v[116:119], v[60:63], a[100:103]
v_mfma_f32_16x16x32_bf16 a[104:107], v[120:123], v[60:63], a[104:107]
s_add_u32 s56, s56, 524288
ds_read_b128 v[24:27], v156 offset:4096
v_mfma_f32_16x16x32_bf16 a[108:111], v[124:127], v[60:63], a[108:111]
v_mfma_f32_16x16x32_bf16 a[112:115], v[128:131], v[60:63], a[112:115]
s_xor_b32 s55, s55, 0x8000
ds_read_b128 v[28:31], v156 offset:6144
v_mfma_f32_16x16x32_bf16 a[116:119], v[132:135], v[60:63], a[116:119]
v_mfma_f32_16x16x32_bf16 a[120:123], v[136:139], v[60:63], a[120:123]
s_add_u32 m0, s68, 0
ds_read_b128 v[32:35], v156 offset:8192
v_mfma_f32_16x16x32_bf16 a[124:127], v[140:143], v[60:63], a[124:127]
v_mfma_f32_16x16x32_bf16 a[128:131], v[112:115], v[64:67], a[128:131]
ds_read_b128 v[36:39], v156 offset:10240
v_mfma_f32_16x16x32_bf16 a[132:135], v[116:119], v[64:67], a[132:135]
buffer_load_dwordx4 v144, s[4:7], s69 offen offset:0 lds
v_mfma_f32_16x16x32_bf16 a[136:139], v[120:123], v[64:67], a[136:139]
ds_read_b128 v[40:43], v156 offset:12288
v_mfma_f32_16x16x32_bf16 a[140:143], v[124:127], v[64:67], a[140:143]
v_mfma_f32_16x16x32_bf16 a[144:147], v[128:131], v[64:67], a[144:147]
ds_read_b128 v[44:47], v156 offset:14336
v_mfma_f32_16x16x32_bf16 a[148:151], v[132:135], v[64:67], a[148:151]
v_mfma_f32_16x16x32_bf16 a[152:155], v[136:139], v[64:67], a[152:155]
v_mfma_f32_16x16x32_bf16 a[156:159], v[140:143], v[64:67], a[156:159]
buffer_load_dwordx4 v145, s[4:7], s69 offen offset:1024 lds
v_mfma_f32_16x16x32_bf16 a[160:163], v[112:115], v[68:71], a[160:163]
v_mfma_f32_16x16x32_bf16 a[164:167], v[116:119], v[68:71], a[164:167]
v_mfma_f32_16x16x32_bf16 a[168:171], v[120:123], v[68:71], a[168:171]
v_mfma_f32_16x16x32_bf16 a[172:175], v[124:127], v[68:71], a[172:175]
v_mfma_f32_16x16x32_bf16 a[176:179], v[128:131], v[68:71], a[176:179]
v_mfma_f32_16x16x32_bf16 a[180:183], v[132:135], v[68:71], a[180:183]
buffer_load_dwordx4 v146, s[4:7], s69 offen offset:2048 lds
v_mfma_f32_16x16x32_bf16 a[184:187], v[136:139], v[68:71], a[184:187]
v_mfma_f32_16x16x32_bf16 a[188:191], v[140:143], v[68:71], a[188:191]
v_mfma_f32_16x16x32_bf16 a[192:195], v[112:115], v[72:75], a[192:195]
v_mfma_f32_16x16x32_bf16 a[196:199], v[116:119], v[72:75], a[196:199]
v_mfma_f32_16x16x32_bf16 a[200:203], v[120:123], v[72:75], a[200:203]
v_mfma_f32_16x16x32_bf16 a[204:207], v[124:127], v[72:75], a[204:207]
buffer_load_dwordx4 v147, s[4:7], s69 offen offset:3072 lds
v_mfma_f32_16x16x32_bf16 a[208:211], v[128:131], v[72:75], a[208:211]
v_mfma_f32_16x16x32_bf16 a[212:215], v[132:135], v[72:75], a[212:215]
v_mfma_f32_16x16x32_bf16 a[216:219], v[136:139], v[72:75], a[216:219]
s_add_u32 s68, s68, 32768
v_mfma_f32_16x16x32_bf16 a[220:223], v[140:143], v[72:75], a[220:223]
s_cmp_eq_u32 s68, s70
s_cselect_b32 s42, 98304, 0
s_sub_u32 s68, s68, s42
v_mfma_f32_16x16x32_bf16 a[224:227], v[112:115], v[76:79], a[224:227]
s_add_u32 s69, s69, 128
v_mfma_f32_16x16x32_bf16 a[228:231], v[116:119], v[76:79], a[228:231]
v_mfma_f32_16x16x32_bf16 a[232:235], v[120:123], v[76:79], a[232:235]
s_add_u32 s38, s38, 1
v_mfma_f32_16x16x32_bf16 a[236:239], v[124:127], v[76:79], a[236:239]
v_mfma_f32_16x16x32_bf16 a[240:243], v[128:131], v[76:79], a[240:243]
v_mfma_f32_16x16x32_bf16 a[244:247], v[132:135], v[76:79], a[244:247]
v_mfma_f32_16x16x32_bf16 a[248:251], v[136:139], v[76:79], a[248:251]
v_mfma_f32_16x16x32_bf16 a[252:255], v[140:143], v[76:79], a[252:255]
s_cmp_lt_u32 s38, 16
s_cbranch_scc1 K1_LOOP_K
s_branch K1_EPI_K
K1_HOOK_K:
s_cmp_eq_u32 s38, 2
s_cbranch_scc0 K1HK_3
s_mov_b32 s48, s88
s_and_b32 s49, s89, 0xffff
s_mov_b32 s50, 256
s_mov_b32 s51, 0x20000
s_cmp_eq_u32 s30, 0
s_cbranch_scc0 K1HK_2E
v_mov_b32 v11, 0
v_mov_b32 v12, 1
v_cmp_eq_u32 vcc, 0, v2
s_and_saveexec_b64 s[52:53], vcc
s_cbranch_execz K1HK_2X
buffer_atomic_add v12, v11, s[48:51], 0 offen
K1HK_2X:
s_mov_b64 exec, s[52:53]
K1HK_2E:
s_mov_b32 s53, 0
s_lshr_b32 s40, s2, 3
s_and_b32 s40, s40, 3
s_add_u32 s40, s40, 3
s_branch K1_BACK_K
K1HK_3:
s_cmp_eq_u32 s38, 14
s_cbranch_scc1 K1HK_14
s_cmp_eq_u32 s53, 2
s_cbranch_scc1 K1HK_12
s_lshl_b32 s41, s2, 2
s_add_u32 s41, s41, s30
s_lshl_b32 s42, s53, 10
s_add_u32 s41, s41, s42
s_mov_b32 s48, s76
s_mov_b32 s49, s77
s_mov_b32 s50, 3670016
s_mov_b32 s42, 0
s_cmp_ge_u32 s41, 448
s_cselect_b32 s48, s80, s48
s_cselect_b32 s49, s81, s49
s_cselect_b32 s50, 1605632, s50
s_cselect_b32 s42, 448, s42
s_cmp_ge_u32 s41, 644
s_cselect_b32 s48, s82, s48
s_cselect_b32 s49, s83, s49
s_cselect_b32 s50, 1605632, s50
s_cselect_b32 s42, 644, s42
s_cmp_ge_u32 s41, 840
s_cselect_b32 s48, s78, s48
s_cselect_b32 s49, s79, s49
s_cselect_b32 s50, 3670016, s50
s_cselect_b32 s42, 840, s42
s_cmp_ge_u32 s41, 1288
s_cselect_b32 s48, s84, s48
s_cselect_b32 s49, s85, s49
s_cselect_b32 s50, 1605632, s50
s_cselect_b32 s42, 1288, s42
s_sub_u32 s41, s41, s42
s_and_b32 s49, s49, 0xffff
s_mov_b32 s51, 0x20000
s_lshl_b32 s41, s41, 13
v_lshlrev_b32 v11, 7, v2
buffer_load_dword v222, v11, s[48:51], s41 offen
s_add_u32 s53, s53, 1
s_cmp_eq_u32 s53, 2
s_cselect_b32 s42, 3, 4
s_add_u32 s40, s38, s42
s_branch K1_BACK_K
K1HK_12:
s_mov_b32 s48, s88
s_and_b32 s49, s89, 0xffff
s_mov_b32 s50, 256
s_mov_b32 s51, 0x20000
s_cmp_eq_u32 s30, 0
s_cbranch_scc0 K1HK_12E
v_mov_b32 v11, 0
buffer_load_dwordx2 v[220:221], v11, s[48:51], 0 offen sc1
K1HK_12E:
s_mov_b32 s40, 14
s_branch K1_BACK_K
K1HK_14:
v_mov_b32 v152, v216
v_mov_b32 v153, v217
v_mov_b32 v154, v218
v_mov_b32 v155, v219
s_mov_b32 s8, s76
s_and_b32 s9, s77, 0xffff
s_mov_b32 s10, 3670016
s_mov_b32 s11, 0x20000
s_lshl_b32 s35, s30, 17
s_lshl_b32 s41, s31, 9
s_add_u32 s35, s35, s41
s_add_u32 s56, s35, 256
s_mov_b32 s40, 99
s_branch K1_BACK_K
.p2align 6
K1_LOOP_V:
s_waitcnt vmcnt(20) lgkmcnt(0)
s_barrier
v_mfma_f32_16x16x32_bf16 a[0:3], v[16:19], v[80:83], a[0:3]
s_cmp_eq_u32 s38, s40
ds_read_b128 v[48:51], v157 offset:0
v_mfma_f32_16x16x32_bf16 a[4:7], v[16:19], v[84:87], a[4:7]
s_cbranch_scc1 K1_HOOK_V
K1_BACK_V:
v_mfma_f32_16x16x32_bf16 a[8:11], v[16:19], v[88:91], a[8:11]
s_add_u32 m0, s66, 4096
ds_read_b64_tr_b16 v[112:113], v158 offset:16384
ds_read_b64_tr_b16 v[114:115], v158 offset:18432
v_mfma_f32_16x16x32_bf16 a[12:15], v[16:19], v[92:95], a[12:15]
v_mfma_f32_16x16x32_bf16 a[16:19], v[16:19], v[96:99], a[16:19]
ds_read_b64_tr_b16 v[116:117], v159 offset:16384
ds_read_b64_tr_b16 v[118:119], v159 offset:18432
v_mfma_f32_16x16x32_bf16 a[20:23], v[16:19], v[100:103], a[20:23]
buffer_load_dwordx4 v148, s[4:7], s67 offen offset:0 lds
v_mfma_f32_16x16x32_bf16 a[24:27], v[16:19], v[104:107], a[24:27]
ds_read_b64_tr_b16 v[120:121], v160 offset:16384
ds_read_b64_tr_b16 v[122:123], v160 offset:18432
v_mfma_f32_16x16x32_bf16 a[28:31], v[16:19], v[108:111], a[28:31]
v_mfma_f32_16x16x32_bf16 a[32:35], v[20:23], v[80:83], a[32:35]
ds_read_b64_tr_b16 v[124:125], v161 offset:16384
ds_read_b64_tr_b16 v[126:127], v161 offset:18432
v_mfma_f32_16x16x32_bf16 a[36:39], v[20:23], v[84:87], a[36:39]
v_mfma_f32_16x16x32_bf16 a[40:43], v[20:23], v[88:91], a[40:43]
ds_read_b64_tr_b16 v[128:129], v162 offset:16384
ds_read_b64_tr_b16 v[130:131], v162 offset:18432
v_mfma_f32_16x16x32_bf16 a[44:47], v[20:23], v[92:95], a[44:47]
buffer_load_dwordx4 v149, s[4:7], s67 offen offset:1024 lds
v_mfma_f32_16x16x32_bf16 a[48:51], v[20:23], v[96:99], a[48:51]
ds_read_b64_tr_b16 v[132:133], v163 offset:16384
ds_read_b64_tr_b16 v[134:135], v163 offset:18432
v_mfma_f32_16x16x32_bf16 a[52:55], v[20:23], v[100:103], a[52:55]
v_mfma_f32_16x16x32_bf16 a[56:59], v[20:23], v[104:107], a[56:59]
ds_read_b64_tr_b16 v[136:137], v164 offset:16384
ds_read_b64_tr_b16 v[138:139], v164 offset:18432
v_mfma_f32_16x16x32_bf16 a[60:63], v[20:23], v[108:111], a[60:63]
v_mfma_f32_16x16x32_bf16 a[64:67], v[24:27], v[80:83], a[64:67]
ds_read_b64_tr_b16 v[140:141], v165 offset:16384
ds_read_b64_tr_b16 v[142:143], v165 offset:18432
v_mfma_f32_16x16x32_bf16 a[68:71], v[24:27], v[84:87], a[68:71]
buffer_load_dwordx4 v150, s[4:7], s67 offen offset:2048 lds
v_mfma_f32_16x16x32_bf16 a[72:75], v[24:27], v[88:91], a[72:75]
ds_read_b128 v[52:55], v157 offset:2048
v_mfma_f32_16x16x32_bf16 a[76:79], v[24:27], v[92:95], a[76:79]
v_mfma_f32_16x16x32_bf16 a[80:83], v[24:27], v[96:99], a[80:83]
ds_read_b128 v[56:59], v157 offset:4096
v_mfma_f32_16x16x32_bf16 a[84:87], v[24:27], v[100:103], a[84:87]
v_mfma_f32_16x16x32_bf16 a[88:91], v[24:27], v[104:107], a[88:91]
ds_read_b128 v[60:63], v157 offset:6144
v_mfma_f32_16x16x32_bf16 a[92:95], v[24:27], v[108:111], a[92:95]
buffer_load_dwordx4 v151, s[4:7], s67 offen offset:3072 lds
v_mfma_f32_16x16x32_bf16 a[96:99], v[28:31], v[80:83], a[96:99]
ds_read_b128 v[64:67], v157 offset:8192
v_mfma_f32_16x16x32_bf16 a[100:103], v[28:31], v[84:87], a[100:103]
v_mfma_f32_16x16x32_bf16 a[104:107], v[28:31], v[88:91], a[104:107]
s_cmp_ge_u32 s38, 13
ds_read_b128 v[68:71], v157 offset:10240
v_mfma_f32_16x16x32_bf16 a[108:111], v[28:31], v[92:95], a[108:111]
s_cselect_b32 s6, 0, 4194304
v_mfma_f32_16x16x32_bf16 a[112:115], v[28:31], v[96:99], a[112:115]
ds_read_b128 v[72:75], v157 offset:12288
v_mfma_f32_16x16x32_bf16 a[116:119], v[28:31], v[100:103], a[116:119]
v_mfma_f32_16x16x32_bf16 a[120:123], v[28:31], v[104:107], a[120:123]
s_mov_b32 m0, s54
ds_read_b128 v[76:79], v157 offset:14336
v_mfma_f32_16x16x32_bf16 a[124:127], v[28:31], v[108:111], a[124:127]
v_mfma_f32_16x16x32_bf16 a[128:131], v[32:35], v[80:83], a[128:131]
s_add_u32 s66, s66, 32768
v_mfma_f32_16x16x32_bf16 a[132:135], v[32:35], v[84:87], a[132:135]
buffer_load_dwordx4 v152, s[8:11], s35 offen offset:0 lds
v_mfma_f32_16x16x32_bf16 a[136:139], v[32:35], v[88:91], a[136:139]
v_mfma_f32_16x16x32_bf16 a[140:143], v[32:35], v[92:95], a[140:143]
s_cmp_eq_u32 s66, s70
s_cselect_b32 s42, 98304, 0
s_sub_u32 s66, s66, s42
v_mfma_f32_16x16x32_bf16 a[144:147], v[32:35], v[96:99], a[144:147]
s_add_u32 s67, s67, 128
v_mfma_f32_16x16x32_bf16 a[148:151], v[32:35], v[100:103], a[148:151]
v_mfma_f32_16x16x32_bf16 a[152:155], v[32:35], v[104:107], a[152:155]
s_add_u32 s57, s57, 1
v_mfma_f32_16x16x32_bf16 a[156:159], v[32:35], v[108:111], a[156:159]
buffer_load_dwordx4 v153, s[8:11], s35 offen offset:1024 lds
v_mfma_f32_16x16x32_bf16 a[160:163], v[36:39], v[80:83], a[160:163]
v_mfma_f32_16x16x32_bf16 a[164:167], v[36:39], v[84:87], a[164:167]
s_cmp_eq_u32 s57, 3
s_cselect_b32 s39, s59, s58
s_cselect_b32 s57, 0, s57
v_mfma_f32_16x16x32_bf16 a[168:171], v[36:39], v[88:91], a[168:171]
v_mfma_f32_16x16x32_bf16 a[172:175], v[36:39], v[92:95], a[172:175]
v_mfma_f32_16x16x32_bf16 a[176:179], v[36:39], v[96:99], a[176:179]
v_mfma_f32_16x16x32_bf16 a[180:183], v[36:39], v[100:103], a[180:183]
buffer_load_dwordx4 v154, s[8:11], s35 offen offset:2048 lds
v_mfma_f32_16x16x32_bf16 a[184:187], v[36:39], v[104:107], a[184:187]
v_mfma_f32_16x16x32_bf16 a[188:191], v[36:39], v[108:111], a[188:191]
v_mfma_f32_16x16x32_bf16 a[192:195], v[40:43], v[80:83], a[192:195]
v_mfma_f32_16x16x32_bf16 a[196:199], v[40:43], v[84:87], a[196:199]
v_mfma_f32_16x16x32_bf16 a[200:203], v[40:43], v[88:91], a[200:203]
v_mfma_f32_16x16x32_bf16 a[204:207], v[40:43], v[92:95], a[204:207]
buffer_load_dwordx4 v155, s[8:11], s35 offen offset:3072 lds
v_mfma_f32_16x16x32_bf16 a[208:211], v[40:43], v[96:99], a[208:211]
v_mfma_f32_16x16x32_bf16 a[212:215], v[40:43], v[100:103], a[212:215]
v_mfma_f32_16x16x32_bf16 a[216:219], v[40:43], v[104:107], a[216:219]
s_add_u32 s35, s35, 524288
v_mfma_f32_16x16x32_bf16 a[220:223], v[40:43], v[108:111], a[220:223]
v_mfma_f32_16x16x32_bf16 a[224:227], v[44:47], v[80:83], a[224:227]
s_xor_b32 s54, s54, 0x8000
v_mfma_f32_16x16x32_bf16 a[228:231], v[44:47], v[84:87], a[228:231]
v_mfma_f32_16x16x32_bf16 a[232:235], v[44:47], v[88:91], a[232:235]
v_mfma_f32_16x16x32_bf16 a[236:239], v[44:47], v[92:95], a[236:239]
v_mfma_f32_16x16x32_bf16 a[240:243], v[44:47], v[96:99], a[240:243]
v_mfma_f32_16x16x32_bf16 a[244:247], v[44:47], v[100:103], a[244:247]
v_mfma_f32_16x16x32_bf16 a[248:251], v[44:47], v[104:107], a[248:251]
v_mfma_f32_16x16x32_bf16 a[252:255], v[44:47], v[108:111], a[252:255]
s_waitcnt vmcnt(16) lgkmcnt(0)
s_barrier
v_mfma_f32_16x16x32_bf16 a[0:3], v[48:51], v[112:115], a[0:3]
v_add_u32 v156, s39, v156
v_add_u32 v157, s39, v157
v_mfma_f32_16x16x32_bf16 a[4:7], v[48:51], v[116:119], a[4:7]
v_xor_b32 v158, 0x8000, v158
v_xor_b32 v159, 0x8000, v159
v_mfma_f32_16x16x32_bf16 a[8:11], v[48:51], v[120:123], a[8:11]
s_mov_b32 m0, s55
v_xor_b32 v160, 0x8000, v160
v_xor_b32 v161, 0x8000, v161
v_mfma_f32_16x16x32_bf16 a[12:15], v[48:51], v[124:127], a[12:15]
v_xor_b32 v162, 0x8000, v162
v_xor_b32 v163, 0x8000, v163
v_mfma_f32_16x16x32_bf16 a[16:19], v[48:51], v[128:131], a[16:19]
v_xor_b32 v164, 0x8000, v164
v_xor_b32 v165, 0x8000, v165
v_mfma_f32_16x16x32_bf16 a[20:23], v[48:51], v[132:135], a[20:23]
buffer_load_dwordx4 v152, s[8:11], s56 offen offset:0 lds
v_mfma_f32_16x16x32_bf16 a[24:27], v[48:51], v[136:139], a[24:27]
ds_read_b128 v[16:19], v156 offset:0
v_mfma_f32_16x16x32_bf16 a[28:31], v[48:51], v[140:143], a[28:31]
v_mfma_f32_16x16x32_bf16 a[32:35], v[52:55], v[112:115], a[32:35]
ds_read_b64_tr_b16 v[80:81], v158 offset:0
ds_read_b64_tr_b16 v[82:83], v158 offset:2048
v_mfma_f32_16x16x32_bf16 a[36:39], v[52:55], v[116:119], a[36:39]
v_mfma_f32_16x16x32_bf16 a[40:43], v[52:55], v[120:123], a[40:43]
ds_read_b64_tr_b16 v[84:85], v159 offset:0
ds_read_b64_tr_b16 v[86:87], v159 offset:2048
v_mfma_f32_16x16x32_bf16 a[44:47], v[52:55], v[124:127], a[44:47]
buffer_load_dwordx4 v153, s[8:11], s56 offen offset:1024 lds
v_mfma_f32_16x16x32_bf16 a[48:51], v[52:55], v[128:131], a[48:51]
ds_read_b64_tr_b16 v[88:89], v160 offset:0
ds_read_b64_tr_b16 v[90:91], v160 offset:2048
v_mfma_f32_16x16x32_bf16 a[52:55], v[52:55], v[132:135], a[52:55]
v_mfma_f32_16x16x32_bf16 a[56:59], v[52:55], v[136:139], a[56:59]
ds_read_b64_tr_b16 v[92:93], v161 offset:0
ds_read_b64_tr_b16 v[94:95], v161 offset:2048
v_mfma_f32_16x16x32_bf16 a[60:63], v[52:55], v[140:143], a[60:63]
v_mfma_f32_16x16x32_bf16 a[64:67], v[56:59], v[112:115], a[64:67]
ds_read_b64_tr_b16 v[96:97], v162 offset:0
ds_read_b64_tr_b16 v[98:99], v162 offset:2048
v_mfma_f32_16x16x32_bf16 a[68:71], v[56:59], v[116:119], a[68:71]
buffer_load_dwordx4 v154, s[8:11], s56 offen offset:2048 lds
v_mfma_f32_16x16x32_bf16 a[72:75], v[56:59], v[120:123], a[72:75]
ds_read_b64_tr_b16 v[100:101], v163 offset:0
ds_read_b64_tr_b16 v[102:103], v163 offset:2048
v_mfma_f32_16x16x32_bf16 a[76:79], v[56:59], v[124:127], a[76:79]
v_mfma_f32_16x16x32_bf16 a[80:83], v[56:59], v[128:131], a[80:83]
ds_read_b64_tr_b16 v[104:105], v164 offset:0
ds_read_b64_tr_b16 v[106:107], v164 offset:2048
v_mfma_f32_16x16x32_bf16 a[84:87], v[56:59], v[132:135], a[84:87]
v_mfma_f32_16x16x32_bf16 a[88:91], v[56:59], v[136:139], a[88:91]
ds_read_b64_tr_b16 v[108:109], v165 offset:0
ds_read_b64_tr_b16 v[110:111], v165 offset:2048
v_mfma_f32_16x16x32_bf16 a[92:95], v[56:59], v[140:143], a[92:95]
buffer_load_dwordx4 v155, s[8:11], s56 offen offset:3072 lds
v_mfma_f32_16x16x32_bf16 a[96:99], v[60:63], v[112:115], a[96:99]
ds_read_b128 v[20:23], v156 offset:2048
v_mfma_f32_16x16x32_bf16 a[100:103], v[60:63], v[116:119], a[100:103]
v_mfma_f32_16x16x32_bf16 a[104:107], v[60:63], v[120:123], a[104:107]
s_add_u32 s56, s56, 524288
ds_read_b128 v[24:27], v156 offset:4096
v_mfma_f32_16x16x32_bf16 a[108:111], v[60:63], v[124:127], a[108:111]
v_mfma_f32_16x16x32_bf16 a[112:115], v[60:63], v[128:131], a[112:115]
s_xor_b32 s55, s55, 0x8000
ds_read_b128 v[28:31], v156 offset:6144
v_mfma_f32_16x16x32_bf16 a[116:119], v[60:63], v[132:135], a[116:119]
v_mfma_f32_16x16x32_bf16 a[120:123], v[60:63], v[136:139], a[120:123]
s_add_u32 m0, s68, 0
ds_read_b128 v[32:35], v156 offset:8192
v_mfma_f32_16x16x32_bf16 a[124:127], v[60:63], v[140:143], a[124:127]
v_mfma_f32_16x16x32_bf16 a[128:131], v[64:67], v[112:115], a[128:131]
ds_read_b128 v[36:39], v156 offset:10240
v_mfma_f32_16x16x32_bf16 a[132:135], v[64:67], v[116:119], a[132:135]
buffer_load_dwordx4 v144, s[4:7], s69 offen offset:0 lds
v_mfma_f32_16x16x32_bf16 a[136:139], v[64:67], v[120:123], a[136:139]
ds_read_b128 v[40:43], v156 offset:12288
v_mfma_f32_16x16x32_bf16 a[140:143], v[64:67], v[124:127], a[140:143]
v_mfma_f32_16x16x32_bf16 a[144:147], v[64:67], v[128:131], a[144:147]
ds_read_b128 v[44:47], v156 offset:14336
v_mfma_f32_16x16x32_bf16 a[148:151], v[64:67], v[132:135], a[148:151]
v_mfma_f32_16x16x32_bf16 a[152:155], v[64:67], v[136:139], a[152:155]
v_mfma_f32_16x16x32_bf16 a[156:159], v[64:67], v[140:143], a[156:159]
buffer_load_dwordx4 v145, s[4:7], s69 offen offset:1024 lds
v_mfma_f32_16x16x32_bf16 a[160:163], v[68:71], v[112:115], a[160:163]
v_mfma_f32_16x16x32_bf16 a[164:167], v[68:71], v[116:119], a[164:167]
v_mfma_f32_16x16x32_bf16 a[168:171], v[68:71], v[120:123], a[168:171]
v_mfma_f32_16x16x32_bf16 a[172:175], v[68:71], v[124:127], a[172:175]
v_mfma_f32_16x16x32_bf16 a[176:179], v[68:71], v[128:131], a[176:179]
v_mfma_f32_16x16x32_bf16 a[180:183], v[68:71], v[132:135], a[180:183]
buffer_load_dwordx4 v146, s[4:7], s69 offen offset:2048 lds
v_mfma_f32_16x16x32_bf16 a[184:187], v[68:71], v[136:139], a[184:187]
v_mfma_f32_16x16x32_bf16 a[188:191], v[68:71], v[140:143], a[188:191]
v_mfma_f32_16x16x32_bf16 a[192:195], v[72:75], v[112:115], a[192:195]
v_mfma_f32_16x16x32_bf16 a[196:199], v[72:75], v[116:119], a[196:199]
v_mfma_f32_16x16x32_bf16 a[200:203], v[72:75], v[120:123], a[200:203]
v_mfma_f32_16x16x32_bf16 a[204:207], v[72:75], v[124:127], a[204:207]
buffer_load_dwordx4 v147, s[4:7], s69 offen offset:3072 lds
v_mfma_f32_16x16x32_bf16 a[208:211], v[72:75], v[128:131], a[208:211]
v_mfma_f32_16x16x32_bf16 a[212:215], v[72:75], v[132:135], a[212:215]
v_mfma_f32_16x16x32_bf16 a[216:219], v[72:75], v[136:139], a[216:219]
s_add_u32 s68, s68, 32768
v_mfma_f32_16x16x32_bf16 a[220:223], v[72:75], v[140:143], a[220:223]
s_cmp_eq_u32 s68, s70
s_cselect_b32 s42, 98304, 0
s_sub_u32 s68, s68, s42
v_mfma_f32_16x16x32_bf16 a[224:227], v[76:79], v[112:115], a[224:227]
s_add_u32 s69, s69, 128
v_mfma_f32_16x16x32_bf16 a[228:231], v[76:79], v[116:119], a[228:231]
v_mfma_f32_16x16x32_bf16 a[232:235], v[76:79], v[120:123], a[232:235]
s_add_u32 s38, s38, 1
v_mfma_f32_16x16x32_bf16 a[236:239], v[76:79], v[124:127], a[236:239]
v_mfma_f32_16x16x32_bf16 a[240:243], v[76:79], v[128:131], a[240:243]
v_mfma_f32_16x16x32_bf16 a[244:247], v[76:79], v[132:135], a[244:247]
v_mfma_f32_16x16x32_bf16 a[248:251], v[76:79], v[136:139], a[248:251]
v_mfma_f32_16x16x32_bf16 a[252:255], v[76:79], v[140:143], a[252:255]
s_cmp_lt_u32 s38, 16
s_cbranch_scc1 K1_LOOP_V
s_branch K1_EPI_V
K1_HOOK_V:
s_cmp_eq_u32 s38, 2
s_cbranch_scc0 K1HV_3
s_mov_b32 s48, s88
s_and_b32 s49, s89, 0xffff
s_mov_b32 s50, 256
s_mov_b32 s51, 0x20000
s_cmp_eq_u32 s30, 0
s_cbranch_scc0 K1HV_2E
v_mov_b32 v11, 0
v_mov_b32 v12, 1
v_cmp_eq_u32 vcc, 0, v2
s_and_saveexec_b64 s[52:53], vcc
s_cbranch_execz K1HV_2X
buffer_atomic_add v12, v11, s[48:51], 0 offen
K1HV_2X:
s_mov_b64 exec, s[52:53]
K1HV_2E:
s_mov_b32 s53, 0
s_lshr_b32 s40, s2, 3
s_and_b32 s40, s40, 3
s_add_u32 s40, s40, 3
s_branch K1_BACK_V
K1HV_3:
s_cmp_eq_u32 s38, 14
s_cbranch_scc1 K1HV_14
s_cmp_eq_u32 s53, 2
s_cbranch_scc1 K1HV_12
s_lshl_b32 s41, s2, 2
s_add_u32 s41, s41, s30
s_lshl_b32 s42, s53, 10
s_add_u32 s41, s41, s42
s_mov_b32 s48, s76
s_mov_b32 s49, s77
s_mov_b32 s50, 3670016
s_mov_b32 s42, 0
s_cmp_ge_u32 s41, 448
s_cselect_b32 s48, s80, s48
s_cselect_b32 s49, s81, s49
s_cselect_b32 s50, 1605632, s50
s_cselect_b32 s42, 448, s42
s_cmp_ge_u32 s41, 644
s_cselect_b32 s48, s82, s48
s_cselect_b32 s49, s83, s49
s_cselect_b32 s50, 1605632, s50
s_cselect_b32 s42, 644, s42
s_cmp_ge_u32 s41, 840
s_cselect_b32 s48, s78, s48
s_cselect_b32 s49, s79, s49
s_cselect_b32 s50, 3670016, s50
s_cselect_b32 s42, 840, s42
s_cmp_ge_u32 s41, 1288
s_cselect_b32 s48, s84, s48
s_cselect_b32 s49, s85, s49
s_cselect_b32 s50, 1605632, s50
s_cselect_b32 s42, 1288, s42
s_sub_u32 s41, s41, s42
s_and_b32 s49, s49, 0xffff
s_mov_b32 s51, 0x20000
s_lshl_b32 s41, s41, 13
v_lshlrev_b32 v11, 7, v2
buffer_load_dword v222, v11, s[48:51], s41 offen
s_add_u32 s53, s53, 1
s_cmp_eq_u32 s53, 2
s_cselect_b32 s42, 3, 4
s_add_u32 s40, s38, s42
s_branch K1_BACK_V
K1HV_12:
s_mov_b32 s48, s88
s_and_b32 s49, s89, 0xffff
s_mov_b32 s50, 256
s_mov_b32 s51, 0x20000
s_cmp_eq_u32 s30, 0
s_cbranch_scc0 K1HV_12E
v_mov_b32 v11, 0
buffer_load_dwordx2 v[220:221], v11, s[48:51], 0 offen sc1
K1HV_12E:
s_mov_b32 s40, 14
s_branch K1_BACK_V
K1HV_14:
v_mov_b32 v152, v216
v_mov_b32 v153, v217
v_mov_b32 v154, v218
v_mov_b32 v155, v219
s_mov_b32 s8, s76
s_and_b32 s9, s77, 0xffff
s_mov_b32 s10, 3670016
s_mov_b32 s11, 0x20000
s_lshl_b32 s35, s30, 17
s_lshl_b32 s41, s31, 9
s_add_u32 s35, s35, s41
s_add_u32 s56, s35, 256
s_mov_b32 s40, 99
s_branch K1_BACK_V
K1_EPI_K:
s_waitcnt lgkmcnt(0)
s_waitcnt vmcnt(16)
s_cmp_eq_u32 s30, 0
s_cbranch_scc0 PEK_OK
s_mov_b32 s48, s88
s_and_b32 s49, s89, 0xffff
s_mov_b32 s50, 256
s_mov_b32 s51, 0x20000
v_mov_b32 v11, 0
s_mov_b32 s52, 0x10000
PEK_P:
v_readfirstlane_b32 s53, v220
s_cmp_ge_u32 s53, 256
s_cbranch_scc1 PEK_OK
s_sub_u32 s52, s52, 1
s_cmp_eq_u32 s52, 0
s_cbranch_scc1 PEK_OK
s_sleep 2
buffer_load_dwordx2 v[220:221], v11, s[48:51], 0 offen sc1
s_waitcnt vmcnt(0)
s_branch PEK_P
PEK_OK:
v_mov_b32 v1, v221
s_barrier
s_lshr_b32 s52, s2, 3
s_bfe_u32 s53, s52, 0x30001
s_sub_u32 s52, 15, s53
s_cmp_lt_u32 s2, 128
s_cselect_b32 s52, s52, s53
s_lshl_b32 s52, s52, 3
s_lshl_b32 s53, s30, 1
s_add_u32 s52, s52, s53
s_mul_i32 s48, s52, 14336
s_mov_b32 s4, s28
s_and_b32 s5, s29, 0xffff
s_mov_b32 s6, 1835008
s_mov_b32 s7, 0x20000
v_lshlrev_b32 v3, 4, v2
v_mov_b32 v16, v216
v_mov_b32 v17, v217
v_mov_b32 v18, v218
v_mov_b32 v19, v219
s_lshl_b32 s40, s30, 12
s_lshl_b32 s46, s30, 17
s_lshl_b32 s52, s31, 9
s_add_u32 s46, s46, s52
s_lshl_b32 s60, s31, 6
s_lshl_b32 s41, s32, 3
s_add_u32 s60, s60, s41
s_lshl_b32 s41, s44, 2
s_add_u32 s60, s60, s41
s_lshl_b32 s60, s60, 14
s_lshl_b32 s41, s45, 12
s_add_u32 s60, s60, s41
s_mov_b32 s66, 0x3db8aa3b
s_add_u32 s47, s48, 0
s_nop 0
buffer_load_dwordx4 v[72:75], v3, s[4:7], s47 offen offset:0 sc1
v_accvgpr_read_b32 v184, a0
v_accvgpr_read_b32 v185, a1
v_accvgpr_read_b32 v186, a2
v_accvgpr_read_b32 v187, a3
v_accvgpr_read_b32 v188, a4
v_accvgpr_read_b32 v189, a5
v_accvgpr_read_b32 v190, a6
v_accvgpr_read_b32 v191, a7
v_mul_f32 v184, s66, v184
v_mul_f32 v185, s66, v185
v_mul_f32 v186, s66, v186
v_mul_f32 v187, s66, v187
v_mul_f32 v188, s66, v188
v_mul_f32 v189, s66, v189
buffer_load_dwordx4 v[80:83], v3, s[4:7], s47 offen offset:1024 sc1
v_mul_f32 v190, s66, v190
v_mul_f32 v191, s66, v191
v_cvt_pk_bf16_f32 v192, v184, v185
v_cvt_pk_bf16_f32 v193, v186, v187
v_cvt_pk_bf16_f32 v194, v188, v189
v_cvt_pk_bf16_f32 v195, v190, v191
v_accvgpr_read_b32 v184, a8
v_accvgpr_read_b32 v185, a9
v_accvgpr_read_b32 v186, a10
v_accvgpr_read_b32 v187, a11
v_accvgpr_read_b32 v188, a12
v_accvgpr_read_b32 v189, a13
v_accvgpr_read_b32 v190, a14
v_accvgpr_read_b32 v191, a15
s_add_u32 s47, s48, 14336
s_nop 0
buffer_load_dwordx4 v[76:79], v3, s[4:7], s47 offen offset:0 sc1
v_mul_f32 v184, s66, v184
v_mul_f32 v185, s66, v185
v_mul_f32 v186, s66, v186
v_mul_f32 v187, s66, v187
v_mul_f32 v188, s66, v188
v_mul_f32 v189, s66, v189
v_mul_f32 v190, s66, v190
v_mul_f32 v191, s66, v191
v_cvt_pk_bf16_f32 v196, v184, v185
v_cvt_pk_bf16_f32 v197, v186, v187
v_cvt_pk_bf16_f32 v198, v188, v189
v_cvt_pk_bf16_f32 v199, v190, v191
v_accvgpr_read_b32 v184, a16
v_accvgpr_read_b32 v185, a17
buffer_load_dwordx4 v[84:87], v3, s[4:7], s47 offen offset:1024 sc1
v_accvgpr_read_b32 v186, a18
v_accvgpr_read_b32 v187, a19
v_accvgpr_read_b32 v188, a20
v_accvgpr_read_b32 v189, a21
v_accvgpr_read_b32 v190, a22
v_accvgpr_read_b32 v191, a23
v_mul_f32 v184, s66, v184
v_mul_f32 v185, s66, v185
v_mul_f32 v186, s66, v186
v_mul_f32 v187, s66, v187
v_mul_f32 v188, s66, v188
v_mul_f32 v189, s66, v189
v_mul_f32 v190, s66, v190
v_mul_f32 v191, s66, v191
s_add_u32 s47, s48, 2048
s_nop 0
buffer_load_dwordx4 v[88:91], v3, s[4:7], s47 offen offset:0 sc1
v_cvt_pk_bf16_f32 v200, v184, v185
v_cvt_pk_bf16_f32 v201, v186, v187
v_cvt_pk_bf16_f32 v202, v188, v189
v_cvt_pk_bf16_f32 v203, v190, v191
v_accvgpr_read_b32 v184, a24
v_accvgpr_read_b32 v185, a25
v_accvgpr_read_b32 v186, a26
v_accvgpr_read_b32 v187, a27
v_accvgpr_read_b32 v188, a28
v_accvgpr_read_b32 v189, a29
v_accvgpr_read_b32 v190, a30
v_accvgpr_read_b32 v191, a31
v_mul_f32 v184, s66, v184
v_mul_f32 v185, s66, v185
buffer_load_dwordx4 v[96:99], v3, s[4:7], s47 offen offset:1024 sc1
v_mul_f32 v186, s66, v186
v_mul_f32 v187, s66, v187
v_mul_f32 v188, s66, v188
v_mul_f32 v189, s66, v189
v_mul_f32 v190, s66, v190
v_mul_f32 v191, s66, v191
v_cvt_pk_bf16_f32 v204, v184, v185
v_cvt_pk_bf16_f32 v205, v186, v187
v_cvt_pk_bf16_f32 v206, v188, v189
v_cvt_pk_bf16_f32 v207, v190, v191
v_accvgpr_read_b32 v184, a32
v_accvgpr_read_b32 v185, a33
v_accvgpr_read_b32 v186, a34
v_accvgpr_read_b32 v187, a35
s_add_u32 s47, s48, 16384
s_nop 0
buffer_load_dwordx4 v[92:95], v3, s[4:7], s47 offen offset:0 sc1
v_accvgpr_read_b32 v188, a36
v_accvgpr_read_b32 v189, a37
v_accvgpr_read_b32 v190, a38
v_accvgpr_read_b32 v191, a39
v_mul_f32 v184, s66, v184
v_mul_f32 v185, s66, v185
v_mul_f32 v186, s66, v186
v_mul_f32 v187, s66, v187
v_mul_f32 v188, s66, v188
v_mul_f32 v189, s66, v189
v_mul_f32 v190, s66, v190
v_mul_f32 v191, s66, v191
v_cvt_pk_bf16_f32 v208, v184, v185
v_cvt_pk_bf16_f32 v209, v186, v187
buffer_load_dwordx4 v[100:103], v3, s[4:7], s47 offen offset:1024 sc1
v_cvt_pk_bf16_f32 v210, v188, v189
v_cvt_pk_bf16_f32 v211, v190, v191
v_accvgpr_read_b32 v184, a40
v_accvgpr_read_b32 v185, a41
v_accvgpr_read_b32 v186, a42
v_accvgpr_read_b32 v187, a43
v_accvgpr_read_b32 v188, a44
v_accvgpr_read_b32 v189, a45
v_accvgpr_read_b32 v190, a46
v_accvgpr_read_b32 v191, a47
v_mul_f32 v184, s66, v184
v_mul_f32 v185, s66, v185
v_mul_f32 v186, s66, v186
v_mul_f32 v187, s66, v187
s_add_u32 s47, s46, 1048576
s_add_u32 m0, s40, 65536
s_nop 0
buffer_load_dwordx4 v16, s[8:11], s47 offen offset:0 lds
v_mul_f32 v188, s66, v188
v_mul_f32 v189, s66, v189
v_mul_f32 v190, s66, v190
v_mul_f32 v191, s66, v191
v_cvt_pk_bf16_f32 v212, v184, v185
v_cvt_pk_bf16_f32 v213, v186, v187
v_cvt_pk_bf16_f32 v214, v188, v189
v_cvt_pk_bf16_f32 v215, v190, v191
v_accvgpr_read_b32 v184, a48
v_accvgpr_read_b32 v185, a49
v_accvgpr_read_b32 v186, a50
v_accvgpr_read_b32 v187, a51
v_accvgpr_read_b32 v188, a52
v_accvgpr_read_b32 v189, a53
buffer_load_dwordx4 v17, s[8:11], s47 offen offset:1024 lds
v_accvgpr_read_b32 v190, a54
v_accvgpr_read_b32 v191, a55
v_mul_f32 v184, s66, v184
v_mul_f32 v185, s66, v185
v_mul_f32 v186, s66, v186
v_mul_f32 v187, s66, v187
v_mul_f32 v188, s66, v188
v_mul_f32 v189, s66, v189
v_mul_f32 v190, s66, v190
v_mul_f32 v191, s66, v191
v_cvt_pk_bf16_f32 v216, v184, v185
v_cvt_pk_bf16_f32 v217, v186, v187
v_cvt_pk_bf16_f32 v218, v188, v189
v_cvt_pk_bf16_f32 v219, v190, v191
buffer_load_dwordx4 v18, s[8:11], s47 offen offset:2048 lds
v_accvgpr_read_b32 v184, a56
v_accvgpr_read_b32 v185, a57
v_accvgpr_read_b32 v186, a58
v_accvgpr_read_b32 v187, a59
v_accvgpr_read_b32 v188, a60
v_accvgpr_read_b32 v189, a61
v_accvgpr_read_b32 v190, a62
v_accvgpr_read_b32 v191, a63
v_mul_f32 v184, s66, v184
v_mul_f32 v185, s66, v185
v_mul_f32 v186, s66, v186
v_mul_f32 v187, s66, v187
v_mul_f32 v188, s66, v188
v_mul_f32 v189, s66, v189
buffer_load_dwordx4 v19, s[8:11], s47 offen offset:3072 lds
v_mul_f32 v190, s66, v190
v_mul_f32 v191, s66, v191
v_cvt_pk_bf16_f32 v220, v184, v185
v_cvt_pk_bf16_f32 v221, v186, v187
v_cvt_pk_bf16_f32 v222, v188, v189
v_cvt_pk_bf16_f32 v223, v190, v191
v_accvgpr_read_b32 v184, a64
v_accvgpr_read_b32 v185, a65
v_accvgpr_read_b32 v186, a66
v_accvgpr_read_b32 v187, a67
v_accvgpr_read_b32 v188, a68
v_accvgpr_read_b32 v189, a69
v_accvgpr_read_b32 v190, a70
v_accvgpr_read_b32 v191, a71
s_add_u32 s47, s46, 1048832
s_add_u32 m0, s40, 81920
s_nop 0
buffer_load_dwordx4 v16, s[8:11], s47 offen offset:0 lds
v_mul_f32 v184, s66, v184
v_mul_f32 v185, s66, v185
v_mul_f32 v186, s66, v186
v_mul_f32 v187, s66, v187
v_mul_f32 v188, s66, v188
v_mul_f32 v189, s66, v189
v_mul_f32 v190, s66, v190
v_mul_f32 v191, s66, v191
v_cvt_pk_bf16_f32 v224, v184, v185
v_cvt_pk_bf16_f32 v225, v186, v187
v_cvt_pk_bf16_f32 v226, v188, v189
v_cvt_pk_bf16_f32 v227, v190, v191
v_accvgpr_read_b32 v184, a72
v_accvgpr_read_b32 v185, a73
buffer_load_dwordx4 v17, s[8:11], s47 offen offset:1024 lds
v_accvgpr_read_b32 v186, a74
v_accvgpr_read_b32 v187, a75
v_accvgpr_read_b32 v188, a76
v_accvgpr_read_b32 v189, a77
v_accvgpr_read_b32 v190, a78
v_accvgpr_read_b32 v191, a79
v_mul_f32 v184, s66, v184
v_mul_f32 v185, s66, v185
v_mul_f32 v186, s66, v186
v_mul_f32 v187, s66, v187
v_mul_f32 v188, s66, v188
v_mul_f32 v189, s66, v189
v_mul_f32 v190, s66, v190
v_mul_f32 v191, s66, v191
buffer_load_dwordx4 v18, s[8:11], s47 offen offset:2048 lds
v_cvt_pk_bf16_f32 v228, v184, v185
v_cvt_pk_bf16_f32 v229, v186, v187
v_cvt_pk_bf16_f32 v230, v188, v189
v_cvt_pk_bf16_f32 v231, v190, v191
v_accvgpr_read_b32 v184, a80
v_accvgpr_read_b32 v185, a81
v_accvgpr_read_b32 v186, a82
v_accvgpr_read_b32 v187, a83
v_accvgpr_read_b32 v188, a84
v_accvgpr_read_b32 v189, a85
v_accvgpr_read_b32 v190, a86
v_accvgpr_read_b32 v191, a87
v_mul_f32 v184, s66, v184
v_mul_f32 v185, s66, v185
buffer_load_dwordx4 v19, s[8:11], s47 offen offset:3072 lds
v_mul_f32 v186, s66, v186
v_mul_f32 v187, s66, v187
v_mul_f32 v188, s66, v188
v_mul_f32 v189, s66, v189
v_mul_f32 v190, s66, v190
v_mul_f32 v191, s66, v191
v_cvt_pk_bf16_f32 v232, v184, v185
v_cvt_pk_bf16_f32 v233, v186, v187
v_cvt_pk_bf16_f32 v234, v188, v189
v_cvt_pk_bf16_f32 v235, v190, v191
v_accvgpr_read_b32 v184, a88
v_accvgpr_read_b32 v185, a89
v_accvgpr_read_b32 v186, a90
v_accvgpr_read_b32 v187, a91
s_add_u32 s47, s48, 4096
s_nop 0
buffer_load_dwordx4 v[104:107], v3, s[4:7], s47 offen offset:0 sc1
v_accvgpr_read_b32 v188, a92
v_accvgpr_read_b32 v189, a93
v_accvgpr_read_b32 v190, a94
v_accvgpr_read_b32 v191, a95
v_mul_f32 v184, s66, v184
v_mul_f32 v185, s66, v185
v_mul_f32 v186, s66, v186
v_mul_f32 v187, s66, v187
v_mul_f32 v188, s66, v188
v_mul_f32 v189, s66, v189
v_mul_f32 v190, s66, v190
v_mul_f32 v191, s66, v191
v_cvt_pk_bf16_f32 v236, v184, v185
v_cvt_pk_bf16_f32 v237, v186, v187
buffer_load_dwordx4 v[112:115], v3, s[4:7], s47 offen offset:1024 sc1
v_cvt_pk_bf16_f32 v238, v188, v189
v_cvt_pk_bf16_f32 v239, v190, v191
v_accvgpr_read_b32 v184, a96
v_accvgpr_read_b32 v185, a97
v_accvgpr_read_b32 v186, a98
v_accvgpr_read_b32 v187, a99
v_accvgpr_read_b32 v188, a100
v_accvgpr_read_b32 v189, a101
v_accvgpr_read_b32 v190, a102
v_accvgpr_read_b32 v191, a103
v_mul_f32 v184, s66, v184
v_mul_f32 v185, s66, v185
v_mul_f32 v186, s66, v186
v_mul_f32 v187, s66, v187
s_add_u32 s47, s48, 18432
s_nop 0
buffer_load_dwordx4 v[108:111], v3, s[4:7], s47 offen offset:0 sc1
v_mul_f32 v188, s66, v188
v_mul_f32 v189, s66, v189
v_mul_f32 v190, s66, v190
v_mul_f32 v191, s66, v191
v_cvt_pk_bf16_f32 v240, v184, v185
v_cvt_pk_bf16_f32 v241, v186, v187
v_cvt_pk_bf16_f32 v242, v188, v189
v_cvt_pk_bf16_f32 v243, v190, v191
v_accvgpr_read_b32 v184, a104
v_accvgpr_read_b32 v185, a105
v_accvgpr_read_b32 v186, a106
v_accvgpr_read_b32 v187, a107
v_accvgpr_read_b32 v188, a108
v_accvgpr_read_b32 v189, a109
buffer_load_dwordx4 v[116:119], v3, s[4:7], s47 offen offset:1024 sc1
v_accvgpr_read_b32 v190, a110
v_accvgpr_read_b32 v191, a111
v_mul_f32 v184, s66, v184
v_mul_f32 v185, s66, v185
v_mul_f32 v186, s66, v186
v_mul_f32 v187, s66, v187
v_mul_f32 v188, s66, v188
v_mul_f32 v189, s66, v189
v_mul_f32 v190, s66, v190
v_mul_f32 v191, s66, v191
v_cvt_pk_bf16_f32 v244, v184, v185
v_cvt_pk_bf16_f32 v245, v186, v187
v_cvt_pk_bf16_f32 v246, v188, v189
v_cvt_pk_bf16_f32 v247, v190, v191
s_add_u32 s47, s46, 1572864
s_add_u32 m0, s40, 98304
s_nop 0
buffer_load_dwordx4 v16, s[8:11], s47 offen offset:0 lds
v_accvgpr_read_b32 v184, a112
v_accvgpr_read_b32 v185, a113
v_accvgpr_read_b32 v186, a114
v_accvgpr_read_b32 v187, a115
v_accvgpr_read_b32 v188, a116
v_accvgpr_read_b32 v189, a117
v_accvgpr_read_b32 v190, a118
v_accvgpr_read_b32 v191, a119
v_mul_f32 v184, s66, v184
v_mul_f32 v185, s66, v185
v_mul_f32 v186, s66, v186
v_mul_f32 v187, s66, v187
v_mul_f32 v188, s66, v188
v_mul_f32 v189, s66, v189
buffer_load_dwordx4 v17, s[8:11], s47 offen offset:1024 lds
v_mul_f32 v190, s66, v190
v_mul_f32 v191, s66, v191
v_cvt_pk_bf16_f32 v248, v184, v185
v_cvt_pk_bf16_f32 v249, v186, v187
v_cvt_pk_bf16_f32 v250, v188, v189
v_cvt_pk_bf16_f32 v251, v190, v191
v_accvgpr_read_b32 v184, a120
v_accvgpr_read_b32 v185, a121
v_accvgpr_read_b32 v186, a122
v_accvgpr_read_b32 v187, a123
v_accvgpr_read_b32 v188, a124
v_accvgpr_read_b32 v189, a125
v_accvgpr_read_b32 v190, a126
v_accvgpr_read_b32 v191, a127
buffer_load_dwordx4 v18, s[8:11], s47 offen offset:2048 lds
v_mul_f32 v184, s66, v184
v_mul_f32 v185, s66, v185
v_mul_f32 v186, s66, v186
v_mul_f32 v187, s66, v187
v_mul_f32 v188, s66, v188
v_mul_f32 v189, s66, v189
v_mul_f32 v190, s66, v190
v_mul_f32 v191, s66, v191
v_cvt_pk_bf16_f32 v252, v184, v185
v_cvt_pk_bf16_f32 v253, v186, v187
v_cvt_pk_bf16_f32 v254, v188, v189
v_cvt_pk_bf16_f32 v255, v190, v191
v_accvgpr_read_b32 v184, a128
v_accvgpr_read_b32 v185, a129
buffer_load_dwordx4 v19, s[8:11], s47 offen offset:3072 lds
v_accvgpr_read_b32 v186, a130
v_accvgpr_read_b32 v187, a131
v_accvgpr_read_b32 v188, a132
v_accvgpr_read_b32 v189, a133
v_accvgpr_read_b32 v190, a134
v_accvgpr_read_b32 v191, a135
v_mul_f32 v184, s66, v184
v_mul_f32 v185, s66, v185
v_mul_f32 v186, s66, v186
v_mul_f32 v187, s66, v187
v_mul_f32 v188, s66, v188
v_mul_f32 v189, s66, v189
v_mul_f32 v190, s66, v190
v_mul_f32 v191, s66, v191
s_add_u32 s47, s46, 1573120
s_add_u32 m0, s40, 114688
s_nop 0
buffer_load_dwordx4 v16, s[8:11], s47 offen offset:0 lds
v_cvt_pk_bf16_f32 v184, v184, v185
v_cvt_pk_bf16_f32 v185, v186, v187
v_cvt_pk_bf16_f32 v186, v188, v189
v_cvt_pk_bf16_f32 v187, v190, v191
v_accvgpr_write_b32 a128, v184
v_accvgpr_write_b32 a129, v185
v_accvgpr_write_b32 a130, v186
v_accvgpr_write_b32 a131, v187
v_accvgpr_read_b32 v184, a136
v_accvgpr_read_b32 v185, a137
v_accvgpr_read_b32 v186, a138
v_accvgpr_read_b32 v187, a139
v_accvgpr_read_b32 v188, a140
v_accvgpr_read_b32 v189, a141
buffer_load_dwordx4 v17, s[8:11], s47 offen offset:1024 lds
v_accvgpr_read_b32 v190, a142
v_accvgpr_read_b32 v191, a143
v_mul_f32 v184, s66, v184
v_mul_f32 v185, s66, v185
v_mul_f32 v186, s66, v186
v_mul_f32 v187, s66, v187
v_mul_f32 v188, s66, v188
v_mul_f32 v189, s66, v189
v_mul_f32 v190, s66, v190
v_mul_f32 v191, s66, v191
v_cvt_pk_bf16_f32 v184, v184, v185
v_cvt_pk_bf16_f32 v185, v186, v187
v_cvt_pk_bf16_f32 v186, v188, v189
v_cvt_pk_bf16_f32 v187, v190, v191
buffer_load_dwordx4 v18, s[8:11], s47 offen offset:2048 lds
v_accvgpr_write_b32 a132, v184
v_accvgpr_write_b32 a133, v185
v_accvgpr_write_b32 a134, v186
v_accvgpr_write_b32 a135, v187
v_accvgpr_read_b32 v184, a144
v_accvgpr_read_b32 v185, a145
v_accvgpr_read_b32 v186, a146
v_accvgpr_read_b32 v187, a147
v_accvgpr_read_b32 v188, a148
v_accvgpr_read_b32 v189, a149
v_accvgpr_read_b32 v190, a150
v_accvgpr_read_b32 v191, a151
v_mul_f32 v184, s66, v184
v_mul_f32 v185, s66, v185
buffer_load_dwordx4 v19, s[8:11], s47 offen offset:3072 lds
v_mul_f32 v186, s66, v186
v_mul_f32 v187, s66, v187
v_mul_f32 v188, s66, v188
v_mul_f32 v189, s66, v189
v_mul_f32 v190, s66, v190
v_mul_f32 v191, s66, v191
v_cvt_pk_bf16_f32 v184, v184, v185
v_cvt_pk_bf16_f32 v185, v186, v187
v_cvt_pk_bf16_f32 v186, v188, v189
v_cvt_pk_bf16_f32 v187, v190, v191
v_accvgpr_write_b32 a136, v184
v_accvgpr_write_b32 a137, v185
v_accvgpr_write_b32 a138, v186
v_accvgpr_write_b32 a139, v187
s_add_u32 s47, s48, 6144
s_nop 0
buffer_load_dwordx4 v[120:123], v3, s[4:7], s47 offen offset:0 sc1
v_accvgpr_read_b32 v184, a152
v_accvgpr_read_b32 v185, a153
v_accvgpr_read_b32 v186, a154
v_accvgpr_read_b32 v187, a155
v_accvgpr_read_b32 v188, a156
v_accvgpr_read_b32 v189, a157
v_accvgpr_read_b32 v190, a158
v_accvgpr_read_b32 v191, a159
v_mul_f32 v184, s66, v184
v_mul_f32 v185, s66, v185
v_mul_f32 v186, s66, v186
v_mul_f32 v187, s66, v187
v_mul_f32 v188, s66, v188
v_mul_f32 v189, s66, v189
buffer_load_dwordx4 v[128:131], v3, s[4:7], s47 offen offset:1024 sc1
v_mul_f32 v190, s66, v190
v_mul_f32 v191, s66, v191
v_cvt_pk_bf16_f32 v184, v184, v185
v_cvt_pk_bf16_f32 v185, v186, v187
v_cvt_pk_bf16_f32 v186, v188, v189
v_cvt_pk_bf16_f32 v187, v190, v191
v_accvgpr_write_b32 a140, v184
v_accvgpr_write_b32 a141, v185
v_accvgpr_write_b32 a142, v186
v_accvgpr_write_b32 a143, v187
v_accvgpr_read_b32 v184, a160
v_accvgpr_read_b32 v185, a161
v_accvgpr_read_b32 v186, a162
v_accvgpr_read_b32 v187, a163
s_add_u32 s47, s48, 20480
s_nop 0
buffer_load_dwordx4 v[124:127], v3, s[4:7], s47 offen offset:0 sc1
v_accvgpr_read_b32 v188, a164
v_accvgpr_read_b32 v189, a165
v_accvgpr_read_b32 v190, a166
v_accvgpr_read_b32 v191, a167
v_mul_f32 v184, s66, v184
v_mul_f32 v185, s66, v185
v_mul_f32 v186, s66, v186
v_mul_f32 v187, s66, v187
v_mul_f32 v188, s66, v188
v_mul_f32 v189, s66, v189
v_mul_f32 v190, s66, v190
v_mul_f32 v191, s66, v191
v_cvt_pk_bf16_f32 v184, v184, v185
v_cvt_pk_bf16_f32 v185, v186, v187
buffer_load_dwordx4 v[132:135], v3, s[4:7], s47 offen offset:1024 sc1
v_cvt_pk_bf16_f32 v186, v188, v189
v_cvt_pk_bf16_f32 v187, v190, v191
v_accvgpr_write_b32 a144, v184
v_accvgpr_write_b32 a145, v185
v_accvgpr_write_b32 a146, v186
v_accvgpr_write_b32 a147, v187
v_accvgpr_read_b32 v184, a168
v_accvgpr_read_b32 v185, a169
v_accvgpr_read_b32 v186, a170
v_accvgpr_read_b32 v187, a171
v_accvgpr_read_b32 v188, a172
v_accvgpr_read_b32 v189, a173
v_accvgpr_read_b32 v190, a174
v_accvgpr_read_b32 v191, a175
s_add_u32 s47, s46, 2097152
s_add_u32 m0, s40, 131072
s_nop 0
buffer_load_dwordx4 v16, s[8:11], s47 offen offset:0 lds
v_mul_f32 v184, s66, v184
v_mul_f32 v185, s66, v185
v_mul_f32 v186, s66, v186
v_mul_f32 v187, s66, v187
v_mul_f32 v188, s66, v188
v_mul_f32 v189, s66, v189
v_mul_f32 v190, s66, v190
v_mul_f32 v191, s66, v191
v_cvt_pk_bf16_f32 v184, v184, v185
v_cvt_pk_bf16_f32 v185, v186, v187
v_cvt_pk_bf16_f32 v186, v188, v189
v_cvt_pk_bf16_f32 v187, v190, v191
v_accvgpr_write_b32 a148, v184
v_accvgpr_write_b32 a149, v185
buffer_load_dwordx4 v17, s[8:11], s47 offen offset:1024 lds
v_accvgpr_write_b32 a150, v186
v_accvgpr_write_b32 a151, v187
v_accvgpr_read_b32 v184, a176
v_accvgpr_read_b32 v185, a177
v_accvgpr_read_b32 v186, a178
v_accvgpr_read_b32 v187, a179
v_accvgpr_read_b32 v188, a180
v_accvgpr_read_b32 v189, a181
v_accvgpr_read_b32 v190, a182
v_accvgpr_read_b32 v191, a183
v_mul_f32 v184, s66, v184
v_mul_f32 v185, s66, v185
v_mul_f32 v186, s66, v186
v_mul_f32 v187, s66, v187
buffer_load_dwordx4 v18, s[8:11], s47 offen offset:2048 lds
v_mul_f32 v188, s66, v188
v_mul_f32 v189, s66, v189
v_mul_f32 v190, s66, v190
v_mul_f32 v191, s66, v191
v_cvt_pk_bf16_f32 v184, v184, v185
v_cvt_pk_bf16_f32 v185, v186, v187
v_cvt_pk_bf16_f32 v186, v188, v189
v_cvt_pk_bf16_f32 v187, v190, v191
v_accvgpr_write_b32 a152, v184
v_accvgpr_write_b32 a153, v185
v_accvgpr_write_b32 a154, v186
v_accvgpr_write_b32 a155, v187
v_accvgpr_read_b32 v184, a184
v_accvgpr_read_b32 v185, a185
buffer_load_dwordx4 v19, s[8:11], s47 offen offset:3072 lds
v_accvgpr_read_b32 v186, a186
v_accvgpr_read_b32 v187, a187
v_accvgpr_read_b32 v188, a188
v_accvgpr_read_b32 v189, a189
v_accvgpr_read_b32 v190, a190
v_accvgpr_read_b32 v191, a191
v_mul_f32 v184, s66, v184
v_mul_f32 v185, s66, v185
v_mul_f32 v186, s66, v186
v_mul_f32 v187, s66, v187
v_mul_f32 v188, s66, v188
v_mul_f32 v189, s66, v189
v_mul_f32 v190, s66, v190
v_mul_f32 v191, s66, v191
s_add_u32 s47, s46, 2097408
s_add_u32 m0, s40, 147456
s_nop 0
buffer_load_dwordx4 v16, s[8:11], s47 offen offset:0 lds
v_cvt_pk_bf16_f32 v184, v184, v185
v_cvt_pk_bf16_f32 v185, v186, v187
v_cvt_pk_bf16_f32 v186, v188, v189
v_cvt_pk_bf16_f32 v187, v190, v191
v_accvgpr_write_b32 a156, v184
v_accvgpr_write_b32 a157, v185
v_accvgpr_write_b32 a158, v186
v_accvgpr_write_b32 a159, v187
v_accvgpr_read_b32 v184, a192
v_accvgpr_read_b32 v185, a193
v_accvgpr_read_b32 v186, a194
v_accvgpr_read_b32 v187, a195
v_accvgpr_read_b32 v188, a196
v_accvgpr_read_b32 v189, a197
buffer_load_dwordx4 v17, s[8:11], s47 offen offset:1024 lds
v_accvgpr_read_b32 v190, a198
v_accvgpr_read_b32 v191, a199
v_mul_f32 v184, s66, v184
v_mul_f32 v185, s66, v185
v_mul_f32 v186, s66, v186
v_mul_f32 v187, s66, v187
v_mul_f32 v188, s66, v188
v_mul_f32 v189, s66, v189
v_mul_f32 v190, s66, v190
v_mul_f32 v191, s66, v191
v_cvt_pk_bf16_f32 v184, v184, v185
v_cvt_pk_bf16_f32 v185, v186, v187
v_cvt_pk_bf16_f32 v186, v188, v189
v_cvt_pk_bf16_f32 v187, v190, v191
buffer_load_dwordx4 v18, s[8:11], s47 offen offset:2048 lds
v_accvgpr_write_b32 a160, v184
v_accvgpr_write_b32 a161, v185
v_accvgpr_write_b32 a162, v186
v_accvgpr_write_b32 a163, v187
v_accvgpr_read_b32 v184, a200
v_accvgpr_read_b32 v185, a201
v_accvgpr_read_b32 v186, a202
v_accvgpr_read_b32 v187, a203
v_accvgpr_read_b32 v188, a204
v_accvgpr_read_b32 v189, a205
v_accvgpr_read_b32 v190, a206
v_accvgpr_read_b32 v191, a207
v_mul_f32 v184, s66, v184
v_mul_f32 v185, s66, v185
buffer_load_dwordx4 v19, s[8:11], s47 offen offset:3072 lds
v_mul_f32 v186, s66, v186
v_mul_f32 v187, s66, v187
v_mul_f32 v188, s66, v188
v_mul_f32 v189, s66, v189
v_mul_f32 v190, s66, v190
v_mul_f32 v191, s66, v191
v_cvt_pk_bf16_f32 v184, v184, v185
v_cvt_pk_bf16_f32 v185, v186, v187
v_cvt_pk_bf16_f32 v186, v188, v189
v_cvt_pk_bf16_f32 v187, v190, v191
v_accvgpr_write_b32 a164, v184
v_accvgpr_write_b32 a165, v185
v_accvgpr_write_b32 a166, v186
v_accvgpr_write_b32 a167, v187
s_add_u32 s47, s48, 8192
s_nop 0
buffer_load_dwordx4 v[136:139], v3, s[4:7], s47 offen offset:0 sc1
v_accvgpr_read_b32 v184, a208
v_accvgpr_read_b32 v185, a209
v_accvgpr_read_b32 v186, a210
v_accvgpr_read_b32 v187, a211
v_accvgpr_read_b32 v188, a212
v_accvgpr_read_b32 v189, a213
v_accvgpr_read_b32 v190, a214
v_accvgpr_read_b32 v191, a215
v_mul_f32 v184, s66, v184
v_mul_f32 v185, s66, v185
v_mul_f32 v186, s66, v186
v_mul_f32 v187, s66, v187
v_mul_f32 v188, s66, v188
v_mul_f32 v189, s66, v189
buffer_load_dwordx4 v[144:147], v3, s[4:7], s47 offen offset:1024 sc1
v_mul_f32 v190, s66, v190
v_mul_f32 v191, s66, v191
v_cvt_pk_bf16_f32 v184, v184, v185
v_cvt_pk_bf16_f32 v185, v186, v187
v_cvt_pk_bf16_f32 v186, v188, v189
v_cvt_pk_bf16_f32 v187, v190, v191
v_accvgpr_write_b32 a168, v184
v_accvgpr_write_b32 a169, v185
v_accvgpr_write_b32 a170, v186
v_accvgpr_write_b32 a171, v187
v_accvgpr_read_b32 v184, a216
v_accvgpr_read_b32 v185, a217
v_accvgpr_read_b32 v186, a218
v_accvgpr_read_b32 v187, a219
s_add_u32 s47, s48, 22528
s_nop 0
buffer_load_dwordx4 v[140:143], v3, s[4:7], s47 offen offset:0 sc1
v_accvgpr_read_b32 v188, a220
v_accvgpr_read_b32 v189, a221
v_accvgpr_read_b32 v190, a222
v_accvgpr_read_b32 v191, a223
v_mul_f32 v184, s66, v184
v_mul_f32 v185, s66, v185
v_mul_f32 v186, s66, v186
v_mul_f32 v187, s66, v187
v_mul_f32 v188, s66, v188
v_mul_f32 v189, s66, v189
v_mul_f32 v190, s66, v190
v_mul_f32 v191, s66, v191
v_cvt_pk_bf16_f32 v184, v184, v185
v_cvt_pk_bf16_f32 v185, v186, v187
buffer_load_dwordx4 v[148:151], v3, s[4:7], s47 offen offset:1024 sc1
v_cvt_pk_bf16_f32 v186, v188, v189
v_cvt_pk_bf16_f32 v187, v190, v191
v_accvgpr_write_b32 a172, v184
v_accvgpr_write_b32 a173, v185
v_accvgpr_write_b32 a174, v186
v_accvgpr_write_b32 a175, v187
v_accvgpr_read_b32 v184, a224
v_accvgpr_read_b32 v185, a225
v_accvgpr_read_b32 v186, a226
v_accvgpr_read_b32 v187, a227
v_accvgpr_read_b32 v188, a228
v_accvgpr_read_b32 v189, a229
v_accvgpr_read_b32 v190, a230
v_accvgpr_read_b32 v191, a231
s_add_u32 s47, s48, 10240
s_nop 0
buffer_load_dwordx4 v[152:155], v3, s[4:7], s47 offen offset:0 sc1
v_mul_f32 v184, s66, v184
v_mul_f32 v185, s66, v185
v_mul_f32 v186, s66, v186
v_mul_f32 v187, s66, v187
v_mul_f32 v188, s66, v188
v_mul_f32 v189, s66, v189
v_mul_f32 v190, s66, v190
v_mul_f32 v191, s66, v191
v_cvt_pk_bf16_f32 v184, v184, v185
v_cvt_pk_bf16_f32 v185, v186, v187
v_cvt_pk_bf16_f32 v186, v188, v189
v_cvt_pk_bf16_f32 v187, v190, v191
v_accvgpr_write_b32 a176, v184
v_accvgpr_write_b32 a177, v185
buffer_load_dwordx4 v[160:163], v3, s[4:7], s47 offen offset:1024 sc1
v_accvgpr_write_b32 a178, v186
v_accvgpr_write_b32 a179, v187
v_accvgpr_read_b32 v184, a232
v_accvgpr_read_b32 v185, a233
v_accvgpr_read_b32 v186, a234
v_accvgpr_read_b32 v187, a235
v_accvgpr_read_b32 v188, a236
v_accvgpr_read_b32 v189, a237
v_accvgpr_read_b32 v190, a238
v_accvgpr_read_b32 v191, a239
v_mul_f32 v184, s66, v184
v_mul_f32 v185, s66, v185
v_mul_f32 v186, s66, v186
v_mul_f32 v187, s66, v187
s_add_u32 s47, s48, 24576
s_nop 0
buffer_load_dwordx4 v[156:159], v3, s[4:7], s47 offen offset:0 sc1
v_mul_f32 v188, s66, v188
v_mul_f32 v189, s66, v189
v_mul_f32 v190, s66, v190
v_mul_f32 v191, s66, v191
v_cvt_pk_bf16_f32 v184, v184, v185
v_cvt_pk_bf16_f32 v185, v186, v187
v_cvt_pk_bf16_f32 v186, v188, v189
v_cvt_pk_bf16_f32 v187, v190, v191
v_accvgpr_write_b32 a180, v184
v_accvgpr_write_b32 a181, v185
v_accvgpr_write_b32 a182, v186
v_accvgpr_write_b32 a183, v187
v_accvgpr_read_b32 v184, a240
v_accvgpr_read_b32 v185, a241
buffer_load_dwordx4 v[164:167], v3, s[4:7], s47 offen offset:1024 sc1
v_accvgpr_read_b32 v186, a242
v_accvgpr_read_b32 v187, a243
v_accvgpr_read_b32 v188, a244
v_accvgpr_read_b32 v189, a245
v_accvgpr_read_b32 v190, a246
v_accvgpr_read_b32 v191, a247
v_mul_f32 v184, s66, v184
v_mul_f32 v185, s66, v185
v_mul_f32 v186, s66, v186
v_mul_f32 v187, s66, v187
v_mul_f32 v188, s66, v188
v_mul_f32 v189, s66, v189
v_mul_f32 v190, s66, v190
v_mul_f32 v191, s66, v191
s_add_u32 s47, s48, 12288
s_nop 0
buffer_load_dwordx4 v[168:171], v3, s[4:7], s47 offen offset:0 sc1
v_cvt_pk_bf16_f32 v184, v184, v185
v_cvt_pk_bf16_f32 v185, v186, v187
v_cvt_pk_bf16_f32 v186, v188, v189
v_cvt_pk_bf16_f32 v187, v190, v191
v_accvgpr_write_b32 a184, v184
v_accvgpr_write_b32 a185, v185
v_accvgpr_write_b32 a186, v186
v_accvgpr_write_b32 a187, v187
v_accvgpr_read_b32 v184, a248
v_accvgpr_read_b32 v185, a249
v_accvgpr_read_b32 v186, a250
v_accvgpr_read_b32 v187, a251
v_accvgpr_read_b32 v188, a252
v_accvgpr_read_b32 v189, a253
buffer_load_dwordx4 v[176:179], v3, s[4:7], s47 offen offset:1024 sc1
v_accvgpr_read_b32 v190, a254
v_accvgpr_read_b32 v191, a255
v_mul_f32 v184, s66, v184
v_mul_f32 v185, s66, v185
v_mul_f32 v186, s66, v186
v_mul_f32 v187, s66, v187
v_mul_f32 v188, s66, v188
v_mul_f32 v189, s66, v189
v_mul_f32 v190, s66, v190
v_mul_f32 v191, s66, v191
v_cvt_pk_bf16_f32 v184, v184, v185
v_cvt_pk_bf16_f32 v185, v186, v187
v_cvt_pk_bf16_f32 v186, v188, v189
v_cvt_pk_bf16_f32 v187, v190, v191
s_add_u32 s47, s48, 26624
s_nop 0
buffer_load_dwordx4 v[172:175], v3, s[4:7], s47 offen offset:0 sc1
v_accvgpr_write_b32 a188, v184
v_accvgpr_write_b32 a189, v185
v_accvgpr_write_b32 a190, v186
v_accvgpr_write_b32 a191, v187
buffer_load_dwordx4 v[180:183], v3, s[4:7], s47 offen offset:1024 sc1
s_mov_b32 s53, 8192
s_mov_b32 s52, 8192
s_branch K1_FIN
K1_EPI_V:
s_waitcnt lgkmcnt(0)
s_waitcnt vmcnt(16)
s_cmp_eq_u32 s30, 0
s_cbranch_scc0 PEV_OK
s_mov_b32 s48, s88
s_and_b32 s49, s89, 0xffff
s_mov_b32 s50, 256
s_mov_b32 s51, 0x20000
v_mov_b32 v11, 0
s_mov_b32 s52, 0x10000
PEV_P:
v_readfirstlane_b32 s53, v220
s_cmp_ge_u32 s53, 256
s_cbranch_scc1 PEV_OK
s_sub_u32 s52, s52, 1
s_cmp_eq_u32 s52, 0
s_cbranch_scc1 PEV_OK
s_sleep 2
buffer_load_dwordx2 v[220:221], v11, s[48:51], 0 offen sc1
s_waitcnt vmcnt(0)
s_branch PEV_P
PEV_OK:
v_mov_b32 v1, v221
s_barrier
s_lshr_b32 s52, s2, 3
s_bfe_u32 s53, s52, 0x30001
s_sub_u32 s52, 15, s53
s_cmp_lt_u32 s2, 128
s_cselect_b32 s52, s52, s53
s_lshl_b32 s52, s52, 3
s_lshl_b32 s53, s30, 1
s_add_u32 s52, s52, s53
s_mul_i32 s48, s52, 14336
s_mov_b32 s4, s28
s_and_b32 s5, s29, 0xffff
s_mov_b32 s6, 1835008
s_mov_b32 s7, 0x20000
v_lshlrev_b32 v3, 4, v2
v_mov_b32 v16, v216
v_mov_b32 v17, v217
v_mov_b32 v18, v218
v_mov_b32 v19, v219
s_lshl_b32 s40, s30, 12
s_lshl_b32 s46, s30, 17
s_lshl_b32 s52, s31, 9
s_add_u32 s46, s46, s52
s_lshl_b32 s60, s31, 6
s_lshl_b32 s41, s32, 3
s_add_u32 s60, s60, s41
s_lshl_b32 s41, s44, 2
s_add_u32 s60, s60, s41
s_lshl_b32 s60, s60, 14
s_lshl_b32 s41, s45, 13
s_add_u32 s60, s60, s41
s_mov_b32 s66, 0x3db8aa3b
s_add_u32 s47, s48, 0
s_nop 0
buffer_load_dwordx4 v[72:75], v3, s[4:7], s47 offen offset:0 sc1
v_accvgpr_read_b32 v184, a0
v_accvgpr_read_b32 v185, a1
v_accvgpr_read_b32 v186, a2
v_accvgpr_read_b32 v187, a3
v_accvgpr_read_b32 v188, a32
v_accvgpr_read_b32 v189, a33
v_accvgpr_read_b32 v190, a34
v_accvgpr_read_b32 v191, a35
v_cvt_pk_bf16_f32 v192, v184, v185
buffer_load_dwordx4 v[80:83], v3, s[4:7], s47 offen offset:1024 sc1
v_cvt_pk_bf16_f32 v193, v186, v187
v_cvt_pk_bf16_f32 v194, v188, v189
v_cvt_pk_bf16_f32 v195, v190, v191
v_accvgpr_read_b32 v184, a4
v_accvgpr_read_b32 v185, a5
v_accvgpr_read_b32 v186, a6
v_accvgpr_read_b32 v187, a7
v_accvgpr_read_b32 v188, a36
v_accvgpr_read_b32 v189, a37
s_add_u32 s47, s48, 14336
s_nop 0
buffer_load_dwordx4 v[76:79], v3, s[4:7], s47 offen offset:0 sc1
v_accvgpr_read_b32 v190, a38
v_accvgpr_read_b32 v191, a39
v_cvt_pk_bf16_f32 v196, v184, v185
v_cvt_pk_bf16_f32 v197, v186, v187
v_cvt_pk_bf16_f32 v198, v188, v189
v_cvt_pk_bf16_f32 v199, v190, v191
v_accvgpr_read_b32 v184, a8
v_accvgpr_read_b32 v185, a9
v_accvgpr_read_b32 v186, a10
buffer_load_dwordx4 v[84:87], v3, s[4:7], s47 offen offset:1024 sc1
v_accvgpr_read_b32 v187, a11
v_accvgpr_read_b32 v188, a40
v_accvgpr_read_b32 v189, a41
v_accvgpr_read_b32 v190, a42
v_accvgpr_read_b32 v191, a43
v_cvt_pk_bf16_f32 v200, v184, v185
v_cvt_pk_bf16_f32 v201, v186, v187
v_cvt_pk_bf16_f32 v202, v188, v189
v_cvt_pk_bf16_f32 v203, v190, v191
s_add_u32 s47, s48, 2048
s_nop 0
buffer_load_dwordx4 v[88:91], v3, s[4:7], s47 offen offset:0 sc1
v_accvgpr_read_b32 v184, a12
v_accvgpr_read_b32 v185, a13
v_accvgpr_read_b32 v186, a14
v_accvgpr_read_b32 v187, a15
v_accvgpr_read_b32 v188, a44
v_accvgpr_read_b32 v189, a45
v_accvgpr_read_b32 v190, a46
v_accvgpr_read_b32 v191, a47
v_cvt_pk_bf16_f32 v204, v184, v185
buffer_load_dwordx4 v[96:99], v3, s[4:7], s47 offen offset:1024 sc1
v_cvt_pk_bf16_f32 v205, v186, v187
v_cvt_pk_bf16_f32 v206, v188, v189
v_cvt_pk_bf16_f32 v207, v190, v191
v_accvgpr_read_b32 v184, a16
v_accvgpr_read_b32 v185, a17
v_accvgpr_read_b32 v186, a18
v_accvgpr_read_b32 v187, a19
v_accvgpr_read_b32 v188, a48
v_accvgpr_read_b32 v189, a49
s_add_u32 s47, s48, 16384
s_nop 0
buffer_load_dwordx4 v[92:95], v3, s[4:7], s47 offen offset:0 sc1
v_accvgpr_read_b32 v190, a50
v_accvgpr_read_b32 v191, a51
v_cvt_pk_bf16_f32 v208, v184, v185
v_cvt_pk_bf16_f32 v209, v186, v187
v_cvt_pk_bf16_f32 v210, v188, v189
v_cvt_pk_bf16_f32 v211, v190, v191
v_accvgpr_read_b32 v184, a20
v_accvgpr_read_b32 v185, a21
v_accvgpr_read_b32 v186, a22
buffer_load_dwordx4 v[100:103], v3, s[4:7], s47 offen offset:1024 sc1
v_accvgpr_read_b32 v187, a23
v_accvgpr_read_b32 v188, a52
v_accvgpr_read_b32 v189, a53
v_accvgpr_read_b32 v190, a54
v_accvgpr_read_b32 v191, a55
v_cvt_pk_bf16_f32 v212, v184, v185
v_cvt_pk_bf16_f32 v213, v186, v187
v_cvt_pk_bf16_f32 v214, v188, v189
v_cvt_pk_bf16_f32 v215, v190, v191
s_add_u32 s47, s46, 1048576
s_add_u32 m0, s40, 65536
s_nop 0
buffer_load_dwordx4 v16, s[8:11], s47 offen offset:0 lds
v_accvgpr_read_b32 v184, a24
v_accvgpr_read_b32 v185, a25
v_accvgpr_read_b32 v186, a26
v_accvgpr_read_b32 v187, a27
v_accvgpr_read_b32 v188, a56
v_accvgpr_read_b32 v189, a57
v_accvgpr_read_b32 v190, a58
v_accvgpr_read_b32 v191, a59
v_cvt_pk_bf16_f32 v216, v184, v185
buffer_load_dwordx4 v17, s[8:11], s47 offen offset:1024 lds
v_cvt_pk_bf16_f32 v217, v186, v187
v_cvt_pk_bf16_f32 v218, v188, v189
v_cvt_pk_bf16_f32 v219, v190, v191
v_accvgpr_read_b32 v184, a28
v_accvgpr_read_b32 v185, a29
v_accvgpr_read_b32 v186, a30
v_accvgpr_read_b32 v187, a31
v_accvgpr_read_b32 v188, a60
v_accvgpr_read_b32 v189, a61
buffer_load_dwordx4 v18, s[8:11], s47 offen offset:2048 lds
v_accvgpr_read_b32 v190, a62
v_accvgpr_read_b32 v191, a63
v_cvt_pk_bf16_f32 v220, v184, v185
v_cvt_pk_bf16_f32 v221, v186, v187
v_cvt_pk_bf16_f32 v222, v188, v189
v_cvt_pk_bf16_f32 v223, v190, v191
v_accvgpr_read_b32 v184, a64
v_accvgpr_read_b32 v185, a65
v_accvgpr_read_b32 v186, a66
buffer_load_dwordx4 v19, s[8:11], s47 offen offset:3072 lds
v_accvgpr_read_b32 v187, a67
v_accvgpr_read_b32 v188, a96
v_accvgpr_read_b32 v189, a97
v_accvgpr_read_b32 v190, a98
v_accvgpr_read_b32 v191, a99
v_cvt_pk_bf16_f32 v224, v184, v185
v_cvt_pk_bf16_f32 v225, v186, v187
v_cvt_pk_bf16_f32 v226, v188, v189
v_cvt_pk_bf16_f32 v227, v190, v191
s_add_u32 s47, s46, 1048832
s_add_u32 m0, s40, 81920
s_nop 0
buffer_load_dwordx4 v16, s[8:11], s47 offen offset:0 lds
v_accvgpr_read_b32 v184, a68
v_accvgpr_read_b32 v185, a69
v_accvgpr_read_b32 v186, a70
v_accvgpr_read_b32 v187, a71
v_accvgpr_read_b32 v188, a100
v_accvgpr_read_b32 v189, a101
v_accvgpr_read_b32 v190, a102
v_accvgpr_read_b32 v191, a103
v_cvt_pk_bf16_f32 v228, v184, v185
buffer_load_dwordx4 v17, s[8:11], s47 offen offset:1024 lds
v_cvt_pk_bf16_f32 v229, v186, v187
v_cvt_pk_bf16_f32 v230, v188, v189
v_cvt_pk_bf16_f32 v231, v190, v191
v_accvgpr_read_b32 v184, a72
v_accvgpr_read_b32 v185, a73
v_accvgpr_read_b32 v186, a74
v_accvgpr_read_b32 v187, a75
v_accvgpr_read_b32 v188, a104
v_accvgpr_read_b32 v189, a105
buffer_load_dwordx4 v18, s[8:11], s47 offen offset:2048 lds
v_accvgpr_read_b32 v190, a106
v_accvgpr_read_b32 v191, a107
v_cvt_pk_bf16_f32 v232, v184, v185
v_cvt_pk_bf16_f32 v233, v186, v187
v_cvt_pk_bf16_f32 v234, v188, v189
v_cvt_pk_bf16_f32 v235, v190, v191
v_accvgpr_read_b32 v184, a76
v_accvgpr_read_b32 v185, a77
v_accvgpr_read_b32 v186, a78
buffer_load_dwordx4 v19, s[8:11], s47 offen offset:3072 lds
v_accvgpr_read_b32 v187, a79
v_accvgpr_read_b32 v188, a108
v_accvgpr_read_b32 v189, a109
v_accvgpr_read_b32 v190, a110
v_accvgpr_read_b32 v191, a111
v_cvt_pk_bf16_f32 v236, v184, v185
v_cvt_pk_bf16_f32 v237, v186, v187
v_cvt_pk_bf16_f32 v238, v188, v189
v_cvt_pk_bf16_f32 v239, v190, v191
s_add_u32 s47, s48, 4096
s_nop 0
buffer_load_dwordx4 v[104:107], v3, s[4:7], s47 offen offset:0 sc1
v_accvgpr_read_b32 v184, a80
v_accvgpr_read_b32 v185, a81
v_accvgpr_read_b32 v186, a82
v_accvgpr_read_b32 v187, a83
v_accvgpr_read_b32 v188, a112
v_accvgpr_read_b32 v189, a113
v_accvgpr_read_b32 v190, a114
v_accvgpr_read_b32 v191, a115
v_cvt_pk_bf16_f32 v240, v184, v185
buffer_load_dwordx4 v[112:115], v3, s[4:7], s47 offen offset:1024 sc1
v_cvt_pk_bf16_f32 v241, v186, v187
v_cvt_pk_bf16_f32 v242, v188, v189
v_cvt_pk_bf16_f32 v243, v190, v191
v_accvgpr_read_b32 v184, a84
v_accvgpr_read_b32 v185, a85
v_accvgpr_read_b32 v186, a86
v_accvgpr_read_b32 v187, a87
v_accvgpr_read_b32 v188, a116
v_accvgpr_read_b32 v189, a117
s_add_u32 s47, s48, 18432
s_nop 0
buffer_load_dwordx4 v[108:111], v3, s[4:7], s47 offen offset:0 sc1
v_accvgpr_read_b32 v190, a118
v_accvgpr_read_b32 v191, a119
v_cvt_pk_bf16_f32 v244, v184, v185
v_cvt_pk_bf16_f32 v245, v186, v187
v_cvt_pk_bf16_f32 v246, v188, v189
v_cvt_pk_bf16_f32 v247, v190, v191
v_accvgpr_read_b32 v184, a88
v_accvgpr_read_b32 v185, a89
v_accvgpr_read_b32 v186, a90
buffer_load_dwordx4 v[116:119], v3, s[4:7], s47 offen offset:1024 sc1
v_accvgpr_read_b32 v187, a91
v_accvgpr_read_b32 v188, a120
v_accvgpr_read_b32 v189, a121
v_accvgpr_read_b32 v190, a122
v_accvgpr_read_b32 v191, a123
v_cvt_pk_bf16_f32 v248, v184, v185
v_cvt_pk_bf16_f32 v249, v186, v187
v_cvt_pk_bf16_f32 v250, v188, v189
v_cvt_pk_bf16_f32 v251, v190, v191
s_add_u32 s47, s46, 1572864
s_add_u32 m0, s40, 98304
s_nop 0
buffer_load_dwordx4 v16, s[8:11], s47 offen offset:0 lds
v_accvgpr_read_b32 v184, a92
v_accvgpr_read_b32 v185, a93
v_accvgpr_read_b32 v186, a94
v_accvgpr_read_b32 v187, a95
v_accvgpr_read_b32 v188, a124
v_accvgpr_read_b32 v189, a125
v_accvgpr_read_b32 v190, a126
v_accvgpr_read_b32 v191, a127
v_cvt_pk_bf16_f32 v252, v184, v185
buffer_load_dwordx4 v17, s[8:11], s47 offen offset:1024 lds
v_cvt_pk_bf16_f32 v253, v186, v187
v_cvt_pk_bf16_f32 v254, v188, v189
v_cvt_pk_bf16_f32 v255, v190, v191
v_accvgpr_read_b32 v184, a128
v_accvgpr_read_b32 v185, a129
v_accvgpr_read_b32 v186, a130
v_accvgpr_read_b32 v187, a131
v_accvgpr_read_b32 v188, a160
v_accvgpr_read_b32 v189, a161
buffer_load_dwordx4 v18, s[8:11], s47 offen offset:2048 lds
v_accvgpr_read_b32 v190, a162
v_accvgpr_read_b32 v191, a163
v_cvt_pk_bf16_f32 v184, v184, v185
v_cvt_pk_bf16_f32 v185, v186, v187
v_cvt_pk_bf16_f32 v186, v188, v189
v_cvt_pk_bf16_f32 v187, v190, v191
v_accvgpr_write_b32 a128, v184
v_accvgpr_write_b32 a129, v185
v_accvgpr_write_b32 a130, v186
buffer_load_dwordx4 v19, s[8:11], s47 offen offset:3072 lds
v_accvgpr_write_b32 a131, v187
v_accvgpr_read_b32 v184, a132
v_accvgpr_read_b32 v185, a133
v_accvgpr_read_b32 v186, a134
v_accvgpr_read_b32 v187, a135
v_accvgpr_read_b32 v188, a164
v_accvgpr_read_b32 v189, a165
v_accvgpr_read_b32 v190, a166
v_accvgpr_read_b32 v191, a167
s_add_u32 s47, s46, 1573120
s_add_u32 m0, s40, 114688
s_nop 0
buffer_load_dwordx4 v16, s[8:11], s47 offen offset:0 lds
v_cvt_pk_bf16_f32 v184, v184, v185
v_cvt_pk_bf16_f32 v185, v186, v187
v_cvt_pk_bf16_f32 v186, v188, v189
v_cvt_pk_bf16_f32 v187, v190, v191
v_accvgpr_write_b32 a132, v184
v_accvgpr_write_b32 a133, v185
v_accvgpr_write_b32 a134, v186
v_accvgpr_write_b32 a135, v187
v_accvgpr_read_b32 v184, a136
buffer_load_dwordx4 v17, s[8:11], s47 offen offset:1024 lds
v_accvgpr_read_b32 v185, a137
v_accvgpr_read_b32 v186, a138
v_accvgpr_read_b32 v187, a139
v_accvgpr_read_b32 v188, a168
v_accvgpr_read_b32 v189, a169
v_accvgpr_read_b32 v190, a170
v_accvgpr_read_b32 v191, a171
v_cvt_pk_bf16_f32 v184, v184, v185
v_cvt_pk_bf16_f32 v185, v186, v187
buffer_load_dwordx4 v18, s[8:11], s47 offen offset:2048 lds
v_cvt_pk_bf16_f32 v186, v188, v189
v_cvt_pk_bf16_f32 v187, v190, v191
v_accvgpr_write_b32 a136, v184
v_accvgpr_write_b32 a137, v185
v_accvgpr_write_b32 a138, v186
v_accvgpr_write_b32 a139, v187
v_accvgpr_read_b32 v184, a140
v_accvgpr_read_b32 v185, a141
v_accvgpr_read_b32 v186, a142
buffer_load_dwordx4 v19, s[8:11], s47 offen offset:3072 lds
v_accvgpr_read_b32 v187, a143
v_accvgpr_read_b32 v188, a172
v_accvgpr_read_b32 v189, a173
v_accvgpr_read_b32 v190, a174
v_accvgpr_read_b32 v191, a175
v_cvt_pk_bf16_f32 v184, v184, v185
v_cvt_pk_bf16_f32 v185, v186, v187
v_cvt_pk_bf16_f32 v186, v188, v189
v_cvt_pk_bf16_f32 v187, v190, v191
s_add_u32 s47, s48, 6144
s_nop 0
buffer_load_dwordx4 v[120:123], v3, s[4:7], s47 offen offset:0 sc1
v_accvgpr_write_b32 a140, v184
v_accvgpr_write_b32 a141, v185
v_accvgpr_write_b32 a142, v186
v_accvgpr_write_b32 a143, v187
v_accvgpr_read_b32 v184, a144
v_accvgpr_read_b32 v185, a145
v_accvgpr_read_b32 v186, a146
v_accvgpr_read_b32 v187, a147
v_accvgpr_read_b32 v188, a176
buffer_load_dwordx4 v[128:131], v3, s[4:7], s47 offen offset:1024 sc1
v_accvgpr_read_b32 v189, a177
v_accvgpr_read_b32 v190, a178
v_accvgpr_read_b32 v191, a179
v_cvt_pk_bf16_f32 v184, v184, v185
v_cvt_pk_bf16_f32 v185, v186, v187
v_cvt_pk_bf16_f32 v186, v188, v189
v_cvt_pk_bf16_f32 v187, v190, v191
v_accvgpr_write_b32 a144, v184
v_accvgpr_write_b32 a145, v185
s_add_u32 s47, s48, 20480
s_nop 0
buffer_load_dwordx4 v[124:127], v3, s[4:7], s47 offen offset:0 sc1
v_accvgpr_write_b32 a146, v186
v_accvgpr_write_b32 a147, v187
v_accvgpr_read_b32 v184, a148
v_accvgpr_read_b32 v185, a149
v_accvgpr_read_b32 v186, a150
v_accvgpr_read_b32 v187, a151
v_accvgpr_read_b32 v188, a180
v_accvgpr_read_b32 v189, a181
v_accvgpr_read_b32 v190, a182
buffer_load_dwordx4 v[132:135], v3, s[4:7], s47 offen offset:1024 sc1
v_accvgpr_read_b32 v191, a183
v_cvt_pk_bf16_f32 v184, v184, v185
v_cvt_pk_bf16_f32 v185, v186, v187
v_cvt_pk_bf16_f32 v186, v188, v189
v_cvt_pk_bf16_f32 v187, v190, v191
v_accvgpr_write_b32 a148, v184
v_accvgpr_write_b32 a149, v185
v_accvgpr_write_b32 a150, v186
v_accvgpr_write_b32 a151, v187
s_add_u32 s47, s46, 2097152
s_add_u32 m0, s40, 131072
s_nop 0
buffer_load_dwordx4 v16, s[8:11], s47 offen offset:0 lds
v_accvgpr_read_b32 v184, a152
v_accvgpr_read_b32 v185, a153
v_accvgpr_read_b32 v186, a154
v_accvgpr_read_b32 v187, a155
v_accvgpr_read_b32 v188, a184
v_accvgpr_read_b32 v189, a185
v_accvgpr_read_b32 v190, a186
v_accvgpr_read_b32 v191, a187
v_cvt_pk_bf16_f32 v184, v184, v185
buffer_load_dwordx4 v17, s[8:11], s47 offen offset:1024 lds
v_cvt_pk_bf16_f32 v185, v186, v187
v_cvt_pk_bf16_f32 v186, v188, v189
v_cvt_pk_bf16_f32 v187, v190, v191
v_accvgpr_write_b32 a152, v184
v_accvgpr_write_b32 a153, v185
v_accvgpr_write_b32 a154, v186
v_accvgpr_write_b32 a155, v187
v_accvgpr_read_b32 v184, a156
v_accvgpr_read_b32 v185, a157
buffer_load_dwordx4 v18, s[8:11], s47 offen offset:2048 lds
v_accvgpr_read_b32 v186, a158
v_accvgpr_read_b32 v187, a159
v_accvgpr_read_b32 v188, a188
v_accvgpr_read_b32 v189, a189
v_accvgpr_read_b32 v190, a190
v_accvgpr_read_b32 v191, a191
v_cvt_pk_bf16_f32 v184, v184, v185
v_cvt_pk_bf16_f32 v185, v186, v187
v_cvt_pk_bf16_f32 v186, v188, v189
buffer_load_dwordx4 v19, s[8:11], s47 offen offset:3072 lds
v_cvt_pk_bf16_f32 v187, v190, v191
v_accvgpr_write_b32 a156, v184
v_accvgpr_write_b32 a157, v185
v_accvgpr_write_b32 a158, v186
v_accvgpr_write_b32 a159, v187
v_accvgpr_read_b32 v184, a192
v_accvgpr_read_b32 v185, a193
v_accvgpr_read_b32 v186, a194
v_accvgpr_read_b32 v187, a195
s_add_u32 s47, s46, 2097408
s_add_u32 m0, s40, 147456
s_nop 0
buffer_load_dwordx4 v16, s[8:11], s47 offen offset:0 lds
v_accvgpr_read_b32 v188, a224
v_accvgpr_read_b32 v189, a225
v_accvgpr_read_b32 v190, a226
v_accvgpr_read_b32 v191, a227
v_cvt_pk_bf16_f32 v184, v184, v185
v_cvt_pk_bf16_f32 v185, v186, v187
v_cvt_pk_bf16_f32 v186, v188, v189
v_cvt_pk_bf16_f32 v187, v190, v191
v_accvgpr_write_b32 a160, v184
buffer_load_dwordx4 v17, s[8:11], s47 offen offset:1024 lds
v_accvgpr_write_b32 a161, v185
v_accvgpr_write_b32 a162, v186
v_accvgpr_write_b32 a163, v187
v_accvgpr_read_b32 v184, a196
v_accvgpr_read_b32 v185, a197
v_accvgpr_read_b32 v186, a198
v_accvgpr_read_b32 v187, a199
v_accvgpr_read_b32 v188, a228
v_accvgpr_read_b32 v189, a229
buffer_load_dwordx4 v18, s[8:11], s47 offen offset:2048 lds
v_accvgpr_read_b32 v190, a230
v_accvgpr_read_b32 v191, a231
v_cvt_pk_bf16_f32 v184, v184, v185
v_cvt_pk_bf16_f32 v185, v186, v187
v_cvt_pk_bf16_f32 v186, v188, v189
v_cvt_pk_bf16_f32 v187, v190, v191
v_accvgpr_write_b32 a164, v184
v_accvgpr_write_b32 a165, v185
v_accvgpr_write_b32 a166, v186
buffer_load_dwordx4 v19, s[8:11], s47 offen offset:3072 lds
v_accvgpr_write_b32 a167, v187
v_accvgpr_read_b32 v184, a200
v_accvgpr_read_b32 v185, a201
v_accvgpr_read_b32 v186, a202
v_accvgpr_read_b32 v187, a203
v_accvgpr_read_b32 v188, a232
v_accvgpr_read_b32 v189, a233
v_accvgpr_read_b32 v190, a234
v_accvgpr_read_b32 v191, a235
s_add_u32 s47, s48, 8192
s_nop 0
buffer_load_dwordx4 v[136:139], v3, s[4:7], s47 offen offset:0 sc1
v_cvt_pk_bf16_f32 v184, v184, v185
v_cvt_pk_bf16_f32 v185, v186, v187
v_cvt_pk_bf16_f32 v186, v188, v189
v_cvt_pk_bf16_f32 v187, v190, v191
v_accvgpr_write_b32 a168, v184
v_accvgpr_write_b32 a169, v185
v_accvgpr_write_b32 a170, v186
v_accvgpr_write_b32 a171, v187
v_accvgpr_read_b32 v184, a204
buffer_load_dwordx4 v[144:147], v3, s[4:7], s47 offen offset:1024 sc1
v_accvgpr_read_b32 v185, a205
v_accvgpr_read_b32 v186, a206
v_accvgpr_read_b32 v187, a207
v_accvgpr_read_b32 v188, a236
v_accvgpr_read_b32 v189, a237
v_accvgpr_read_b32 v190, a238
v_accvgpr_read_b32 v191, a239
v_cvt_pk_bf16_f32 v184, v184, v185
v_cvt_pk_bf16_f32 v185, v186, v187
s_add_u32 s47, s48, 22528
s_nop 0
buffer_load_dwordx4 v[140:143], v3, s[4:7], s47 offen offset:0 sc1
v_cvt_pk_bf16_f32 v186, v188, v189
v_cvt_pk_bf16_f32 v187, v190, v191
v_accvgpr_write_b32 a172, v184
v_accvgpr_write_b32 a173, v185
v_accvgpr_write_b32 a174, v186
v_accvgpr_write_b32 a175, v187
v_accvgpr_read_b32 v184, a208
v_accvgpr_read_b32 v185, a209
v_accvgpr_read_b32 v186, a210
buffer_load_dwordx4 v[148:151], v3, s[4:7], s47 offen offset:1024 sc1
v_accvgpr_read_b32 v187, a211
v_accvgpr_read_b32 v188, a240
v_accvgpr_read_b32 v189, a241
v_accvgpr_read_b32 v190, a242
v_accvgpr_read_b32 v191, a243
v_cvt_pk_bf16_f32 v184, v184, v185
v_cvt_pk_bf16_f32 v185, v186, v187
v_cvt_pk_bf16_f32 v186, v188, v189
v_cvt_pk_bf16_f32 v187, v190, v191
s_add_u32 s47, s48, 10240
s_nop 0
buffer_load_dwordx4 v[152:155], v3, s[4:7], s47 offen offset:0 sc1
v_accvgpr_write_b32 a176, v184
v_accvgpr_write_b32 a177, v185
v_accvgpr_write_b32 a178, v186
v_accvgpr_write_b32 a179, v187
v_accvgpr_read_b32 v184, a212
v_accvgpr_read_b32 v185, a213
v_accvgpr_read_b32 v186, a214
v_accvgpr_read_b32 v187, a215
v_accvgpr_read_b32 v188, a244
buffer_load_dwordx4 v[160:163], v3, s[4:7], s47 offen offset:1024 sc1
v_accvgpr_read_b32 v189, a245
v_accvgpr_read_b32 v190, a246
v_accvgpr_read_b32 v191, a247
v_cvt_pk_bf16_f32 v184, v184, v185
v_cvt_pk_bf16_f32 v185, v186, v187
v_cvt_pk_bf16_f32 v186, v188, v189
v_cvt_pk_bf16_f32 v187, v190, v191
v_accvgpr_write_b32 a180, v184
v_accvgpr_write_b32 a181, v185
s_add_u32 s47, s48, 24576
s_nop 0
buffer_load_dwordx4 v[156:159], v3, s[4:7], s47 offen offset:0 sc1
v_accvgpr_write_b32 a182, v186
v_accvgpr_write_b32 a183, v187
v_accvgpr_read_b32 v184, a216
v_accvgpr_read_b32 v185, a217
v_accvgpr_read_b32 v186, a218
v_accvgpr_read_b32 v187, a219
v_accvgpr_read_b32 v188, a248
v_accvgpr_read_b32 v189, a249
v_accvgpr_read_b32 v190, a250
buffer_load_dwordx4 v[164:167], v3, s[4:7], s47 offen offset:1024 sc1
v_accvgpr_read_b32 v191, a251
v_cvt_pk_bf16_f32 v184, v184, v185
v_cvt_pk_bf16_f32 v185, v186, v187
v_cvt_pk_bf16_f32 v186, v188, v189
v_cvt_pk_bf16_f32 v187, v190, v191
v_accvgpr_write_b32 a184, v184
v_accvgpr_write_b32 a185, v185
v_accvgpr_write_b32 a186, v186
v_accvgpr_write_b32 a187, v187
s_add_u32 s47, s48, 12288
s_nop 0
buffer_load_dwordx4 v[168:171], v3, s[4:7], s47 offen offset:0 sc1
v_accvgpr_read_b32 v184, a220
v_accvgpr_read_b32 v185, a221
v_accvgpr_read_b32 v186, a222
v_accvgpr_read_b32 v187, a223
v_accvgpr_read_b32 v188, a252
v_accvgpr_read_b32 v189, a253
v_accvgpr_read_b32 v190, a254
v_accvgpr_read_b32 v191, a255
v_cvt_pk_bf16_f32 v184, v184, v185
buffer_load_dwordx4 v[176:179], v3, s[4:7], s47 offen offset:1024 sc1
v_cvt_pk_bf16_f32 v185, v186, v187
v_cvt_pk_bf16_f32 v186, v188, v189
v_cvt_pk_bf16_f32 v187, v190, v191
v_accvgpr_write_b32 a188, v184
v_accvgpr_write_b32 a189, v185
v_accvgpr_write_b32 a190, v186
v_accvgpr_write_b32 a191, v187
s_add_u32 s47, s48, 26624
s_nop 0
buffer_load_dwordx4 v[172:175], v3, s[4:7], s47 offen offset:0 sc1
buffer_load_dwordx4 v[180:183], v3, s[4:7], s47 offen offset:1024 sc1
s_mov_b32 s53, 4096
s_mov_b32 s52, 12288
K1_FIN:
s_load_dwordx4 s[56:59], s[0:1], 56
v_lshlrev_b32 v3, 4, v2
v_add_u32 v7, 98304, v3
v_xor_b32 v4, 16, v2
v_lshlrev_b32 v4, 2, v4
v_xor_b32 v5, 32, v2
v_lshlrev_b32 v5, 2, v5
v_and_b32 v6, 15, v2
v_lshrrev_b32 v9, 4, v2
v_lshlrev_b32 v9, 2, v9
v_sub_u32 v6, v6, v9
s_lshl_b32 s40, s30, 12
s_mov_b32 s43, 0x53800000
s_and_b32 s3, s2, 7
s_lshr_b32 s33, s2, 3
s_and_b32 s34, s33, 1
s_lshl_b32 s31, s3, 1
s_add_u32 s31, s31, s34
s_bfe_u32 s63, s33, 0x30001
s_lshr_b32 s61, s2, 7
s_lshl_b32 s62, s31, 3
s_add_u32 s62, s62, s63
s_and_b32 s34, s33, 15
s_cmp_lt_u32 s34, 12
s_cselect_b32 s65, 2, 1
s_cselect_b32 s64, 27, 31
s_mul_i32 s66, s3, 28
s_add_u32 s66, s66, s34
s_waitcnt lgkmcnt(0)
s_sub_u32 s33, 15, s63
s_cmp_eq_u32 s61, 0
s_cselect_b32 s32, s33, s63
s_lshl_b32 s49, s32, 3
s_lshl_b32 s33, s30, 1
s_add_u32 s49, s49, s33
s_mul_i32 s48, s49, 14336
s_lshl_b32 s45, s30, 17
s_lshl_b32 s33, s31, 9
s_add_u32 s45, s45, s33
s_add_u32 s16, s28, 2097152
s_addc_u32 s17, s29, 0
s_and_b32 s17, s17, 0xffff
s_mov_b32 s18, 16777216
s_mov_b32 s19, 0x20000
s_add_u32 s20, s28, 18857984
s_addc_u32 s21, s29, 0
s_and_b32 s21, s21, 0xffff
s_mov_b32 s22, 16777216
s_mov_b32 s23, 0x20000
s_add_u32 s24, s28, 35651584
s_addc_u32 s25, s29, 0
s_and_b32 s25, s25, 0xffff
s_mov_b32 s26, 24117248
s_mov_b32 s27, 0x20000
s_add_u32 s68, s28, 60817408
s_addc_u32 s69, s29, 0
s_and_b32 s69, s69, 0xffff
s_mov_b32 s70, 17301504
s_mov_b32 s71, 0x20000
s_add_u32 s72, s28, 100663296
s_addc_u32 s73, s29, 0
s_and_b32 s73, s73, 0xffff
s_mov_b32 s74, 131072
s_mov_b32 s75, 0x20000
s_mov_b32 s80, s56
s_and_b32 s81, s57, 0xffff
s_mov_b32 s82, 1605632
s_mov_b32 s83, 0x20000
s_mov_b32 s84, s58
s_and_b32 s85, s59, 0xffff
s_mov_b32 s86, 1605632
s_mov_b32 s87, 0x20000
v_bfe_u32 v9, v2, 2, 2
v_lshrrev_b32 v10, 4, v2
v_lshl_add_u32 v10, v10, 3, v9
v_lshlrev_b32 v10, 8, v10
v_and_b32 v11, 1, v2
v_lshl_add_u32 v10, v11, 3, v10
v_bfe_u32 v11, v2, 4, 1
v_lshl_add_u32 v9, v11, 2, v9
v_lshlrev_b32 v9, 1, v9
v_bfe_u32 v11, v2, 1, 1
v_add_u32 v12, 0, v11
v_xor_b32 v12, v12, v9
v_lshl_add_u32 v20, v12, 4, v10
v_add_u32 v12, 2, v11
v_xor_b32 v12, v12, v9
v_lshl_add_u32 v21, v12, 4, v10
v_add_u32 v12, 4, v11
v_xor_b32 v12, v12, v9
v_lshl_add_u32 v22, v12, 4, v10
v_add_u32 v12, 6, v11
v_xor_b32 v12, v12, v9
v_lshl_add_u32 v23, v12, 4, v10
v_add_u32 v12, 8, v11
v_xor_b32 v12, v12, v9
v_lshl_add_u32 v24, v12, 4, v10
v_add_u32 v12, 10, v11
v_xor_b32 v12, v12, v9
v_lshl_add_u32 v25, v12, 4, v10
v_add_u32 v12, 12, v11
v_xor_b32 v12, v12, v9
v_lshl_add_u32 v26, v12, 4, v10
v_add_u32 v12, 14, v11
v_xor_b32 v12, v12, v9
v_lshl_add_u32 v27, v12, 4, v10
s_lshl_b32 s42, s63, 2
s_add_u32 s42, s42, 4
s_cmp_eq_u32 s61, 0
s_cselect_b32 s42, s64, s42
s_mov_b32 s41, 0
s_mov_b32 s50, 0
s_mov_b32 s88, 0
s_lshl_b32 s33, s32, 2
s_add_u32 s33, s33, s30
s_sub_u32 s34, s42, 1
s_min_u32 s35, s33, s34
s_sub_u32 s38, s34, s35
s_sub_u32 s36, s35, s41
s_cmp_eq_u32 s35, s33
s_cselect_b32 s37, 1, -1
s_lshl_b32 s33, s31, 6
s_add_u32 s34, s33, s42
s_lshl_b32 s18, s34, 14
s_add_u32 s22, s18, 16384
s_add_u32 s39, s33, s41
s_lshl_b32 s39, s39, 14
s_add_u32 s39, s39, s40
s_waitcnt vmcnt(52)
s_barrier
ds_read_b64_tr_b16 v[40:41], v20 offset:0
ds_read_b64_tr_b16 v[42:43], v20 offset:1024
ds_read_b64_tr_b16 v[44:45], v21 offset:0
ds_read_b64_tr_b16 v[46:47], v21 offset:1024
ds_read_b64_tr_b16 v[48:49], v22 offset:0
ds_read_b64_tr_b16 v[50:51], v22 offset:1024
ds_read_b64_tr_b16 v[52:53], v23 offset:0
ds_read_b64_tr_b16 v[54:55], v23 offset:1024
ds_read_b64_tr_b16 v[56:57], v24 offset:0
ds_read_b64_tr_b16 v[58:59], v24 offset:1024
ds_read_b64_tr_b16 v[60:61], v25 offset:0
ds_read_b64_tr_b16 v[62:63], v25 offset:1024
s_waitcnt vmcnt(48)
s_barrier
s_waitcnt lgkmcnt(10)
v_mfma_f32_16x16x32_bf16 a[0:3], v[40:43], v[72:75], 0
s_waitcnt lgkmcnt(8)
ds_read_b64_tr_b16 v[64:65], v26 offset:0
ds_read_b64_tr_b16 v[66:67], v26 offset:1024
v_mfma_f32_16x16x32_bf16 a[4:7], v[40:43], v[76:79], 0
v_mfma_f32_16x16x32_bf16 a[8:11], v[44:47], v[72:75], 0
s_waitcnt lgkmcnt(8)
ds_read_b64_tr_b16 v[68:69], v27 offset:0
ds_read_b64_tr_b16 v[70:71], v27 offset:1024
v_mfma_f32_16x16x32_bf16 a[12:15], v[44:47], v[76:79], 0
buffer_store_dwordx4 v[192:195], v3, s[12:15], s60 offen offset:0 sc1
v_mfma_f32_16x16x32_bf16 a[16:19], v[48:51], v[72:75], 0
s_waitcnt lgkmcnt(8)
ds_read_b64_tr_b16 v[40:41], v20 offset:16384
ds_read_b64_tr_b16 v[42:43], v20 offset:17408
v_mfma_f32_16x16x32_bf16 a[20:23], v[48:51], v[76:79], 0
buffer_store_dwordx4 v[196:199], v3, s[12:15], s60 offen offset:1024 sc1
v_mfma_f32_16x16x32_bf16 a[24:27], v[52:55], v[72:75], 0
s_waitcnt lgkmcnt(8)
ds_read_b64_tr_b16 v[44:45], v21 offset:16384
ds_read_b64_tr_b16 v[46:47], v21 offset:17408
v_mfma_f32_16x16x32_bf16 a[28:31], v[52:55], v[76:79], 0
v_mfma_f32_16x16x32_bf16 a[32:35], v[56:59], v[72:75], 0
s_waitcnt lgkmcnt(8)
ds_read_b64_tr_b16 v[48:49], v22 offset:16384
ds_read_b64_tr_b16 v[50:51], v22 offset:17408
v_mfma_f32_16x16x32_bf16 a[36:39], v[56:59], v[76:79], 0
buffer_store_dwordx4 v[200:203], v3, s[12:15], s60 offen offset:2048 sc1
v_mfma_f32_16x16x32_bf16 a[40:43], v[60:63], v[72:75], 0
s_waitcnt lgkmcnt(8)
ds_read_b64_tr_b16 v[52:53], v23 offset:16384
ds_read_b64_tr_b16 v[54:55], v23 offset:17408
v_mfma_f32_16x16x32_bf16 a[44:47], v[60:63], v[76:79], 0
v_mfma_f32_16x16x32_bf16 a[48:51], v[64:67], v[72:75], 0
s_waitcnt lgkmcnt(8)
ds_read_b64_tr_b16 v[56:57], v24 offset:16384
ds_read_b64_tr_b16 v[58:59], v24 offset:17408
v_mfma_f32_16x16x32_bf16 a[52:55], v[64:67], v[76:79], 0
buffer_store_dwordx4 v[204:207], v3, s[12:15], s60 offen offset:3072 sc1
v_mfma_f32_16x16x32_bf16 a[56:59], v[68:71], v[72:75], 0
s_waitcnt lgkmcnt(8)
ds_read_b64_tr_b16 v[60:61], v25 offset:16384
ds_read_b64_tr_b16 v[62:63], v25 offset:17408
v_mfma_f32_16x16x32_bf16 a[60:63], v[68:71], v[76:79], 0
s_add_u32 s60, s60, s53
v_mfma_f32_16x16x32_bf16 a[64:67], v[40:43], v[72:75], 0
s_waitcnt lgkmcnt(8)
ds_read_b64_tr_b16 v[64:65], v26 offset:16384
ds_read_b64_tr_b16 v[66:67], v26 offset:17408
v_mfma_f32_16x16x32_bf16 a[68:71], v[40:43], v[76:79], 0
buffer_store_dwordx4 v[208:211], v3, s[12:15], s60 offen offset:0 sc1
v_mfma_f32_16x16x32_bf16 a[72:75], v[44:47], v[72:75], 0
s_waitcnt lgkmcnt(8)
ds_read_b64_tr_b16 v[68:69], v27 offset:16384
ds_read_b64_tr_b16 v[70:71], v27 offset:17408
v_mfma_f32_16x16x32_bf16 a[76:79], v[44:47], v[76:79], 0
v_mfma_f32_16x16x32_bf16 a[80:83], v[48:51], v[72:75], 0
s_waitcnt lgkmcnt(8)
ds_read_b64_tr_b16 v[40:41], v20 offset:8192
ds_read_b64_tr_b16 v[42:43], v20 offset:9216
v_mfma_f32_16x16x32_bf16 a[84:87], v[48:51], v[76:79], 0
buffer_store_dwordx4 v[212:215], v3, s[12:15], s60 offen offset:1024 sc1
v_mfma_f32_16x16x32_bf16 a[88:91], v[52:55], v[72:75], 0
s_waitcnt lgkmcnt(8)
ds_read_b64_tr_b16 v[44:45], v21 offset:8192
ds_read_b64_tr_b16 v[46:47], v21 offset:9216
v_mfma_f32_16x16x32_bf16 a[92:95], v[52:55], v[76:79], 0
v_mfma_f32_16x16x32_bf16 a[96:99], v[56:59], v[72:75], 0
s_waitcnt lgkmcnt(8)
ds_read_b64_tr_b16 v[48:49], v22 offset:8192
ds_read_b64_tr_b16 v[50:51], v22 offset:9216
v_mfma_f32_16x16x32_bf16 a[100:103], v[56:59], v[76:79], 0
buffer_store_dwordx4 v[216:219], v3, s[12:15], s60 offen offset:2048 sc1
v_mfma_f32_16x16x32_bf16 a[104:107], v[60:63], v[72:75], 0
s_waitcnt lgkmcnt(8)
ds_read_b64_tr_b16 v[52:53], v23 offset:8192
ds_read_b64_tr_b16 v[54:55], v23 offset:9216
v_mfma_f32_16x16x32_bf16 a[108:111], v[60:63], v[76:79], 0
v_mfma_f32_16x16x32_bf16 a[112:115], v[64:67], v[72:75], 0
s_waitcnt lgkmcnt(8)
ds_read_b64_tr_b16 v[56:57], v24 offset:8192
ds_read_b64_tr_b16 v[58:59], v24 offset:9216
v_mfma_f32_16x16x32_bf16 a[116:119], v[64:67], v[76:79], 0
buffer_store_dwordx4 v[220:223], v3, s[12:15], s60 offen offset:3072 sc1
v_mfma_f32_16x16x32_bf16 a[120:123], v[68:71], v[72:75], 0
s_waitcnt lgkmcnt(8)
ds_read_b64_tr_b16 v[60:61], v25 offset:8192
ds_read_b64_tr_b16 v[62:63], v25 offset:9216
v_mfma_f32_16x16x32_bf16 a[124:127], v[68:71], v[76:79], 0
s_add_u32 s60, s60, s52
v_mfma_f32_16x16x32_bf16 a[0:3], v[40:43], v[80:83], a[0:3]
s_waitcnt lgkmcnt(8)
ds_read_b64_tr_b16 v[64:65], v26 offset:8192
ds_read_b64_tr_b16 v[66:67], v26 offset:9216
v_mfma_f32_16x16x32_bf16 a[4:7], v[40:43], v[84:87], a[4:7]
buffer_store_dwordx4 v[224:227], v3, s[12:15], s60 offen offset:0 sc1
v_mfma_f32_16x16x32_bf16 a[8:11], v[44:47], v[80:83], a[8:11]
s_waitcnt lgkmcnt(8)
ds_read_b64_tr_b16 v[68:69], v27 offset:8192
ds_read_b64_tr_b16 v[70:71], v27 offset:9216
v_mfma_f32_16x16x32_bf16 a[12:15], v[44:47], v[84:87], a[12:15]
v_mfma_f32_16x16x32_bf16 a[16:19], v[48:51], v[80:83], a[16:19]
s_waitcnt lgkmcnt(8)
ds_read_b64_tr_b16 v[40:41], v20 offset:24576
ds_read_b64_tr_b16 v[42:43], v20 offset:25600
v_mfma_f32_16x16x32_bf16 a[20:23], v[48:51], v[84:87], a[20:23]
buffer_store_dwordx4 v[228:231], v3, s[12:15], s60 offen offset:1024 sc1
v_mfma_f32_16x16x32_bf16 a[24:27], v[52:55], v[80:83], a[24:27]
s_waitcnt lgkmcnt(8)
ds_read_b64_tr_b16 v[44:45], v21 offset:24576
ds_read_b64_tr_b16 v[46:47], v21 offset:25600
v_mfma_f32_16x16x32_bf16 a[28:31], v[52:55], v[84:87], a[28:31]
v_mfma_f32_16x16x32_bf16 a[32:35], v[56:59], v[80:83], a[32:35]
s_waitcnt lgkmcnt(8)
ds_read_b64_tr_b16 v[48:49], v22 offset:24576
ds_read_b64_tr_b16 v[50:51], v22 offset:25600
v_mfma_f32_16x16x32_bf16 a[36:39], v[56:59], v[84:87], a[36:39]
buffer_store_dwordx4 v[232:235], v3, s[12:15], s60 offen offset:2048 sc1
v_mfma_f32_16x16x32_bf16 a[40:43], v[60:63], v[80:83], a[40:43]
s_waitcnt lgkmcnt(8)
ds_read_b64_tr_b16 v[52:53], v23 offset:24576
ds_read_b64_tr_b16 v[54:55], v23 offset:25600
v_mfma_f32_16x16x32_bf16 a[44:47], v[60:63], v[84:87], a[44:47]
v_mfma_f32_16x16x32_bf16 a[48:51], v[64:67], v[80:83], a[48:51]
s_waitcnt lgkmcnt(8)
ds_read_b64_tr_b16 v[56:57], v24 offset:24576
ds_read_b64_tr_b16 v[58:59], v24 offset:25600
v_mfma_f32_16x16x32_bf16 a[52:55], v[64:67], v[84:87], a[52:55]
buffer_store_dwordx4 v[236:239], v3, s[12:15], s60 offen offset:3072 sc1
v_mfma_f32_16x16x32_bf16 a[56:59], v[68:71], v[80:83], a[56:59]
s_waitcnt lgkmcnt(8)
ds_read_b64_tr_b16 v[60:61], v25 offset:24576
ds_read_b64_tr_b16 v[62:63], v25 offset:25600
v_mfma_f32_16x16x32_bf16 a[60:63], v[68:71], v[84:87], a[60:63]
s_add_u32 s60, s60, s53
v_mfma_f32_16x16x32_bf16 a[64:67], v[40:43], v[80:83], a[64:67]
s_waitcnt lgkmcnt(8)
ds_read_b64_tr_b16 v[64:65], v26 offset:24576
ds_read_b64_tr_b16 v[66:67], v26 offset:25600
v_mfma_f32_16x16x32_bf16 a[68:71], v[40:43], v[84:87], a[68:71]
buffer_store_dwordx4 v[240:243], v3, s[12:15], s60 offen offset:0 sc1
v_mfma_f32_16x16x32_bf16 a[72:75], v[44:47], v[80:83], a[72:75]
s_waitcnt lgkmcnt(8)
ds_read_b64_tr_b16 v[68:69], v27 offset:24576
ds_read_b64_tr_b16 v[70:71], v27 offset:25600
v_mfma_f32_16x16x32_bf16 a[76:79], v[44:47], v[84:87], a[76:79]
v_mfma_f32_16x16x32_bf16 a[80:83], v[48:51], v[80:83], a[80:83]
s_waitcnt lgkmcnt(8)
ds_read_b64_tr_b16 v[40:41], v20 offset:32768
ds_read_b64_tr_b16 v[42:43], v20 offset:33792
v_mfma_f32_16x16x32_bf16 a[84:87], v[48:51], v[84:87], a[84:87]
buffer_store_dwordx4 v[244:247], v3, s[12:15], s60 offen offset:1024 sc1
v_mfma_f32_16x16x32_bf16 a[88:91], v[52:55], v[80:83], a[88:91]
s_waitcnt lgkmcnt(8)
ds_read_b64_tr_b16 v[44:45], v21 offset:32768
ds_read_b64_tr_b16 v[46:47], v21 offset:33792
v_mfma_f32_16x16x32_bf16 a[92:95], v[52:55], v[84:87], a[92:95]
v_mfma_f32_16x16x32_bf16 a[96:99], v[56:59], v[80:83], a[96:99]
s_waitcnt lgkmcnt(8)
ds_read_b64_tr_b16 v[48:49], v22 offset:32768
ds_read_b64_tr_b16 v[50:51], v22 offset:33792
v_mfma_f32_16x16x32_bf16 a[100:103], v[56:59], v[84:87], a[100:103]
buffer_store_dwordx4 v[248:251], v3, s[12:15], s60 offen offset:2048 sc1
v_mfma_f32_16x16x32_bf16 a[104:107], v[60:63], v[80:83], a[104:107]
s_waitcnt lgkmcnt(8)
ds_read_b64_tr_b16 v[52:53], v23 offset:32768
ds_read_b64_tr_b16 v[54:55], v23 offset:33792
v_mfma_f32_16x16x32_bf16 a[108:111], v[60:63], v[84:87], a[108:111]
v_mfma_f32_16x16x32_bf16 a[112:115], v[64:67], v[80:83], a[112:115]
s_waitcnt lgkmcnt(8)
ds_read_b64_tr_b16 v[56:57], v24 offset:32768
ds_read_b64_tr_b16 v[58:59], v24 offset:33792
v_mfma_f32_16x16x32_bf16 a[116:119], v[64:67], v[84:87], a[116:119]
buffer_store_dwordx4 v[252:255], v3, s[12:15], s60 offen offset:3072 sc1
v_mfma_f32_16x16x32_bf16 a[120:123], v[68:71], v[80:83], a[120:123]
s_waitcnt lgkmcnt(8)
ds_read_b64_tr_b16 v[60:61], v25 offset:32768
ds_read_b64_tr_b16 v[62:63], v25 offset:33792
v_mfma_f32_16x16x32_bf16 a[124:127], v[68:71], v[84:87], a[124:127]
s_waitcnt vmcnt(52)
s_barrier
s_waitcnt lgkmcnt(10)
v_mfma_f32_16x16x32_bf16 a[0:3], v[40:43], v[88:91], a[0:3]
s_waitcnt lgkmcnt(8)
ds_read_b64_tr_b16 v[64:65], v26 offset:32768
ds_read_b64_tr_b16 v[66:67], v26 offset:33792
v_mfma_f32_16x16x32_bf16 a[4:7], v[40:43], v[92:95], a[4:7]
s_add_u32 s60, s60, s52
s_add_u32 s47, s45, 2621440
s_add_u32 m0, s40, 0
v_mfma_f32_16x16x32_bf16 a[8:11], v[44:47], v[88:91], a[8:11]
s_waitcnt lgkmcnt(8)
ds_read_b64_tr_b16 v[68:69], v27 offset:32768
ds_read_b64_tr_b16 v[70:71], v27 offset:33792
v_mfma_f32_16x16x32_bf16 a[12:15], v[44:47], v[92:95], a[12:15]
buffer_load_dwordx4 v16, s[8:11], s47 offen offset:0 lds
v_mfma_f32_16x16x32_bf16 a[16:19], v[48:51], v[88:91], a[16:19]
s_waitcnt lgkmcnt(8)
ds_read_b64_tr_b16 v[40:41], v20 offset:49152
ds_read_b64_tr_b16 v[42:43], v20 offset:50176
v_mfma_f32_16x16x32_bf16 a[20:23], v[48:51], v[92:95], a[20:23]
buffer_load_dwordx4 v17, s[8:11], s47 offen offset:1024 lds
v_mfma_f32_16x16x32_bf16 a[24:27], v[52:55], v[88:91], a[24:27]
s_waitcnt lgkmcnt(8)
ds_read_b64_tr_b16 v[44:45], v21 offset:49152
ds_read_b64_tr_b16 v[46:47], v21 offset:50176
v_mfma_f32_16x16x32_bf16 a[28:31], v[52:55], v[92:95], a[28:31]
buffer_load_dwordx4 v18, s[8:11], s47 offen offset:2048 lds
v_mfma_f32_16x16x32_bf16 a[32:35], v[56:59], v[88:91], a[32:35]
s_waitcnt lgkmcnt(8)
ds_read_b64_tr_b16 v[48:49], v22 offset:49152
ds_read_b64_tr_b16 v[50:51], v22 offset:50176
v_mfma_f32_16x16x32_bf16 a[36:39], v[56:59], v[92:95], a[36:39]
buffer_load_dwordx4 v19, s[8:11], s47 offen offset:3072 lds
v_mfma_f32_16x16x32_bf16 a[40:43], v[60:63], v[88:91], a[40:43]
s_waitcnt lgkmcnt(8)
s_add_u32 s47, s45, 2621696
s_add_u32 m0, s40, 16384
ds_read_b64_tr_b16 v[52:53], v23 offset:49152
ds_read_b64_tr_b16 v[54:55], v23 offset:50176
v_mfma_f32_16x16x32_bf16 a[44:47], v[60:63], v[92:95], a[44:47]
buffer_load_dwordx4 v16, s[8:11], s47 offen offset:0 lds
v_mfma_f32_16x16x32_bf16 a[48:51], v[64:67], v[88:91], a[48:51]
s_waitcnt lgkmcnt(8)
ds_read_b64_tr_b16 v[56:57], v24 offset:49152
ds_read_b64_tr_b16 v[58:59], v24 offset:50176
v_mfma_f32_16x16x32_bf16 a[52:55], v[64:67], v[92:95], a[52:55]
v_mfma_f32_16x16x32_bf16 a[56:59], v[68:71], v[88:91], a[56:59]
s_waitcnt lgkmcnt(8)
ds_read_b64_tr_b16 v[60:61], v25 offset:49152
ds_read_b64_tr_b16 v[62:63], v25 offset:50176
v_mfma_f32_16x16x32_bf16 a[60:63], v[68:71], v[92:95], a[60:63]
buffer_load_dwordx4 v17, s[8:11], s47 offen offset:1024 lds
v_mfma_f32_16x16x32_bf16 a[64:67], v[40:43], v[88:91], a[64:67]
s_waitcnt lgkmcnt(8)
ds_read_b64_tr_b16 v[64:65], v26 offset:49152
ds_read_b64_tr_b16 v[66:67], v26 offset:50176
v_mfma_f32_16x16x32_bf16 a[68:71], v[40:43], v[92:95], a[68:71]
buffer_load_dwordx4 v18, s[8:11], s47 offen offset:2048 lds
v_mfma_f32_16x16x32_bf16 a[72:75], v[44:47], v[88:91], a[72:75]
s_waitcnt lgkmcnt(8)
ds_read_b64_tr_b16 v[68:69], v27 offset:49152
ds_read_b64_tr_b16 v[70:71], v27 offset:50176
v_mfma_f32_16x16x32_bf16 a[76:79], v[44:47], v[92:95], a[76:79]
buffer_load_dwordx4 v19, s[8:11], s47 offen offset:3072 lds
v_mfma_f32_16x16x32_bf16 a[80:83], v[48:51], v[88:91], a[80:83]
s_waitcnt lgkmcnt(8)
ds_read_b64_tr_b16 v[40:41], v20 offset:40960
ds_read_b64_tr_b16 v[42:43], v20 offset:41984
v_mfma_f32_16x16x32_bf16 a[84:87], v[48:51], v[92:95], a[84:87]
buffer_store_dwordx4 a[128:131], v3, s[12:15], s60 offen offset:0 sc1
v_mfma_f32_16x16x32_bf16 a[88:91], v[52:55], v[88:91], a[88:91]
s_waitcnt lgkmcnt(8)
ds_read_b64_tr_b16 v[44:45], v21 offset:40960
ds_read_b64_tr_b16 v[46:47], v21 offset:41984
v_mfma_f32_16x16x32_bf16 a[92:95], v[52:55], v[92:95], a[92:95]
buffer_store_dwordx4 a[132:135], v3, s[12:15], s60 offen offset:1024 sc1
v_mfma_f32_16x16x32_bf16 a[96:99], v[56:59], v[88:91], a[96:99]
s_waitcnt lgkmcnt(8)
ds_read_b64_tr_b16 v[48:49], v22 offset:40960
ds_read_b64_tr_b16 v[50:51], v22 offset:41984
v_mfma_f32_16x16x32_bf16 a[100:103], v[56:59], v[92:95], a[100:103]
v_mfma_f32_16x16x32_bf16 a[104:107], v[60:63], v[88:91], a[104:107]
s_waitcnt lgkmcnt(8)
ds_read_b64_tr_b16 v[52:53], v23 offset:40960
ds_read_b64_tr_b16 v[54:55], v23 offset:41984
v_mfma_f32_16x16x32_bf16 a[108:111], v[60:63], v[92:95], a[108:111]
buffer_store_dwordx4 a[136:139], v3, s[12:15], s60 offen offset:2048 sc1
v_mfma_f32_16x16x32_bf16 a[112:115], v[64:67], v[88:91], a[112:115]
s_waitcnt lgkmcnt(8)
ds_read_b64_tr_b16 v[56:57], v24 offset:40960
ds_read_b64_tr_b16 v[58:59], v24 offset:41984
v_mfma_f32_16x16x32_bf16 a[116:119], v[64:67], v[92:95], a[116:119]
buffer_store_dwordx4 a[140:143], v3, s[12:15], s60 offen offset:3072 sc1
v_mfma_f32_16x16x32_bf16 a[120:123], v[68:71], v[88:91], a[120:123]
s_waitcnt lgkmcnt(8)
s_add_u32 s60, s60, s53
ds_read_b64_tr_b16 v[60:61], v25 offset:40960
ds_read_b64_tr_b16 v[62:63], v25 offset:41984
v_mfma_f32_16x16x32_bf16 a[124:127], v[68:71], v[92:95], a[124:127]
buffer_store_dwordx4 a[144:147], v3, s[12:15], s60 offen offset:0 sc1
v_mfma_f32_16x16x32_bf16 a[0:3], v[40:43], v[96:99], a[0:3]
s_waitcnt lgkmcnt(8)
ds_read_b64_tr_b16 v[64:65], v26 offset:40960
ds_read_b64_tr_b16 v[66:67], v26 offset:41984
v_mfma_f32_16x16x32_bf16 a[4:7], v[40:43], v[100:103], a[4:7]
buffer_store_dwordx4 a[148:151], v3, s[12:15], s60 offen offset:1024 sc1
v_mfma_f32_16x16x32_bf16 a[8:11], v[44:47], v[96:99], a[8:11]
s_waitcnt lgkmcnt(8)
ds_read_b64_tr_b16 v[68:69], v27 offset:40960
ds_read_b64_tr_b16 v[70:71], v27 offset:41984
v_mfma_f32_16x16x32_bf16 a[12:15], v[44:47], v[100:103], a[12:15]
v_mfma_f32_16x16x32_bf16 a[16:19], v[48:51], v[96:99], a[16:19]
s_waitcnt lgkmcnt(8)
ds_read_b64_tr_b16 v[40:41], v20 offset:57344
ds_read_b64_tr_b16 v[42:43], v20 offset:58368
v_mfma_f32_16x16x32_bf16 a[20:23], v[48:51], v[100:103], a[20:23]
buffer_store_dwordx4 a[152:155], v3, s[12:15], s60 offen offset:2048 sc1
v_mfma_f32_16x16x32_bf16 a[24:27], v[52:55], v[96:99], a[24:27]
s_waitcnt lgkmcnt(8)
ds_read_b64_tr_b16 v[44:45], v21 offset:57344
ds_read_b64_tr_b16 v[46:47], v21 offset:58368
v_mfma_f32_16x16x32_bf16 a[28:31], v[52:55], v[100:103], a[28:31]
buffer_store_dwordx4 a[156:159], v3, s[12:15], s60 offen offset:3072 sc1
v_mfma_f32_16x16x32_bf16 a[32:35], v[56:59], v[96:99], a[32:35]
s_waitcnt lgkmcnt(8)
s_add_u32 s60, s60, s52
ds_read_b64_tr_b16 v[48:49], v22 offset:57344
ds_read_b64_tr_b16 v[50:51], v22 offset:58368
v_mfma_f32_16x16x32_bf16 a[36:39], v[56:59], v[100:103], a[36:39]
buffer_store_dwordx4 a[160:163], v3, s[12:15], s60 offen offset:0 sc1
v_mfma_f32_16x16x32_bf16 a[40:43], v[60:63], v[96:99], a[40:43]
s_waitcnt lgkmcnt(8)
ds_read_b64_tr_b16 v[52:53], v23 offset:57344
ds_read_b64_tr_b16 v[54:55], v23 offset:58368
v_mfma_f32_16x16x32_bf16 a[44:47], v[60:63], v[100:103], a[44:47]
buffer_store_dwordx4 a[164:167], v3, s[12:15], s60 offen offset:1024 sc1
v_mfma_f32_16x16x32_bf16 a[48:51], v[64:67], v[96:99], a[48:51]
s_waitcnt lgkmcnt(8)
ds_read_b64_tr_b16 v[56:57], v24 offset:57344
ds_read_b64_tr_b16 v[58:59], v24 offset:58368
v_mfma_f32_16x16x32_bf16 a[52:55], v[64:67], v[100:103], a[52:55]
buffer_store_dwordx4 a[168:171], v3, s[12:15], s60 offen offset:2048 sc1
v_mfma_f32_16x16x32_bf16 a[56:59], v[68:71], v[96:99], a[56:59]
s_waitcnt lgkmcnt(8)
ds_read_b64_tr_b16 v[60:61], v25 offset:57344
ds_read_b64_tr_b16 v[62:63], v25 offset:58368
v_mfma_f32_16x16x32_bf16 a[60:63], v[68:71], v[100:103], a[60:63]
v_mfma_f32_16x16x32_bf16 a[64:67], v[40:43], v[96:99], a[64:67]
s_waitcnt lgkmcnt(8)
ds_read_b64_tr_b16 v[64:65], v26 offset:57344
ds_read_b64_tr_b16 v[66:67], v26 offset:58368
v_mfma_f32_16x16x32_bf16 a[68:71], v[40:43], v[100:103], a[68:71]
buffer_store_dwordx4 a[172:175], v3, s[12:15], s60 offen offset:3072 sc1
v_mfma_f32_16x16x32_bf16 a[72:75], v[44:47], v[96:99], a[72:75]
s_waitcnt lgkmcnt(8)
ds_read_b64_tr_b16 v[68:69], v27 offset:57344
ds_read_b64_tr_b16 v[70:71], v27 offset:58368
v_mfma_f32_16x16x32_bf16 a[76:79], v[44:47], v[100:103], a[76:79]
v_add_u32 v20, 65536, v20
v_add_u32 v21, 65536, v21
v_add_u32 v22, 65536, v22
v_add_u32 v23, 65536, v23
v_add_u32 v24, 65536, v24
v_add_u32 v25, 65536, v25
v_add_u32 v26, 65536, v26
v_add_u32 v27, 65536, v27
v_mfma_f32_16x16x32_bf16 a[80:83], v[48:51], v[96:99], a[80:83]
s_waitcnt lgkmcnt(8)
s_add_u32 s60, s60, s53
ds_read_b64_tr_b16 v[40:41], v20 offset:0
ds_read_b64_tr_b16 v[42:43], v20 offset:1024
v_mfma_f32_16x16x32_bf16 a[84:87], v[48:51], v[100:103], a[84:87]
buffer_store_dwordx4 a[176:179], v3, s[12:15], s60 offen offset:0 sc1
v_mfma_f32_16x16x32_bf16 a[88:91], v[52:55], v[96:99], a[88:91]
s_waitcnt lgkmcnt(8)
ds_read_b64_tr_b16 v[44:45], v21 offset:0
ds_read_b64_tr_b16 v[46:47], v21 offset:1024
v_mfma_f32_16x16x32_bf16 a[92:95], v[52:55], v[100:103], a[92:95]
buffer_store_dwordx4 a[180:183], v3, s[12:15], s60 offen offset:1024 sc1
v_mfma_f32_16x16x32_bf16 a[96:99], v[56:59], v[96:99], a[96:99]
s_waitcnt lgkmcnt(8)
ds_read_b64_tr_b16 v[48:49], v22 offset:0
ds_read_b64_tr_b16 v[50:51], v22 offset:1024
v_mfma_f32_16x16x32_bf16 a[100:103], v[56:59], v[100:103], a[100:103]
buffer_store_dwordx4 a[184:187], v3, s[12:15], s60 offen offset:2048 sc1
v_mfma_f32_16x16x32_bf16 a[104:107], v[60:63], v[96:99], a[104:107]
s_waitcnt lgkmcnt(8)
ds_read_b64_tr_b16 v[52:53], v23 offset:0
ds_read_b64_tr_b16 v[54:55], v23 offset:1024
v_mfma_f32_16x16x32_bf16 a[108:111], v[60:63], v[100:103], a[108:111]
v_mfma_f32_16x16x32_bf16 a[112:115], v[64:67], v[96:99], a[112:115]
s_waitcnt lgkmcnt(8)
ds_read_b64_tr_b16 v[56:57], v24 offset:0
ds_read_b64_tr_b16 v[58:59], v24 offset:1024
v_mfma_f32_16x16x32_bf16 a[116:119], v[64:67], v[100:103], a[116:119]
buffer_store_dwordx4 a[188:191], v3, s[12:15], s60 offen offset:3072 sc1
v_mfma_f32_16x16x32_bf16 a[120:123], v[68:71], v[96:99], a[120:123]
s_waitcnt lgkmcnt(8)
ds_read_b64_tr_b16 v[60:61], v25 offset:0
ds_read_b64_tr_b16 v[62:63], v25 offset:1024
v_mfma_f32_16x16x32_bf16 a[124:127], v[68:71], v[100:103], a[124:127]
s_waitcnt vmcnt(63)
s_barrier
s_waitcnt lgkmcnt(10)
v_mfma_f32_16x16x32_bf16 a[0:3], v[40:43], v[104:107], a[0:3]
s_waitcnt lgkmcnt(8)
ds_read_b64_tr_b16 v[64:65], v26 offset:0
ds_read_b64_tr_b16 v[66:67], v26 offset:1024
v_mfma_f32_16x16x32_bf16 a[4:7], v[40:43], v[108:111], a[4:7]
s_add_u32 s47, s45, 3145728
s_add_u32 m0, s40, 32768
v_mfma_f32_16x16x32_bf16 a[8:11], v[44:47], v[104:107], a[8:11]
s_waitcnt lgkmcnt(8)
ds_read_b64_tr_b16 v[68:69], v27 offset:0
ds_read_b64_tr_b16 v[70:71], v27 offset:1024
v_mfma_f32_16x16x32_bf16 a[12:15], v[44:47], v[108:111], a[12:15]
buffer_load_dwordx4 v16, s[8:11], s47 offen offset:0 lds
v_mfma_f32_16x16x32_bf16 a[16:19], v[48:51], v[104:107], a[16:19]
s_waitcnt lgkmcnt(8)
ds_read_b64_tr_b16 v[40:41], v20 offset:16384
ds_read_b64_tr_b16 v[42:43], v20 offset:17408
v_mfma_f32_16x16x32_bf16 a[20:23], v[48:51], v[108:111], a[20:23]
v_mfma_f32_16x16x32_bf16 a[24:27], v[52:55], v[104:107], a[24:27]
s_waitcnt lgkmcnt(8)
ds_read_b64_tr_b16 v[44:45], v21 offset:16384
ds_read_b64_tr_b16 v[46:47], v21 offset:17408
v_mfma_f32_16x16x32_bf16 a[28:31], v[52:55], v[108:111], a[28:31]
v_mfma_f32_16x16x32_bf16 a[32:35], v[56:59], v[104:107], a[32:35]
s_waitcnt lgkmcnt(8)
ds_read_b64_tr_b16 v[48:49], v22 offset:16384
ds_read_b64_tr_b16 v[50:51], v22 offset:17408
v_mfma_f32_16x16x32_bf16 a[36:39], v[56:59], v[108:111], a[36:39]
v_mfma_f32_16x16x32_bf16 a[40:43], v[60:63], v[104:107], a[40:43]
s_waitcnt lgkmcnt(8)
ds_read_b64_tr_b16 v[52:53], v23 offset:16384
ds_read_b64_tr_b16 v[54:55], v23 offset:17408
v_mfma_f32_16x16x32_bf16 a[44:47], v[60:63], v[108:111], a[44:47]
buffer_load_dwordx4 v17, s[8:11], s47 offen offset:1024 lds
v_mfma_f32_16x16x32_bf16 a[48:51], v[64:67], v[104:107], a[48:51]
s_waitcnt lgkmcnt(8)
ds_read_b64_tr_b16 v[56:57], v24 offset:16384
ds_read_b64_tr_b16 v[58:59], v24 offset:17408
v_mfma_f32_16x16x32_bf16 a[52:55], v[64:67], v[108:111], a[52:55]
v_mfma_f32_16x16x32_bf16 a[56:59], v[68:71], v[104:107], a[56:59]
s_waitcnt lgkmcnt(8)
ds_read_b64_tr_b16 v[60:61], v25 offset:16384
ds_read_b64_tr_b16 v[62:63], v25 offset:17408
v_mfma_f32_16x16x32_bf16 a[60:63], v[68:71], v[108:111], a[60:63]
v_mfma_f32_16x16x32_bf16 a[64:67], v[40:43], v[104:107], a[64:67]
s_waitcnt lgkmcnt(8)
ds_read_b64_tr_b16 v[64:65], v26 offset:16384
ds_read_b64_tr_b16 v[66:67], v26 offset:17408
v_mfma_f32_16x16x32_bf16 a[68:71], v[40:43], v[108:111], a[68:71]
v_mfma_f32_16x16x32_bf16 a[72:75], v[44:47], v[104:107], a[72:75]
s_waitcnt lgkmcnt(8)
ds_read_b64_tr_b16 v[68:69], v27 offset:16384
ds_read_b64_tr_b16 v[70:71], v27 offset:17408
v_mfma_f32_16x16x32_bf16 a[76:79], v[44:47], v[108:111], a[76:79]
buffer_load_dwordx4 v18, s[8:11], s47 offen offset:2048 lds
v_mfma_f32_16x16x32_bf16 a[80:83], v[48:51], v[104:107], a[80:83]
s_waitcnt lgkmcnt(8)
ds_read_b64_tr_b16 v[40:41], v20 offset:8192
ds_read_b64_tr_b16 v[42:43], v20 offset:9216
v_mfma_f32_16x16x32_bf16 a[84:87], v[48:51], v[108:111], a[84:87]
v_mfma_f32_16x16x32_bf16 a[88:91], v[52:55], v[104:107], a[88:91]
s_waitcnt lgkmcnt(8)
ds_read_b64_tr_b16 v[44:45], v21 offset:8192
ds_read_b64_tr_b16 v[46:47], v21 offset:9216
v_mfma_f32_16x16x32_bf16 a[92:95], v[52:55], v[108:111], a[92:95]
v_mfma_f32_16x16x32_bf16 a[96:99], v[56:59], v[104:107], a[96:99]
s_waitcnt lgkmcnt(8)
ds_read_b64_tr_b16 v[48:49], v22 offset:8192
ds_read_b64_tr_b16 v[50:51], v22 offset:9216
v_mfma_f32_16x16x32_bf16 a[100:103], v[56:59], v[108:111], a[100:103]
v_mfma_f32_16x16x32_bf16 a[104:107], v[60:63], v[104:107], a[104:107]
s_waitcnt lgkmcnt(8)
ds_read_b64_tr_b16 v[52:53], v23 offset:8192
ds_read_b64_tr_b16 v[54:55], v23 offset:9216
v_mfma_f32_16x16x32_bf16 a[108:111], v[60:63], v[108:111], a[108:111]
buffer_load_dwordx4 v19, s[8:11], s47 offen offset:3072 lds
v_mfma_f32_16x16x32_bf16 a[112:115], v[64:67], v[104:107], a[112:115]
s_waitcnt lgkmcnt(8)
ds_read_b64_tr_b16 v[56:57], v24 offset:8192
ds_read_b64_tr_b16 v[58:59], v24 offset:9216
v_mfma_f32_16x16x32_bf16 a[116:119], v[64:67], v[108:111], a[116:119]
v_mfma_f32_16x16x32_bf16 a[120:123], v[68:71], v[104:107], a[120:123]
s_waitcnt lgkmcnt(8)
ds_read_b64_tr_b16 v[60:61], v25 offset:8192
ds_read_b64_tr_b16 v[62:63], v25 offset:9216
v_mfma_f32_16x16x32_bf16 a[124:127], v[68:71], v[108:111], a[124:127]
v_mfma_f32_16x16x32_bf16 a[0:3], v[40:43], v[112:115], a[0:3]
s_waitcnt lgkmcnt(8)
ds_read_b64_tr_b16 v[64:65], v26 offset:8192
ds_read_b64_tr_b16 v[66:67], v26 offset:9216
v_mfma_f32_16x16x32_bf16 a[4:7], v[40:43], v[116:119], a[4:7]
s_add_u32 s47, s45, 3145984
s_add_u32 m0, s40, 49152
v_mfma_f32_16x16x32_bf16 a[8:11], v[44:47], v[112:115], a[8:11]
s_waitcnt lgkmcnt(8)
ds_read_b64_tr_b16 v[68:69], v27 offset:8192
ds_read_b64_tr_b16 v[70:71], v27 offset:9216
v_mfma_f32_16x16x32_bf16 a[12:15], v[44:47], v[116:119], a[12:15]
buffer_load_dwordx4 v16, s[8:11], s47 offen offset:0 lds
v_mfma_f32_16x16x32_bf16 a[16:19], v[48:51], v[112:115], a[16:19]
s_waitcnt lgkmcnt(8)
ds_read_b64_tr_b16 v[40:41], v20 offset:24576
ds_read_b64_tr_b16 v[42:43], v20 offset:25600
v_mfma_f32_16x16x32_bf16 a[20:23], v[48:51], v[116:119], a[20:23]
v_mfma_f32_16x16x32_bf16 a[24:27], v[52:55], v[112:115], a[24:27]
s_waitcnt lgkmcnt(8)
ds_read_b64_tr_b16 v[44:45], v21 offset:24576
ds_read_b64_tr_b16 v[46:47], v21 offset:25600
v_mfma_f32_16x16x32_bf16 a[28:31], v[52:55], v[116:119], a[28:31]
v_mfma_f32_16x16x32_bf16 a[32:35], v[56:59], v[112:115], a[32:35]
s_waitcnt lgkmcnt(8)
ds_read_b64_tr_b16 v[48:49], v22 offset:24576
ds_read_b64_tr_b16 v[50:51], v22 offset:25600
v_mfma_f32_16x16x32_bf16 a[36:39], v[56:59], v[116:119], a[36:39]
v_mfma_f32_16x16x32_bf16 a[40:43], v[60:63], v[112:115], a[40:43]
s_waitcnt lgkmcnt(8)
ds_read_b64_tr_b16 v[52:53], v23 offset:24576
ds_read_b64_tr_b16 v[54:55], v23 offset:25600
v_mfma_f32_16x16x32_bf16 a[44:47], v[60:63], v[116:119], a[44:47]
buffer_load_dwordx4 v17, s[8:11], s47 offen offset:1024 lds
v_mfma_f32_16x16x32_bf16 a[48:51], v[64:67], v[112:115], a[48:51]
s_waitcnt lgkmcnt(8)
ds_read_b64_tr_b16 v[56:57], v24 offset:24576
ds_read_b64_tr_b16 v[58:59], v24 offset:25600
v_mfma_f32_16x16x32_bf16 a[52:55], v[64:67], v[116:119], a[52:55]
v_mfma_f32_16x16x32_bf16 a[56:59], v[68:71], v[112:115], a[56:59]
s_waitcnt lgkmcnt(8)
ds_read_b64_tr_b16 v[60:61], v25 offset:24576
ds_read_b64_tr_b16 v[62:63], v25 offset:25600
v_mfma_f32_16x16x32_bf16 a[60:63], v[68:71], v[116:119], a[60:63]
v_mfma_f32_16x16x32_bf16 a[64:67], v[40:43], v[112:115], a[64:67]
s_waitcnt lgkmcnt(8)
ds_read_b64_tr_b16 v[64:65], v26 offset:24576
ds_read_b64_tr_b16 v[66:67], v26 offset:25600
v_mfma_f32_16x16x32_bf16 a[68:71], v[40:43], v[116:119], a[68:71]
v_mfma_f32_16x16x32_bf16 a[72:75], v[44:47], v[112:115], a[72:75]
s_waitcnt lgkmcnt(8)
ds_read_b64_tr_b16 v[68:69], v27 offset:24576
ds_read_b64_tr_b16 v[70:71], v27 offset:25600
v_mfma_f32_16x16x32_bf16 a[76:79], v[44:47], v[116:119], a[76:79]
buffer_load_dwordx4 v18, s[8:11], s47 offen offset:2048 lds
v_mfma_f32_16x16x32_bf16 a[80:83], v[48:51], v[112:115], a[80:83]
s_waitcnt lgkmcnt(8)
ds_read_b64_tr_b16 v[40:41], v20 offset:32768
ds_read_b64_tr_b16 v[42:43], v20 offset:33792
v_mfma_f32_16x16x32_bf16 a[84:87], v[48:51], v[116:119], a[84:87]
v_mfma_f32_16x16x32_bf16 a[88:91], v[52:55], v[112:115], a[88:91]
s_waitcnt lgkmcnt(8)
ds_read_b64_tr_b16 v[44:45], v21 offset:32768
ds_read_b64_tr_b16 v[46:47], v21 offset:33792
v_mfma_f32_16x16x32_bf16 a[92:95], v[52:55], v[116:119], a[92:95]
v_mfma_f32_16x16x32_bf16 a[96:99], v[56:59], v[112:115], a[96:99]
s_waitcnt lgkmcnt(8)
ds_read_b64_tr_b16 v[48:49], v22 offset:32768
ds_read_b64_tr_b16 v[50:51], v22 offset:33792
v_mfma_f32_16x16x32_bf16 a[100:103], v[56:59], v[116:119], a[100:103]
v_mfma_f32_16x16x32_bf16 a[104:107], v[60:63], v[112:115], a[104:107]
s_waitcnt lgkmcnt(8)
ds_read_b64_tr_b16 v[52:53], v23 offset:32768
ds_read_b64_tr_b16 v[54:55], v23 offset:33792
v_mfma_f32_16x16x32_bf16 a[108:111], v[60:63], v[116:119], a[108:111]
v_mfma_f32_16x16x32_bf16 a[112:115], v[64:67], v[112:115], a[112:115]
s_waitcnt lgkmcnt(8)
ds_read_b64_tr_b16 v[56:57], v24 offset:32768
ds_read_b64_tr_b16 v[58:59], v24 offset:33792
v_mfma_f32_16x16x32_bf16 a[116:119], v[64:67], v[116:119], a[116:119]
buffer_load_dwordx4 v19, s[8:11], s47 offen offset:3072 lds
v_mfma_f32_16x16x32_bf16 a[120:123], v[68:71], v[112:115], a[120:123]
s_waitcnt lgkmcnt(8)
ds_read_b64_tr_b16 v[60:61], v25 offset:32768
ds_read_b64_tr_b16 v[62:63], v25 offset:33792
v_mfma_f32_16x16x32_bf16 a[124:127], v[68:71], v[116:119], a[124:127]
s_waitcnt vmcnt(60)
s_barrier
s_waitcnt lgkmcnt(10)
v_mfma_f32_16x16x32_bf16 a[0:3], v[40:43], v[120:123], a[0:3]
s_waitcnt lgkmcnt(8)
ds_read_b64_tr_b16 v[64:65], v26 offset:32768
ds_read_b64_tr_b16 v[66:67], v26 offset:33792
v_mfma_f32_16x16x32_bf16 a[4:7], v[40:43], v[124:127], a[4:7]
v_mfma_f32_16x16x32_bf16 a[8:11], v[44:47], v[120:123], a[8:11]
s_waitcnt lgkmcnt(8)
ds_read_b64_tr_b16 v[68:69], v27 offset:32768
ds_read_b64_tr_b16 v[70:71], v27 offset:33792
v_mfma_f32_16x16x32_bf16 a[12:15], v[44:47], v[124:127], a[12:15]
v_mfma_f32_16x16x32_bf16 a[16:19], v[48:51], v[120:123], a[16:19]
s_waitcnt lgkmcnt(8)
ds_read_b64_tr_b16 v[40:41], v20 offset:49152
ds_read_b64_tr_b16 v[42:43], v20 offset:50176
v_mfma_f32_16x16x32_bf16 a[20:23], v[48:51], v[124:127], a[20:23]
v_mfma_f32_16x16x32_bf16 a[24:27], v[52:55], v[120:123], a[24:27]
s_waitcnt lgkmcnt(8)
ds_read_b64_tr_b16 v[44:45], v21 offset:49152
ds_read_b64_tr_b16 v[46:47], v21 offset:50176
v_mfma_f32_16x16x32_bf16 a[28:31], v[52:55], v[124:127], a[28:31]
v_mfma_f32_16x16x32_bf16 a[32:35], v[56:59], v[120:123], a[32:35]
s_waitcnt lgkmcnt(8)
ds_read_b64_tr_b16 v[48:49], v22 offset:49152
ds_read_b64_tr_b16 v[50:51], v22 offset:50176
v_mfma_f32_16x16x32_bf16 a[36:39], v[56:59], v[124:127], a[36:39]
v_mfma_f32_16x16x32_bf16 a[40:43], v[60:63], v[120:123], a[40:43]
s_waitcnt lgkmcnt(8)
ds_read_b64_tr_b16 v[52:53], v23 offset:49152
ds_read_b64_tr_b16 v[54:55], v23 offset:50176
v_mfma_f32_16x16x32_bf16 a[44:47], v[60:63], v[124:127], a[44:47]
v_mfma_f32_16x16x32_bf16 a[48:51], v[64:67], v[120:123], a[48:51]
s_waitcnt lgkmcnt(8)
ds_read_b64_tr_b16 v[56:57], v24 offset:49152
ds_read_b64_tr_b16 v[58:59], v24 offset:50176
v_mfma_f32_16x16x32_bf16 a[52:55], v[64:67], v[124:127], a[52:55]
v_mfma_f32_16x16x32_bf16 a[56:59], v[68:71], v[120:123], a[56:59]
s_waitcnt lgkmcnt(8)
ds_read_b64_tr_b16 v[60:61], v25 offset:49152
ds_read_b64_tr_b16 v[62:63], v25 offset:50176
v_mfma_f32_16x16x32_bf16 a[60:63], v[68:71], v[124:127], a[60:63]
v_mfma_f32_16x16x32_bf16 a[64:67], v[40:43], v[120:123], a[64:67]
s_waitcnt lgkmcnt(8)
ds_read_b64_tr_b16 v[64:65], v26 offset:49152
ds_read_b64_tr_b16 v[66:67], v26 offset:50176
v_mfma_f32_16x16x32_bf16 a[68:71], v[40:43], v[124:127], a[68:71]
v_mfma_f32_16x16x32_bf16 a[72:75], v[44:47], v[120:123], a[72:75]
s_waitcnt lgkmcnt(8)
ds_read_b64_tr_b16 v[68:69], v27 offset:49152
ds_read_b64_tr_b16 v[70:71], v27 offset:50176
v_mfma_f32_16x16x32_bf16 a[76:79], v[44:47], v[124:127], a[76:79]
v_mfma_f32_16x16x32_bf16 a[80:83], v[48:51], v[120:123], a[80:83]
s_waitcnt lgkmcnt(8)
ds_read_b64_tr_b16 v[40:41], v20 offset:40960
ds_read_b64_tr_b16 v[42:43], v20 offset:41984
v_mfma_f32_16x16x32_bf16 a[84:87], v[48:51], v[124:127], a[84:87]
v_mfma_f32_16x16x32_bf16 a[88:91], v[52:55], v[120:123], a[88:91]
s_waitcnt lgkmcnt(8)
ds_read_b64_tr_b16 v[44:45], v21 offset:40960
ds_read_b64_tr_b16 v[46:47], v21 offset:41984
v_mfma_f32_16x16x32_bf16 a[92:95], v[52:55], v[124:127], a[92:95]
v_mfma_f32_16x16x32_bf16 a[96:99], v[56:59], v[120:123], a[96:99]
s_waitcnt lgkmcnt(8)
ds_read_b64_tr_b16 v[48:49], v22 offset:40960
ds_read_b64_tr_b16 v[50:51], v22 offset:41984
v_mfma_f32_16x16x32_bf16 a[100:103], v[56:59], v[124:127], a[100:103]
v_mfma_f32_16x16x32_bf16 a[104:107], v[60:63], v[120:123], a[104:107]
s_waitcnt lgkmcnt(8)
ds_read_b64_tr_b16 v[52:53], v23 offset:40960
ds_read_b64_tr_b16 v[54:55], v23 offset:41984
v_mfma_f32_16x16x32_bf16 a[108:111], v[60:63], v[124:127], a[108:111]
v_mfma_f32_16x16x32_bf16 a[112:115], v[64:67], v[120:123], a[112:115]
s_waitcnt lgkmcnt(8)
ds_read_b64_tr_b16 v[56:57], v24 offset:40960
ds_read_b64_tr_b16 v[58:59], v24 offset:41984
v_mfma_f32_16x16x32_bf16 a[116:119], v[64:67], v[124:127], a[116:119]
v_mfma_f32_16x16x32_bf16 a[120:123], v[68:71], v[120:123], a[120:123]
s_waitcnt lgkmcnt(8)
ds_read_b64_tr_b16 v[60:61], v25 offset:40960
ds_read_b64_tr_b16 v[62:63], v25 offset:41984
v_mfma_f32_16x16x32_bf16 a[124:127], v[68:71], v[124:127], a[124:127]
v_mfma_f32_16x16x32_bf16 a[0:3], v[40:43], v[128:131], a[0:3]
s_waitcnt lgkmcnt(8)
ds_read_b64_tr_b16 v[64:65], v26 offset:40960
ds_read_b64_tr_b16 v[66:67], v26 offset:41984
v_mfma_f32_16x16x32_bf16 a[4:7], v[40:43], v[132:135], a[4:7]
v_mfma_f32_16x16x32_bf16 a[8:11], v[44:47], v[128:131], a[8:11]
s_waitcnt lgkmcnt(8)
ds_read_b64_tr_b16 v[68:69], v27 offset:40960
ds_read_b64_tr_b16 v[70:71], v27 offset:41984
v_mfma_f32_16x16x32_bf16 a[12:15], v[44:47], v[132:135], a[12:15]
v_mfma_f32_16x16x32_bf16 a[16:19], v[48:51], v[128:131], a[16:19]
s_waitcnt lgkmcnt(8)
ds_read_b64_tr_b16 v[40:41], v20 offset:57344
ds_read_b64_tr_b16 v[42:43], v20 offset:58368
v_mfma_f32_16x16x32_bf16 a[20:23], v[48:51], v[132:135], a[20:23]
v_mfma_f32_16x16x32_bf16 a[24:27], v[52:55], v[128:131], a[24:27]
s_waitcnt lgkmcnt(8)
ds_read_b64_tr_b16 v[44:45], v21 offset:57344
ds_read_b64_tr_b16 v[46:47], v21 offset:58368
v_mfma_f32_16x16x32_bf16 a[28:31], v[52:55], v[132:135], a[28:31]
v_mfma_f32_16x16x32_bf16 a[32:35], v[56:59], v[128:131], a[32:35]
s_waitcnt lgkmcnt(8)
ds_read_b64_tr_b16 v[48:49], v22 offset:57344
ds_read_b64_tr_b16 v[50:51], v22 offset:58368
v_mfma_f32_16x16x32_bf16 a[36:39], v[56:59], v[132:135], a[36:39]
v_mfma_f32_16x16x32_bf16 a[40:43], v[60:63], v[128:131], a[40:43]
s_waitcnt lgkmcnt(8)
ds_read_b64_tr_b16 v[52:53], v23 offset:57344
ds_read_b64_tr_b16 v[54:55], v23 offset:58368
v_mfma_f32_16x16x32_bf16 a[44:47], v[60:63], v[132:135], a[44:47]
v_mfma_f32_16x16x32_bf16 a[48:51], v[64:67], v[128:131], a[48:51]
s_waitcnt lgkmcnt(8)
ds_read_b64_tr_b16 v[56:57], v24 offset:57344
ds_read_b64_tr_b16 v[58:59], v24 offset:58368
v_mfma_f32_16x16x32_bf16 a[52:55], v[64:67], v[132:135], a[52:55]
v_mfma_f32_16x16x32_bf16 a[56:59], v[68:71], v[128:131], a[56:59]
s_waitcnt lgkmcnt(8)
ds_read_b64_tr_b16 v[60:61], v25 offset:57344
ds_read_b64_tr_b16 v[62:63], v25 offset:58368
v_mfma_f32_16x16x32_bf16 a[60:63], v[68:71], v[132:135], a[60:63]
v_mfma_f32_16x16x32_bf16 a[64:67], v[40:43], v[128:131], a[64:67]
s_waitcnt lgkmcnt(8)
ds_read_b64_tr_b16 v[64:65], v26 offset:57344
ds_read_b64_tr_b16 v[66:67], v26 offset:58368
v_mfma_f32_16x16x32_bf16 a[68:71], v[40:43], v[132:135], a[68:71]
v_mfma_f32_16x16x32_bf16 a[72:75], v[44:47], v[128:131], a[72:75]
s_waitcnt lgkmcnt(8)
ds_read_b64_tr_b16 v[68:69], v27 offset:57344
ds_read_b64_tr_b16 v[70:71], v27 offset:58368
v_mfma_f32_16x16x32_bf16 a[76:79], v[44:47], v[132:135], a[76:79]
v_add_u32 v20, 65536, v20
v_add_u32 v21, 65536, v21
v_add_u32 v22, 65536, v22
v_add_u32 v23, 65536, v23
v_add_u32 v24, 65536, v24
v_add_u32 v25, 65536, v25
v_add_u32 v26, 65536, v26
v_add_u32 v27, 65536, v27
v_mfma_f32_16x16x32_bf16 a[80:83], v[48:51], v[128:131], a[80:83]
s_waitcnt lgkmcnt(8)
ds_read_b64_tr_b16 v[40:41], v20 offset:0
ds_read_b64_tr_b16 v[42:43], v20 offset:1024
v_mfma_f32_16x16x32_bf16 a[84:87], v[48:51], v[132:135], a[84:87]
v_mfma_f32_16x16x32_bf16 a[88:91], v[52:55], v[128:131], a[88:91]
s_waitcnt lgkmcnt(8)
ds_read_b64_tr_b16 v[44:45], v21 offset:0
ds_read_b64_tr_b16 v[46:47], v21 offset:1024
v_mfma_f32_16x16x32_bf16 a[92:95], v[52:55], v[132:135], a[92:95]
v_mfma_f32_16x16x32_bf16 a[96:99], v[56:59], v[128:131], a[96:99]
s_waitcnt lgkmcnt(8)
ds_read_b64_tr_b16 v[48:49], v22 offset:0
ds_read_b64_tr_b16 v[50:51], v22 offset:1024
v_mfma_f32_16x16x32_bf16 a[100:103], v[56:59], v[132:135], a[100:103]
v_mfma_f32_16x16x32_bf16 a[104:107], v[60:63], v[128:131], a[104:107]
s_waitcnt lgkmcnt(8)
ds_read_b64_tr_b16 v[52:53], v23 offset:0
ds_read_b64_tr_b16 v[54:55], v23 offset:1024
v_mfma_f32_16x16x32_bf16 a[108:111], v[60:63], v[132:135], a[108:111]
v_mfma_f32_16x16x32_bf16 a[112:115], v[64:67], v[128:131], a[112:115]
s_waitcnt lgkmcnt(8)
ds_read_b64_tr_b16 v[56:57], v24 offset:0
ds_read_b64_tr_b16 v[58:59], v24 offset:1024
v_mfma_f32_16x16x32_bf16 a[116:119], v[64:67], v[132:135], a[116:119]
v_mfma_f32_16x16x32_bf16 a[120:123], v[68:71], v[128:131], a[120:123]
s_waitcnt lgkmcnt(8)
ds_read_b64_tr_b16 v[60:61], v25 offset:0
ds_read_b64_tr_b16 v[62:63], v25 offset:1024
v_mfma_f32_16x16x32_bf16 a[124:127], v[68:71], v[132:135], a[124:127]
s_waitcnt vmcnt(24)
s_barrier
s_waitcnt lgkmcnt(10)
v_mfma_f32_16x16x32_bf16 a[0:3], v[40:43], v[136:139], a[0:3]
s_waitcnt lgkmcnt(8)
ds_read_b64_tr_b16 v[64:65], v26 offset:0
ds_read_b64_tr_b16 v[66:67], v26 offset:1024
v_mfma_f32_16x16x32_bf16 a[4:7], v[40:43], v[140:143], a[4:7]
v_mfma_f32_16x16x32_bf16 a[8:11], v[44:47], v[136:139], a[8:11]
s_waitcnt lgkmcnt(8)
ds_read_b64_tr_b16 v[68:69], v27 offset:0
ds_read_b64_tr_b16 v[70:71], v27 offset:1024
v_mfma_f32_16x16x32_bf16 a[12:15], v[44:47], v[140:143], a[12:15]
v_mfma_f32_16x16x32_bf16 a[16:19], v[48:51], v[136:139], a[16:19]
s_waitcnt lgkmcnt(8)
ds_read_b64_tr_b16 v[40:41], v20 offset:16384
ds_read_b64_tr_b16 v[42:43], v20 offset:17408
v_mfma_f32_16x16x32_bf16 a[20:23], v[48:51], v[140:143], a[20:23]
v_mfma_f32_16x16x32_bf16 a[24:27], v[52:55], v[136:139], a[24:27]
s_waitcnt lgkmcnt(8)
ds_read_b64_tr_b16 v[44:45], v21 offset:16384
ds_read_b64_tr_b16 v[46:47], v21 offset:17408
v_mfma_f32_16x16x32_bf16 a[28:31], v[52:55], v[140:143], a[28:31]
v_mfma_f32_16x16x32_bf16 a[32:35], v[56:59], v[136:139], a[32:35]
s_waitcnt lgkmcnt(8)
ds_read_b64_tr_b16 v[48:49], v22 offset:16384
ds_read_b64_tr_b16 v[50:51], v22 offset:17408
v_mfma_f32_16x16x32_bf16 a[36:39], v[56:59], v[140:143], a[36:39]
v_mfma_f32_16x16x32_bf16 a[40:43], v[60:63], v[136:139], a[40:43]
s_waitcnt lgkmcnt(8)
ds_read_b64_tr_b16 v[52:53], v23 offset:16384
ds_read_b64_tr_b16 v[54:55], v23 offset:17408
v_mfma_f32_16x16x32_bf16 a[44:47], v[60:63], v[140:143], a[44:47]
v_mfma_f32_16x16x32_bf16 a[48:51], v[64:67], v[136:139], a[48:51]
s_waitcnt lgkmcnt(8)
ds_read_b64_tr_b16 v[56:57], v24 offset:16384
ds_read_b64_tr_b16 v[58:59], v24 offset:17408
v_mfma_f32_16x16x32_bf16 a[52:55], v[64:67], v[140:143], a[52:55]
v_mfma_f32_16x16x32_bf16 a[56:59], v[68:71], v[136:139], a[56:59]
s_waitcnt lgkmcnt(8)
ds_read_b64_tr_b16 v[60:61], v25 offset:16384
ds_read_b64_tr_b16 v[62:63], v25 offset:17408
v_mfma_f32_16x16x32_bf16 a[60:63], v[68:71], v[140:143], a[60:63]
v_mfma_f32_16x16x32_bf16 a[64:67], v[40:43], v[136:139], a[64:67]
s_waitcnt lgkmcnt(8)
ds_read_b64_tr_b16 v[64:65], v26 offset:16384
ds_read_b64_tr_b16 v[66:67], v26 offset:17408
v_mfma_f32_16x16x32_bf16 a[68:71], v[40:43], v[140:143], a[68:71]
v_mfma_f32_16x16x32_bf16 a[72:75], v[44:47], v[136:139], a[72:75]
s_waitcnt lgkmcnt(8)
ds_read_b64_tr_b16 v[68:69], v27 offset:16384
ds_read_b64_tr_b16 v[70:71], v27 offset:17408
v_mfma_f32_16x16x32_bf16 a[76:79], v[44:47], v[140:143], a[76:79]
v_mfma_f32_16x16x32_bf16 a[80:83], v[48:51], v[136:139], a[80:83]
s_waitcnt lgkmcnt(8)
ds_read_b64_tr_b16 v[40:41], v20 offset:8192
ds_read_b64_tr_b16 v[42:43], v20 offset:9216
v_mfma_f32_16x16x32_bf16 a[84:87], v[48:51], v[140:143], a[84:87]
v_mfma_f32_16x16x32_bf16 a[88:91], v[52:55], v[136:139], a[88:91]
s_waitcnt lgkmcnt(8)
ds_read_b64_tr_b16 v[44:45], v21 offset:8192
ds_read_b64_tr_b16 v[46:47], v21 offset:9216
v_mfma_f32_16x16x32_bf16 a[92:95], v[52:55], v[140:143], a[92:95]
v_mfma_f32_16x16x32_bf16 a[96:99], v[56:59], v[136:139], a[96:99]
s_waitcnt lgkmcnt(8)
ds_read_b64_tr_b16 v[48:49], v22 offset:8192
ds_read_b64_tr_b16 v[50:51], v22 offset:9216
v_mfma_f32_16x16x32_bf16 a[100:103], v[56:59], v[140:143], a[100:103]
v_mfma_f32_16x16x32_bf16 a[104:107], v[60:63], v[136:139], a[104:107]
s_waitcnt lgkmcnt(8)
ds_read_b64_tr_b16 v[52:53], v23 offset:8192
ds_read_b64_tr_b16 v[54:55], v23 offset:9216
v_mfma_f32_16x16x32_bf16 a[108:111], v[60:63], v[140:143], a[108:111]
v_mfma_f32_16x16x32_bf16 a[112:115], v[64:67], v[136:139], a[112:115]
s_waitcnt lgkmcnt(8)
ds_read_b64_tr_b16 v[56:57], v24 offset:8192
ds_read_b64_tr_b16 v[58:59], v24 offset:9216
v_mfma_f32_16x16x32_bf16 a[116:119], v[64:67], v[140:143], a[116:119]
v_mfma_f32_16x16x32_bf16 a[120:123], v[68:71], v[136:139], a[120:123]
s_waitcnt lgkmcnt(8)
ds_read_b64_tr_b16 v[60:61], v25 offset:8192
ds_read_b64_tr_b16 v[62:63], v25 offset:9216
v_mfma_f32_16x16x32_bf16 a[124:127], v[68:71], v[140:143], a[124:127]
v_mfma_f32_16x16x32_bf16 a[0:3], v[40:43], v[144:147], a[0:3]
s_waitcnt lgkmcnt(8)
ds_read_b64_tr_b16 v[64:65], v26 offset:8192
ds_read_b64_tr_b16 v[66:67], v26 offset:9216
v_mfma_f32_16x16x32_bf16 a[4:7], v[40:43], v[148:151], a[4:7]
v_mfma_f32_16x16x32_bf16 a[8:11], v[44:47], v[144:147], a[8:11]
s_waitcnt lgkmcnt(8)
ds_read_b64_tr_b16 v[68:69], v27 offset:8192
ds_read_b64_tr_b16 v[70:71], v27 offset:9216
v_mfma_f32_16x16x32_bf16 a[12:15], v[44:47], v[148:151], a[12:15]
v_mfma_f32_16x16x32_bf16 a[16:19], v[48:51], v[144:147], a[16:19]
s_waitcnt lgkmcnt(8)
ds_read_b64_tr_b16 v[40:41], v20 offset:24576
ds_read_b64_tr_b16 v[42:43], v20 offset:25600
v_mfma_f32_16x16x32_bf16 a[20:23], v[48:51], v[148:151], a[20:23]
v_mfma_f32_16x16x32_bf16 a[24:27], v[52:55], v[144:147], a[24:27]
s_waitcnt lgkmcnt(8)
ds_read_b64_tr_b16 v[44:45], v21 offset:24576
ds_read_b64_tr_b16 v[46:47], v21 offset:25600
v_mfma_f32_16x16x32_bf16 a[28:31], v[52:55], v[148:151], a[28:31]
v_mfma_f32_16x16x32_bf16 a[32:35], v[56:59], v[144:147], a[32:35]
s_waitcnt lgkmcnt(8)
ds_read_b64_tr_b16 v[48:49], v22 offset:24576
ds_read_b64_tr_b16 v[50:51], v22 offset:25600
v_mfma_f32_16x16x32_bf16 a[36:39], v[56:59], v[148:151], a[36:39]
v_mfma_f32_16x16x32_bf16 a[40:43], v[60:63], v[144:147], a[40:43]
s_waitcnt lgkmcnt(8)
ds_read_b64_tr_b16 v[52:53], v23 offset:24576
ds_read_b64_tr_b16 v[54:55], v23 offset:25600
v_mfma_f32_16x16x32_bf16 a[44:47], v[60:63], v[148:151], a[44:47]
v_mfma_f32_16x16x32_bf16 a[48:51], v[64:67], v[144:147], a[48:51]
s_waitcnt lgkmcnt(8)
ds_read_b64_tr_b16 v[56:57], v24 offset:24576
ds_read_b64_tr_b16 v[58:59], v24 offset:25600
v_mfma_f32_16x16x32_bf16 a[52:55], v[64:67], v[148:151], a[52:55]
v_mfma_f32_16x16x32_bf16 a[56:59], v[68:71], v[144:147], a[56:59]
s_waitcnt lgkmcnt(8)
ds_read_b64_tr_b16 v[60:61], v25 offset:24576
ds_read_b64_tr_b16 v[62:63], v25 offset:25600
v_mfma_f32_16x16x32_bf16 a[60:63], v[68:71], v[148:151], a[60:63]
v_mfma_f32_16x16x32_bf16 a[64:67], v[40:43], v[144:147], a[64:67]
s_waitcnt lgkmcnt(8)
ds_read_b64_tr_b16 v[64:65], v26 offset:24576
ds_read_b64_tr_b16 v[66:67], v26 offset:25600
v_mfma_f32_16x16x32_bf16 a[68:71], v[40:43], v[148:151], a[68:71]
v_mfma_f32_16x16x32_bf16 a[72:75], v[44:47], v[144:147], a[72:75]
s_waitcnt lgkmcnt(8)
ds_read_b64_tr_b16 v[68:69], v27 offset:24576
ds_read_b64_tr_b16 v[70:71], v27 offset:25600
v_mfma_f32_16x16x32_bf16 a[76:79], v[44:47], v[148:151], a[76:79]
v_add_u32 v20, 4294836224, v20
v_add_u32 v21, 4294836224, v21
v_add_u32 v22, 4294836224, v22
v_add_u32 v23, 4294836224, v23
v_add_u32 v24, 4294836224, v24
v_add_u32 v25, 4294836224, v25
v_add_u32 v26, 4294836224, v26
v_add_u32 v27, 4294836224, v27
v_mfma_f32_16x16x32_bf16 a[80:83], v[48:51], v[144:147], a[80:83]
s_waitcnt lgkmcnt(8)
ds_read_b64_tr_b16 v[40:41], v20 offset:0
ds_read_b64_tr_b16 v[42:43], v20 offset:1024
v_mfma_f32_16x16x32_bf16 a[84:87], v[48:51], v[148:151], a[84:87]
v_mfma_f32_16x16x32_bf16 a[88:91], v[52:55], v[144:147], a[88:91]
s_waitcnt lgkmcnt(8)
ds_read_b64_tr_b16 v[44:45], v21 offset:0
ds_read_b64_tr_b16 v[46:47], v21 offset:1024
v_mfma_f32_16x16x32_bf16 a[92:95], v[52:55], v[148:151], a[92:95]
v_mfma_f32_16x16x32_bf16 a[96:99], v[56:59], v[144:147], a[96:99]
s_waitcnt lgkmcnt(8)
ds_read_b64_tr_b16 v[48:49], v22 offset:0
ds_read_b64_tr_b16 v[50:51], v22 offset:1024
v_mfma_f32_16x16x32_bf16 a[100:103], v[56:59], v[148:151], a[100:103]
v_mfma_f32_16x16x32_bf16 a[104:107], v[60:63], v[144:147], a[104:107]
s_waitcnt lgkmcnt(8)
ds_read_b64_tr_b16 v[52:53], v23 offset:0
ds_read_b64_tr_b16 v[54:55], v23 offset:1024
v_mfma_f32_16x16x32_bf16 a[108:111], v[60:63], v[148:151], a[108:111]
v_mfma_f32_16x16x32_bf16 a[112:115], v[64:67], v[144:147], a[112:115]
s_waitcnt lgkmcnt(8)
ds_read_b64_tr_b16 v[56:57], v24 offset:0
ds_read_b64_tr_b16 v[58:59], v24 offset:1024
v_mfma_f32_16x16x32_bf16 a[116:119], v[64:67], v[148:151], a[116:119]
v_mfma_f32_16x16x32_bf16 a[120:123], v[68:71], v[144:147], a[120:123]
s_waitcnt lgkmcnt(8)
ds_read_b64_tr_b16 v[60:61], v25 offset:0
ds_read_b64_tr_b16 v[62:63], v25 offset:1024
v_mfma_f32_16x16x32_bf16 a[124:127], v[68:71], v[148:151], a[124:127]
s_waitcnt vmcnt(0)
s_barrier
s_lshl_b32 s33, s31, 8
s_add_u32 s33, s33, 81920
s_cmp_eq_u32 s30, 0
s_cbranch_scc0 AR_3921
v_mov_b32 v9, s33
v_mov_b32 v10, 1
v_cmp_eq_u32 s[78:79], 0, v2
s_and_saveexec_b64 s[76:77], s[78:79]
s_cbranch_execz AR_3921X
buffer_atomic_add v10, v9, s[72:75], 0 offen
AR_3921X:
s_mov_b64 exec, s[76:77]
AR_3921:
s_waitcnt lgkmcnt(10)
v_mfma_f32_16x16x32_bf16 a[0:3], v[40:43], v[152:155], a[0:3]
s_waitcnt lgkmcnt(8)
ds_read_b64_tr_b16 v[64:65], v26 offset:0
ds_read_b64_tr_b16 v[66:67], v26 offset:1024
v_mfma_f32_16x16x32_bf16 a[4:7], v[40:43], v[156:159], a[4:7]
v_mfma_f32_16x16x32_bf16 a[8:11], v[44:47], v[152:155], a[8:11]
s_waitcnt lgkmcnt(8)
ds_read_b64_tr_b16 v[68:69], v27 offset:0
ds_read_b64_tr_b16 v[70:71], v27 offset:1024
v_mfma_f32_16x16x32_bf16 a[12:15], v[44:47], v[156:159], a[12:15]
v_mfma_f32_16x16x32_bf16 a[16:19], v[48:51], v[152:155], a[16:19]
s_waitcnt lgkmcnt(8)
ds_read_b64_tr_b16 v[40:41], v20 offset:16384
ds_read_b64_tr_b16 v[42:43], v20 offset:17408
v_mfma_f32_16x16x32_bf16 a[20:23], v[48:51], v[156:159], a[20:23]
v_mfma_f32_16x16x32_bf16 a[24:27], v[52:55], v[152:155], a[24:27]
s_waitcnt lgkmcnt(8)
ds_read_b64_tr_b16 v[44:45], v21 offset:16384
ds_read_b64_tr_b16 v[46:47], v21 offset:17408
v_mfma_f32_16x16x32_bf16 a[28:31], v[52:55], v[156:159], a[28:31]
v_mfma_f32_16x16x32_bf16 a[32:35], v[56:59], v[152:155], a[32:35]
s_waitcnt lgkmcnt(8)
ds_read_b64_tr_b16 v[48:49], v22 offset:16384
ds_read_b64_tr_b16 v[50:51], v22 offset:17408
v_mfma_f32_16x16x32_bf16 a[36:39], v[56:59], v[156:159], a[36:39]
v_mfma_f32_16x16x32_bf16 a[40:43], v[60:63], v[152:155], a[40:43]
s_waitcnt lgkmcnt(8)
ds_read_b64_tr_b16 v[52:53], v23 offset:16384
ds_read_b64_tr_b16 v[54:55], v23 offset:17408
v_mfma_f32_16x16x32_bf16 a[44:47], v[60:63], v[156:159], a[44:47]
v_mfma_f32_16x16x32_bf16 a[48:51], v[64:67], v[152:155], a[48:51]
s_waitcnt lgkmcnt(8)
ds_read_b64_tr_b16 v[56:57], v24 offset:16384
ds_read_b64_tr_b16 v[58:59], v24 offset:17408
v_mfma_f32_16x16x32_bf16 a[52:55], v[64:67], v[156:159], a[52:55]
v_mfma_f32_16x16x32_bf16 a[56:59], v[68:71], v[152:155], a[56:59]
s_waitcnt lgkmcnt(8)
ds_read_b64_tr_b16 v[60:61], v25 offset:16384
ds_read_b64_tr_b16 v[62:63], v25 offset:17408
v_mfma_f32_16x16x32_bf16 a[60:63], v[68:71], v[156:159], a[60:63]
v_mfma_f32_16x16x32_bf16 a[64:67], v[40:43], v[152:155], a[64:67]
s_waitcnt lgkmcnt(8)
ds_read_b64_tr_b16 v[64:65], v26 offset:16384
ds_read_b64_tr_b16 v[66:67], v26 offset:17408
v_mfma_f32_16x16x32_bf16 a[68:71], v[40:43], v[156:159], a[68:71]
v_mfma_f32_16x16x32_bf16 a[72:75], v[44:47], v[152:155], a[72:75]
s_waitcnt lgkmcnt(8)
ds_read_b64_tr_b16 v[68:69], v27 offset:16384
ds_read_b64_tr_b16 v[70:71], v27 offset:17408
v_mfma_f32_16x16x32_bf16 a[76:79], v[44:47], v[156:159], a[76:79]
v_mfma_f32_16x16x32_bf16 a[80:83], v[48:51], v[152:155], a[80:83]
s_waitcnt lgkmcnt(8)
ds_read_b64_tr_b16 v[40:41], v20 offset:8192
ds_read_b64_tr_b16 v[42:43], v20 offset:9216
v_mfma_f32_16x16x32_bf16 a[84:87], v[48:51], v[156:159], a[84:87]
v_mfma_f32_16x16x32_bf16 a[88:91], v[52:55], v[152:155], a[88:91]
s_waitcnt lgkmcnt(8)
ds_read_b64_tr_b16 v[44:45], v21 offset:8192
ds_read_b64_tr_b16 v[46:47], v21 offset:9216
v_mfma_f32_16x16x32_bf16 a[92:95], v[52:55], v[156:159], a[92:95]
v_mfma_f32_16x16x32_bf16 a[96:99], v[56:59], v[152:155], a[96:99]
s_waitcnt lgkmcnt(8)
ds_read_b64_tr_b16 v[48:49], v22 offset:8192
ds_read_b64_tr_b16 v[50:51], v22 offset:9216
v_mfma_f32_16x16x32_bf16 a[100:103], v[56:59], v[156:159], a[100:103]
v_mfma_f32_16x16x32_bf16 a[104:107], v[60:63], v[152:155], a[104:107]
s_waitcnt lgkmcnt(8)
ds_read_b64_tr_b16 v[52:53], v23 offset:8192
ds_read_b64_tr_b16 v[54:55], v23 offset:9216
v_mfma_f32_16x16x32_bf16 a[108:111], v[60:63], v[156:159], a[108:111]
v_mfma_f32_16x16x32_bf16 a[112:115], v[64:67], v[152:155], a[112:115]
s_waitcnt lgkmcnt(8)
ds_read_b64_tr_b16 v[56:57], v24 offset:8192
ds_read_b64_tr_b16 v[58:59], v24 offset:9216
v_mfma_f32_16x16x32_bf16 a[116:119], v[64:67], v[156:159], a[116:119]
v_mfma_f32_16x16x32_bf16 a[120:123], v[68:71], v[152:155], a[120:123]
s_waitcnt lgkmcnt(8)
ds_read_b64_tr_b16 v[60:61], v25 offset:8192
ds_read_b64_tr_b16 v[62:63], v25 offset:9216
v_mfma_f32_16x16x32_bf16 a[124:127], v[68:71], v[156:159], a[124:127]
v_mfma_f32_16x16x32_bf16 a[0:3], v[40:43], v[160:163], a[0:3]
s_waitcnt lgkmcnt(8)
ds_read_b64_tr_b16 v[64:65], v26 offset:8192
ds_read_b64_tr_b16 v[66:67], v26 offset:9216
v_mfma_f32_16x16x32_bf16 a[4:7], v[40:43], v[164:167], a[4:7]
v_mfma_f32_16x16x32_bf16 a[8:11], v[44:47], v[160:163], a[8:11]
s_waitcnt lgkmcnt(8)
ds_read_b64_tr_b16 v[68:69], v27 offset:8192
ds_read_b64_tr_b16 v[70:71], v27 offset:9216
v_mfma_f32_16x16x32_bf16 a[12:15], v[44:47], v[164:167], a[12:15]
v_mfma_f32_16x16x32_bf16 a[16:19], v[48:51], v[160:163], a[16:19]
s_waitcnt lgkmcnt(8)
ds_read_b64_tr_b16 v[40:41], v20 offset:24576
ds_read_b64_tr_b16 v[42:43], v20 offset:25600
v_mfma_f32_16x16x32_bf16 a[20:23], v[48:51], v[164:167], a[20:23]
v_mfma_f32_16x16x32_bf16 a[24:27], v[52:55], v[160:163], a[24:27]
s_waitcnt lgkmcnt(8)
ds_read_b64_tr_b16 v[44:45], v21 offset:24576
ds_read_b64_tr_b16 v[46:47], v21 offset:25600
v_mfma_f32_16x16x32_bf16 a[28:31], v[52:55], v[164:167], a[28:31]
v_mfma_f32_16x16x32_bf16 a[32:35], v[56:59], v[160:163], a[32:35]
s_waitcnt lgkmcnt(8)
ds_read_b64_tr_b16 v[48:49], v22 offset:24576
ds_read_b64_tr_b16 v[50:51], v22 offset:25600
v_mfma_f32_16x16x32_bf16 a[36:39], v[56:59], v[164:167], a[36:39]
v_mfma_f32_16x16x32_bf16 a[40:43], v[60:63], v[160:163], a[40:43]
s_waitcnt lgkmcnt(8)
ds_read_b64_tr_b16 v[52:53], v23 offset:24576
ds_read_b64_tr_b16 v[54:55], v23 offset:25600
v_mfma_f32_16x16x32_bf16 a[44:47], v[60:63], v[164:167], a[44:47]
v_mfma_f32_16x16x32_bf16 a[48:51], v[64:67], v[160:163], a[48:51]
s_waitcnt lgkmcnt(8)
ds_read_b64_tr_b16 v[56:57], v24 offset:24576
ds_read_b64_tr_b16 v[58:59], v24 offset:25600
v_mfma_f32_16x16x32_bf16 a[52:55], v[64:67], v[164:167], a[52:55]
v_mfma_f32_16x16x32_bf16 a[56:59], v[68:71], v[160:163], a[56:59]
s_waitcnt lgkmcnt(8)
ds_read_b64_tr_b16 v[60:61], v25 offset:24576
ds_read_b64_tr_b16 v[62:63], v25 offset:25600
v_mfma_f32_16x16x32_bf16 a[60:63], v[68:71], v[164:167], a[60:63]
v_mfma_f32_16x16x32_bf16 a[64:67], v[40:43], v[160:163], a[64:67]
s_waitcnt lgkmcnt(8)
ds_read_b64_tr_b16 v[64:65], v26 offset:24576
ds_read_b64_tr_b16 v[66:67], v26 offset:25600
v_mfma_f32_16x16x32_bf16 a[68:71], v[40:43], v[164:167], a[68:71]
v_mfma_f32_16x16x32_bf16 a[72:75], v[44:47], v[160:163], a[72:75]
s_waitcnt lgkmcnt(8)
ds_read_b64_tr_b16 v[68:69], v27 offset:24576
ds_read_b64_tr_b16 v[70:71], v27 offset:25600
v_mfma_f32_16x16x32_bf16 a[76:79], v[44:47], v[164:167], a[76:79]
v_mfma_f32_16x16x32_bf16 a[80:83], v[48:51], v[160:163], a[80:83]
s_waitcnt lgkmcnt(8)
ds_read_b64_tr_b16 v[40:41], v20 offset:32768
ds_read_b64_tr_b16 v[42:43], v20 offset:33792
v_mfma_f32_16x16x32_bf16 a[84:87], v[48:51], v[164:167], a[84:87]
v_mfma_f32_16x16x32_bf16 a[88:91], v[52:55], v[160:163], a[88:91]
s_waitcnt lgkmcnt(8)
ds_read_b64_tr_b16 v[44:45], v21 offset:32768
ds_read_b64_tr_b16 v[46:47], v21 offset:33792
v_mfma_f32_16x16x32_bf16 a[92:95], v[52:55], v[164:167], a[92:95]
v_mfma_f32_16x16x32_bf16 a[96:99], v[56:59], v[160:163], a[96:99]
s_waitcnt lgkmcnt(8)
ds_read_b64_tr_b16 v[48:49], v22 offset:32768
ds_read_b64_tr_b16 v[50:51], v22 offset:33792
v_mfma_f32_16x16x32_bf16 a[100:103], v[56:59], v[164:167], a[100:103]
v_mfma_f32_16x16x32_bf16 a[104:107], v[60:63], v[160:163], a[104:107]
s_waitcnt lgkmcnt(8)
ds_read_b64_tr_b16 v[52:53], v23 offset:32768
ds_read_b64_tr_b16 v[54:55], v23 offset:33792
v_mfma_f32_16x16x32_bf16 a[108:111], v[60:63], v[164:167], a[108:111]
v_mfma_f32_16x16x32_bf16 a[112:115], v[64:67], v[160:163], a[112:115]
s_waitcnt lgkmcnt(8)
ds_read_b64_tr_b16 v[56:57], v24 offset:32768
ds_read_b64_tr_b16 v[58:59], v24 offset:33792
v_mfma_f32_16x16x32_bf16 a[116:119], v[64:67], v[164:167], a[116:119]
v_mfma_f32_16x16x32_bf16 a[120:123], v[68:71], v[160:163], a[120:123]
s_waitcnt lgkmcnt(8)
ds_read_b64_tr_b16 v[60:61], v25 offset:32768
ds_read_b64_tr_b16 v[62:63], v25 offset:33792
v_mfma_f32_16x16x32_bf16 a[124:127], v[68:71], v[164:167], a[124:127]
s_barrier
s_cmp_eq_u32 s30, 0
s_cbranch_scc0 K2_H3E
s_lshl_b32 s33, s31, 8
s_add_u32 s33, s33, 81920
v_mov_b32 v9, s33
buffer_load_dword v255, v9, s[72:75], 0 offen sc1
K2_H3E:
s_waitcnt lgkmcnt(10)
v_mfma_f32_16x16x32_bf16 a[0:3], v[40:43], v[168:171], a[0:3]
s_waitcnt lgkmcnt(8)
ds_read_b64_tr_b16 v[64:65], v26 offset:32768
ds_read_b64_tr_b16 v[66:67], v26 offset:33792
v_mfma_f32_16x16x32_bf16 a[4:7], v[40:43], v[172:175], a[4:7]
v_mfma_f32_16x16x32_bf16 a[8:11], v[44:47], v[168:171], a[8:11]
s_waitcnt lgkmcnt(8)
ds_read_b64_tr_b16 v[68:69], v27 offset:32768
ds_read_b64_tr_b16 v[70:71], v27 offset:33792
v_mfma_f32_16x16x32_bf16 a[12:15], v[44:47], v[172:175], a[12:15]
v_mfma_f32_16x16x32_bf16 a[16:19], v[48:51], v[168:171], a[16:19]
s_waitcnt lgkmcnt(8)
ds_read_b64_tr_b16 v[40:41], v20 offset:49152
ds_read_b64_tr_b16 v[42:43], v20 offset:50176
v_mfma_f32_16x16x32_bf16 a[20:23], v[48:51], v[172:175], a[20:23]
v_mfma_f32_16x16x32_bf16 a[24:27], v[52:55], v[168:171], a[24:27]
s_waitcnt lgkmcnt(8)
ds_read_b64_tr_b16 v[44:45], v21 offset:49152
ds_read_b64_tr_b16 v[46:47], v21 offset:50176
v_mfma_f32_16x16x32_bf16 a[28:31], v[52:55], v[172:175], a[28:31]
v_mfma_f32_16x16x32_bf16 a[32:35], v[56:59], v[168:171], a[32:35]
s_waitcnt lgkmcnt(8)
ds_read_b64_tr_b16 v[48:49], v22 offset:49152
ds_read_b64_tr_b16 v[50:51], v22 offset:50176
v_mfma_f32_16x16x32_bf16 a[36:39], v[56:59], v[172:175], a[36:39]
v_mfma_f32_16x16x32_bf16 a[40:43], v[60:63], v[168:171], a[40:43]
s_waitcnt lgkmcnt(8)
ds_read_b64_tr_b16 v[52:53], v23 offset:49152
ds_read_b64_tr_b16 v[54:55], v23 offset:50176
v_mfma_f32_16x16x32_bf16 a[44:47], v[60:63], v[172:175], a[44:47]
v_mfma_f32_16x16x32_bf16 a[48:51], v[64:67], v[168:171], a[48:51]
s_waitcnt lgkmcnt(8)
ds_read_b64_tr_b16 v[56:57], v24 offset:49152
ds_read_b64_tr_b16 v[58:59], v24 offset:50176
v_mfma_f32_16x16x32_bf16 a[52:55], v[64:67], v[172:175], a[52:55]
v_mfma_f32_16x16x32_bf16 a[56:59], v[68:71], v[168:171], a[56:59]
s_waitcnt lgkmcnt(8)
ds_read_b64_tr_b16 v[60:61], v25 offset:49152
ds_read_b64_tr_b16 v[62:63], v25 offset:50176
v_mfma_f32_16x16x32_bf16 a[60:63], v[68:71], v[172:175], a[60:63]
v_mfma_f32_16x16x32_bf16 a[64:67], v[40:43], v[168:171], a[64:67]
s_waitcnt lgkmcnt(8)
ds_read_b64_tr_b16 v[64:65], v26 offset:49152
ds_read_b64_tr_b16 v[66:67], v26 offset:50176
v_mfma_f32_16x16x32_bf16 a[68:71], v[40:43], v[172:175], a[68:71]
v_mfma_f32_16x16x32_bf16 a[72:75], v[44:47], v[168:171], a[72:75]
s_waitcnt lgkmcnt(8)
ds_read_b64_tr_b16 v[68:69], v27 offset:49152
ds_read_b64_tr_b16 v[70:71], v27 offset:50176
v_mfma_f32_16x16x32_bf16 a[76:79], v[44:47], v[172:175], a[76:79]
v_mfma_f32_16x16x32_bf16 a[80:83], v[48:51], v[168:171], a[80:83]
s_waitcnt lgkmcnt(8)
ds_read_b64_tr_b16 v[40:41], v20 offset:40960
ds_read_b64_tr_b16 v[42:43], v20 offset:41984
v_mfma_f32_16x16x32_bf16 a[84:87], v[48:51], v[172:175], a[84:87]
v_mfma_f32_16x16x32_bf16 a[88:91], v[52:55], v[168:171], a[88:91]
s_waitcnt lgkmcnt(8)
ds_read_b64_tr_b16 v[44:45], v21 offset:40960
ds_read_b64_tr_b16 v[46:47], v21 offset:41984
v_mfma_f32_16x16x32_bf16 a[92:95], v[52:55], v[172:175], a[92:95]
v_mfma_f32_16x16x32_bf16 a[96:99], v[56:59], v[168:171], a[96:99]
s_waitcnt lgkmcnt(8)
ds_read_b64_tr_b16 v[48:49], v22 offset:40960
ds_read_b64_tr_b16 v[50:51], v22 offset:41984
v_mfma_f32_16x16x32_bf16 a[100:103], v[56:59], v[172:175], a[100:103]
v_mfma_f32_16x16x32_bf16 a[104:107], v[60:63], v[168:171], a[104:107]
s_waitcnt lgkmcnt(8)
ds_read_b64_tr_b16 v[52:53], v23 offset:40960
ds_read_b64_tr_b16 v[54:55], v23 offset:41984
v_mfma_f32_16x16x32_bf16 a[108:111], v[60:63], v[172:175], a[108:111]
v_mfma_f32_16x16x32_bf16 a[112:115], v[64:67], v[168:171], a[112:115]
s_waitcnt lgkmcnt(8)
ds_read_b64_tr_b16 v[56:57], v24 offset:40960
ds_read_b64_tr_b16 v[58:59], v24 offset:41984
v_mfma_f32_16x16x32_bf16 a[116:119], v[64:67], v[172:175], a[116:119]
v_mfma_f32_16x16x32_bf16 a[120:123], v[68:71], v[168:171], a[120:123]
s_waitcnt lgkmcnt(8)
ds_read_b64_tr_b16 v[60:61], v25 offset:40960
ds_read_b64_tr_b16 v[62:63], v25 offset:41984
v_mfma_f32_16x16x32_bf16 a[124:127], v[68:71], v[172:175], a[124:127]
v_mfma_f32_16x16x32_bf16 a[0:3], v[40:43], v[176:179], a[0:3]
s_waitcnt lgkmcnt(8)
ds_read_b64_tr_b16 v[64:65], v26 offset:40960
ds_read_b64_tr_b16 v[66:67], v26 offset:41984
v_mfma_f32_16x16x32_bf16 a[4:7], v[40:43], v[180:183], a[4:7]
v_mfma_f32_16x16x32_bf16 a[8:11], v[44:47], v[176:179], a[8:11]
s_waitcnt lgkmcnt(8)
ds_read_b64_tr_b16 v[68:69], v27 offset:40960
ds_read_b64_tr_b16 v[70:71], v27 offset:41984
v_mfma_f32_16x16x32_bf16 a[12:15], v[44:47], v[180:183], a[12:15]
v_mfma_f32_16x16x32_bf16 a[16:19], v[48:51], v[176:179], a[16:19]
s_waitcnt lgkmcnt(8)
ds_read_b64_tr_b16 v[40:41], v20 offset:57344
ds_read_b64_tr_b16 v[42:43], v20 offset:58368
v_mfma_f32_16x16x32_bf16 a[20:23], v[48:51], v[180:183], a[20:23]
v_mfma_f32_16x16x32_bf16 a[24:27], v[52:55], v[176:179], a[24:27]
s_waitcnt lgkmcnt(8)
ds_read_b64_tr_b16 v[44:45], v21 offset:57344
ds_read_b64_tr_b16 v[46:47], v21 offset:58368
v_mfma_f32_16x16x32_bf16 a[28:31], v[52:55], v[180:183], a[28:31]
v_mfma_f32_16x16x32_bf16 a[32:35], v[56:59], v[176:179], a[32:35]
s_waitcnt lgkmcnt(8)
ds_read_b64_tr_b16 v[48:49], v22 offset:57344
ds_read_b64_tr_b16 v[50:51], v22 offset:58368
v_mfma_f32_16x16x32_bf16 a[36:39], v[56:59], v[180:183], a[36:39]
v_mfma_f32_16x16x32_bf16 a[40:43], v[60:63], v[176:179], a[40:43]
s_waitcnt lgkmcnt(8)
ds_read_b64_tr_b16 v[52:53], v23 offset:57344
ds_read_b64_tr_b16 v[54:55], v23 offset:58368
v_mfma_f32_16x16x32_bf16 a[44:47], v[60:63], v[180:183], a[44:47]
v_mfma_f32_16x16x32_bf16 a[48:51], v[64:67], v[176:179], a[48:51]
s_waitcnt lgkmcnt(8)
ds_read_b64_tr_b16 v[56:57], v24 offset:57344
ds_read_b64_tr_b16 v[58:59], v24 offset:58368
v_mfma_f32_16x16x32_bf16 a[52:55], v[64:67], v[180:183], a[52:55]
v_mfma_f32_16x16x32_bf16 a[56:59], v[68:71], v[176:179], a[56:59]
s_waitcnt lgkmcnt(8)
ds_read_b64_tr_b16 v[60:61], v25 offset:57344
ds_read_b64_tr_b16 v[62:63], v25 offset:58368
v_mfma_f32_16x16x32_bf16 a[60:63], v[68:71], v[180:183], a[60:63]
v_mfma_f32_16x16x32_bf16 a[64:67], v[40:43], v[176:179], a[64:67]
s_waitcnt lgkmcnt(8)
ds_read_b64_tr_b16 v[64:65], v26 offset:57344
ds_read_b64_tr_b16 v[66:67], v26 offset:58368
v_mfma_f32_16x16x32_bf16 a[68:71], v[40:43], v[180:183], a[68:71]
v_mfma_f32_16x16x32_bf16 a[72:75], v[44:47], v[176:179], a[72:75]
s_waitcnt lgkmcnt(8)
ds_read_b64_tr_b16 v[68:69], v27 offset:57344
ds_read_b64_tr_b16 v[70:71], v27 offset:58368
v_mfma_f32_16x16x32_bf16 a[76:79], v[44:47], v[180:183], a[76:79]
v_mfma_f32_16x16x32_bf16 a[80:83], v[48:51], v[176:179], a[80:83]
s_waitcnt lgkmcnt(8)
v_mfma_f32_16x16x32_bf16 a[84:87], v[48:51], v[180:183], a[84:87]
v_mfma_f32_16x16x32_bf16 a[88:91], v[52:55], v[176:179], a[88:91]
s_waitcnt lgkmcnt(6)
v_mfma_f32_16x16x32_bf16 a[92:95], v[52:55], v[180:183], a[92:95]
v_mfma_f32_16x16x32_bf16 a[96:99], v[56:59], v[176:179], a[96:99]
s_waitcnt lgkmcnt(4)
v_mfma_f32_16x16x32_bf16 a[100:103], v[56:59], v[180:183], a[100:103]
v_mfma_f32_16x16x32_bf16 a[104:107], v[60:63], v[176:179], a[104:107]
s_waitcnt lgkmcnt(2)
v_mfma_f32_16x16x32_bf16 a[108:111], v[60:63], v[180:183], a[108:111]
v_mfma_f32_16x16x32_bf16 a[112:115], v[64:67], v[176:179], a[112:115]
s_waitcnt lgkmcnt(0)
v_mfma_f32_16x16x32_bf16 a[116:119], v[64:67], v[180:183], a[116:119]
v_mfma_f32_16x16x32_bf16 a[120:123], v[68:71], v[176:179], a[120:123]
v_mfma_f32_16x16x32_bf16 a[124:127], v[68:71], v[180:183], a[124:127]
s_nop 4
v_accvgpr_read_b32 v208, a0
v_accvgpr_read_b32 v209, a1
v_accvgpr_read_b32 v210, a2
v_accvgpr_read_b32 v211, a3
v_accvgpr_read_b32 v212, a8
v_accvgpr_read_b32 v213, a9
v_accvgpr_read_b32 v214, a10
v_accvgpr_read_b32 v215, a11
v_cvt_pk_bf16_f32 v136, v208, v209
v_cvt_pk_bf16_f32 v137, v210, v211
v_cvt_pk_bf16_f32 v138, v212, v213
v_cvt_pk_bf16_f32 v139, v214, v215
v_accvgpr_read_b32 v216, a16
v_accvgpr_read_b32 v217, a17
v_accvgpr_read_b32 v218, a18
v_accvgpr_read_b32 v219, a19
v_accvgpr_read_b32 v220, a24
v_accvgpr_read_b32 v221, a25
v_accvgpr_read_b32 v222, a26
v_accvgpr_read_b32 v223, a27
v_cvt_pk_bf16_f32 v140, v216, v217
v_cvt_pk_bf16_f32 v141, v218, v219
v_cvt_pk_bf16_f32 v142, v220, v221
v_cvt_pk_bf16_f32 v143, v222, v223
v_accvgpr_read_b32 v224, a32
v_accvgpr_read_b32 v225, a33
v_accvgpr_read_b32 v226, a34
v_accvgpr_read_b32 v227, a35
v_accvgpr_read_b32 v228, a40
v_accvgpr_read_b32 v229, a41
v_accvgpr_read_b32 v230, a42
v_accvgpr_read_b32 v231, a43
v_cvt_pk_bf16_f32 v144, v224, v225
v_cvt_pk_bf16_f32 v145, v226, v227
v_cvt_pk_bf16_f32 v146, v228, v229
v_cvt_pk_bf16_f32 v147, v230, v231
v_accvgpr_read_b32 v232, a48
v_accvgpr_read_b32 v233, a49
v_accvgpr_read_b32 v234, a50
v_accvgpr_read_b32 v235, a51
v_accvgpr_read_b32 v236, a56
v_accvgpr_read_b32 v237, a57
v_accvgpr_read_b32 v238, a58
v_accvgpr_read_b32 v239, a59
v_cvt_pk_bf16_f32 v148, v232, v233
v_cvt_pk_bf16_f32 v149, v234, v235
v_cvt_pk_bf16_f32 v150, v236, v237
v_cvt_pk_bf16_f32 v151, v238, v239
v_accvgpr_read_b32 v208, a64
v_accvgpr_read_b32 v209, a65
v_accvgpr_read_b32 v210, a66
v_accvgpr_read_b32 v211, a67
v_accvgpr_read_b32 v212, a72
v_accvgpr_read_b32 v213, a73
v_accvgpr_read_b32 v214, a74
v_accvgpr_read_b32 v215, a75
v_cvt_pk_bf16_f32 v152, v208, v209
v_cvt_pk_bf16_f32 v153, v210, v211
v_cvt_pk_bf16_f32 v154, v212, v213
v_cvt_pk_bf16_f32 v155, v214, v215
v_accvgpr_read_b32 v216, a80
v_accvgpr_read_b32 v217, a81
v_accvgpr_read_b32 v218, a82
v_accvgpr_read_b32 v219, a83
v_accvgpr_read_b32 v220, a88
v_accvgpr_read_b32 v221, a89
v_accvgpr_read_b32 v222, a90
v_accvgpr_read_b32 v223, a91
v_cvt_pk_bf16_f32 v156, v216, v217
v_cvt_pk_bf16_f32 v157, v218, v219
v_cvt_pk_bf16_f32 v158, v220, v221
v_cvt_pk_bf16_f32 v159, v222, v223
v_accvgpr_read_b32 v224, a96
v_accvgpr_read_b32 v225, a97
v_accvgpr_read_b32 v226, a98
v_accvgpr_read_b32 v227, a99
v_accvgpr_read_b32 v228, a104
v_accvgpr_read_b32 v229, a105
v_accvgpr_read_b32 v230, a106
v_accvgpr_read_b32 v231, a107
v_cvt_pk_bf16_f32 v160, v224, v225
v_cvt_pk_bf16_f32 v161, v226, v227
v_cvt_pk_bf16_f32 v162, v228, v229
v_cvt_pk_bf16_f32 v163, v230, v231
v_accvgpr_read_b32 v232, a112
v_accvgpr_read_b32 v233, a113
v_accvgpr_read_b32 v234, a114
v_accvgpr_read_b32 v235, a115
v_accvgpr_read_b32 v236, a120
v_accvgpr_read_b32 v237, a121
v_accvgpr_read_b32 v238, a122
v_accvgpr_read_b32 v239, a123
v_cvt_pk_bf16_f32 v164, v232, v233
v_cvt_pk_bf16_f32 v165, v234, v235
v_cvt_pk_bf16_f32 v166, v236, v237
v_cvt_pk_bf16_f32 v167, v238, v239
v_accvgpr_read_b32 v208, a4
v_accvgpr_read_b32 v209, a5
v_accvgpr_read_b32 v210, a6
v_accvgpr_read_b32 v211, a7
v_accvgpr_read_b32 v212, a12
v_accvgpr_read_b32 v213, a13
v_accvgpr_read_b32 v214, a14
v_accvgpr_read_b32 v215, a15
v_cvt_pk_bf16_f32 v168, v208, v209
v_cvt_pk_bf16_f32 v169, v210, v211
v_cvt_pk_bf16_f32 v170, v212, v213
v_cvt_pk_bf16_f32 v171, v214, v215
v_accvgpr_read_b32 v216, a20
v_accvgpr_read_b32 v217, a21
v_accvgpr_read_b32 v218, a22
v_accvgpr_read_b32 v219, a23
v_accvgpr_read_b32 v220, a28
v_accvgpr_read_b32 v221, a29
v_accvgpr_read_b32 v222, a30
v_accvgpr_read_b32 v223, a31
v_cvt_pk_bf16_f32 v172, v216, v217
v_cvt_pk_bf16_f32 v173, v218, v219
v_cvt_pk_bf16_f32 v174, v220, v221
v_cvt_pk_bf16_f32 v175, v222, v223
v_accvgpr_read_b32 v224, a36
v_accvgpr_read_b32 v225, a37
v_accvgpr_read_b32 v226, a38
v_accvgpr_read_b32 v227, a39
v_accvgpr_read_b32 v228, a44
v_accvgpr_read_b32 v229, a45
v_accvgpr_read_b32 v230, a46
v_accvgpr_read_b32 v231, a47
v_cvt_pk_bf16_f32 v176, v224, v225
v_cvt_pk_bf16_f32 v177, v226, v227
v_cvt_pk_bf16_f32 v178, v228, v229
v_cvt_pk_bf16_f32 v179, v230, v231
v_accvgpr_read_b32 v232, a52
v_accvgpr_read_b32 v233, a53
v_accvgpr_read_b32 v234, a54
v_accvgpr_read_b32 v235, a55
v_accvgpr_read_b32 v236, a60
v_accvgpr_read_b32 v237, a61
v_accvgpr_read_b32 v238, a62
v_accvgpr_read_b32 v239, a63
v_cvt_pk_bf16_f32 v180, v232, v233
v_cvt_pk_bf16_f32 v181, v234, v235
v_cvt_pk_bf16_f32 v182, v236, v237
v_cvt_pk_bf16_f32 v183, v238, v239
v_accvgpr_read_b32 v208, a68
v_accvgpr_read_b32 v209, a69
v_accvgpr_read_b32 v210, a70
v_accvgpr_read_b32 v211, a71
v_accvgpr_read_b32 v212, a76
v_accvgpr_read_b32 v213, a77
v_accvgpr_read_b32 v214, a78
v_accvgpr_read_b32 v215, a79
v_cvt_pk_bf16_f32 v184, v208, v209
v_cvt_pk_bf16_f32 v185, v210, v211
v_cvt_pk_bf16_f32 v186, v212, v213
v_cvt_pk_bf16_f32 v187, v214, v215
v_accvgpr_read_b32 v216, a84
v_accvgpr_read_b32 v217, a85
v_accvgpr_read_b32 v218, a86
v_accvgpr_read_b32 v219, a87
v_accvgpr_read_b32 v220, a92
v_accvgpr_read_b32 v221, a93
v_accvgpr_read_b32 v222, a94
v_accvgpr_read_b32 v223, a95
v_cvt_pk_bf16_f32 v188, v216, v217
v_cvt_pk_bf16_f32 v189, v218, v219
v_cvt_pk_bf16_f32 v190, v220, v221
v_cvt_pk_bf16_f32 v191, v222, v223
v_accvgpr_read_b32 v224, a100
v_accvgpr_read_b32 v225, a101
v_accvgpr_read_b32 v226, a102
v_accvgpr_read_b32 v227, a103
v_accvgpr_read_b32 v228, a108
v_accvgpr_read_b32 v229, a109
v_accvgpr_read_b32 v230, a110
v_accvgpr_read_b32 v231, a111
v_cvt_pk_bf16_f32 v192, v224, v225
v_cvt_pk_bf16_f32 v193, v226, v227
v_cvt_pk_bf16_f32 v194, v228, v229
v_cvt_pk_bf16_f32 v195, v230, v231
v_accvgpr_read_b32 v232, a116
v_accvgpr_read_b32 v233, a117
v_accvgpr_read_b32 v234, a118
v_accvgpr_read_b32 v235, a119
v_accvgpr_read_b32 v236, a124
v_accvgpr_read_b32 v237, a125
v_accvgpr_read_b32 v238, a126
v_accvgpr_read_b32 v239, a127
v_cvt_pk_bf16_f32 v196, v232, v233
v_cvt_pk_bf16_f32 v197, v234, v235
v_cvt_pk_bf16_f32 v198, v236, v237
v_cvt_pk_bf16_f32 v199, v238, v239
s_cmp_eq_u32 s30, 0
s_cbranch_scc0 K2_KVOK
s_mov_b32 s35, 0x10000
s_waitcnt vmcnt(0)
K2_KVP:
v_readfirstlane_b32 s33, v255
s_cmp_ge_u32 s33, 16
s_cbranch_scc1 K2_KVOK
s_sub_u32 s35, s35, 1
s_cmp_eq_u32 s35, 0
s_cbranch_scc1 K2_KVOK
s_sleep 1
buffer_load_dword v255, v9, s[72:75], 0 offen sc1
s_waitcnt vmcnt(0)
s_branch K2_KVP
K2_KVOK:
s_cmp_eq_u32 s30, 0
s_cbranch_scc0 K2_TG
v_mov_b32 v13, 65540
ds_write_b32 v13, v1
s_waitcnt lgkmcnt(0)
K2_TG:
s_barrier
s_add_u32 m0, s40, 0
s_add_u32 s47, s39, 0
s_nop 0
buffer_load_dwordx4 v3, s[16:19], s47 offen offset:0 sc1 lds
buffer_load_dwordx4 v3, s[16:19], s47 offen offset:1024 sc1 lds
buffer_load_dwordx4 v3, s[16:19], s47 offen offset:2048 sc1 lds
buffer_load_dwordx4 v3, s[16:19], s47 offen offset:3072 sc1 lds
s_add_u32 m0, s40, 16384
s_add_u32 s47, s39, 16384
s_nop 0
buffer_load_dwordx4 v3, s[16:19], s47 offen offset:0 sc1 lds
buffer_load_dwordx4 v3, s[16:19], s47 offen offset:1024 sc1 lds
buffer_load_dwordx4 v3, s[16:19], s47 offen offset:2048 sc1 lds
buffer_load_dwordx4 v3, s[16:19], s47 offen offset:3072 sc1 lds
v_mov_b32 v13, 65540
ds_read_b32 v1, v13
s_waitcnt lgkmcnt(0)
v_readfirstlane_b32 s55, v1
v_lshrrev_b32 v9, 4, v2
v_and_b32 v10, 15, v2
v_or_b32 v11, 0, v9
v_lshlrev_b32 v11, 1, v11
v_xor_b32 v11, v11, v10
v_lshlrev_b32 v11, 4, v11
v_add_u32 v204, 0, v9
v_mul_u32_u24 v204, 3584, v204
v_add_u32 v204, v204, v11
v_subrev_u32 v204, 0, v204
v_or_b32 v11, 0, v9
v_lshlrev_b32 v11, 1, v11
v_xor_b32 v11, v11, v10
v_lshlrev_b32 v11, 4, v11
v_add_u32 v205, 4, v9
v_mul_u32_u24 v205, 3584, v205
v_add_u32 v205, v205, v11
v_subrev_u32 v205, 1024, v205
v_or_b32 v11, 4, v9
v_lshlrev_b32 v11, 1, v11
v_xor_b32 v11, v11, v10
v_lshlrev_b32 v11, 4, v11
v_add_u32 v206, 8, v9
v_mul_u32_u24 v206, 3584, v206
v_add_u32 v206, v206, v11
v_subrev_u32 v206, 2048, v206
v_or_b32 v11, 4, v9
v_lshlrev_b32 v11, 1, v11
v_xor_b32 v11, v11, v10
v_lshlrev_b32 v11, 4, v11
v_add_u32 v207, 12, v9
v_mul_u32_u24 v207, 3584, v207
v_add_u32 v207, v207, v11
v_subrev_u32 v207, 3072, v207
s_mov_b32 s44, -1
s_cmp_eq_u32 s61, 0
s_cbranch_scc0 K2_NOPUBQ
s_sub_u32 s44, s36, 1
K2_NOPUBQ:
v_accvgpr_write_b32 a0, 0
v_accvgpr_write_b32 a1, 0
v_accvgpr_write_b32 a2, 0
v_accvgpr_write_b32 a3, 0
v_accvgpr_write_b32 a4, 0
v_accvgpr_write_b32 a5, 0
v_accvgpr_write_b32 a6, 0
v_accvgpr_write_b32 a7, 0
v_accvgpr_write_b32 a8, 0
v_accvgpr_write_b32 a9, 0
v_accvgpr_write_b32 a10, 0
v_accvgpr_write_b32 a11, 0
v_accvgpr_write_b32 a12, 0
v_accvgpr_write_b32 a13, 0
v_accvgpr_write_b32 a14, 0
v_accvgpr_write_b32 a15, 0
v_accvgpr_write_b32 a16, 0
v_accvgpr_write_b32 a17, 0
v_accvgpr_write_b32 a18, 0
v_accvgpr_write_b32 a19, 0
v_accvgpr_write_b32 a20, 0
v_accvgpr_write_b32 a21, 0
v_accvgpr_write_b32 a22, 0
v_accvgpr_write_b32 a23, 0
v_accvgpr_write_b32 a24, 0
v_accvgpr_write_b32 a25, 0
v_accvgpr_write_b32 a26, 0
v_accvgpr_write_b32 a27, 0
v_accvgpr_write_b32 a28, 0
v_accvgpr_write_b32 a29, 0
v_accvgpr_write_b32 a30, 0
v_accvgpr_write_b32 a31, 0
v_accvgpr_write_b32 a32, 0
v_accvgpr_write_b32 a33, 0
v_accvgpr_write_b32 a34, 0
v_accvgpr_write_b32 a35, 0
v_accvgpr_write_b32 a36, 0
v_accvgpr_write_b32 a37, 0
v_accvgpr_write_b32 a38, 0
v_accvgpr_write_b32 a39, 0
v_accvgpr_write_b32 a40, 0
v_accvgpr_write_b32 a41, 0
v_accvgpr_write_b32 a42, 0
v_accvgpr_write_b32 a43, 0
v_accvgpr_write_b32 a44, 0
v_accvgpr_write_b32 a45, 0
v_accvgpr_write_b32 a46, 0
v_accvgpr_write_b32 a47, 0
v_accvgpr_write_b32 a48, 0
v_accvgpr_write_b32 a49, 0
v_accvgpr_write_b32 a50, 0
v_accvgpr_write_b32 a51, 0
v_accvgpr_write_b32 a52, 0
v_accvgpr_write_b32 a53, 0
v_accvgpr_write_b32 a54, 0
v_accvgpr_write_b32 a55, 0
v_accvgpr_write_b32 a56, 0
v_accvgpr_write_b32 a57, 0
v_accvgpr_write_b32 a58, 0
v_accvgpr_write_b32 a59, 0
v_accvgpr_write_b32 a60, 0
v_accvgpr_write_b32 a61, 0
v_accvgpr_write_b32 a62, 0
v_accvgpr_write_b32 a63, 0
v_accvgpr_write_b32 a64, 0
v_accvgpr_write_b32 a65, 0
v_accvgpr_write_b32 a66, 0
v_accvgpr_write_b32 a67, 0
v_accvgpr_write_b32 a68, 0
v_accvgpr_write_b32 a69, 0
v_accvgpr_write_b32 a70, 0
v_accvgpr_write_b32 a71, 0
v_accvgpr_write_b32 a72, 0
v_accvgpr_write_b32 a73, 0
v_accvgpr_write_b32 a74, 0
v_accvgpr_write_b32 a75, 0
v_accvgpr_write_b32 a76, 0
v_accvgpr_write_b32 a77, 0
v_accvgpr_write_b32 a78, 0
v_accvgpr_write_b32 a79, 0
v_accvgpr_write_b32 a80, 0
v_accvgpr_write_b32 a81, 0
v_accvgpr_write_b32 a82, 0
v_accvgpr_write_b32 a83, 0
v_accvgpr_write_b32 a84, 0
v_accvgpr_write_b32 a85, 0
v_accvgpr_write_b32 a86, 0
v_accvgpr_write_b32 a87, 0
v_accvgpr_write_b32 a88, 0
v_accvgpr_write_b32 a89, 0
v_accvgpr_write_b32 a90, 0
v_accvgpr_write_b32 a91, 0
v_accvgpr_write_b32 a92, 0
v_accvgpr_write_b32 a93, 0
v_accvgpr_write_b32 a94, 0
v_accvgpr_write_b32 a95, 0
v_accvgpr_write_b32 a96, 0
v_accvgpr_write_b32 a97, 0
v_accvgpr_write_b32 a98, 0
v_accvgpr_write_b32 a99, 0
v_accvgpr_write_b32 a100, 0
v_accvgpr_write_b32 a101, 0
v_accvgpr_write_b32 a102, 0
v_accvgpr_write_b32 a103, 0
v_accvgpr_write_b32 a104, 0
v_accvgpr_write_b32 a105, 0
v_accvgpr_write_b32 a106, 0
v_accvgpr_write_b32 a107, 0
v_accvgpr_write_b32 a108, 0
v_accvgpr_write_b32 a109, 0
v_accvgpr_write_b32 a110, 0
v_accvgpr_write_b32 a111, 0
v_accvgpr_write_b32 a112, 0
v_accvgpr_write_b32 a113, 0
v_accvgpr_write_b32 a114, 0
v_accvgpr_write_b32 a115, 0
v_accvgpr_write_b32 a116, 0
v_accvgpr_write_b32 a117, 0
v_accvgpr_write_b32 a118, 0
v_accvgpr_write_b32 a119, 0
v_accvgpr_write_b32 a120, 0
v_accvgpr_write_b32 a121, 0
v_accvgpr_write_b32 a122, 0
v_accvgpr_write_b32 a123, 0
v_accvgpr_write_b32 a124, 0
v_accvgpr_write_b32 a125, 0
v_accvgpr_write_b32 a126, 0
v_accvgpr_write_b32 a127, 0
s_waitcnt vmcnt(0)
K2_GO:
s_barrier
K2_CORE:
s_mov_b32 s54, 0
v_mov_b32 v28, 0
v_mov_b32 v29, 0
ds_read_b128 v[40:43], v3 offset:0
ds_read_b128 v[44:47], v3 offset:1024
ds_read_b128 v[48:51], v3 offset:2048
ds_read_b128 v[52:55], v3 offset:3072
ds_read_b128 v[56:59], v3 offset:4096
ds_read_b128 v[60:63], v3 offset:5120
ds_read_b128 v[64:67], v3 offset:6144
ds_read_b128 v[68:71], v3 offset:7168
s_waitcnt lgkmcnt(0)
v_mfma_f32_16x16x32_bf16 v[72:75], v[40:43], v[136:139], 0
s_add_u32 m0, s40, 98304
s_add_u32 s47, s39, 16384
buffer_load_dwordx4 v3, s[20:23], s47 offen offset:0 sc1 lds
v_mfma_f32_16x16x32_bf16 v[76:79], v[40:43], v[168:171], 0
ds_read_b128 v[40:43], v3 offset:8192
v_mfma_f32_16x16x32_bf16 v[72:75], v[44:47], v[140:143], v[72:75]
buffer_load_dwordx4 v3, s[20:23], s47 offen offset:1024 sc1 lds
v_mfma_f32_16x16x32_bf16 v[76:79], v[44:47], v[172:175], v[76:79]
ds_read_b128 v[44:47], v3 offset:9216
v_mfma_f32_16x16x32_bf16 v[72:75], v[48:51], v[144:147], v[72:75]
buffer_load_dwordx4 v3, s[20:23], s47 offen offset:2048 sc1 lds
v_mfma_f32_16x16x32_bf16 v[76:79], v[48:51], v[176:179], v[76:79]
ds_read_b128 v[48:51], v3 offset:10240
v_mfma_f32_16x16x32_bf16 v[72:75], v[52:55], v[148:151], v[72:75]
buffer_load_dwordx4 v3, s[20:23], s47 offen offset:3072 sc1 lds
v_mfma_f32_16x16x32_bf16 v[76:79], v[52:55], v[180:183], v[76:79]
ds_read_b128 v[52:55], v3 offset:11264
v_mfma_f32_16x16x32_bf16 v[72:75], v[56:59], v[152:155], v[72:75]
s_add_u32 m0, s40, 32768
s_add_u32 s47, s39, 32768
buffer_load_dwordx4 v3, s[16:19], s47 offen offset:0 sc1 lds
v_mfma_f32_16x16x32_bf16 v[76:79], v[56:59], v[184:187], v[76:79]
ds_read_b128 v[56:59], v3 offset:12288
v_mfma_f32_16x16x32_bf16 v[72:75], v[60:63], v[156:159], v[72:75]
buffer_load_dwordx4 v3, s[16:19], s47 offen offset:1024 sc1 lds
v_mfma_f32_16x16x32_bf16 v[76:79], v[60:63], v[188:191], v[76:79]
ds_read_b128 v[60:63], v3 offset:13312
v_mfma_f32_16x16x32_bf16 v[72:75], v[64:67], v[160:163], v[72:75]
buffer_load_dwordx4 v3, s[16:19], s47 offen offset:2048 sc1 lds
v_mfma_f32_16x16x32_bf16 v[76:79], v[64:67], v[192:195], v[76:79]
ds_read_b128 v[64:67], v3 offset:14336
v_mfma_f32_16x16x32_bf16 v[72:75], v[68:71], v[164:167], v[72:75]
buffer_load_dwordx4 v3, s[16:19], s47 offen offset:3072 sc1 lds
v_mfma_f32_16x16x32_bf16 v[76:79], v[68:71], v[196:199], v[76:79]
s_nop 0
ds_read_b128 v[68:71], v3 offset:15360
s_waitcnt lgkmcnt(0)
v_mfma_f32_16x16x32_bf16 v[80:83], v[40:43], v[136:139], 0
s_add_u32 m0, s40, 114688
s_add_u32 s47, s39, 32768
buffer_load_dwordx4 v3, s[20:23], s47 offen offset:0 sc1 lds
v_mfma_f32_16x16x32_bf16 v[84:87], v[40:43], v[168:171], 0
buffer_load_dwordx4 v3, s[20:23], s47 offen offset:1024 sc1 lds
v_mfma_f32_16x16x32_bf16 v[80:83], v[44:47], v[140:143], v[80:83]
buffer_load_dwordx4 v3, s[20:23], s47 offen offset:2048 sc1 lds
v_mfma_f32_16x16x32_bf16 v[84:87], v[44:47], v[172:175], v[84:87]
buffer_load_dwordx4 v3, s[20:23], s47 offen offset:3072 sc1 lds
v_mfma_f32_16x16x32_bf16 v[80:83], v[48:51], v[144:147], v[80:83]
s_add_u32 m0, s40, 49152
s_add_u32 s47, s39, 49152
buffer_load_dwordx4 v3, s[16:19], s47 offen offset:0 sc1 lds
v_mfma_f32_16x16x32_bf16 v[84:87], v[48:51], v[176:179], v[84:87]
buffer_load_dwordx4 v3, s[16:19], s47 offen offset:1024 sc1 lds
v_mfma_f32_16x16x32_bf16 v[80:83], v[52:55], v[148:151], v[80:83]
buffer_load_dwordx4 v3, s[16:19], s47 offen offset:2048 sc1 lds
v_mfma_f32_16x16x32_bf16 v[84:87], v[52:55], v[180:183], v[84:87]
buffer_load_dwordx4 v3, s[16:19], s47 offen offset:3072 sc1 lds
v_mfma_f32_16x16x32_bf16 v[80:83], v[56:59], v[152:155], v[80:83]
s_add_u32 m0, s40, 131072
s_add_u32 s47, s39, 49152
buffer_load_dwordx4 v3, s[20:23], s47 offen offset:0 sc1 lds
v_mfma_f32_16x16x32_bf16 v[84:87], v[56:59], v[184:187], v[84:87]
buffer_load_dwordx4 v3, s[20:23], s47 offen offset:1024 sc1 lds
v_mfma_f32_16x16x32_bf16 v[80:83], v[60:63], v[156:159], v[80:83]
buffer_load_dwordx4 v3, s[20:23], s47 offen offset:2048 sc1 lds
v_mfma_f32_16x16x32_bf16 v[84:87], v[60:63], v[188:191], v[84:87]
buffer_load_dwordx4 v3, s[20:23], s47 offen offset:3072 sc1 lds
v_mfma_f32_16x16x32_bf16 v[80:83], v[64:67], v[160:163], v[80:83]
v_mfma_f32_16x16x32_bf16 v[84:87], v[64:67], v[192:195], v[84:87]
v_mfma_f32_16x16x32_bf16 v[80:83], v[68:71], v[164:167], v[80:83]
v_mfma_f32_16x16x32_bf16 v[84:87], v[68:71], v[196:199], v[84:87]
s_add_u32 s39, s39, 65536
s_cmp_eq_u32 s61, 0
s_cbranch_scc0 K2_NOQS
s_lshl_b32 s33, s62, 16
s_lshl_b32 s34, s30, 14
s_add_u32 s33, s33, s34
buffer_store_dwordx4 v[136:139], v3, s[68:71], s33 offen offset:0 sc1
buffer_store_dwordx4 v[140:143], v3, s[68:71], s33 offen offset:1024 sc1
buffer_store_dwordx4 v[144:147], v3, s[68:71], s33 offen offset:2048 sc1
buffer_store_dwordx4 v[148:151], v3, s[68:71], s33 offen offset:3072 sc1
s_add_u32 s33, s33, 4096
buffer_store_dwordx4 v[152:155], v3, s[68:71], s33 offen offset:0 sc1
buffer_store_dwordx4 v[156:159], v3, s[68:71], s33 offen offset:1024 sc1
buffer_store_dwordx4 v[160:163], v3, s[68:71], s33 offen offset:2048 sc1
buffer_store_dwordx4 v[164:167], v3, s[68:71], s33 offen offset:3072 sc1
s_add_u32 s33, s33, 4096
buffer_store_dwordx4 v[168:171], v3, s[68:71], s33 offen offset:0 sc1
buffer_store_dwordx4 v[172:175], v3, s[68:71], s33 offen offset:1024 sc1
buffer_store_dwordx4 v[176:179], v3, s[68:71], s33 offen offset:2048 sc1
buffer_store_dwordx4 v[180:183], v3, s[68:71], s33 offen offset:3072 sc1
s_add_u32 s33, s33, 4096
buffer_store_dwordx4 v[184:187], v3, s[68:71], s33 offen offset:0 sc1
buffer_store_dwordx4 v[188:191], v3, s[68:71], s33 offen offset:1024 sc1
buffer_store_dwordx4 v[192:195], v3, s[68:71], s33 offen offset:2048 sc1
buffer_store_dwordx4 v[196:199], v3, s[68:71], s33 offen offset:3072 sc1
K2_NOQS:
ds_read_b128 v[40:43], v3 offset:16384
ds_read_b128 v[44:47], v3 offset:17408
ds_read_b128 v[48:51], v3 offset:18432
ds_read_b128 v[52:55], v3 offset:19456
ds_read_b128 v[56:59], v3 offset:20480
ds_read_b128 v[60:63], v3 offset:21504
s_cmp_eq_u32 s36, 0
s_cbranch_scc0 K2A_NM0
s_cmp_eq_u32 s37, 1
s_cbranch_scc0 K2A_NM0
s_nop 7
v_mov_b32 v15, 0xff800000
v_cmp_gt_i32 vcc, 0, v6
s_nop 1
v_cndmask_b32 v72, v72, v15, vcc
v_cndmask_b32 v84, v84, v15, vcc
v_mov_b32 v80, v15
v_cmp_gt_i32 vcc, 1, v6
s_nop 1
v_cndmask_b32 v73, v73, v15, vcc
v_cndmask_b32 v85, v85, v15, vcc
v_mov_b32 v81, v15
v_cmp_gt_i32 vcc, 2, v6
s_nop 1
v_cndmask_b32 v74, v74, v15, vcc
v_cndmask_b32 v86, v86, v15, vcc
v_mov_b32 v82, v15
v_cmp_gt_i32 vcc, 3, v6
s_nop 1
v_cndmask_b32 v75, v75, v15, vcc
v_cndmask_b32 v87, v87, v15, vcc
v_mov_b32 v83, v15
K2A_NM0:
s_nop 7
v_max3_f32 v9, v72, v73, v74
v_max3_f32 v9, v9, v75, v80
v_max3_f32 v9, v9, v81, v82
v_max_f32 v9, v9, v83
v_max3_f32 v10, v76, v77, v78
v_max3_f32 v10, v10, v79, v84
v_max3_f32 v10, v10, v85, v86
v_max_f32 v10, v10, v87
ds_bpermute_b32 v11, v4, v9
ds_bpermute_b32 v12, v4, v10
s_waitcnt lgkmcnt(0)
v_max_f32 v9, v9, v11
v_max_f32 v10, v10, v12
ds_bpermute_b32 v11, v5, v9
ds_bpermute_b32 v12, v5, v10
s_waitcnt lgkmcnt(0)
v_max_f32 v9, v9, v11
v_max_f32 v10, v10, v12
v_sub_f32 v32, 0, v9
v_sub_f32 v33, 0, v9
v_sub_f32 v34, 0, v9
v_sub_f32 v35, 0, v9
v_sub_f32 v72, v72, v9
v_sub_f32 v73, v73, v9
v_sub_f32 v74, v74, v9
v_sub_f32 v75, v75, v9
v_sub_f32 v80, v80, v9
v_sub_f32 v81, v81, v9
v_sub_f32 v82, v82, v9
v_sub_f32 v83, v83, v9
v_sub_f32 v36, 0, v10
v_sub_f32 v37, 0, v10
v_sub_f32 v38, 0, v10
v_sub_f32 v39, 0, v10
v_sub_f32 v76, v76, v10
v_sub_f32 v77, v77, v10
v_sub_f32 v78, v78, v10
v_sub_f32 v79, v79, v10
v_sub_f32 v84, v84, v10
v_sub_f32 v85, v85, v10
v_sub_f32 v86, v86, v10
v_sub_f32 v87, v87, v10
v_exp_f32 v104, v72
v_exp_f32 v105, v73
v_exp_f32 v106, v74
v_exp_f32 v107, v75
v_exp_f32 v108, v76
v_exp_f32 v109, v77
v_exp_f32 v110, v78
v_exp_f32 v111, v79
s_nop 0
v_cvt_pk_bf16_f32 v120, v104, v105
v_add_f32 v200, v104, v105
v_cvt_pk_bf16_f32 v121, v106, v107
v_add_f32 v201, v106, v107
v_add_f32 v200, v200, v201
v_cvt_pk_bf16_f32 v124, v108, v109
v_add_f32 v202, v108, v109
v_cvt_pk_bf16_f32 v125, v110, v111
v_add_f32 v203, v110, v111
v_add_f32 v202, v202, v203
s_cmp_eq_u32 s36, 0
s_cbranch_scc1 K2A_LAST0
.p2align 6
K2A_LOOP:
s_waitcnt vmcnt(8) lgkmcnt(4)
s_barrier
v_mfma_f32_16x16x32_bf16 v[88:91], v[40:43], v[136:139], v[32:35]
ds_read_b128 v[64:67], v3 offset:22528
v_mfma_f32_16x16x32_bf16 v[92:95], v[40:43], v[168:171], v[36:39]
v_exp_f32 v112, v80
v_mfma_f32_16x16x32_bf16 v[88:91], v[44:47], v[140:143], v[88:91]
ds_read_b128 v[68:71], v3 offset:23552
v_mfma_f32_16x16x32_bf16 v[92:95], v[44:47], v[172:175], v[92:95]
s_waitcnt lgkmcnt(4)
v_exp_f32 v113, v81
v_mfma_f32_16x16x32_bf16 v[88:91], v[48:51], v[144:147], v[88:91]
s_cmp_eq_u32 s36, s44
ds_read_b128 v[40:43], v3 offset:24576
v_mfma_f32_16x16x32_bf16 v[92:95], v[48:51], v[176:179], v[92:95]
s_cbranch_scc1 K2A_HOOK0
K2A_BACKH0:
v_exp_f32 v114, v82
v_mfma_f32_16x16x32_bf16 v[88:91], v[52:55], v[148:151], v[88:91]
ds_read_b128 v[44:47], v3 offset:25600
v_mfma_f32_16x16x32_bf16 v[92:95], v[52:55], v[180:183], v[92:95]
s_waitcnt lgkmcnt(4)
v_exp_f32 v115, v83
v_mfma_f32_16x16x32_bf16 v[88:91], v[56:59], v[152:155], v[88:91]
ds_read_b128 v[48:51], v3 offset:26624
v_mfma_f32_16x16x32_bf16 v[92:95], v[56:59], v[184:187], v[92:95]
v_exp_f32 v116, v84
v_mfma_f32_16x16x32_bf16 v[88:91], v[60:63], v[156:159], v[88:91]
ds_read_b128 v[52:55], v3 offset:27648
v_cvt_pk_bf16_f32 v122, v112, v113
v_mfma_f32_16x16x32_bf16 v[92:95], v[60:63], v[188:191], v[92:95]
s_waitcnt lgkmcnt(4)
v_exp_f32 v117, v85
v_mfma_f32_16x16x32_bf16 v[88:91], v[64:67], v[160:163], v[88:91]
ds_read_b128 v[56:59], v3 offset:28672
v_add_f32 v201, v112, v113
v_mfma_f32_16x16x32_bf16 v[92:95], v[64:67], v[192:195], v[92:95]
v_exp_f32 v118, v86
v_mfma_f32_16x16x32_bf16 v[88:91], v[68:71], v[164:167], v[88:91]
ds_read_b128 v[60:63], v3 offset:29696
v_cvt_pk_bf16_f32 v123, v114, v115
v_mfma_f32_16x16x32_bf16 v[92:95], v[68:71], v[196:199], v[92:95]
s_waitcnt lgkmcnt(4)
v_exp_f32 v119, v87
v_mfma_f32_16x16x32_bf16 v[96:99], v[40:43], v[136:139], v[32:35]
s_add_u32 m0, s40, 0
ds_read_b128 v[64:67], v3 offset:30720
v_add_f32 v200, v200, v201
v_mfma_f32_16x16x32_bf16 v[100:103], v[40:43], v[168:171], v[36:39]
buffer_load_dwordx4 v3, s[16:19], s39 offen offset:0 sc1 lds
v_mfma_f32_16x16x32_bf16 v[96:99], v[44:47], v[140:143], v[96:99]
ds_read_b128 v[68:71], v3 offset:31744
v_add_f32 v201, v114, v115
v_mfma_f32_16x16x32_bf16 v[100:103], v[44:47], v[172:175], v[100:103]
s_waitcnt lgkmcnt(4)
v_add_f32 v30, v200, v201
v_cvt_pk_bf16_f32 v126, v116, v117
v_mfma_f32_16x16x32_bf16 v[96:99], v[48:51], v[144:147], v[96:99]
ds_read_b128 v[40:43], v7 offset:0
v_add_f32 v203, v116, v117
v_mfma_f32_16x16x32_bf16 v[100:103], v[48:51], v[176:179], v[100:103]
buffer_load_dwordx4 v3, s[16:19], s39 offen offset:1024 sc1 lds
v_mfma_f32_16x16x32_bf16 v[96:99], v[52:55], v[148:151], v[96:99]
ds_read_b128 v[44:47], v7 offset:1024
v_cvt_pk_bf16_f32 v127, v118, v119
v_mfma_f32_16x16x32_bf16 v[100:103], v[52:55], v[180:183], v[100:103]
s_waitcnt lgkmcnt(4)
v_add_f32 v202, v202, v203
v_mfma_f32_16x16x32_bf16 v[96:99], v[56:59], v[152:155], v[96:99]
ds_read_b128 v[48:51], v7 offset:2048
v_add_f32 v203, v118, v119
v_mfma_f32_16x16x32_bf16 v[100:103], v[56:59], v[184:187], v[100:103]
buffer_load_dwordx4 v3, s[16:19], s39 offen offset:2048 sc1 lds
v_mfma_f32_16x16x32_bf16 v[96:99], v[60:63], v[156:159], v[96:99]
ds_read_b128 v[52:55], v7 offset:3072
v_add_f32 v31, v202, v203
v_mfma_f32_16x16x32_bf16 v[100:103], v[60:63], v[188:191], v[100:103]
s_waitcnt lgkmcnt(4)
v_add_f32 v13, v30, v31
v_mfma_f32_16x16x32_bf16 v[96:99], v[64:67], v[160:163], v[96:99]
ds_read_b128 v[56:59], v7 offset:4096
v_cmp_nge_f32 vcc, s43, v13
v_mfma_f32_16x16x32_bf16 v[100:103], v[64:67], v[192:195], v[100:103]
buffer_load_dwordx4 v3, s[16:19], s39 offen offset:3072 sc1 lds
v_mfma_f32_16x16x32_bf16 v[96:99], v[68:71], v[164:167], v[96:99]
ds_read_b128 v[60:63], v7 offset:5120
v_mfma_f32_16x16x32_bf16 v[100:103], v[68:71], v[196:199], v[100:103]
s_waitcnt lgkmcnt(4)
s_cbranch_vccnz K2A_SLOW0
K2A_BACK0:
v_mfma_f32_16x16x32_bf16 a[0:3], v[40:43], v[120:123], a[0:3]
s_cmp_eq_u32 s36, s37
ds_read_b128 v[64:67], v7 offset:6144
v_add_f32 v28, v28, v30
v_mfma_f32_16x16x32_bf16 a[4:7], v[40:43], v[124:127], a[4:7]
s_cbranch_scc1 K2A_MASK0
K2A_BACKM0:
v_exp_f32 v104, v88
v_mfma_f32_16x16x32_bf16 a[8:11], v[44:47], v[120:123], a[8:11]
ds_read_b128 v[68:71], v7 offset:7168
v_add_f32 v29, v29, v31
v_mfma_f32_16x16x32_bf16 a[12:15], v[44:47], v[124:127], a[12:15]
s_waitcnt lgkmcnt(4)
v_exp_f32 v105, v89
v_mfma_f32_16x16x32_bf16 a[16:19], v[48:51], v[120:123], a[16:19]
ds_read_b128 v[40:43], v7 offset:8192
v_mfma_f32_16x16x32_bf16 a[20:23], v[48:51], v[124:127], a[20:23]
v_exp_f32 v106, v90
v_mfma_f32_16x16x32_bf16 a[24:27], v[52:55], v[120:123], a[24:27]
ds_read_b128 v[44:47], v7 offset:9216
v_mfma_f32_16x16x32_bf16 a[28:31], v[52:55], v[124:127], a[28:31]
s_waitcnt lgkmcnt(4)
v_exp_f32 v107, v91
v_mfma_f32_16x16x32_bf16 a[32:35], v[56:59], v[120:123], a[32:35]
ds_read_b128 v[48:51], v7 offset:10240
v_mfma_f32_16x16x32_bf16 a[36:39], v[56:59], v[124:127], a[36:39]
v_exp_f32 v108, v92
v_mfma_f32_16x16x32_bf16 a[40:43], v[60:63], v[120:123], a[40:43]
ds_read_b128 v[52:55], v7 offset:11264
v_cvt_pk_bf16_f32 v128, v104, v105
v_mfma_f32_16x16x32_bf16 a[44:47], v[60:63], v[124:127], a[44:47]
s_waitcnt lgkmcnt(4)
v_exp_f32 v109, v93
v_mfma_f32_16x16x32_bf16 a[48:51], v[64:67], v[120:123], a[48:51]
ds_read_b128 v[56:59], v7 offset:12288
v_add_f32 v200, v104, v105
v_mfma_f32_16x16x32_bf16 a[52:55], v[64:67], v[124:127], a[52:55]
v_exp_f32 v110, v94
v_mfma_f32_16x16x32_bf16 a[56:59], v[68:71], v[120:123], a[56:59]
ds_read_b128 v[60:63], v7 offset:13312
v_cvt_pk_bf16_f32 v129, v106, v107
v_mfma_f32_16x16x32_bf16 a[60:63], v[68:71], v[124:127], a[60:63]
s_waitcnt lgkmcnt(4)
v_exp_f32 v111, v95
v_mfma_f32_16x16x32_bf16 a[64:67], v[40:43], v[120:123], a[64:67]
s_add_u32 m0, s40, 147456
ds_read_b128 v[64:67], v7 offset:14336
v_add_f32 v201, v106, v107
v_mfma_f32_16x16x32_bf16 a[68:71], v[40:43], v[124:127], a[68:71]
buffer_load_dwordx4 v3, s[20:23], s39 offen offset:0 sc1 lds
v_mfma_f32_16x16x32_bf16 a[72:75], v[44:47], v[120:123], a[72:75]
ds_read_b128 v[68:71], v7 offset:15360
v_add_f32 v200, v200, v201
v_mfma_f32_16x16x32_bf16 a[76:79], v[44:47], v[124:127], a[76:79]
s_waitcnt lgkmcnt(4)
v_cvt_pk_bf16_f32 v132, v108, v109
v_mfma_f32_16x16x32_bf16 a[80:83], v[48:51], v[120:123], a[80:83]
ds_read_b128 v[40:43], v3 offset:32768
v_add_f32 v202, v108, v109
v_mfma_f32_16x16x32_bf16 a[84:87], v[48:51], v[124:127], a[84:87]
buffer_load_dwordx4 v3, s[20:23], s39 offen offset:1024 sc1 lds
v_mfma_f32_16x16x32_bf16 a[88:91], v[52:55], v[120:123], a[88:91]
ds_read_b128 v[44:47], v3 offset:33792
v_cvt_pk_bf16_f32 v133, v110, v111
v_mfma_f32_16x16x32_bf16 a[92:95], v[52:55], v[124:127], a[92:95]
s_waitcnt lgkmcnt(4)
v_add_f32 v203, v110, v111
v_mfma_f32_16x16x32_bf16 a[96:99], v[56:59], v[120:123], a[96:99]
ds_read_b128 v[48:51], v3 offset:34816
v_add_f32 v202, v202, v203
v_mfma_f32_16x16x32_bf16 a[100:103], v[56:59], v[124:127], a[100:103]
buffer_load_dwordx4 v3, s[20:23], s39 offen offset:2048 sc1 lds
v_mfma_f32_16x16x32_bf16 a[104:107], v[60:63], v[120:123], a[104:107]
ds_read_b128 v[52:55], v3 offset:35840
v_mfma_f32_16x16x32_bf16 a[108:111], v[60:63], v[124:127], a[108:111]
s_waitcnt lgkmcnt(4)
v_mfma_f32_16x16x32_bf16 a[112:115], v[64:67], v[120:123], a[112:115]
s_sub_u32 s36, s36, 1
ds_read_b128 v[56:59], v3 offset:36864
v_mfma_f32_16x16x32_bf16 a[116:119], v[64:67], v[124:127], a[116:119]
buffer_load_dwordx4 v3, s[20:23], s39 offen offset:3072 sc1 lds
v_mfma_f32_16x16x32_bf16 a[120:123], v[68:71], v[120:123], a[120:123]
s_add_u32 s39, s39, 16384
ds_read_b128 v[60:63], v3 offset:37888
v_mfma_f32_16x16x32_bf16 a[124:127], v[68:71], v[124:127], a[124:127]
s_cmp_eq_u32 s36, 0
s_cbranch_scc1 K2A_LAST1
s_waitcnt vmcnt(8) lgkmcnt(4)
s_barrier
v_mfma_f32_16x16x32_bf16 v[72:75], v[40:43], v[136:139], v[32:35]
ds_read_b128 v[64:67], v3 offset:38912
v_mfma_f32_16x16x32_bf16 v[76:79], v[40:43], v[168:171], v[36:39]
v_exp_f32 v112, v96
v_mfma_f32_16x16x32_bf16 v[72:75], v[44:47], v[140:143], v[72:75]
ds_read_b128 v[68:71], v3 offset:39936
v_mfma_f32_16x16x32_bf16 v[76:79], v[44:47], v[172:175], v[76:79]
s_waitcnt lgkmcnt(4)
v_exp_f32 v113, v97
v_mfma_f32_16x16x32_bf16 v[72:75], v[48:51], v[144:147], v[72:75]
s_cmp_eq_u32 s36, s44
ds_read_b128 v[40:43], v3 offset:40960
v_mfma_f32_16x16x32_bf16 v[76:79], v[48:51], v[176:179], v[76:79]
s_cbranch_scc1 K2A_HOOK1
K2A_BACKH1:
v_exp_f32 v114, v98
v_mfma_f32_16x16x32_bf16 v[72:75], v[52:55], v[148:151], v[72:75]
ds_read_b128 v[44:47], v3 offset:41984
v_mfma_f32_16x16x32_bf16 v[76:79], v[52:55], v[180:183], v[76:79]
s_waitcnt lgkmcnt(4)
v_exp_f32 v115, v99
v_mfma_f32_16x16x32_bf16 v[72:75], v[56:59], v[152:155], v[72:75]
ds_read_b128 v[48:51], v3 offset:43008
v_mfma_f32_16x16x32_bf16 v[76:79], v[56:59], v[184:187], v[76:79]
v_exp_f32 v116, v100
v_mfma_f32_16x16x32_bf16 v[72:75], v[60:63], v[156:159], v[72:75]
ds_read_b128 v[52:55], v3 offset:44032
v_cvt_pk_bf16_f32 v130, v112, v113
v_mfma_f32_16x16x32_bf16 v[76:79], v[60:63], v[188:191], v[76:79]
s_waitcnt lgkmcnt(4)
v_exp_f32 v117, v101
v_mfma_f32_16x16x32_bf16 v[72:75], v[64:67], v[160:163], v[72:75]
ds_read_b128 v[56:59], v3 offset:45056
v_add_f32 v201, v112, v113
v_mfma_f32_16x16x32_bf16 v[76:79], v[64:67], v[192:195], v[76:79]
v_exp_f32 v118, v102
v_mfma_f32_16x16x32_bf16 v[72:75], v[68:71], v[164:167], v[72:75]
ds_read_b128 v[60:63], v3 offset:46080
v_cvt_pk_bf16_f32 v131, v114, v115
v_mfma_f32_16x16x32_bf16 v[76:79], v[68:71], v[196:199], v[76:79]
s_waitcnt lgkmcnt(4)
v_exp_f32 v119, v103
v_mfma_f32_16x16x32_bf16 v[80:83], v[40:43], v[136:139], v[32:35]
s_add_u32 m0, s40, 16384
ds_read_b128 v[64:67], v3 offset:47104
v_add_f32 v200, v200, v201
v_mfma_f32_16x16x32_bf16 v[84:87], v[40:43], v[168:171], v[36:39]
buffer_load_dwordx4 v3, s[16:19], s39 offen offset:0 sc1 lds
v_mfma_f32_16x16x32_bf16 v[80:83], v[44:47], v[140:143], v[80:83]
ds_read_b128 v[68:71], v3 offset:48128
v_add_f32 v201, v114, v115
v_mfma_f32_16x16x32_bf16 v[84:87], v[44:47], v[172:175], v[84:87]
s_waitcnt lgkmcnt(4)
v_add_f32 v30, v200, v201
v_cvt_pk_bf16_f32 v134, v116, v117
v_mfma_f32_16x16x32_bf16 v[80:83], v[48:51], v[144:147], v[80:83]
ds_read_b128 v[40:43], v7 offset:16384
v_add_f32 v203, v116, v117
v_mfma_f32_16x16x32_bf16 v[84:87], v[48:51], v[176:179], v[84:87]
buffer_load_dwordx4 v3, s[16:19], s39 offen offset:1024 sc1 lds
v_mfma_f32_16x16x32_bf16 v[80:83], v[52:55], v[148:151], v[80:83]
ds_read_b128 v[44:47], v7 offset:17408
v_cvt_pk_bf16_f32 v135, v118, v119
v_mfma_f32_16x16x32_bf16 v[84:87], v[52:55], v[180:183], v[84:87]
s_waitcnt lgkmcnt(4)
v_add_f32 v202, v202, v203
v_mfma_f32_16x16x32_bf16 v[80:83], v[56:59], v[152:155], v[80:83]
ds_read_b128 v[48:51], v7 offset:18432
v_add_f32 v203, v118, v119
v_mfma_f32_16x16x32_bf16 v[84:87], v[56:59], v[184:187], v[84:87]
buffer_load_dwordx4 v3, s[16:19], s39 offen offset:2048 sc1 lds
v_mfma_f32_16x16x32_bf16 v[80:83], v[60:63], v[156:159], v[80:83]
ds_read_b128 v[52:55], v7 offset:19456
v_add_f32 v31, v202, v203
v_mfma_f32_16x16x32_bf16 v[84:87], v[60:63], v[188:191], v[84:87]
s_waitcnt lgkmcnt(4)
v_add_f32 v13, v30, v31
v_mfma_f32_16x16x32_bf16 v[80:83], v[64:67], v[160:163], v[80:83]
ds_read_b128 v[56:59], v7 offset:20480
v_cmp_nge_f32 vcc, s43, v13
v_mfma_f32_16x16x32_bf16 v[84:87], v[64:67], v[192:195], v[84:87]
buffer_load_dwordx4 v3, s[16:19], s39 offen offset:3072 sc1 lds
v_mfma_f32_16x16x32_bf16 v[80:83], v[68:71], v[164:167], v[80:83]
ds_read_b128 v[60:63], v7 offset:21504
v_mfma_f32_16x16x32_bf16 v[84:87], v[68:71], v[196:199], v[84:87]
s_waitcnt lgkmcnt(4)
s_cbranch_vccnz K2A_SLOW1
K2A_BACK1:
v_mfma_f32_16x16x32_bf16 a[0:3], v[40:43], v[128:131], a[0:3]
s_cmp_eq_u32 s36, s37
ds_read_b128 v[64:67], v7 offset:22528
v_add_f32 v28, v28, v30
v_mfma_f32_16x16x32_bf16 a[4:7], v[40:43], v[132:135], a[4:7]
s_cbranch_scc1 K2A_MASK1
K2A_BACKM1:
v_exp_f32 v104, v72
v_mfma_f32_16x16x32_bf16 a[8:11], v[44:47], v[128:131], a[8:11]
ds_read_b128 v[68:71], v7 offset:23552
v_add_f32 v29, v29, v31
v_mfma_f32_16x16x32_bf16 a[12:15], v[44:47], v[132:135], a[12:15]
s_waitcnt lgkmcnt(4)
v_exp_f32 v105, v73
v_mfma_f32_16x16x32_bf16 a[16:19], v[48:51], v[128:131], a[16:19]
ds_read_b128 v[40:43], v7 offset:24576
v_mfma_f32_16x16x32_bf16 a[20:23], v[48:51], v[132:135], a[20:23]
v_exp_f32 v106, v74
v_mfma_f32_16x16x32_bf16 a[24:27], v[52:55], v[128:131], a[24:27]
ds_read_b128 v[44:47], v7 offset:25600
v_mfma_f32_16x16x32_bf16 a[28:31], v[52:55], v[132:135], a[28:31]
s_waitcnt lgkmcnt(4)
v_exp_f32 v107, v75
v_mfma_f32_16x16x32_bf16 a[32:35], v[56:59], v[128:131], a[32:35]
ds_read_b128 v[48:51], v7 offset:26624
v_mfma_f32_16x16x32_bf16 a[36:39], v[56:59], v[132:135], a[36:39]
v_exp_f32 v108, v76
v_mfma_f32_16x16x32_bf16 a[40:43], v[60:63], v[128:131], a[40:43]
ds_read_b128 v[52:55], v7 offset:27648
v_cvt_pk_bf16_f32 v120, v104, v105
v_mfma_f32_16x16x32_bf16 a[44:47], v[60:63], v[132:135], a[44:47]
s_waitcnt lgkmcnt(4)
v_exp_f32 v109, v77
v_mfma_f32_16x16x32_bf16 a[48:51], v[64:67], v[128:131], a[48:51]
ds_read_b128 v[56:59], v7 offset:28672
v_add_f32 v200, v104, v105
v_mfma_f32_16x16x32_bf16 a[52:55], v[64:67], v[132:135], a[52:55]
v_exp_f32 v110, v78
v_mfma_f32_16x16x32_bf16 a[56:59], v[68:71], v[128:131], a[56:59]
ds_read_b128 v[60:63], v7 offset:29696
v_cvt_pk_bf16_f32 v121, v106, v107
v_mfma_f32_16x16x32_bf16 a[60:63], v[68:71], v[132:135], a[60:63]
s_waitcnt lgkmcnt(4)
v_exp_f32 v111, v79
v_mfma_f32_16x16x32_bf16 a[64:67], v[40:43], v[128:131], a[64:67]
s_add_u32 m0, s40, 98304
ds_read_b128 v[64:67], v7 offset:30720
v_add_f32 v201, v106, v107
v_mfma_f32_16x16x32_bf16 a[68:71], v[40:43], v[132:135], a[68:71]
buffer_load_dwordx4 v3, s[20:23], s39 offen offset:0 sc1 lds
v_mfma_f32_16x16x32_bf16 a[72:75], v[44:47], v[128:131], a[72:75]
ds_read_b128 v[68:71], v7 offset:31744
v_add_f32 v200, v200, v201
v_mfma_f32_16x16x32_bf16 a[76:79], v[44:47], v[132:135], a[76:79]
s_waitcnt lgkmcnt(4)
v_cvt_pk_bf16_f32 v124, v108, v109
v_mfma_f32_16x16x32_bf16 a[80:83], v[48:51], v[128:131], a[80:83]
ds_read_b128 v[40:43], v3 offset:49152
v_add_f32 v202, v108, v109
v_mfma_f32_16x16x32_bf16 a[84:87], v[48:51], v[132:135], a[84:87]
buffer_load_dwordx4 v3, s[20:23], s39 offen offset:1024 sc1 lds
v_mfma_f32_16x16x32_bf16 a[88:91], v[52:55], v[128:131], a[88:91]
ds_read_b128 v[44:47], v3 offset:50176
v_cvt_pk_bf16_f32 v125, v110, v111
v_mfma_f32_16x16x32_bf16 a[92:95], v[52:55], v[132:135], a[92:95]
s_waitcnt lgkmcnt(4)
v_add_f32 v203, v110, v111
v_mfma_f32_16x16x32_bf16 a[96:99], v[56:59], v[128:131], a[96:99]
ds_read_b128 v[48:51], v3 offset:51200
v_add_f32 v202, v202, v203
v_mfma_f32_16x16x32_bf16 a[100:103], v[56:59], v[132:135], a[100:103]
buffer_load_dwordx4 v3, s[20:23], s39 offen offset:2048 sc1 lds
v_mfma_f32_16x16x32_bf16 a[104:107], v[60:63], v[128:131], a[104:107]
ds_read_b128 v[52:55], v3 offset:52224
v_mfma_f32_16x16x32_bf16 a[108:111], v[60:63], v[132:135], a[108:111]
s_waitcnt lgkmcnt(4)
v_mfma_f32_16x16x32_bf16 a[112:115], v[64:67], v[128:131], a[112:115]
s_sub_u32 s36, s36, 1
ds_read_b128 v[56:59], v3 offset:53248
v_mfma_f32_16x16x32_bf16 a[116:119], v[64:67], v[132:135], a[116:119]
buffer_load_dwordx4 v3, s[20:23], s39 offen offset:3072 sc1 lds
v_mfma_f32_16x16x32_bf16 a[120:123], v[68:71], v[128:131], a[120:123]
s_add_u32 s39, s39, 16384
ds_read_b128 v[60:63], v3 offset:54272
v_mfma_f32_16x16x32_bf16 a[124:127], v[68:71], v[132:135], a[124:127]
s_cmp_eq_u32 s36, 0
s_cbranch_scc1 K2A_LAST2
s_waitcnt vmcnt(8) lgkmcnt(4)
s_barrier
v_mfma_f32_16x16x32_bf16 v[88:91], v[40:43], v[136:139], v[32:35]
ds_read_b128 v[64:67], v3 offset:55296
v_mfma_f32_16x16x32_bf16 v[92:95], v[40:43], v[168:171], v[36:39]
v_exp_f32 v112, v80
v_mfma_f32_16x16x32_bf16 v[88:91], v[44:47], v[140:143], v[88:91]
ds_read_b128 v[68:71], v3 offset:56320
v_mfma_f32_16x16x32_bf16 v[92:95], v[44:47], v[172:175], v[92:95]
s_waitcnt lgkmcnt(4)
v_exp_f32 v113, v81
v_mfma_f32_16x16x32_bf16 v[88:91], v[48:51], v[144:147], v[88:91]
s_cmp_eq_u32 s36, s44
ds_read_b128 v[40:43], v3 offset:57344
v_mfma_f32_16x16x32_bf16 v[92:95], v[48:51], v[176:179], v[92:95]
s_cbranch_scc1 K2A_HOOK2
K2A_BACKH2:
v_exp_f32 v114, v82
v_mfma_f32_16x16x32_bf16 v[88:91], v[52:55], v[148:151], v[88:91]
ds_read_b128 v[44:47], v3 offset:58368
v_mfma_f32_16x16x32_bf16 v[92:95], v[52:55], v[180:183], v[92:95]
s_waitcnt lgkmcnt(4)
v_exp_f32 v115, v83
v_mfma_f32_16x16x32_bf16 v[88:91], v[56:59], v[152:155], v[88:91]
ds_read_b128 v[48:51], v3 offset:59392
v_mfma_f32_16x16x32_bf16 v[92:95], v[56:59], v[184:187], v[92:95]
v_exp_f32 v116, v84
v_mfma_f32_16x16x32_bf16 v[88:91], v[60:63], v[156:159], v[88:91]
ds_read_b128 v[52:55], v3 offset:60416
v_cvt_pk_bf16_f32 v122, v112, v113
v_mfma_f32_16x16x32_bf16 v[92:95], v[60:63], v[188:191], v[92:95]
s_waitcnt lgkmcnt(4)
v_exp_f32 v117, v85
v_mfma_f32_16x16x32_bf16 v[88:91], v[64:67], v[160:163], v[88:91]
ds_read_b128 v[56:59], v3 offset:61440
v_add_f32 v201, v112, v113
v_mfma_f32_16x16x32_bf16 v[92:95], v[64:67], v[192:195], v[92:95]
v_exp_f32 v118, v86
v_mfma_f32_16x16x32_bf16 v[88:91], v[68:71], v[164:167], v[88:91]
ds_read_b128 v[60:63], v3 offset:62464
v_cvt_pk_bf16_f32 v123, v114, v115
v_mfma_f32_16x16x32_bf16 v[92:95], v[68:71], v[196:199], v[92:95]
s_waitcnt lgkmcnt(4)
v_exp_f32 v119, v87
v_mfma_f32_16x16x32_bf16 v[96:99], v[40:43], v[136:139], v[32:35]
s_add_u32 m0, s40, 32768
ds_read_b128 v[64:67], v3 offset:63488
v_add_f32 v200, v200, v201
v_mfma_f32_16x16x32_bf16 v[100:103], v[40:43], v[168:171], v[36:39]
buffer_load_dwordx4 v3, s[16:19], s39 offen offset:0 sc1 lds
v_mfma_f32_16x16x32_bf16 v[96:99], v[44:47], v[140:143], v[96:99]
ds_read_b128 v[68:71], v3 offset:64512
v_add_f32 v201, v114, v115
v_mfma_f32_16x16x32_bf16 v[100:103], v[44:47], v[172:175], v[100:103]
s_waitcnt lgkmcnt(4)
v_add_f32 v30, v200, v201
v_cvt_pk_bf16_f32 v126, v116, v117
v_mfma_f32_16x16x32_bf16 v[96:99], v[48:51], v[144:147], v[96:99]
ds_read_b128 v[40:43], v7 offset:32768
v_add_f32 v203, v116, v117
v_mfma_f32_16x16x32_bf16 v[100:103], v[48:51], v[176:179], v[100:103]
buffer_load_dwordx4 v3, s[16:19], s39 offen offset:1024 sc1 lds
v_mfma_f32_16x16x32_bf16 v[96:99], v[52:55], v[148:151], v[96:99]
ds_read_b128 v[44:47], v7 offset:33792
v_cvt_pk_bf16_f32 v127, v118, v119
v_mfma_f32_16x16x32_bf16 v[100:103], v[52:55], v[180:183], v[100:103]
s_waitcnt lgkmcnt(4)
v_add_f32 v202, v202, v203
v_mfma_f32_16x16x32_bf16 v[96:99], v[56:59], v[152:155], v[96:99]
ds_read_b128 v[48:51], v7 offset:34816
v_add_f32 v203, v118, v119
v_mfma_f32_16x16x32_bf16 v[100:103], v[56:59], v[184:187], v[100:103]
buffer_load_dwordx4 v3, s[16:19], s39 offen offset:2048 sc1 lds
v_mfma_f32_16x16x32_bf16 v[96:99], v[60:63], v[156:159], v[96:99]
ds_read_b128 v[52:55], v7 offset:35840
v_add_f32 v31, v202, v203
v_mfma_f32_16x16x32_bf16 v[100:103], v[60:63], v[188:191], v[100:103]
s_waitcnt lgkmcnt(4)
v_add_f32 v13, v30, v31
v_mfma_f32_16x16x32_bf16 v[96:99], v[64:67], v[160:163], v[96:99]
ds_read_b128 v[56:59], v7 offset:36864
v_cmp_nge_f32 vcc, s43, v13
v_mfma_f32_16x16x32_bf16 v[100:103], v[64:67], v[192:195], v[100:103]
buffer_load_dwordx4 v3, s[16:19], s39 offen offset:3072 sc1 lds
v_mfma_f32_16x16x32_bf16 v[96:99], v[68:71], v[164:167], v[96:99]
ds_read_b128 v[60:63], v7 offset:37888
v_mfma_f32_16x16x32_bf16 v[100:103], v[68:71], v[196:199], v[100:103]
s_waitcnt lgkmcnt(4)
s_cbranch_vccnz K2A_SLOW2
K2A_BACK2:
v_mfma_f32_16x16x32_bf16 a[0:3], v[40:43], v[120:123], a[0:3]
s_cmp_eq_u32 s36, s37
ds_read_b128 v[64:67], v7 offset:38912
v_add_f32 v28, v28, v30
v_mfma_f32_16x16x32_bf16 a[4:7], v[40:43], v[124:127], a[4:7]
s_cbranch_scc1 K2A_MASK2
K2A_BACKM2:
v_exp_f32 v104, v88
v_mfma_f32_16x16x32_bf16 a[8:11], v[44:47], v[120:123], a[8:11]
ds_read_b128 v[68:71], v7 offset:39936
v_add_f32 v29, v29, v31
v_mfma_f32_16x16x32_bf16 a[12:15], v[44:47], v[124:127], a[12:15]
s_waitcnt lgkmcnt(4)
v_exp_f32 v105, v89
v_mfma_f32_16x16x32_bf16 a[16:19], v[48:51], v[120:123], a[16:19]
ds_read_b128 v[40:43], v7 offset:40960
v_mfma_f32_16x16x32_bf16 a[20:23], v[48:51], v[124:127], a[20:23]
v_exp_f32 v106, v90
v_mfma_f32_16x16x32_bf16 a[24:27], v[52:55], v[120:123], a[24:27]
ds_read_b128 v[44:47], v7 offset:41984
v_mfma_f32_16x16x32_bf16 a[28:31], v[52:55], v[124:127], a[28:31]
s_waitcnt lgkmcnt(4)
v_exp_f32 v107, v91
v_mfma_f32_16x16x32_bf16 a[32:35], v[56:59], v[120:123], a[32:35]
ds_read_b128 v[48:51], v7 offset:43008
v_mfma_f32_16x16x32_bf16 a[36:39], v[56:59], v[124:127], a[36:39]
v_exp_f32 v108, v92
v_mfma_f32_16x16x32_bf16 a[40:43], v[60:63], v[120:123], a[40:43]
ds_read_b128 v[52:55], v7 offset:44032
v_cvt_pk_bf16_f32 v128, v104, v105
v_mfma_f32_16x16x32_bf16 a[44:47], v[60:63], v[124:127], a[44:47]
s_waitcnt lgkmcnt(4)
v_exp_f32 v109, v93
v_mfma_f32_16x16x32_bf16 a[48:51], v[64:67], v[120:123], a[48:51]
ds_read_b128 v[56:59], v7 offset:45056
v_add_f32 v200, v104, v105
v_mfma_f32_16x16x32_bf16 a[52:55], v[64:67], v[124:127], a[52:55]
v_exp_f32 v110, v94
v_mfma_f32_16x16x32_bf16 a[56:59], v[68:71], v[120:123], a[56:59]
ds_read_b128 v[60:63], v7 offset:46080
v_cvt_pk_bf16_f32 v129, v106, v107
v_mfma_f32_16x16x32_bf16 a[60:63], v[68:71], v[124:127], a[60:63]
s_waitcnt lgkmcnt(4)
v_exp_f32 v111, v95
v_mfma_f32_16x16x32_bf16 a[64:67], v[40:43], v[120:123], a[64:67]
s_add_u32 m0, s40, 114688
ds_read_b128 v[64:67], v7 offset:47104
v_add_f32 v201, v106, v107
v_mfma_f32_16x16x32_bf16 a[68:71], v[40:43], v[124:127], a[68:71]
buffer_load_dwordx4 v3, s[20:23], s39 offen offset:0 sc1 lds
v_mfma_f32_16x16x32_bf16 a[72:75], v[44:47], v[120:123], a[72:75]
ds_read_b128 v[68:71], v7 offset:48128
v_add_f32 v200, v200, v201
v_mfma_f32_16x16x32_bf16 a[76:79], v[44:47], v[124:127], a[76:79]
s_waitcnt lgkmcnt(4)
v_cvt_pk_bf16_f32 v132, v108, v109
v_mfma_f32_16x16x32_bf16 a[80:83], v[48:51], v[120:123], a[80:83]
ds_read_b128 v[40:43], v3 offset:0
v_add_f32 v202, v108, v109
v_mfma_f32_16x16x32_bf16 a[84:87], v[48:51], v[124:127], a[84:87]
buffer_load_dwordx4 v3, s[20:23], s39 offen offset:1024 sc1 lds
v_mfma_f32_16x16x32_bf16 a[88:91], v[52:55], v[120:123], a[88:91]
ds_read_b128 v[44:47], v3 offset:1024
v_cvt_pk_bf16_f32 v133, v110, v111
v_mfma_f32_16x16x32_bf16 a[92:95], v[52:55], v[124:127], a[92:95]
s_waitcnt lgkmcnt(4)
v_add_f32 v203, v110, v111
v_mfma_f32_16x16x32_bf16 a[96:99], v[56:59], v[120:123], a[96:99]
ds_read_b128 v[48:51], v3 offset:2048
v_add_f32 v202, v202, v203
v_mfma_f32_16x16x32_bf16 a[100:103], v[56:59], v[124:127], a[100:103]
buffer_load_dwordx4 v3, s[20:23], s39 offen offset:2048 sc1 lds
v_mfma_f32_16x16x32_bf16 a[104:107], v[60:63], v[120:123], a[104:107]
ds_read_b128 v[52:55], v3 offset:3072
v_mfma_f32_16x16x32_bf16 a[108:111], v[60:63], v[124:127], a[108:111]
s_waitcnt lgkmcnt(4)
v_mfma_f32_16x16x32_bf16 a[112:115], v[64:67], v[120:123], a[112:115]
s_sub_u32 s36, s36, 1
ds_read_b128 v[56:59], v3 offset:4096
v_mfma_f32_16x16x32_bf16 a[116:119], v[64:67], v[124:127], a[116:119]
buffer_load_dwordx4 v3, s[20:23], s39 offen offset:3072 sc1 lds
v_mfma_f32_16x16x32_bf16 a[120:123], v[68:71], v[120:123], a[120:123]
s_add_u32 s39, s39, 16384
ds_read_b128 v[60:63], v3 offset:5120
v_mfma_f32_16x16x32_bf16 a[124:127], v[68:71], v[124:127], a[124:127]
s_cmp_eq_u32 s36, 0
s_cbranch_scc1 K2A_LAST3
s_waitcnt vmcnt(8) lgkmcnt(4)
s_barrier
v_mfma_f32_16x16x32_bf16 v[72:75], v[40:43], v[136:139], v[32:35]
ds_read_b128 v[64:67], v3 offset:6144
v_mfma_f32_16x16x32_bf16 v[76:79], v[40:43], v[168:171], v[36:39]
v_exp_f32 v112, v96
v_mfma_f32_16x16x32_bf16 v[72:75], v[44:47], v[140:143], v[72:75]
ds_read_b128 v[68:71], v3 offset:7168
v_mfma_f32_16x16x32_bf16 v[76:79], v[44:47], v[172:175], v[76:79]
s_waitcnt lgkmcnt(4)
v_exp_f32 v113, v97
v_mfma_f32_16x16x32_bf16 v[72:75], v[48:51], v[144:147], v[72:75]
s_cmp_eq_u32 s36, s44
ds_read_b128 v[40:43], v3 offset:8192
v_mfma_f32_16x16x32_bf16 v[76:79], v[48:51], v[176:179], v[76:79]
s_cbranch_scc1 K2A_HOOK3
K2A_BACKH3:
v_exp_f32 v114, v98
v_mfma_f32_16x16x32_bf16 v[72:75], v[52:55], v[148:151], v[72:75]
ds_read_b128 v[44:47], v3 offset:9216
v_mfma_f32_16x16x32_bf16 v[76:79], v[52:55], v[180:183], v[76:79]
s_waitcnt lgkmcnt(4)
v_exp_f32 v115, v99
v_mfma_f32_16x16x32_bf16 v[72:75], v[56:59], v[152:155], v[72:75]
ds_read_b128 v[48:51], v3 offset:10240
v_mfma_f32_16x16x32_bf16 v[76:79], v[56:59], v[184:187], v[76:79]
v_exp_f32 v116, v100
v_mfma_f32_16x16x32_bf16 v[72:75], v[60:63], v[156:159], v[72:75]
ds_read_b128 v[52:55], v3 offset:11264
v_cvt_pk_bf16_f32 v130, v112, v113
v_mfma_f32_16x16x32_bf16 v[76:79], v[60:63], v[188:191], v[76:79]
s_waitcnt lgkmcnt(4)
v_exp_f32 v117, v101
v_mfma_f32_16x16x32_bf16 v[72:75], v[64:67], v[160:163], v[72:75]
ds_read_b128 v[56:59], v3 offset:12288
v_add_f32 v201, v112, v113
v_mfma_f32_16x16x32_bf16 v[76:79], v[64:67], v[192:195], v[76:79]
v_exp_f32 v118, v102
v_mfma_f32_16x16x32_bf16 v[72:75], v[68:71], v[164:167], v[72:75]
ds_read_b128 v[60:63], v3 offset:13312
v_cvt_pk_bf16_f32 v131, v114, v115
v_mfma_f32_16x16x32_bf16 v[76:79], v[68:71], v[196:199], v[76:79]
s_waitcnt lgkmcnt(4)
v_exp_f32 v119, v103
v_mfma_f32_16x16x32_bf16 v[80:83], v[40:43], v[136:139], v[32:35]
s_add_u32 m0, s40, 49152
ds_read_b128 v[64:67], v3 offset:14336
v_add_f32 v200, v200, v201
v_mfma_f32_16x16x32_bf16 v[84:87], v[40:43], v[168:171], v[36:39]
buffer_load_dwordx4 v3, s[16:19], s39 offen offset:0 sc1 lds
v_mfma_f32_16x16x32_bf16 v[80:83], v[44:47], v[140:143], v[80:83]
ds_read_b128 v[68:71], v3 offset:15360
v_add_f32 v201, v114, v115
v_mfma_f32_16x16x32_bf16 v[84:87], v[44:47], v[172:175], v[84:87]
s_waitcnt lgkmcnt(4)
v_add_f32 v30, v200, v201
v_cvt_pk_bf16_f32 v134, v116, v117
v_mfma_f32_16x16x32_bf16 v[80:83], v[48:51], v[144:147], v[80:83]
ds_read_b128 v[40:43], v7 offset:49152
v_add_f32 v203, v116, v117
v_mfma_f32_16x16x32_bf16 v[84:87], v[48:51], v[176:179], v[84:87]
buffer_load_dwordx4 v3, s[16:19], s39 offen offset:1024 sc1 lds
v_mfma_f32_16x16x32_bf16 v[80:83], v[52:55], v[148:151], v[80:83]
ds_read_b128 v[44:47], v7 offset:50176
v_cvt_pk_bf16_f32 v135, v118, v119
v_mfma_f32_16x16x32_bf16 v[84:87], v[52:55], v[180:183], v[84:87]
s_waitcnt lgkmcnt(4)
v_add_f32 v202, v202, v203
v_mfma_f32_16x16x32_bf16 v[80:83], v[56:59], v[152:155], v[80:83]
ds_read_b128 v[48:51], v7 offset:51200
v_add_f32 v203, v118, v119
v_mfma_f32_16x16x32_bf16 v[84:87], v[56:59], v[184:187], v[84:87]
buffer_load_dwordx4 v3, s[16:19], s39 offen offset:2048 sc1 lds
v_mfma_f32_16x16x32_bf16 v[80:83], v[60:63], v[156:159], v[80:83]
ds_read_b128 v[52:55], v7 offset:52224
v_add_f32 v31, v202, v203
v_mfma_f32_16x16x32_bf16 v[84:87], v[60:63], v[188:191], v[84:87]
s_waitcnt lgkmcnt(4)
v_add_f32 v13, v30, v31
v_mfma_f32_16x16x32_bf16 v[80:83], v[64:67], v[160:163], v[80:83]
ds_read_b128 v[56:59], v7 offset:53248
v_cmp_nge_f32 vcc, s43, v13
v_mfma_f32_16x16x32_bf16 v[84:87], v[64:67], v[192:195], v[84:87]
buffer_load_dwordx4 v3, s[16:19], s39 offen offset:3072 sc1 lds
v_mfma_f32_16x16x32_bf16 v[80:83], v[68:71], v[164:167], v[80:83]
ds_read_b128 v[60:63], v7 offset:54272
v_mfma_f32_16x16x32_bf16 v[84:87], v[68:71], v[196:199], v[84:87]
s_waitcnt lgkmcnt(4)
s_cbranch_vccnz K2A_SLOW3
K2A_BACK3:
v_mfma_f32_16x16x32_bf16 a[0:3], v[40:43], v[128:131], a[0:3]
s_cmp_eq_u32 s36, s37
ds_read_b128 v[64:67], v7 offset:55296
v_add_f32 v28, v28, v30
v_mfma_f32_16x16x32_bf16 a[4:7], v[40:43], v[132:135], a[4:7]
s_cbranch_scc1 K2A_MASK3
K2A_BACKM3:
v_exp_f32 v104, v72
v_mfma_f32_16x16x32_bf16 a[8:11], v[44:47], v[128:131], a[8:11]
ds_read_b128 v[68:71], v7 offset:56320
v_add_f32 v29, v29, v31
v_mfma_f32_16x16x32_bf16 a[12:15], v[44:47], v[132:135], a[12:15]
s_waitcnt lgkmcnt(4)
v_exp_f32 v105, v73
v_mfma_f32_16x16x32_bf16 a[16:19], v[48:51], v[128:131], a[16:19]
ds_read_b128 v[40:43], v7 offset:57344
v_mfma_f32_16x16x32_bf16 a[20:23], v[48:51], v[132:135], a[20:23]
v_exp_f32 v106, v74
v_mfma_f32_16x16x32_bf16 a[24:27], v[52:55], v[128:131], a[24:27]
ds_read_b128 v[44:47], v7 offset:58368
v_mfma_f32_16x16x32_bf16 a[28:31], v[52:55], v[132:135], a[28:31]
s_waitcnt lgkmcnt(4)
v_exp_f32 v107, v75
v_mfma_f32_16x16x32_bf16 a[32:35], v[56:59], v[128:131], a[32:35]
ds_read_b128 v[48:51], v7 offset:59392
v_mfma_f32_16x16x32_bf16 a[36:39], v[56:59], v[132:135], a[36:39]
v_exp_f32 v108, v76
v_mfma_f32_16x16x32_bf16 a[40:43], v[60:63], v[128:131], a[40:43]
ds_read_b128 v[52:55], v7 offset:60416
v_cvt_pk_bf16_f32 v120, v104, v105
v_mfma_f32_16x16x32_bf16 a[44:47], v[60:63], v[132:135], a[44:47]
s_waitcnt lgkmcnt(4)
v_exp_f32 v109, v77
v_mfma_f32_16x16x32_bf16 a[48:51], v[64:67], v[128:131], a[48:51]
ds_read_b128 v[56:59], v7 offset:61440
v_add_f32 v200, v104, v105
v_mfma_f32_16x16x32_bf16 a[52:55], v[64:67], v[132:135], a[52:55]
v_exp_f32 v110, v78
v_mfma_f32_16x16x32_bf16 a[56:59], v[68:71], v[128:131], a[56:59]
ds_read_b128 v[60:63], v7 offset:62464
v_cvt_pk_bf16_f32 v121, v106, v107
v_mfma_f32_16x16x32_bf16 a[60:63], v[68:71], v[132:135], a[60:63]
s_waitcnt lgkmcnt(4)
v_exp_f32 v111, v79
v_mfma_f32_16x16x32_bf16 a[64:67], v[40:43], v[128:131], a[64:67]
s_add_u32 m0, s40, 131072
ds_read_b128 v[64:67], v7 offset:63488
v_add_f32 v201, v106, v107
v_mfma_f32_16x16x32_bf16 a[68:71], v[40:43], v[132:135], a[68:71]
buffer_load_dwordx4 v3, s[20:23], s39 offen offset:0 sc1 lds
v_mfma_f32_16x16x32_bf16 a[72:75], v[44:47], v[128:131], a[72:75]
ds_read_b128 v[68:71], v7 offset:64512
v_add_f32 v200, v200, v201
v_mfma_f32_16x16x32_bf16 a[76:79], v[44:47], v[132:135], a[76:79]
s_waitcnt lgkmcnt(4)
v_cvt_pk_bf16_f32 v124, v108, v109
v_mfma_f32_16x16x32_bf16 a[80:83], v[48:51], v[128:131], a[80:83]
ds_read_b128 v[40:43], v3 offset:16384
v_add_f32 v202, v108, v109
v_mfma_f32_16x16x32_bf16 a[84:87], v[48:51], v[132:135], a[84:87]
buffer_load_dwordx4 v3, s[20:23], s39 offen offset:1024 sc1 lds
v_mfma_f32_16x16x32_bf16 a[88:91], v[52:55], v[128:131], a[88:91]
ds_read_b128 v[44:47], v3 offset:17408
v_cvt_pk_bf16_f32 v125, v110, v111
v_mfma_f32_16x16x32_bf16 a[92:95], v[52:55], v[132:135], a[92:95]
s_waitcnt lgkmcnt(4)
v_add_f32 v203, v110, v111
v_mfma_f32_16x16x32_bf16 a[96:99], v[56:59], v[128:131], a[96:99]
ds_read_b128 v[48:51], v3 offset:18432
v_add_f32 v202, v202, v203
v_mfma_f32_16x16x32_bf16 a[100:103], v[56:59], v[132:135], a[100:103]
buffer_load_dwordx4 v3, s[20:23], s39 offen offset:2048 sc1 lds
v_mfma_f32_16x16x32_bf16 a[104:107], v[60:63], v[128:131], a[104:107]
ds_read_b128 v[52:55], v3 offset:19456
v_mfma_f32_16x16x32_bf16 a[108:111], v[60:63], v[132:135], a[108:111]
s_waitcnt lgkmcnt(4)
v_mfma_f32_16x16x32_bf16 a[112:115], v[64:67], v[128:131], a[112:115]
s_sub_u32 s36, s36, 1
ds_read_b128 v[56:59], v3 offset:20480
v_mfma_f32_16x16x32_bf16 a[116:119], v[64:67], v[132:135], a[116:119]
buffer_load_dwordx4 v3, s[20:23], s39 offen offset:3072 sc1 lds
v_mfma_f32_16x16x32_bf16 a[120:123], v[68:71], v[128:131], a[120:123]
s_add_u32 s39, s39, 16384
ds_read_b128 v[60:63], v3 offset:21504
v_mfma_f32_16x16x32_bf16 a[124:127], v[68:71], v[132:135], a[124:127]
s_cmp_eq_u32 s36, 0
s_cbranch_scc0 K2A_LOOP
K2A_LAST0:
s_waitcnt vmcnt(8) lgkmcnt(0)
s_barrier
ds_read_b128 v[40:43], v7 offset:0
ds_read_b128 v[44:47], v7 offset:1024
ds_read_b128 v[48:51], v7 offset:2048
ds_read_b128 v[52:55], v7 offset:3072
ds_read_b128 v[56:59], v7 offset:4096
ds_read_b128 v[60:63], v7 offset:5120
v_exp_f32 v112, v80
v_exp_f32 v113, v81
v_exp_f32 v114, v82
v_exp_f32 v115, v83
v_exp_f32 v116, v84
v_exp_f32 v117, v85
v_exp_f32 v118, v86
v_exp_f32 v119, v87
s_nop 0
v_cvt_pk_bf16_f32 v122, v112, v113
v_add_f32 v201, v112, v113
v_cvt_pk_bf16_f32 v123, v114, v115
v_add_f32 v200, v200, v201
v_add_f32 v201, v114, v115
v_add_f32 v30, v200, v201
v_cvt_pk_bf16_f32 v126, v116, v117
v_add_f32 v203, v116, v117
v_cvt_pk_bf16_f32 v127, v118, v119
v_add_f32 v202, v202, v203
v_add_f32 v203, v118, v119
v_add_f32 v31, v202, v203
v_add_f32 v13, v30, v31
v_cmp_nge_f32 vcc, s43, v13
s_cbranch_vccnz K2A_SLOWL0
K2A_BACKL0:
v_add_f32 v28, v28, v30
v_add_f32 v29, v29, v31
s_waitcnt lgkmcnt(4)
v_mfma_f32_16x16x32_bf16 a[0:3], v[40:43], v[120:123], a[0:3]
ds_read_b128 v[64:67], v7 offset:6144
v_mfma_f32_16x16x32_bf16 a[4:7], v[40:43], v[124:127], a[4:7]
v_mfma_f32_16x16x32_bf16 a[8:11], v[44:47], v[120:123], a[8:11]
s_add_u32 m0, s40, 147456
ds_read_b128 v[68:71], v7 offset:7168
v_mfma_f32_16x16x32_bf16 a[12:15], v[44:47], v[124:127], a[12:15]
s_waitcnt lgkmcnt(4)
v_mfma_f32_16x16x32_bf16 a[16:19], v[48:51], v[120:123], a[16:19]
ds_read_b128 v[40:43], v7 offset:8192
v_mfma_f32_16x16x32_bf16 a[20:23], v[48:51], v[124:127], a[20:23]
buffer_load_dwordx4 v3, s[20:23], s39 offen offset:0 sc1 lds
v_mfma_f32_16x16x32_bf16 a[24:27], v[52:55], v[120:123], a[24:27]
ds_read_b128 v[44:47], v7 offset:9216
v_mfma_f32_16x16x32_bf16 a[28:31], v[52:55], v[124:127], a[28:31]
s_waitcnt lgkmcnt(4)
v_mfma_f32_16x16x32_bf16 a[32:35], v[56:59], v[120:123], a[32:35]
ds_read_b128 v[48:51], v7 offset:10240
v_mfma_f32_16x16x32_bf16 a[36:39], v[56:59], v[124:127], a[36:39]
buffer_load_dwordx4 v3, s[20:23], s39 offen offset:1024 sc1 lds
v_mfma_f32_16x16x32_bf16 a[40:43], v[60:63], v[120:123], a[40:43]
ds_read_b128 v[52:55], v7 offset:11264
v_mfma_f32_16x16x32_bf16 a[44:47], v[60:63], v[124:127], a[44:47]
s_waitcnt lgkmcnt(4)
v_mfma_f32_16x16x32_bf16 a[48:51], v[64:67], v[120:123], a[48:51]
ds_read_b128 v[56:59], v7 offset:12288
v_mfma_f32_16x16x32_bf16 a[52:55], v[64:67], v[124:127], a[52:55]
buffer_load_dwordx4 v3, s[20:23], s39 offen offset:2048 sc1 lds
v_mfma_f32_16x16x32_bf16 a[56:59], v[68:71], v[120:123], a[56:59]
ds_read_b128 v[60:63], v7 offset:13312
v_mfma_f32_16x16x32_bf16 a[60:63], v[68:71], v[124:127], a[60:63]
s_waitcnt lgkmcnt(4)
v_mfma_f32_16x16x32_bf16 a[64:67], v[40:43], v[120:123], a[64:67]
ds_read_b128 v[64:67], v7 offset:14336
v_mfma_f32_16x16x32_bf16 a[68:71], v[40:43], v[124:127], a[68:71]
buffer_load_dwordx4 v3, s[20:23], s39 offen offset:3072 sc1 lds
v_mfma_f32_16x16x32_bf16 a[72:75], v[44:47], v[120:123], a[72:75]
ds_read_b128 v[68:71], v7 offset:15360
v_mfma_f32_16x16x32_bf16 a[76:79], v[44:47], v[124:127], a[76:79]
s_waitcnt lgkmcnt(4)
v_mfma_f32_16x16x32_bf16 a[80:83], v[48:51], v[120:123], a[80:83]
v_mfma_f32_16x16x32_bf16 a[84:87], v[48:51], v[124:127], a[84:87]
v_mfma_f32_16x16x32_bf16 a[88:91], v[52:55], v[120:123], a[88:91]
v_mfma_f32_16x16x32_bf16 a[92:95], v[52:55], v[124:127], a[92:95]
s_waitcnt lgkmcnt(2)
v_mfma_f32_16x16x32_bf16 a[96:99], v[56:59], v[120:123], a[96:99]
v_mfma_f32_16x16x32_bf16 a[100:103], v[56:59], v[124:127], a[100:103]
v_mfma_f32_16x16x32_bf16 a[104:107], v[60:63], v[120:123], a[104:107]
v_mfma_f32_16x16x32_bf16 a[108:111], v[60:63], v[124:127], a[108:111]
s_waitcnt lgkmcnt(0)
v_mfma_f32_16x16x32_bf16 a[112:115], v[64:67], v[120:123], a[112:115]
v_mfma_f32_16x16x32_bf16 a[116:119], v[64:67], v[124:127], a[116:119]
v_mfma_f32_16x16x32_bf16 a[120:123], v[68:71], v[120:123], a[120:123]
v_mfma_f32_16x16x32_bf16 a[124:127], v[68:71], v[124:127], a[124:127]
s_branch K2A_IDLE
K2A_LAST1:
s_waitcnt vmcnt(8) lgkmcnt(0)
s_barrier
ds_read_b128 v[40:43], v7 offset:16384
ds_read_b128 v[44:47], v7 offset:17408
ds_read_b128 v[48:51], v7 offset:18432
ds_read_b128 v[52:55], v7 offset:19456
ds_read_b128 v[56:59], v7 offset:20480
ds_read_b128 v[60:63], v7 offset:21504
v_exp_f32 v112, v96
v_exp_f32 v113, v97
v_exp_f32 v114, v98
v_exp_f32 v115, v99
v_exp_f32 v116, v100
v_exp_f32 v117, v101
v_exp_f32 v118, v102
v_exp_f32 v119, v103
s_nop 0
v_cvt_pk_bf16_f32 v130, v112, v113
v_add_f32 v201, v112, v113
v_cvt_pk_bf16_f32 v131, v114, v115
v_add_f32 v200, v200, v201
v_add_f32 v201, v114, v115
v_add_f32 v30, v200, v201
v_cvt_pk_bf16_f32 v134, v116, v117
v_add_f32 v203, v116, v117
v_cvt_pk_bf16_f32 v135, v118, v119
v_add_f32 v202, v202, v203
v_add_f32 v203, v118, v119
v_add_f32 v31, v202, v203
v_add_f32 v13, v30, v31
v_cmp_nge_f32 vcc, s43, v13
s_cbranch_vccnz K2A_SLOWL1
K2A_BACKL1:
v_add_f32 v28, v28, v30
v_add_f32 v29, v29, v31
s_waitcnt lgkmcnt(4)
v_mfma_f32_16x16x32_bf16 a[0:3], v[40:43], v[128:131], a[0:3]
ds_read_b128 v[64:67], v7 offset:22528
v_mfma_f32_16x16x32_bf16 a[4:7], v[40:43], v[132:135], a[4:7]
v_mfma_f32_16x16x32_bf16 a[8:11], v[44:47], v[128:131], a[8:11]
s_add_u32 m0, s40, 98304
ds_read_b128 v[68:71], v7 offset:23552
v_mfma_f32_16x16x32_bf16 a[12:15], v[44:47], v[132:135], a[12:15]
s_waitcnt lgkmcnt(4)
v_mfma_f32_16x16x32_bf16 a[16:19], v[48:51], v[128:131], a[16:19]
ds_read_b128 v[40:43], v7 offset:24576
v_mfma_f32_16x16x32_bf16 a[20:23], v[48:51], v[132:135], a[20:23]
buffer_load_dwordx4 v3, s[20:23], s39 offen offset:0 sc1 lds
v_mfma_f32_16x16x32_bf16 a[24:27], v[52:55], v[128:131], a[24:27]
ds_read_b128 v[44:47], v7 offset:25600
v_mfma_f32_16x16x32_bf16 a[28:31], v[52:55], v[132:135], a[28:31]
s_waitcnt lgkmcnt(4)
v_mfma_f32_16x16x32_bf16 a[32:35], v[56:59], v[128:131], a[32:35]
ds_read_b128 v[48:51], v7 offset:26624
v_mfma_f32_16x16x32_bf16 a[36:39], v[56:59], v[132:135], a[36:39]
buffer_load_dwordx4 v3, s[20:23], s39 offen offset:1024 sc1 lds
v_mfma_f32_16x16x32_bf16 a[40:43], v[60:63], v[128:131], a[40:43]
ds_read_b128 v[52:55], v7 offset:27648
v_mfma_f32_16x16x32_bf16 a[44:47], v[60:63], v[132:135], a[44:47]
s_waitcnt lgkmcnt(4)
v_mfma_f32_16x16x32_bf16 a[48:51], v[64:67], v[128:131], a[48:51]
ds_read_b128 v[56:59], v7 offset:28672
v_mfma_f32_16x16x32_bf16 a[52:55], v[64:67], v[132:135], a[52:55]
buffer_load_dwordx4 v3, s[20:23], s39 offen offset:2048 sc1 lds
v_mfma_f32_16x16x32_bf16 a[56:59], v[68:71], v[128:131], a[56:59]
ds_read_b128 v[60:63], v7 offset:29696
v_mfma_f32_16x16x32_bf16 a[60:63], v[68:71], v[132:135], a[60:63]
s_waitcnt lgkmcnt(4)
v_mfma_f32_16x16x32_bf16 a[64:67], v[40:43], v[128:131], a[64:67]
ds_read_b128 v[64:67], v7 offset:30720
v_mfma_f32_16x16x32_bf16 a[68:71], v[40:43], v[132:135], a[68:71]
buffer_load_dwordx4 v3, s[20:23], s39 offen offset:3072 sc1 lds
v_mfma_f32_16x16x32_bf16 a[72:75], v[44:47], v[128:131], a[72:75]
ds_read_b128 v[68:71], v7 offset:31744
v_mfma_f32_16x16x32_bf16 a[76:79], v[44:47], v[132:135], a[76:79]
s_waitcnt lgkmcnt(4)
v_mfma_f32_16x16x32_bf16 a[80:83], v[48:51], v[128:131], a[80:83]
v_mfma_f32_16x16x32_bf16 a[84:87], v[48:51], v[132:135], a[84:87]
v_mfma_f32_16x16x32_bf16 a[88:91], v[52:55], v[128:131], a[88:91]
v_mfma_f32_16x16x32_bf16 a[92:95], v[52:55], v[132:135], a[92:95]
s_waitcnt lgkmcnt(2)
v_mfma_f32_16x16x32_bf16 a[96:99], v[56:59], v[128:131], a[96:99]
v_mfma_f32_16x16x32_bf16 a[100:103], v[56:59], v[132:135], a[100:103]
v_mfma_f32_16x16x32_bf16 a[104:107], v[60:63], v[128:131], a[104:107]
v_mfma_f32_16x16x32_bf16 a[108:111], v[60:63], v[132:135], a[108:111]
s_waitcnt lgkmcnt(0)
v_mfma_f32_16x16x32_bf16 a[112:115], v[64:67], v[128:131], a[112:115]
v_mfma_f32_16x16x32_bf16 a[116:119], v[64:67], v[132:135], a[116:119]
v_mfma_f32_16x16x32_bf16 a[120:123], v[68:71], v[128:131], a[120:123]
v_mfma_f32_16x16x32_bf16 a[124:127], v[68:71], v[132:135], a[124:127]
s_branch K2A_IDLE
K2A_LAST2:
s_waitcnt vmcnt(8) lgkmcnt(0)
s_barrier
ds_read_b128 v[40:43], v7 offset:32768
ds_read_b128 v[44:47], v7 offset:33792
ds_read_b128 v[48:51], v7 offset:34816
ds_read_b128 v[52:55], v7 offset:35840
ds_read_b128 v[56:59], v7 offset:36864
ds_read_b128 v[60:63], v7 offset:37888
v_exp_f32 v112, v80
v_exp_f32 v113, v81
v_exp_f32 v114, v82
v_exp_f32 v115, v83
v_exp_f32 v116, v84
v_exp_f32 v117, v85
v_exp_f32 v118, v86
v_exp_f32 v119, v87
s_nop 0
v_cvt_pk_bf16_f32 v122, v112, v113
v_add_f32 v201, v112, v113
v_cvt_pk_bf16_f32 v123, v114, v115
v_add_f32 v200, v200, v201
v_add_f32 v201, v114, v115
v_add_f32 v30, v200, v201
v_cvt_pk_bf16_f32 v126, v116, v117
v_add_f32 v203, v116, v117
v_cvt_pk_bf16_f32 v127, v118, v119
v_add_f32 v202, v202, v203
v_add_f32 v203, v118, v119
v_add_f32 v31, v202, v203
v_add_f32 v13, v30, v31
v_cmp_nge_f32 vcc, s43, v13
s_cbranch_vccnz K2A_SLOWL2
K2A_BACKL2:
v_add_f32 v28, v28, v30
v_add_f32 v29, v29, v31
s_waitcnt lgkmcnt(4)
v_mfma_f32_16x16x32_bf16 a[0:3], v[40:43], v[120:123], a[0:3]
ds_read_b128 v[64:67], v7 offset:38912
v_mfma_f32_16x16x32_bf16 a[4:7], v[40:43], v[124:127], a[4:7]
v_mfma_f32_16x16x32_bf16 a[8:11], v[44:47], v[120:123], a[8:11]
s_add_u32 m0, s40, 114688
ds_read_b128 v[68:71], v7 offset:39936
v_mfma_f32_16x16x32_bf16 a[12:15], v[44:47], v[124:127], a[12:15]
s_waitcnt lgkmcnt(4)
v_mfma_f32_16x16x32_bf16 a[16:19], v[48:51], v[120:123], a[16:19]
ds_read_b128 v[40:43], v7 offset:40960
v_mfma_f32_16x16x32_bf16 a[20:23], v[48:51], v[124:127], a[20:23]
buffer_load_dwordx4 v3, s[20:23], s39 offen offset:0 sc1 lds
v_mfma_f32_16x16x32_bf16 a[24:27], v[52:55], v[120:123], a[24:27]
ds_read_b128 v[44:47], v7 offset:41984
v_mfma_f32_16x16x32_bf16 a[28:31], v[52:55], v[124:127], a[28:31]
s_waitcnt lgkmcnt(4)
v_mfma_f32_16x16x32_bf16 a[32:35], v[56:59], v[120:123], a[32:35]
ds_read_b128 v[48:51], v7 offset:43008
v_mfma_f32_16x16x32_bf16 a[36:39], v[56:59], v[124:127], a[36:39]
buffer_load_dwordx4 v3, s[20:23], s39 offen offset:1024 sc1 lds
v_mfma_f32_16x16x32_bf16 a[40:43], v[60:63], v[120:123], a[40:43]
ds_read_b128 v[52:55], v7 offset:44032
v_mfma_f32_16x16x32_bf16 a[44:47], v[60:63], v[124:127], a[44:47]
s_waitcnt lgkmcnt(4)
v_mfma_f32_16x16x32_bf16 a[48:51], v[64:67], v[120:123], a[48:51]
ds_read_b128 v[56:59], v7 offset:45056
v_mfma_f32_16x16x32_bf16 a[52:55], v[64:67], v[124:127], a[52:55]
buffer_load_dwordx4 v3, s[20:23], s39 offen offset:2048 sc1 lds
v_mfma_f32_16x16x32_bf16 a[56:59], v[68:71], v[120:123], a[56:59]
ds_read_b128 v[60:63], v7 offset:46080
v_mfma_f32_16x16x32_bf16 a[60:63], v[68:71], v[124:127], a[60:63]
s_waitcnt lgkmcnt(4)
v_mfma_f32_16x16x32_bf16 a[64:67], v[40:43], v[120:123], a[64:67]
ds_read_b128 v[64:67], v7 offset:47104
v_mfma_f32_16x16x32_bf16 a[68:71], v[40:43], v[124:127], a[68:71]
buffer_load_dwordx4 v3, s[20:23], s39 offen offset:3072 sc1 lds
v_mfma_f32_16x16x32_bf16 a[72:75], v[44:47], v[120:123], a[72:75]
ds_read_b128 v[68:71], v7 offset:48128
v_mfma_f32_16x16x32_bf16 a[76:79], v[44:47], v[124:127], a[76:79]
s_waitcnt lgkmcnt(4)
v_mfma_f32_16x16x32_bf16 a[80:83], v[48:51], v[120:123], a[80:83]
v_mfma_f32_16x16x32_bf16 a[84:87], v[48:51], v[124:127], a[84:87]
v_mfma_f32_16x16x32_bf16 a[88:91], v[52:55], v[120:123], a[88:91]
v_mfma_f32_16x16x32_bf16 a[92:95], v[52:55], v[124:127], a[92:95]
s_waitcnt lgkmcnt(2)
v_mfma_f32_16x16x32_bf16 a[96:99], v[56:59], v[120:123], a[96:99]
v_mfma_f32_16x16x32_bf16 a[100:103], v[56:59], v[124:127], a[100:103]
v_mfma_f32_16x16x32_bf16 a[104:107], v[60:63], v[120:123], a[104:107]
v_mfma_f32_16x16x32_bf16 a[108:111], v[60:63], v[124:127], a[108:111]
s_waitcnt lgkmcnt(0)
v_mfma_f32_16x16x32_bf16 a[112:115], v[64:67], v[120:123], a[112:115]
v_mfma_f32_16x16x32_bf16 a[116:119], v[64:67], v[124:127], a[116:119]
v_mfma_f32_16x16x32_bf16 a[120:123], v[68:71], v[120:123], a[120:123]
v_mfma_f32_16x16x32_bf16 a[124:127], v[68:71], v[124:127], a[124:127]
s_branch K2A_IDLE
K2A_LAST3:
s_waitcnt vmcnt(8) lgkmcnt(0)
s_barrier
ds_read_b128 v[40:43], v7 offset:49152
ds_read_b128 v[44:47], v7 offset:50176
ds_read_b128 v[48:51], v7 offset:51200
ds_read_b128 v[52:55], v7 offset:52224
ds_read_b128 v[56:59], v7 offset:53248
ds_read_b128 v[60:63], v7 offset:54272
v_exp_f32 v112, v96
v_exp_f32 v113, v97
v_exp_f32 v114, v98
v_exp_f32 v115, v99
v_exp_f32 v116, v100
v_exp_f32 v117, v101
v_exp_f32 v118, v102
v_exp_f32 v119, v103
s_nop 0
v_cvt_pk_bf16_f32 v130, v112, v113
v_add_f32 v201, v112, v113
v_cvt_pk_bf16_f32 v131, v114, v115
v_add_f32 v200, v200, v201
v_add_f32 v201, v114, v115
v_add_f32 v30, v200, v201
v_cvt_pk_bf16_f32 v134, v116, v117
v_add_f32 v203, v116, v117
v_cvt_pk_bf16_f32 v135, v118, v119
v_add_f32 v202, v202, v203
v_add_f32 v203, v118, v119
v_add_f32 v31, v202, v203
v_add_f32 v13, v30, v31
v_cmp_nge_f32 vcc, s43, v13
s_cbranch_vccnz K2A_SLOWL3
K2A_BACKL3:
v_add_f32 v28, v28, v30
v_add_f32 v29, v29, v31
s_waitcnt lgkmcnt(4)
v_mfma_f32_16x16x32_bf16 a[0:3], v[40:43], v[128:131], a[0:3]
ds_read_b128 v[64:67], v7 offset:55296
v_mfma_f32_16x16x32_bf16 a[4:7], v[40:43], v[132:135], a[4:7]
v_mfma_f32_16x16x32_bf16 a[8:11], v[44:47], v[128:131], a[8:11]
s_add_u32 m0, s40, 131072
ds_read_b128 v[68:71], v7 offset:56320
v_mfma_f32_16x16x32_bf16 a[12:15], v[44:47], v[132:135], a[12:15]
s_waitcnt lgkmcnt(4)
v_mfma_f32_16x16x32_bf16 a[16:19], v[48:51], v[128:131], a[16:19]
ds_read_b128 v[40:43], v7 offset:57344
v_mfma_f32_16x16x32_bf16 a[20:23], v[48:51], v[132:135], a[20:23]
buffer_load_dwordx4 v3, s[20:23], s39 offen offset:0 sc1 lds
v_mfma_f32_16x16x32_bf16 a[24:27], v[52:55], v[128:131], a[24:27]
ds_read_b128 v[44:47], v7 offset:58368
v_mfma_f32_16x16x32_bf16 a[28:31], v[52:55], v[132:135], a[28:31]
s_waitcnt lgkmcnt(4)
v_mfma_f32_16x16x32_bf16 a[32:35], v[56:59], v[128:131], a[32:35]
ds_read_b128 v[48:51], v7 offset:59392
v_mfma_f32_16x16x32_bf16 a[36:39], v[56:59], v[132:135], a[36:39]
buffer_load_dwordx4 v3, s[20:23], s39 offen offset:1024 sc1 lds
v_mfma_f32_16x16x32_bf16 a[40:43], v[60:63], v[128:131], a[40:43]
ds_read_b128 v[52:55], v7 offset:60416
v_mfma_f32_16x16x32_bf16 a[44:47], v[60:63], v[132:135], a[44:47]
s_waitcnt lgkmcnt(4)
v_mfma_f32_16x16x32_bf16 a[48:51], v[64:67], v[128:131], a[48:51]
ds_read_b128 v[56:59], v7 offset:61440
v_mfma_f32_16x16x32_bf16 a[52:55], v[64:67], v[132:135], a[52:55]
buffer_load_dwordx4 v3, s[20:23], s39 offen offset:2048 sc1 lds
v_mfma_f32_16x16x32_bf16 a[56:59], v[68:71], v[128:131], a[56:59]
ds_read_b128 v[60:63], v7 offset:62464
v_mfma_f32_16x16x32_bf16 a[60:63], v[68:71], v[132:135], a[60:63]
s_waitcnt lgkmcnt(4)
v_mfma_f32_16x16x32_bf16 a[64:67], v[40:43], v[128:131], a[64:67]
ds_read_b128 v[64:67], v7 offset:63488
v_mfma_f32_16x16x32_bf16 a[68:71], v[40:43], v[132:135], a[68:71]
buffer_load_dwordx4 v3, s[20:23], s39 offen offset:3072 sc1 lds
v_mfma_f32_16x16x32_bf16 a[72:75], v[44:47], v[128:131], a[72:75]
ds_read_b128 v[68:71], v7 offset:64512
v_mfma_f32_16x16x32_bf16 a[76:79], v[44:47], v[132:135], a[76:79]
s_waitcnt lgkmcnt(4)
v_mfma_f32_16x16x32_bf16 a[80:83], v[48:51], v[128:131], a[80:83]
v_mfma_f32_16x16x32_bf16 a[84:87], v[48:51], v[132:135], a[84:87]
v_mfma_f32_16x16x32_bf16 a[88:91], v[52:55], v[128:131], a[88:91]
v_mfma_f32_16x16x32_bf16 a[92:95], v[52:55], v[132:135], a[92:95]
s_waitcnt lgkmcnt(2)
v_mfma_f32_16x16x32_bf16 a[96:99], v[56:59], v[128:131], a[96:99]
v_mfma_f32_16x16x32_bf16 a[100:103], v[56:59], v[132:135], a[100:103]
v_mfma_f32_16x16x32_bf16 a[104:107], v[60:63], v[128:131], a[104:107]
v_mfma_f32_16x16x32_bf16 a[108:111], v[60:63], v[132:135], a[108:111]
s_waitcnt lgkmcnt(0)
v_mfma_f32_16x16x32_bf16 a[112:115], v[64:67], v[128:131], a[112:115]
v_mfma_f32_16x16x32_bf16 a[116:119], v[64:67], v[132:135], a[116:119]
v_mfma_f32_16x16x32_bf16 a[120:123], v[68:71], v[128:131], a[120:123]
v_mfma_f32_16x16x32_bf16 a[124:127], v[68:71], v[132:135], a[124:127]
K2A_IDLE:
s_cmp_eq_u32 s38, 0
s_cbranch_scc1 K2A_DONE
s_sub_u32 s38, s38, 1
s_waitcnt vmcnt(0)
s_barrier
s_branch K2A_IDLE
K2A_HOOK0:
s_cmp_eq_u32 s61, 0
s_cbranch_scc0 CH_5946
s_cmp_eq_u32 s30, 0
s_cbranch_scc0 FS_5948
s_lshl_b32 s33, s62, 9
s_add_u32 s33, s33, 0
v_mov_b32 v9, s33
v_mov_b32 v10, 1
v_cmp_eq_u32 s[78:79], 0, v2
s_and_saveexec_b64 s[76:77], s[78:79]
s_cbranch_execz FS_5948X
buffer_store_dword v10, v9, s[72:75], 0 offen sc1
FS_5948X:
s_mov_b64 exec, s[76:77]
FS_5948:
s_mov_b32 s44, -1
s_branch CH_5946E
CH_5946:
s_cmp_eq_u32 s54, 0
s_cbranch_scc0 CH_5946P1
s_lshl_b32 s33, s63, 2
s_cmp_ge_u32 s31, 6
s_addc_u32 s33, s33, 0
s_cmp_ge_u32 s31, 12
s_addc_u32 s33, s33, 0
s_lshl_b32 s33, s33, 8
s_add_u32 s33, s33, 86016
s_cmp_eq_u32 s30, 0
s_cbranch_scc0 AR_5973
v_mov_b32 v9, s33
v_mov_b32 v10, 1
v_cmp_eq_u32 s[78:79], 0, v2
s_and_saveexec_b64 s[76:77], s[78:79]
s_cbranch_execz AR_5973X
buffer_atomic_add v10, v9, s[72:75], 0 offen
AR_5973X:
s_mov_b64 exec, s[76:77]
AR_5973:
s_mov_b32 s54, 1
s_cmp_gt_u32 s36, 3
s_cselect_b32 s44, 3, -1
s_branch CH_5946E
CH_5946P1:
s_cmp_eq_u32 s54, 1
s_cbranch_scc0 CH_5946P2
s_lshl_b32 s33, s62, 9
s_add_u32 s33, s33, 256
v_mov_b32 v9, s33
buffer_load_dword v255, v9, s[72:75], 0 offen sc1
s_mov_b32 s54, 2
s_mov_b32 s44, 2
s_branch CH_5946E
CH_5946P2:
s_waitcnt vmcnt(8)
v_readfirstlane_b32 s33, v255
s_mov_b32 s44, -1
s_cmp_eq_u32 s33, 1
s_cbranch_scc0 CH_5946E
s_lshl_b32 s33, s62, 12
s_lshl_b32 s34, s30, 10
s_add_u32 s33, s33, s34
s_add_u32 s33, s33, 16777216
buffer_load_dwordx4 v[248:251], v3, s[68:71], s33 offen sc1
s_lshl_b32 s33, s62, 16
s_lshl_b32 s34, s30, 14
s_add_u32 s33, s33, s34
s_add_u32 s33, s33, 8388608
buffer_load_dwordx4 a[128:131], v3, s[68:71], s33 offen offset:0 sc1
buffer_load_dwordx4 a[132:135], v3, s[68:71], s33 offen offset:1024 sc1
buffer_load_dwordx4 a[136:139], v3, s[68:71], s33 offen offset:2048 sc1
buffer_load_dwordx4 a[140:143], v3, s[68:71], s33 offen offset:3072 sc1
s_add_u32 s33, s33, 4096
buffer_load_dwordx4 a[144:147], v3, s[68:71], s33 offen offset:0 sc1
buffer_load_dwordx4 a[148:151], v3, s[68:71], s33 offen offset:1024 sc1
buffer_load_dwordx4 a[152:155], v3, s[68:71], s33 offen offset:2048 sc1
buffer_load_dwordx4 a[156:159], v3, s[68:71], s33 offen offset:3072 sc1
s_add_u32 s33, s33, 4096
buffer_load_dwordx4 a[160:163], v3, s[68:71], s33 offen offset:0 sc1
buffer_load_dwordx4 a[164:167], v3, s[68:71], s33 offen offset:1024 sc1
buffer_load_dwordx4 a[168:171], v3, s[68:71], s33 offen offset:2048 sc1
buffer_load_dwordx4 a[172:175], v3, s[68:71], s33 offen offset:3072 sc1
s_add_u32 s33, s33, 4096
buffer_load_dwordx4 a[176:179], v3, s[68:71], s33 offen offset:0 sc1
buffer_load_dwordx4 a[180:183], v3, s[68:71], s33 offen offset:1024 sc1
buffer_load_dwordx4 a[184:187], v3, s[68:71], s33 offen offset:2048 sc1
buffer_load_dwordx4 a[188:191], v3, s[68:71], s33 offen offset:3072 sc1
s_mov_b32 s54, 3
CH_5946E:
s_branch K2A_BACKH0
K2A_HOOK1:
s_cmp_eq_u32 s61, 0
s_cbranch_scc0 CH_6036
s_cmp_eq_u32 s30, 0
s_cbranch_scc0 FS_6038
s_lshl_b32 s33, s62, 9
s_add_u32 s33, s33, 0
v_mov_b32 v9, s33
v_mov_b32 v10, 1
v_cmp_eq_u32 s[78:79], 0, v2
s_and_saveexec_b64 s[76:77], s[78:79]
s_cbranch_execz FS_6038X
buffer_store_dword v10, v9, s[72:75], 0 offen sc1
FS_6038X:
s_mov_b64 exec, s[76:77]
FS_6038:
s_mov_b32 s44, -1
s_branch CH_6036E
CH_6036:
s_cmp_eq_u32 s54, 0
s_cbranch_scc0 CH_6036P1
s_lshl_b32 s33, s63, 2
s_cmp_ge_u32 s31, 6
s_addc_u32 s33, s33, 0
s_cmp_ge_u32 s31, 12
s_addc_u32 s33, s33, 0
s_lshl_b32 s33, s33, 8
s_add_u32 s33, s33, 86016
s_cmp_eq_u32 s30, 0
s_cbranch_scc0 AR_6063
v_mov_b32 v9, s33
v_mov_b32 v10, 1
v_cmp_eq_u32 s[78:79], 0, v2
s_and_saveexec_b64 s[76:77], s[78:79]
s_cbranch_execz AR_6063X
buffer_atomic_add v10, v9, s[72:75], 0 offen
AR_6063X:
s_mov_b64 exec, s[76:77]
AR_6063:
s_mov_b32 s54, 1
s_cmp_gt_u32 s36, 3
s_cselect_b32 s44, 3, -1
s_branch CH_6036E
CH_6036P1:
s_cmp_eq_u32 s54, 1
s_cbranch_scc0 CH_6036P2
s_lshl_b32 s33, s62, 9
s_add_u32 s33, s33, 256
v_mov_b32 v9, s33
buffer_load_dword v255, v9, s[72:75], 0 offen sc1
s_mov_b32 s54, 2
s_mov_b32 s44, 2
s_branch CH_6036E
CH_6036P2:
s_waitcnt vmcnt(8)
v_readfirstlane_b32 s33, v255
s_mov_b32 s44, -1
s_cmp_eq_u32 s33, 1
s_cbranch_scc0 CH_6036E
s_lshl_b32 s33, s62, 12
s_lshl_b32 s34, s30, 10
s_add_u32 s33, s33, s34
s_add_u32 s33, s33, 16777216
buffer_load_dwordx4 v[248:251], v3, s[68:71], s33 offen sc1
s_lshl_b32 s33, s62, 16
s_lshl_b32 s34, s30, 14
s_add_u32 s33, s33, s34
s_add_u32 s33, s33, 8388608
buffer_load_dwordx4 a[128:131], v3, s[68:71], s33 offen offset:0 sc1
buffer_load_dwordx4 a[132:135], v3, s[68:71], s33 offen offset:1024 sc1
buffer_load_dwordx4 a[136:139], v3, s[68:71], s33 offen offset:2048 sc1
buffer_load_dwordx4 a[140:143], v3, s[68:71], s33 offen offset:3072 sc1
s_add_u32 s33, s33, 4096
buffer_load_dwordx4 a[144:147], v3, s[68:71], s33 offen offset:0 sc1
buffer_load_dwordx4 a[148:151], v3, s[68:71], s33 offen offset:1024 sc1
buffer_load_dwordx4 a[152:155], v3, s[68:71], s33 offen offset:2048 sc1
buffer_load_dwordx4 a[156:159], v3, s[68:71], s33 offen offset:3072 sc1
s_add_u32 s33, s33, 4096
buffer_load_dwordx4 a[160:163], v3, s[68:71], s33 offen offset:0 sc1
buffer_load_dwordx4 a[164:167], v3, s[68:71], s33 offen offset:1024 sc1
buffer_load_dwordx4 a[168:171], v3, s[68:71], s33 offen offset:2048 sc1
buffer_load_dwordx4 a[172:175], v3, s[68:71], s33 offen offset:3072 sc1
s_add_u32 s33, s33, 4096
buffer_load_dwordx4 a[176:179], v3, s[68:71], s33 offen offset:0 sc1
buffer_load_dwordx4 a[180:183], v3, s[68:71], s33 offen offset:1024 sc1
buffer_load_dwordx4 a[184:187], v3, s[68:71], s33 offen offset:2048 sc1
buffer_load_dwordx4 a[188:191], v3, s[68:71], s33 offen offset:3072 sc1
s_mov_b32 s54, 3
CH_6036E:
s_branch K2A_BACKH1
K2A_HOOK2:
s_cmp_eq_u32 s61, 0
s_cbranch_scc0 CH_6126
s_cmp_eq_u32 s30, 0
s_cbranch_scc0 FS_6128
s_lshl_b32 s33, s62, 9
s_add_u32 s33, s33, 0
v_mov_b32 v9, s33
v_mov_b32 v10, 1
v_cmp_eq_u32 s[78:79], 0, v2
s_and_saveexec_b64 s[76:77], s[78:79]
s_cbranch_execz FS_6128X
buffer_store_dword v10, v9, s[72:75], 0 offen sc1
FS_6128X:
s_mov_b64 exec, s[76:77]
FS_6128:
s_mov_b32 s44, -1
s_branch CH_6126E
CH_6126:
s_cmp_eq_u32 s54, 0
s_cbranch_scc0 CH_6126P1
s_lshl_b32 s33, s63, 2
s_cmp_ge_u32 s31, 6
s_addc_u32 s33, s33, 0
s_cmp_ge_u32 s31, 12
s_addc_u32 s33, s33, 0
s_lshl_b32 s33, s33, 8
s_add_u32 s33, s33, 86016
s_cmp_eq_u32 s30, 0
s_cbranch_scc0 AR_6153
v_mov_b32 v9, s33
v_mov_b32 v10, 1
v_cmp_eq_u32 s[78:79], 0, v2
s_and_saveexec_b64 s[76:77], s[78:79]
s_cbranch_execz AR_6153X
buffer_atomic_add v10, v9, s[72:75], 0 offen
AR_6153X:
s_mov_b64 exec, s[76:77]
AR_6153:
s_mov_b32 s54, 1
s_cmp_gt_u32 s36, 3
s_cselect_b32 s44, 3, -1
s_branch CH_6126E
CH_6126P1:
s_cmp_eq_u32 s54, 1
s_cbranch_scc0 CH_6126P2
s_lshl_b32 s33, s62, 9
s_add_u32 s33, s33, 256
v_mov_b32 v9, s33
buffer_load_dword v255, v9, s[72:75], 0 offen sc1
s_mov_b32 s54, 2
s_mov_b32 s44, 2
s_branch CH_6126E
CH_6126P2:
s_waitcnt vmcnt(8)
v_readfirstlane_b32 s33, v255
s_mov_b32 s44, -1
s_cmp_eq_u32 s33, 1
s_cbranch_scc0 CH_6126E
s_lshl_b32 s33, s62, 12
s_lshl_b32 s34, s30, 10
s_add_u32 s33, s33, s34
s_add_u32 s33, s33, 16777216
buffer_load_dwordx4 v[248:251], v3, s[68:71], s33 offen sc1
s_lshl_b32 s33, s62, 16
s_lshl_b32 s34, s30, 14
s_add_u32 s33, s33, s34
s_add_u32 s33, s33, 8388608
buffer_load_dwordx4 a[128:131], v3, s[68:71], s33 offen offset:0 sc1
buffer_load_dwordx4 a[132:135], v3, s[68:71], s33 offen offset:1024 sc1
buffer_load_dwordx4 a[136:139], v3, s[68:71], s33 offen offset:2048 sc1
buffer_load_dwordx4 a[140:143], v3, s[68:71], s33 offen offset:3072 sc1
s_add_u32 s33, s33, 4096
buffer_load_dwordx4 a[144:147], v3, s[68:71], s33 offen offset:0 sc1
buffer_load_dwordx4 a[148:151], v3, s[68:71], s33 offen offset:1024 sc1
buffer_load_dwordx4 a[152:155], v3, s[68:71], s33 offen offset:2048 sc1
buffer_load_dwordx4 a[156:159], v3, s[68:71], s33 offen offset:3072 sc1
s_add_u32 s33, s33, 4096
buffer_load_dwordx4 a[160:163], v3, s[68:71], s33 offen offset:0 sc1
buffer_load_dwordx4 a[164:167], v3, s[68:71], s33 offen offset:1024 sc1
buffer_load_dwordx4 a[168:171], v3, s[68:71], s33 offen offset:2048 sc1
buffer_load_dwordx4 a[172:175], v3, s[68:71], s33 offen offset:3072 sc1
s_add_u32 s33, s33, 4096
buffer_load_dwordx4 a[176:179], v3, s[68:71], s33 offen offset:0 sc1
buffer_load_dwordx4 a[180:183], v3, s[68:71], s33 offen offset:1024 sc1
buffer_load_dwordx4 a[184:187], v3, s[68:71], s33 offen offset:2048 sc1
buffer_load_dwordx4 a[188:191], v3, s[68:71], s33 offen offset:3072 sc1
s_mov_b32 s54, 3
CH_6126E:
s_branch K2A_BACKH2
K2A_HOOK3:
s_cmp_eq_u32 s61, 0
s_cbranch_scc0 CH_6216
s_cmp_eq_u32 s30, 0
s_cbranch_scc0 FS_6218
s_lshl_b32 s33, s62, 9
s_add_u32 s33, s33, 0
v_mov_b32 v9, s33
v_mov_b32 v10, 1
v_cmp_eq_u32 s[78:79], 0, v2
s_and_saveexec_b64 s[76:77], s[78:79]
s_cbranch_execz FS_6218X
buffer_store_dword v10, v9, s[72:75], 0 offen sc1
FS_6218X:
s_mov_b64 exec, s[76:77]
FS_6218:
s_mov_b32 s44, -1
s_branch CH_6216E
CH_6216:
s_cmp_eq_u32 s54, 0
s_cbranch_scc0 CH_6216P1
s_lshl_b32 s33, s63, 2
s_cmp_ge_u32 s31, 6
s_addc_u32 s33, s33, 0
s_cmp_ge_u32 s31, 12
s_addc_u32 s33, s33, 0
s_lshl_b32 s33, s33, 8
s_add_u32 s33, s33, 86016
s_cmp_eq_u32 s30, 0
s_cbranch_scc0 AR_6243
v_mov_b32 v9, s33
v_mov_b32 v10, 1
v_cmp_eq_u32 s[78:79], 0, v2
s_and_saveexec_b64 s[76:77], s[78:79]
s_cbranch_execz AR_6243X
buffer_atomic_add v10, v9, s[72:75], 0 offen
AR_6243X:
s_mov_b64 exec, s[76:77]
AR_6243:
s_mov_b32 s54, 1
s_cmp_gt_u32 s36, 3
s_cselect_b32 s44, 3, -1
s_branch CH_6216E
CH_6216P1:
s_cmp_eq_u32 s54, 1
s_cbranch_scc0 CH_6216P2
s_lshl_b32 s33, s62, 9
s_add_u32 s33, s33, 256
v_mov_b32 v9, s33
buffer_load_dword v255, v9, s[72:75], 0 offen sc1
s_mov_b32 s54, 2
s_mov_b32 s44, 2
s_branch CH_6216E
CH_6216P2:
s_waitcnt vmcnt(8)
v_readfirstlane_b32 s33, v255
s_mov_b32 s44, -1
s_cmp_eq_u32 s33, 1
s_cbranch_scc0 CH_6216E
s_lshl_b32 s33, s62, 12
s_lshl_b32 s34, s30, 10
s_add_u32 s33, s33, s34
s_add_u32 s33, s33, 16777216
buffer_load_dwordx4 v[248:251], v3, s[68:71], s33 offen sc1
s_lshl_b32 s33, s62, 16
s_lshl_b32 s34, s30, 14
s_add_u32 s33, s33, s34
s_add_u32 s33, s33, 8388608
buffer_load_dwordx4 a[128:131], v3, s[68:71], s33 offen offset:0 sc1
buffer_load_dwordx4 a[132:135], v3, s[68:71], s33 offen offset:1024 sc1
buffer_load_dwordx4 a[136:139], v3, s[68:71], s33 offen offset:2048 sc1
buffer_load_dwordx4 a[140:143], v3, s[68:71], s33 offen offset:3072 sc1
s_add_u32 s33, s33, 4096
buffer_load_dwordx4 a[144:147], v3, s[68:71], s33 offen offset:0 sc1
buffer_load_dwordx4 a[148:151], v3, s[68:71], s33 offen offset:1024 sc1
buffer_load_dwordx4 a[152:155], v3, s[68:71], s33 offen offset:2048 sc1
buffer_load_dwordx4 a[156:159], v3, s[68:71], s33 offen offset:3072 sc1
s_add_u32 s33, s33, 4096
buffer_load_dwordx4 a[160:163], v3, s[68:71], s33 offen offset:0 sc1
buffer_load_dwordx4 a[164:167], v3, s[68:71], s33 offen offset:1024 sc1
buffer_load_dwordx4 a[168:171], v3, s[68:71], s33 offen offset:2048 sc1
buffer_load_dwordx4 a[172:175], v3, s[68:71], s33 offen offset:3072 sc1
s_add_u32 s33, s33, 4096
buffer_load_dwordx4 a[176:179], v3, s[68:71], s33 offen offset:0 sc1
buffer_load_dwordx4 a[180:183], v3, s[68:71], s33 offen offset:1024 sc1
buffer_load_dwordx4 a[184:187], v3, s[68:71], s33 offen offset:2048 sc1
buffer_load_dwordx4 a[188:191], v3, s[68:71], s33 offen offset:3072 sc1
s_mov_b32 s54, 3
CH_6216E:
s_branch K2A_BACKH3
K2A_MASK0:
s_nop 7
v_mov_b32 v15, 0xff800000
v_cmp_gt_i32 vcc, 0, v6
s_nop 1
v_cndmask_b32 v88, v88, v15, vcc
v_cndmask_b32 v100, v100, v15, vcc
v_mov_b32 v96, v15
v_cmp_gt_i32 vcc, 1, v6
s_nop 1
v_cndmask_b32 v89, v89, v15, vcc
v_cndmask_b32 v101, v101, v15, vcc
v_mov_b32 v97, v15
v_cmp_gt_i32 vcc, 2, v6
s_nop 1
v_cndmask_b32 v90, v90, v15, vcc
v_cndmask_b32 v102, v102, v15, vcc
v_mov_b32 v98, v15
v_cmp_gt_i32 vcc, 3, v6
s_nop 1
v_cndmask_b32 v91, v91, v15, vcc
v_cndmask_b32 v103, v103, v15, vcc
v_mov_b32 v99, v15
s_branch K2A_BACKM0
K2A_MASK1:
s_nop 7
v_mov_b32 v15, 0xff800000
v_cmp_gt_i32 vcc, 0, v6
s_nop 1
v_cndmask_b32 v72, v72, v15, vcc
v_cndmask_b32 v84, v84, v15, vcc
v_mov_b32 v80, v15
v_cmp_gt_i32 vcc, 1, v6
s_nop 1
v_cndmask_b32 v73, v73, v15, vcc
v_cndmask_b32 v85, v85, v15, vcc
v_mov_b32 v81, v15
v_cmp_gt_i32 vcc, 2, v6
s_nop 1
v_cndmask_b32 v74, v74, v15, vcc
v_cndmask_b32 v86, v86, v15, vcc
v_mov_b32 v82, v15
v_cmp_gt_i32 vcc, 3, v6
s_nop 1
v_cndmask_b32 v75, v75, v15, vcc
v_cndmask_b32 v87, v87, v15, vcc
v_mov_b32 v83, v15
s_branch K2A_BACKM1
K2A_MASK2:
s_nop 7
v_mov_b32 v15, 0xff800000
v_cmp_gt_i32 vcc, 0, v6
s_nop 1
v_cndmask_b32 v88, v88, v15, vcc
v_cndmask_b32 v100, v100, v15, vcc
v_mov_b32 v96, v15
v_cmp_gt_i32 vcc, 1, v6
s_nop 1
v_cndmask_b32 v89, v89, v15, vcc
v_cndmask_b32 v101, v101, v15, vcc
v_mov_b32 v97, v15
v_cmp_gt_i32 vcc, 2, v6
s_nop 1
v_cndmask_b32 v90, v90, v15, vcc
v_cndmask_b32 v102, v102, v15, vcc
v_mov_b32 v98, v15
v_cmp_gt_i32 vcc, 3, v6
s_nop 1
v_cndmask_b32 v91, v91, v15, vcc
v_cndmask_b32 v103, v103, v15, vcc
v_mov_b32 v99, v15
s_branch K2A_BACKM2
K2A_MASK3:
s_nop 7
v_mov_b32 v15, 0xff800000
v_cmp_gt_i32 vcc, 0, v6
s_nop 1
v_cndmask_b32 v72, v72, v15, vcc
v_cndmask_b32 v84, v84, v15, vcc
v_mov_b32 v80, v15
v_cmp_gt_i32 vcc, 1, v6
s_nop 1
v_cndmask_b32 v73, v73, v15, vcc
v_cndmask_b32 v85, v85, v15, vcc
v_mov_b32 v81, v15
v_cmp_gt_i32 vcc, 2, v6
s_nop 1
v_cndmask_b32 v74, v74, v15, vcc
v_cndmask_b32 v86, v86, v15, vcc
v_mov_b32 v82, v15
v_cmp_gt_i32 vcc, 3, v6
s_nop 1
v_cndmask_b32 v75, v75, v15, vcc
v_cndmask_b32 v87, v87, v15, vcc
v_mov_b32 v83, v15
s_branch K2A_BACKM3
K2A_SLOW0:
s_nop 7
s_nop 7
v_max3_f32 v9, v72, v73, v74
v_max3_f32 v9, v9, v75, v80
v_max3_f32 v9, v9, v81, v82
v_max_f32 v9, v9, v83
v_max3_f32 v10, v76, v77, v78
v_max3_f32 v10, v10, v79, v84
v_max3_f32 v10, v10, v85, v86
v_max_f32 v10, v10, v87
ds_bpermute_b32 v11, v4, v9
ds_bpermute_b32 v12, v4, v10
s_waitcnt lgkmcnt(0)
v_max_f32 v9, v9, v11
v_max_f32 v10, v10, v12
ds_bpermute_b32 v11, v5, v9
ds_bpermute_b32 v12, v5, v10
s_waitcnt lgkmcnt(0)
v_max_f32 v9, v9, v11
v_max_f32 v10, v10, v12
v_max_f32 v9, 0, v9
v_sub_f32 v11, 0, v9
v_exp_f32 v11, v11
v_max_f32 v10, 0, v10
v_sub_f32 v12, 0, v10
v_exp_f32 v12, v12
s_nop 0
v_mul_f32 v28, v28, v11
v_sub_f32 v32, v32, v9
v_sub_f32 v33, v33, v9
v_sub_f32 v34, v34, v9
v_sub_f32 v35, v35, v9
v_sub_f32 v72, v72, v9
v_sub_f32 v88, v88, v9
v_sub_f32 v73, v73, v9
v_sub_f32 v89, v89, v9
v_sub_f32 v74, v74, v9
v_sub_f32 v90, v90, v9
v_sub_f32 v75, v75, v9
v_sub_f32 v91, v91, v9
v_sub_f32 v80, v80, v9
v_sub_f32 v96, v96, v9
v_sub_f32 v81, v81, v9
v_sub_f32 v97, v97, v9
v_sub_f32 v82, v82, v9
v_sub_f32 v98, v98, v9
v_sub_f32 v83, v83, v9
v_sub_f32 v99, v99, v9
v_accvgpr_read_b32 v13, a0
v_mul_f32 v13, v13, v11
v_accvgpr_write_b32 a0, v13
v_accvgpr_read_b32 v13, a1
v_mul_f32 v13, v13, v11
v_accvgpr_write_b32 a1, v13
v_accvgpr_read_b32 v13, a2
v_mul_f32 v13, v13, v11
v_accvgpr_write_b32 a2, v13
v_accvgpr_read_b32 v13, a3
v_mul_f32 v13, v13, v11
v_accvgpr_write_b32 a3, v13
v_accvgpr_read_b32 v13, a8
v_mul_f32 v13, v13, v11
v_accvgpr_write_b32 a8, v13
v_accvgpr_read_b32 v13, a9
v_mul_f32 v13, v13, v11
v_accvgpr_write_b32 a9, v13
v_accvgpr_read_b32 v13, a10
v_mul_f32 v13, v13, v11
v_accvgpr_write_b32 a10, v13
v_accvgpr_read_b32 v13, a11
v_mul_f32 v13, v13, v11
v_accvgpr_write_b32 a11, v13
v_accvgpr_read_b32 v13, a16
v_mul_f32 v13, v13, v11
v_accvgpr_write_b32 a16, v13
v_accvgpr_read_b32 v13, a17
v_mul_f32 v13, v13, v11
v_accvgpr_write_b32 a17, v13
v_accvgpr_read_b32 v13, a18
v_mul_f32 v13, v13, v11
v_accvgpr_write_b32 a18, v13
v_accvgpr_read_b32 v13, a19
v_mul_f32 v13, v13, v11
v_accvgpr_write_b32 a19, v13
v_accvgpr_read_b32 v13, a24
v_mul_f32 v13, v13, v11
v_accvgpr_write_b32 a24, v13
v_accvgpr_read_b32 v13, a25
v_mul_f32 v13, v13, v11
v_accvgpr_write_b32 a25, v13
v_accvgpr_read_b32 v13, a26
v_mul_f32 v13, v13, v11
v_accvgpr_write_b32 a26, v13
v_accvgpr_read_b32 v13, a27
v_mul_f32 v13, v13, v11
v_accvgpr_write_b32 a27, v13
v_accvgpr_read_b32 v13, a32
v_mul_f32 v13, v13, v11
v_accvgpr_write_b32 a32, v13
v_accvgpr_read_b32 v13, a33
v_mul_f32 v13, v13, v11
v_accvgpr_write_b32 a33, v13
v_accvgpr_read_b32 v13, a34
v_mul_f32 v13, v13, v11
v_accvgpr_write_b32 a34, v13
v_accvgpr_read_b32 v13, a35
v_mul_f32 v13, v13, v11
v_accvgpr_write_b32 a35, v13
v_accvgpr_read_b32 v13, a40
v_mul_f32 v13, v13, v11
v_accvgpr_write_b32 a40, v13
v_accvgpr_read_b32 v13, a41
v_mul_f32 v13, v13, v11
v_accvgpr_write_b32 a41, v13
v_accvgpr_read_b32 v13, a42
v_mul_f32 v13, v13, v11
v_accvgpr_write_b32 a42, v13
v_accvgpr_read_b32 v13, a43
v_mul_f32 v13, v13, v11
v_accvgpr_write_b32 a43, v13
v_accvgpr_read_b32 v13, a48
v_mul_f32 v13, v13, v11
v_accvgpr_write_b32 a48, v13
v_accvgpr_read_b32 v13, a49
v_mul_f32 v13, v13, v11
v_accvgpr_write_b32 a49, v13
v_accvgpr_read_b32 v13, a50
v_mul_f32 v13, v13, v11
v_accvgpr_write_b32 a50, v13
v_accvgpr_read_b32 v13, a51
v_mul_f32 v13, v13, v11
v_accvgpr_write_b32 a51, v13
v_accvgpr_read_b32 v13, a56
v_mul_f32 v13, v13, v11
v_accvgpr_write_b32 a56, v13
v_accvgpr_read_b32 v13, a57
v_mul_f32 v13, v13, v11
v_accvgpr_write_b32 a57, v13
v_accvgpr_read_b32 v13, a58
v_mul_f32 v13, v13, v11
v_accvgpr_write_b32 a58, v13
v_accvgpr_read_b32 v13, a59
v_mul_f32 v13, v13, v11
v_accvgpr_write_b32 a59, v13
v_accvgpr_read_b32 v13, a64
v_mul_f32 v13, v13, v11
v_accvgpr_write_b32 a64, v13
v_accvgpr_read_b32 v13, a65
v_mul_f32 v13, v13, v11
v_accvgpr_write_b32 a65, v13
v_accvgpr_read_b32 v13, a66
v_mul_f32 v13, v13, v11
v_accvgpr_write_b32 a66, v13
v_accvgpr_read_b32 v13, a67
v_mul_f32 v13, v13, v11
v_accvgpr_write_b32 a67, v13
v_accvgpr_read_b32 v13, a72
v_mul_f32 v13, v13, v11
v_accvgpr_write_b32 a72, v13
v_accvgpr_read_b32 v13, a73
v_mul_f32 v13, v13, v11
v_accvgpr_write_b32 a73, v13
v_accvgpr_read_b32 v13, a74
v_mul_f32 v13, v13, v11
v_accvgpr_write_b32 a74, v13
v_accvgpr_read_b32 v13, a75
v_mul_f32 v13, v13, v11
v_accvgpr_write_b32 a75, v13
v_accvgpr_read_b32 v13, a80
v_mul_f32 v13, v13, v11
v_accvgpr_write_b32 a80, v13
v_accvgpr_read_b32 v13, a81
v_mul_f32 v13, v13, v11
v_accvgpr_write_b32 a81, v13
v_accvgpr_read_b32 v13, a82
v_mul_f32 v13, v13, v11
v_accvgpr_write_b32 a82, v13
v_accvgpr_read_b32 v13, a83
v_mul_f32 v13, v13, v11
v_accvgpr_write_b32 a83, v13
v_accvgpr_read_b32 v13, a88
v_mul_f32 v13, v13, v11
v_accvgpr_write_b32 a88, v13
v_accvgpr_read_b32 v13, a89
v_mul_f32 v13, v13, v11
v_accvgpr_write_b32 a89, v13
v_accvgpr_read_b32 v13, a90
v_mul_f32 v13, v13, v11
v_accvgpr_write_b32 a90, v13
v_accvgpr_read_b32 v13, a91
v_mul_f32 v13, v13, v11
v_accvgpr_write_b32 a91, v13
v_accvgpr_read_b32 v13, a96
v_mul_f32 v13, v13, v11
v_accvgpr_write_b32 a96, v13
v_accvgpr_read_b32 v13, a97
v_mul_f32 v13, v13, v11
v_accvgpr_write_b32 a97, v13
v_accvgpr_read_b32 v13, a98
v_mul_f32 v13, v13, v11
v_accvgpr_write_b32 a98, v13
v_accvgpr_read_b32 v13, a99
v_mul_f32 v13, v13, v11
v_accvgpr_write_b32 a99, v13
v_accvgpr_read_b32 v13, a104
v_mul_f32 v13, v13, v11
v_accvgpr_write_b32 a104, v13
v_accvgpr_read_b32 v13, a105
v_mul_f32 v13, v13, v11
v_accvgpr_write_b32 a105, v13
v_accvgpr_read_b32 v13, a106
v_mul_f32 v13, v13, v11
v_accvgpr_write_b32 a106, v13
v_accvgpr_read_b32 v13, a107
v_mul_f32 v13, v13, v11
v_accvgpr_write_b32 a107, v13
v_accvgpr_read_b32 v13, a112
v_mul_f32 v13, v13, v11
v_accvgpr_write_b32 a112, v13
v_accvgpr_read_b32 v13, a113
v_mul_f32 v13, v13, v11
v_accvgpr_write_b32 a113, v13
v_accvgpr_read_b32 v13, a114
v_mul_f32 v13, v13, v11
v_accvgpr_write_b32 a114, v13
v_accvgpr_read_b32 v13, a115
v_mul_f32 v13, v13, v11
v_accvgpr_write_b32 a115, v13
v_accvgpr_read_b32 v13, a120
v_mul_f32 v13, v13, v11
v_accvgpr_write_b32 a120, v13
v_accvgpr_read_b32 v13, a121
v_mul_f32 v13, v13, v11
v_accvgpr_write_b32 a121, v13
v_accvgpr_read_b32 v13, a122
v_mul_f32 v13, v13, v11
v_accvgpr_write_b32 a122, v13
v_accvgpr_read_b32 v13, a123
v_mul_f32 v13, v13, v11
v_accvgpr_write_b32 a123, v13
v_mul_f32 v29, v29, v12
v_sub_f32 v36, v36, v10
v_sub_f32 v37, v37, v10
v_sub_f32 v38, v38, v10
v_sub_f32 v39, v39, v10
v_sub_f32 v76, v76, v10
v_sub_f32 v92, v92, v10
v_sub_f32 v77, v77, v10
v_sub_f32 v93, v93, v10
v_sub_f32 v78, v78, v10
v_sub_f32 v94, v94, v10
v_sub_f32 v79, v79, v10
v_sub_f32 v95, v95, v10
v_sub_f32 v84, v84, v10
v_sub_f32 v100, v100, v10
v_sub_f32 v85, v85, v10
v_sub_f32 v101, v101, v10
v_sub_f32 v86, v86, v10
v_sub_f32 v102, v102, v10
v_sub_f32 v87, v87, v10
v_sub_f32 v103, v103, v10
v_accvgpr_read_b32 v13, a4
v_mul_f32 v13, v13, v12
v_accvgpr_write_b32 a4, v13
v_accvgpr_read_b32 v13, a5
v_mul_f32 v13, v13, v12
v_accvgpr_write_b32 a5, v13
v_accvgpr_read_b32 v13, a6
v_mul_f32 v13, v13, v12
v_accvgpr_write_b32 a6, v13
v_accvgpr_read_b32 v13, a7
v_mul_f32 v13, v13, v12
v_accvgpr_write_b32 a7, v13
v_accvgpr_read_b32 v13, a12
v_mul_f32 v13, v13, v12
v_accvgpr_write_b32 a12, v13
v_accvgpr_read_b32 v13, a13
v_mul_f32 v13, v13, v12
v_accvgpr_write_b32 a13, v13
v_accvgpr_read_b32 v13, a14
v_mul_f32 v13, v13, v12
v_accvgpr_write_b32 a14, v13
v_accvgpr_read_b32 v13, a15
v_mul_f32 v13, v13, v12
v_accvgpr_write_b32 a15, v13
v_accvgpr_read_b32 v13, a20
v_mul_f32 v13, v13, v12
v_accvgpr_write_b32 a20, v13
v_accvgpr_read_b32 v13, a21
v_mul_f32 v13, v13, v12
v_accvgpr_write_b32 a21, v13
v_accvgpr_read_b32 v13, a22
v_mul_f32 v13, v13, v12
v_accvgpr_write_b32 a22, v13
v_accvgpr_read_b32 v13, a23
v_mul_f32 v13, v13, v12
v_accvgpr_write_b32 a23, v13
v_accvgpr_read_b32 v13, a28
v_mul_f32 v13, v13, v12
v_accvgpr_write_b32 a28, v13
v_accvgpr_read_b32 v13, a29
v_mul_f32 v13, v13, v12
v_accvgpr_write_b32 a29, v13
v_accvgpr_read_b32 v13, a30
v_mul_f32 v13, v13, v12
v_accvgpr_write_b32 a30, v13
v_accvgpr_read_b32 v13, a31
v_mul_f32 v13, v13, v12
v_accvgpr_write_b32 a31, v13
v_accvgpr_read_b32 v13, a36
v_mul_f32 v13, v13, v12
v_accvgpr_write_b32 a36, v13
v_accvgpr_read_b32 v13, a37
v_mul_f32 v13, v13, v12
v_accvgpr_write_b32 a37, v13
v_accvgpr_read_b32 v13, a38
v_mul_f32 v13, v13, v12
v_accvgpr_write_b32 a38, v13
v_accvgpr_read_b32 v13, a39
v_mul_f32 v13, v13, v12
v_accvgpr_write_b32 a39, v13
v_accvgpr_read_b32 v13, a44
v_mul_f32 v13, v13, v12
v_accvgpr_write_b32 a44, v13
v_accvgpr_read_b32 v13, a45
v_mul_f32 v13, v13, v12
v_accvgpr_write_b32 a45, v13
v_accvgpr_read_b32 v13, a46
v_mul_f32 v13, v13, v12
v_accvgpr_write_b32 a46, v13
v_accvgpr_read_b32 v13, a47
v_mul_f32 v13, v13, v12
v_accvgpr_write_b32 a47, v13
v_accvgpr_read_b32 v13, a52
v_mul_f32 v13, v13, v12
v_accvgpr_write_b32 a52, v13
v_accvgpr_read_b32 v13, a53
v_mul_f32 v13, v13, v12
v_accvgpr_write_b32 a53, v13
v_accvgpr_read_b32 v13, a54
v_mul_f32 v13, v13, v12
v_accvgpr_write_b32 a54, v13
v_accvgpr_read_b32 v13, a55
v_mul_f32 v13, v13, v12
v_accvgpr_write_b32 a55, v13
v_accvgpr_read_b32 v13, a60
v_mul_f32 v13, v13, v12
v_accvgpr_write_b32 a60, v13
v_accvgpr_read_b32 v13, a61
v_mul_f32 v13, v13, v12
v_accvgpr_write_b32 a61, v13
v_accvgpr_read_b32 v13, a62
v_mul_f32 v13, v13, v12
v_accvgpr_write_b32 a62, v13
v_accvgpr_read_b32 v13, a63
v_mul_f32 v13, v13, v12
v_accvgpr_write_b32 a63, v13
v_accvgpr_read_b32 v13, a68
v_mul_f32 v13, v13, v12
v_accvgpr_write_b32 a68, v13
v_accvgpr_read_b32 v13, a69
v_mul_f32 v13, v13, v12
v_accvgpr_write_b32 a69, v13
v_accvgpr_read_b32 v13, a70
v_mul_f32 v13, v13, v12
v_accvgpr_write_b32 a70, v13
v_accvgpr_read_b32 v13, a71
v_mul_f32 v13, v13, v12
v_accvgpr_write_b32 a71, v13
v_accvgpr_read_b32 v13, a76
v_mul_f32 v13, v13, v12
v_accvgpr_write_b32 a76, v13
v_accvgpr_read_b32 v13, a77
v_mul_f32 v13, v13, v12
v_accvgpr_write_b32 a77, v13
v_accvgpr_read_b32 v13, a78
v_mul_f32 v13, v13, v12
v_accvgpr_write_b32 a78, v13
v_accvgpr_read_b32 v13, a79
v_mul_f32 v13, v13, v12
v_accvgpr_write_b32 a79, v13
v_accvgpr_read_b32 v13, a84
v_mul_f32 v13, v13, v12
v_accvgpr_write_b32 a84, v13
v_accvgpr_read_b32 v13, a85
v_mul_f32 v13, v13, v12
v_accvgpr_write_b32 a85, v13
v_accvgpr_read_b32 v13, a86
v_mul_f32 v13, v13, v12
v_accvgpr_write_b32 a86, v13
v_accvgpr_read_b32 v13, a87
v_mul_f32 v13, v13, v12
v_accvgpr_write_b32 a87, v13
v_accvgpr_read_b32 v13, a92
v_mul_f32 v13, v13, v12
v_accvgpr_write_b32 a92, v13
v_accvgpr_read_b32 v13, a93
v_mul_f32 v13, v13, v12
v_accvgpr_write_b32 a93, v13
v_accvgpr_read_b32 v13, a94
v_mul_f32 v13, v13, v12
v_accvgpr_write_b32 a94, v13
v_accvgpr_read_b32 v13, a95
v_mul_f32 v13, v13, v12
v_accvgpr_write_b32 a95, v13
v_accvgpr_read_b32 v13, a100
v_mul_f32 v13, v13, v12
v_accvgpr_write_b32 a100, v13
v_accvgpr_read_b32 v13, a101
v_mul_f32 v13, v13, v12
v_accvgpr_write_b32 a101, v13
v_accvgpr_read_b32 v13, a102
v_mul_f32 v13, v13, v12
v_accvgpr_write_b32 a102, v13
v_accvgpr_read_b32 v13, a103
v_mul_f32 v13, v13, v12
v_accvgpr_write_b32 a103, v13
v_accvgpr_read_b32 v13, a108
v_mul_f32 v13, v13, v12
v_accvgpr_write_b32 a108, v13
v_accvgpr_read_b32 v13, a109
v_mul_f32 v13, v13, v12
v_accvgpr_write_b32 a109, v13
v_accvgpr_read_b32 v13, a110
v_mul_f32 v13, v13, v12
v_accvgpr_write_b32 a110, v13
v_accvgpr_read_b32 v13, a111
v_mul_f32 v13, v13, v12
v_accvgpr_write_b32 a111, v13
v_accvgpr_read_b32 v13, a116
v_mul_f32 v13, v13, v12
v_accvgpr_write_b32 a116, v13
v_accvgpr_read_b32 v13, a117
v_mul_f32 v13, v13, v12
v_accvgpr_write_b32 a117, v13
v_accvgpr_read_b32 v13, a118
v_mul_f32 v13, v13, v12
v_accvgpr_write_b32 a118, v13
v_accvgpr_read_b32 v13, a119
v_mul_f32 v13, v13, v12
v_accvgpr_write_b32 a119, v13
v_accvgpr_read_b32 v13, a124
v_mul_f32 v13, v13, v12
v_accvgpr_write_b32 a124, v13
v_accvgpr_read_b32 v13, a125
v_mul_f32 v13, v13, v12
v_accvgpr_write_b32 a125, v13
v_accvgpr_read_b32 v13, a126
v_mul_f32 v13, v13, v12
v_accvgpr_write_b32 a126, v13
v_accvgpr_read_b32 v13, a127
v_mul_f32 v13, v13, v12
v_accvgpr_write_b32 a127, v13
v_exp_f32 v104, v72
v_exp_f32 v105, v73
v_exp_f32 v106, v74
v_exp_f32 v107, v75
v_exp_f32 v112, v80
v_exp_f32 v113, v81
v_exp_f32 v114, v82
v_exp_f32 v115, v83
v_exp_f32 v108, v76
v_exp_f32 v109, v77
v_exp_f32 v110, v78
v_exp_f32 v111, v79
v_exp_f32 v116, v84
v_exp_f32 v117, v85
v_exp_f32 v118, v86
v_exp_f32 v119, v87
s_nop 0
v_cvt_pk_bf16_f32 v120, v104, v105
v_add_f32 v200, v104, v105
v_cvt_pk_bf16_f32 v121, v106, v107
v_add_f32 v201, v106, v107
v_add_f32 v200, v200, v201
v_cvt_pk_bf16_f32 v122, v112, v113
v_add_f32 v201, v112, v113
v_cvt_pk_bf16_f32 v123, v114, v115
v_add_f32 v200, v200, v201
v_add_f32 v201, v114, v115
v_add_f32 v30, v200, v201
v_cvt_pk_bf16_f32 v124, v108, v109
v_add_f32 v202, v108, v109
v_cvt_pk_bf16_f32 v125, v110, v111
v_add_f32 v203, v110, v111
v_add_f32 v202, v202, v203
v_cvt_pk_bf16_f32 v126, v116, v117
v_add_f32 v203, v116, v117
v_cvt_pk_bf16_f32 v127, v118, v119
v_add_f32 v202, v202, v203
v_add_f32 v203, v118, v119
v_add_f32 v31, v202, v203
s_nop 1
s_branch K2A_BACK0
K2A_SLOW1:
s_nop 7
s_nop 7
v_max3_f32 v9, v88, v89, v90
v_max3_f32 v9, v9, v91, v96
v_max3_f32 v9, v9, v97, v98
v_max_f32 v9, v9, v99
v_max3_f32 v10, v92, v93, v94
v_max3_f32 v10, v10, v95, v100
v_max3_f32 v10, v10, v101, v102
v_max_f32 v10, v10, v103
ds_bpermute_b32 v11, v4, v9
ds_bpermute_b32 v12, v4, v10
s_waitcnt lgkmcnt(0)
v_max_f32 v9, v9, v11
v_max_f32 v10, v10, v12
ds_bpermute_b32 v11, v5, v9
ds_bpermute_b32 v12, v5, v10
s_waitcnt lgkmcnt(0)
v_max_f32 v9, v9, v11
v_max_f32 v10, v10, v12
v_max_f32 v9, 0, v9
v_sub_f32 v11, 0, v9
v_exp_f32 v11, v11
v_max_f32 v10, 0, v10
v_sub_f32 v12, 0, v10
v_exp_f32 v12, v12
s_nop 0
v_mul_f32 v28, v28, v11
v_sub_f32 v32, v32, v9
v_sub_f32 v33, v33, v9
v_sub_f32 v34, v34, v9
v_sub_f32 v35, v35, v9
v_sub_f32 v88, v88, v9
v_sub_f32 v72, v72, v9
v_sub_f32 v89, v89, v9
v_sub_f32 v73, v73, v9
v_sub_f32 v90, v90, v9
v_sub_f32 v74, v74, v9
v_sub_f32 v91, v91, v9
v_sub_f32 v75, v75, v9
v_sub_f32 v96, v96, v9
v_sub_f32 v80, v80, v9
v_sub_f32 v97, v97, v9
v_sub_f32 v81, v81, v9
v_sub_f32 v98, v98, v9
v_sub_f32 v82, v82, v9
v_sub_f32 v99, v99, v9
v_sub_f32 v83, v83, v9
v_accvgpr_read_b32 v13, a0
v_mul_f32 v13, v13, v11
v_accvgpr_write_b32 a0, v13
v_accvgpr_read_b32 v13, a1
v_mul_f32 v13, v13, v11
v_accvgpr_write_b32 a1, v13
v_accvgpr_read_b32 v13, a2
v_mul_f32 v13, v13, v11
v_accvgpr_write_b32 a2, v13
v_accvgpr_read_b32 v13, a3
v_mul_f32 v13, v13, v11
v_accvgpr_write_b32 a3, v13
v_accvgpr_read_b32 v13, a8
v_mul_f32 v13, v13, v11
v_accvgpr_write_b32 a8, v13
v_accvgpr_read_b32 v13, a9
v_mul_f32 v13, v13, v11
v_accvgpr_write_b32 a9, v13
v_accvgpr_read_b32 v13, a10
v_mul_f32 v13, v13, v11
v_accvgpr_write_b32 a10, v13
v_accvgpr_read_b32 v13, a11
v_mul_f32 v13, v13, v11
v_accvgpr_write_b32 a11, v13
v_accvgpr_read_b32 v13, a16
v_mul_f32 v13, v13, v11
v_accvgpr_write_b32 a16, v13
v_accvgpr_read_b32 v13, a17
v_mul_f32 v13, v13, v11
v_accvgpr_write_b32 a17, v13
v_accvgpr_read_b32 v13, a18
v_mul_f32 v13, v13, v11
v_accvgpr_write_b32 a18, v13
v_accvgpr_read_b32 v13, a19
v_mul_f32 v13, v13, v11
v_accvgpr_write_b32 a19, v13
v_accvgpr_read_b32 v13, a24
v_mul_f32 v13, v13, v11
v_accvgpr_write_b32 a24, v13
v_accvgpr_read_b32 v13, a25
v_mul_f32 v13, v13, v11
v_accvgpr_write_b32 a25, v13
v_accvgpr_read_b32 v13, a26
v_mul_f32 v13, v13, v11
v_accvgpr_write_b32 a26, v13
v_accvgpr_read_b32 v13, a27
v_mul_f32 v13, v13, v11
v_accvgpr_write_b32 a27, v13
v_accvgpr_read_b32 v13, a32
v_mul_f32 v13, v13, v11
v_accvgpr_write_b32 a32, v13
v_accvgpr_read_b32 v13, a33
v_mul_f32 v13, v13, v11
v_accvgpr_write_b32 a33, v13
v_accvgpr_read_b32 v13, a34
v_mul_f32 v13, v13, v11
v_accvgpr_write_b32 a34, v13
v_accvgpr_read_b32 v13, a35
v_mul_f32 v13, v13, v11
v_accvgpr_write_b32 a35, v13
v_accvgpr_read_b32 v13, a40
v_mul_f32 v13, v13, v11
v_accvgpr_write_b32 a40, v13
v_accvgpr_read_b32 v13, a41
v_mul_f32 v13, v13, v11
v_accvgpr_write_b32 a41, v13
v_accvgpr_read_b32 v13, a42
v_mul_f32 v13, v13, v11
v_accvgpr_write_b32 a42, v13
v_accvgpr_read_b32 v13, a43
v_mul_f32 v13, v13, v11
v_accvgpr_write_b32 a43, v13
v_accvgpr_read_b32 v13, a48
v_mul_f32 v13, v13, v11
v_accvgpr_write_b32 a48, v13
v_accvgpr_read_b32 v13, a49
v_mul_f32 v13, v13, v11
v_accvgpr_write_b32 a49, v13
v_accvgpr_read_b32 v13, a50
v_mul_f32 v13, v13, v11
v_accvgpr_write_b32 a50, v13
v_accvgpr_read_b32 v13, a51
v_mul_f32 v13, v13, v11
v_accvgpr_write_b32 a51, v13
v_accvgpr_read_b32 v13, a56
v_mul_f32 v13, v13, v11
v_accvgpr_write_b32 a56, v13
v_accvgpr_read_b32 v13, a57
v_mul_f32 v13, v13, v11
v_accvgpr_write_b32 a57, v13
v_accvgpr_read_b32 v13, a58
v_mul_f32 v13, v13, v11
v_accvgpr_write_b32 a58, v13
v_accvgpr_read_b32 v13, a59
v_mul_f32 v13, v13, v11
v_accvgpr_write_b32 a59, v13
v_accvgpr_read_b32 v13, a64
v_mul_f32 v13, v13, v11
v_accvgpr_write_b32 a64, v13
v_accvgpr_read_b32 v13, a65
v_mul_f32 v13, v13, v11
v_accvgpr_write_b32 a65, v13
v_accvgpr_read_b32 v13, a66
v_mul_f32 v13, v13, v11
v_accvgpr_write_b32 a66, v13
v_accvgpr_read_b32 v13, a67
v_mul_f32 v13, v13, v11
v_accvgpr_write_b32 a67, v13
v_accvgpr_read_b32 v13, a72
v_mul_f32 v13, v13, v11
v_accvgpr_write_b32 a72, v13
v_accvgpr_read_b32 v13, a73
v_mul_f32 v13, v13, v11
v_accvgpr_write_b32 a73, v13
v_accvgpr_read_b32 v13, a74
v_mul_f32 v13, v13, v11
v_accvgpr_write_b32 a74, v13
v_accvgpr_read_b32 v13, a75
v_mul_f32 v13, v13, v11
v_accvgpr_write_b32 a75, v13
v_accvgpr_read_b32 v13, a80
v_mul_f32 v13, v13, v11
v_accvgpr_write_b32 a80, v13
v_accvgpr_read_b32 v13, a81
v_mul_f32 v13, v13, v11
v_accvgpr_write_b32 a81, v13
v_accvgpr_read_b32 v13, a82
v_mul_f32 v13, v13, v11
v_accvgpr_write_b32 a82, v13
v_accvgpr_read_b32 v13, a83
v_mul_f32 v13, v13, v11
v_accvgpr_write_b32 a83, v13
v_accvgpr_read_b32 v13, a88
v_mul_f32 v13, v13, v11
v_accvgpr_write_b32 a88, v13
v_accvgpr_read_b32 v13, a89
v_mul_f32 v13, v13, v11
v_accvgpr_write_b32 a89, v13
v_accvgpr_read_b32 v13, a90
v_mul_f32 v13, v13, v11
v_accvgpr_write_b32 a90, v13
v_accvgpr_read_b32 v13, a91
v_mul_f32 v13, v13, v11
v_accvgpr_write_b32 a91, v13
v_accvgpr_read_b32 v13, a96
v_mul_f32 v13, v13, v11
v_accvgpr_write_b32 a96, v13
v_accvgpr_read_b32 v13, a97
v_mul_f32 v13, v13, v11
v_accvgpr_write_b32 a97, v13
v_accvgpr_read_b32 v13, a98
v_mul_f32 v13, v13, v11
v_accvgpr_write_b32 a98, v13
v_accvgpr_read_b32 v13, a99
v_mul_f32 v13, v13, v11
v_accvgpr_write_b32 a99, v13
v_accvgpr_read_b32 v13, a104
v_mul_f32 v13, v13, v11
v_accvgpr_write_b32 a104, v13
v_accvgpr_read_b32 v13, a105
v_mul_f32 v13, v13, v11
v_accvgpr_write_b32 a105, v13
v_accvgpr_read_b32 v13, a106
v_mul_f32 v13, v13, v11
v_accvgpr_write_b32 a106, v13
v_accvgpr_read_b32 v13, a107
v_mul_f32 v13, v13, v11
v_accvgpr_write_b32 a107, v13
v_accvgpr_read_b32 v13, a112
v_mul_f32 v13, v13, v11
v_accvgpr_write_b32 a112, v13
v_accvgpr_read_b32 v13, a113
v_mul_f32 v13, v13, v11
v_accvgpr_write_b32 a113, v13
v_accvgpr_read_b32 v13, a114
v_mul_f32 v13, v13, v11
v_accvgpr_write_b32 a114, v13
v_accvgpr_read_b32 v13, a115
v_mul_f32 v13, v13, v11
v_accvgpr_write_b32 a115, v13
v_accvgpr_read_b32 v13, a120
v_mul_f32 v13, v13, v11
v_accvgpr_write_b32 a120, v13
v_accvgpr_read_b32 v13, a121
v_mul_f32 v13, v13, v11
v_accvgpr_write_b32 a121, v13
v_accvgpr_read_b32 v13, a122
v_mul_f32 v13, v13, v11
v_accvgpr_write_b32 a122, v13
v_accvgpr_read_b32 v13, a123
v_mul_f32 v13, v13, v11
v_accvgpr_write_b32 a123, v13
v_mul_f32 v29, v29, v12
v_sub_f32 v36, v36, v10
v_sub_f32 v37, v37, v10
v_sub_f32 v38, v38, v10
v_sub_f32 v39, v39, v10
v_sub_f32 v92, v92, v10
v_sub_f32 v76, v76, v10
v_sub_f32 v93, v93, v10
v_sub_f32 v77, v77, v10
v_sub_f32 v94, v94, v10
v_sub_f32 v78, v78, v10
v_sub_f32 v95, v95, v10
v_sub_f32 v79, v79, v10
v_sub_f32 v100, v100, v10
v_sub_f32 v84, v84, v10
v_sub_f32 v101, v101, v10
v_sub_f32 v85, v85, v10
v_sub_f32 v102, v102, v10
v_sub_f32 v86, v86, v10
v_sub_f32 v103, v103, v10
v_sub_f32 v87, v87, v10
v_accvgpr_read_b32 v13, a4
v_mul_f32 v13, v13, v12
v_accvgpr_write_b32 a4, v13
v_accvgpr_read_b32 v13, a5
v_mul_f32 v13, v13, v12
v_accvgpr_write_b32 a5, v13
v_accvgpr_read_b32 v13, a6
v_mul_f32 v13, v13, v12
v_accvgpr_write_b32 a6, v13
v_accvgpr_read_b32 v13, a7
v_mul_f32 v13, v13, v12
v_accvgpr_write_b32 a7, v13
v_accvgpr_read_b32 v13, a12
v_mul_f32 v13, v13, v12
v_accvgpr_write_b32 a12, v13
v_accvgpr_read_b32 v13, a13
v_mul_f32 v13, v13, v12
v_accvgpr_write_b32 a13, v13
v_accvgpr_read_b32 v13, a14
v_mul_f32 v13, v13, v12
v_accvgpr_write_b32 a14, v13
v_accvgpr_read_b32 v13, a15
v_mul_f32 v13, v13, v12
v_accvgpr_write_b32 a15, v13
v_accvgpr_read_b32 v13, a20
v_mul_f32 v13, v13, v12
v_accvgpr_write_b32 a20, v13
v_accvgpr_read_b32 v13, a21
v_mul_f32 v13, v13, v12
v_accvgpr_write_b32 a21, v13
v_accvgpr_read_b32 v13, a22
v_mul_f32 v13, v13, v12
v_accvgpr_write_b32 a22, v13
v_accvgpr_read_b32 v13, a23
v_mul_f32 v13, v13, v12
v_accvgpr_write_b32 a23, v13
v_accvgpr_read_b32 v13, a28
v_mul_f32 v13, v13, v12
v_accvgpr_write_b32 a28, v13
v_accvgpr_read_b32 v13, a29
v_mul_f32 v13, v13, v12
v_accvgpr_write_b32 a29, v13
v_accvgpr_read_b32 v13, a30
v_mul_f32 v13, v13, v12
v_accvgpr_write_b32 a30, v13
v_accvgpr_read_b32 v13, a31
v_mul_f32 v13, v13, v12
v_accvgpr_write_b32 a31, v13
v_accvgpr_read_b32 v13, a36
v_mul_f32 v13, v13, v12
v_accvgpr_write_b32 a36, v13
v_accvgpr_read_b32 v13, a37
v_mul_f32 v13, v13, v12
v_accvgpr_write_b32 a37, v13
v_accvgpr_read_b32 v13, a38
v_mul_f32 v13, v13, v12
v_accvgpr_write_b32 a38, v13
v_accvgpr_read_b32 v13, a39
v_mul_f32 v13, v13, v12
v_accvgpr_write_b32 a39, v13
v_accvgpr_read_b32 v13, a44
v_mul_f32 v13, v13, v12
v_accvgpr_write_b32 a44, v13
v_accvgpr_read_b32 v13, a45
v_mul_f32 v13, v13, v12
v_accvgpr_write_b32 a45, v13
v_accvgpr_read_b32 v13, a46
v_mul_f32 v13, v13, v12
v_accvgpr_write_b32 a46, v13
v_accvgpr_read_b32 v13, a47
v_mul_f32 v13, v13, v12
v_accvgpr_write_b32 a47, v13
v_accvgpr_read_b32 v13, a52
v_mul_f32 v13, v13, v12
v_accvgpr_write_b32 a52, v13
v_accvgpr_read_b32 v13, a53
v_mul_f32 v13, v13, v12
v_accvgpr_write_b32 a53, v13
v_accvgpr_read_b32 v13, a54
v_mul_f32 v13, v13, v12
v_accvgpr_write_b32 a54, v13
v_accvgpr_read_b32 v13, a55
v_mul_f32 v13, v13, v12
v_accvgpr_write_b32 a55, v13
v_accvgpr_read_b32 v13, a60
v_mul_f32 v13, v13, v12
v_accvgpr_write_b32 a60, v13
v_accvgpr_read_b32 v13, a61
v_mul_f32 v13, v13, v12
v_accvgpr_write_b32 a61, v13
v_accvgpr_read_b32 v13, a62
v_mul_f32 v13, v13, v12
v_accvgpr_write_b32 a62, v13
v_accvgpr_read_b32 v13, a63
v_mul_f32 v13, v13, v12
v_accvgpr_write_b32 a63, v13
v_accvgpr_read_b32 v13, a68
v_mul_f32 v13, v13, v12
v_accvgpr_write_b32 a68, v13
v_accvgpr_read_b32 v13, a69
v_mul_f32 v13, v13, v12
v_accvgpr_write_b32 a69, v13
v_accvgpr_read_b32 v13, a70
v_mul_f32 v13, v13, v12
v_accvgpr_write_b32 a70, v13
v_accvgpr_read_b32 v13, a71
v_mul_f32 v13, v13, v12
v_accvgpr_write_b32 a71, v13
v_accvgpr_read_b32 v13, a76
v_mul_f32 v13, v13, v12
v_accvgpr_write_b32 a76, v13
v_accvgpr_read_b32 v13, a77
v_mul_f32 v13, v13, v12
v_accvgpr_write_b32 a77, v13
v_accvgpr_read_b32 v13, a78
v_mul_f32 v13, v13, v12
v_accvgpr_write_b32 a78, v13
v_accvgpr_read_b32 v13, a79
v_mul_f32 v13, v13, v12
v_accvgpr_write_b32 a79, v13
v_accvgpr_read_b32 v13, a84
v_mul_f32 v13, v13, v12
v_accvgpr_write_b32 a84, v13
v_accvgpr_read_b32 v13, a85
v_mul_f32 v13, v13, v12
v_accvgpr_write_b32 a85, v13
v_accvgpr_read_b32 v13, a86
v_mul_f32 v13, v13, v12
v_accvgpr_write_b32 a86, v13
v_accvgpr_read_b32 v13, a87
v_mul_f32 v13, v13, v12
v_accvgpr_write_b32 a87, v13
v_accvgpr_read_b32 v13, a92
v_mul_f32 v13, v13, v12
v_accvgpr_write_b32 a92, v13
v_accvgpr_read_b32 v13, a93
v_mul_f32 v13, v13, v12
v_accvgpr_write_b32 a93, v13
v_accvgpr_read_b32 v13, a94
v_mul_f32 v13, v13, v12
v_accvgpr_write_b32 a94, v13
v_accvgpr_read_b32 v13, a95
v_mul_f32 v13, v13, v12
v_accvgpr_write_b32 a95, v13
v_accvgpr_read_b32 v13, a100
v_mul_f32 v13, v13, v12
v_accvgpr_write_b32 a100, v13
v_accvgpr_read_b32 v13, a101
v_mul_f32 v13, v13, v12
v_accvgpr_write_b32 a101, v13
v_accvgpr_read_b32 v13, a102
v_mul_f32 v13, v13, v12
v_accvgpr_write_b32 a102, v13
v_accvgpr_read_b32 v13, a103
v_mul_f32 v13, v13, v12
v_accvgpr_write_b32 a103, v13
v_accvgpr_read_b32 v13, a108
v_mul_f32 v13, v13, v12
v_accvgpr_write_b32 a108, v13
v_accvgpr_read_b32 v13, a109
v_mul_f32 v13, v13, v12
v_accvgpr_write_b32 a109, v13
v_accvgpr_read_b32 v13, a110
v_mul_f32 v13, v13, v12
v_accvgpr_write_b32 a110, v13
v_accvgpr_read_b32 v13, a111
v_mul_f32 v13, v13, v12
v_accvgpr_write_b32 a111, v13
v_accvgpr_read_b32 v13, a116
v_mul_f32 v13, v13, v12
v_accvgpr_write_b32 a116, v13
v_accvgpr_read_b32 v13, a117
v_mul_f32 v13, v13, v12
v_accvgpr_write_b32 a117, v13
v_accvgpr_read_b32 v13, a118
v_mul_f32 v13, v13, v12
v_accvgpr_write_b32 a118, v13
v_accvgpr_read_b32 v13, a119
v_mul_f32 v13, v13, v12
v_accvgpr_write_b32 a119, v13
v_accvgpr_read_b32 v13, a124
v_mul_f32 v13, v13, v12
v_accvgpr_write_b32 a124, v13
v_accvgpr_read_b32 v13, a125
v_mul_f32 v13, v13, v12
v_accvgpr_write_b32 a125, v13
v_accvgpr_read_b32 v13, a126
v_mul_f32 v13, v13, v12
v_accvgpr_write_b32 a126, v13
v_accvgpr_read_b32 v13, a127
v_mul_f32 v13, v13, v12
v_accvgpr_write_b32 a127, v13
v_exp_f32 v104, v88
v_exp_f32 v105, v89
v_exp_f32 v106, v90
v_exp_f32 v107, v91
v_exp_f32 v112, v96
v_exp_f32 v113, v97
v_exp_f32 v114, v98
v_exp_f32 v115, v99
v_exp_f32 v108, v92
v_exp_f32 v109, v93
v_exp_f32 v110, v94
v_exp_f32 v111, v95
v_exp_f32 v116, v100
v_exp_f32 v117, v101
v_exp_f32 v118, v102
v_exp_f32 v119, v103
s_nop 0
v_cvt_pk_bf16_f32 v128, v104, v105
v_add_f32 v200, v104, v105
v_cvt_pk_bf16_f32 v129, v106, v107
v_add_f32 v201, v106, v107
v_add_f32 v200, v200, v201
v_cvt_pk_bf16_f32 v130, v112, v113
v_add_f32 v201, v112, v113
v_cvt_pk_bf16_f32 v131, v114, v115
v_add_f32 v200, v200, v201
v_add_f32 v201, v114, v115
v_add_f32 v30, v200, v201
v_cvt_pk_bf16_f32 v132, v108, v109
v_add_f32 v202, v108, v109
v_cvt_pk_bf16_f32 v133, v110, v111
v_add_f32 v203, v110, v111
v_add_f32 v202, v202, v203
v_cvt_pk_bf16_f32 v134, v116, v117
v_add_f32 v203, v116, v117
v_cvt_pk_bf16_f32 v135, v118, v119
v_add_f32 v202, v202, v203
v_add_f32 v203, v118, v119
v_add_f32 v31, v202, v203
s_nop 1
s_branch K2A_BACK1
K2A_SLOW2:
s_nop 7
s_nop 7
v_max3_f32 v9, v72, v73, v74
v_max3_f32 v9, v9, v75, v80
v_max3_f32 v9, v9, v81, v82
v_max_f32 v9, v9, v83
v_max3_f32 v10, v76, v77, v78
v_max3_f32 v10, v10, v79, v84
v_max3_f32 v10, v10, v85, v86
v_max_f32 v10, v10, v87
ds_bpermute_b32 v11, v4, v9
ds_bpermute_b32 v12, v4, v10
s_waitcnt lgkmcnt(0)
v_max_f32 v9, v9, v11
v_max_f32 v10, v10, v12
ds_bpermute_b32 v11, v5, v9
ds_bpermute_b32 v12, v5, v10
s_waitcnt lgkmcnt(0)
v_max_f32 v9, v9, v11
v_max_f32 v10, v10, v12
v_max_f32 v9, 0, v9
v_sub_f32 v11, 0, v9
v_exp_f32 v11, v11
v_max_f32 v10, 0, v10
v_sub_f32 v12, 0, v10
v_exp_f32 v12, v12
s_nop 0
v_mul_f32 v28, v28, v11
v_sub_f32 v32, v32, v9
v_sub_f32 v33, v33, v9
v_sub_f32 v34, v34, v9
v_sub_f32 v35, v35, v9
v_sub_f32 v72, v72, v9
v_sub_f32 v88, v88, v9
v_sub_f32 v73, v73, v9
v_sub_f32 v89, v89, v9
v_sub_f32 v74, v74, v9
v_sub_f32 v90, v90, v9
v_sub_f32 v75, v75, v9
v_sub_f32 v91, v91, v9
v_sub_f32 v80, v80, v9
v_sub_f32 v96, v96, v9
v_sub_f32 v81, v81, v9
v_sub_f32 v97, v97, v9
v_sub_f32 v82, v82, v9
v_sub_f32 v98, v98, v9
v_sub_f32 v83, v83, v9
v_sub_f32 v99, v99, v9
v_accvgpr_read_b32 v13, a0
v_mul_f32 v13, v13, v11
v_accvgpr_write_b32 a0, v13
v_accvgpr_read_b32 v13, a1
v_mul_f32 v13, v13, v11
v_accvgpr_write_b32 a1, v13
v_accvgpr_read_b32 v13, a2
v_mul_f32 v13, v13, v11
v_accvgpr_write_b32 a2, v13
v_accvgpr_read_b32 v13, a3
v_mul_f32 v13, v13, v11
v_accvgpr_write_b32 a3, v13
v_accvgpr_read_b32 v13, a8
v_mul_f32 v13, v13, v11
v_accvgpr_write_b32 a8, v13
v_accvgpr_read_b32 v13, a9
v_mul_f32 v13, v13, v11
v_accvgpr_write_b32 a9, v13
v_accvgpr_read_b32 v13, a10
v_mul_f32 v13, v13, v11
v_accvgpr_write_b32 a10, v13
v_accvgpr_read_b32 v13, a11
v_mul_f32 v13, v13, v11
v_accvgpr_write_b32 a11, v13
v_accvgpr_read_b32 v13, a16
v_mul_f32 v13, v13, v11
v_accvgpr_write_b32 a16, v13
v_accvgpr_read_b32 v13, a17
v_mul_f32 v13, v13, v11
v_accvgpr_write_b32 a17, v13
v_accvgpr_read_b32 v13, a18
v_mul_f32 v13, v13, v11
v_accvgpr_write_b32 a18, v13
v_accvgpr_read_b32 v13, a19
v_mul_f32 v13, v13, v11
v_accvgpr_write_b32 a19, v13
v_accvgpr_read_b32 v13, a24
v_mul_f32 v13, v13, v11
v_accvgpr_write_b32 a24, v13
v_accvgpr_read_b32 v13, a25
v_mul_f32 v13, v13, v11
v_accvgpr_write_b32 a25, v13
v_accvgpr_read_b32 v13, a26
v_mul_f32 v13, v13, v11
v_accvgpr_write_b32 a26, v13
v_accvgpr_read_b32 v13, a27
v_mul_f32 v13, v13, v11
v_accvgpr_write_b32 a27, v13
v_accvgpr_read_b32 v13, a32
v_mul_f32 v13, v13, v11
v_accvgpr_write_b32 a32, v13
v_accvgpr_read_b32 v13, a33
v_mul_f32 v13, v13, v11
v_accvgpr_write_b32 a33, v13
v_accvgpr_read_b32 v13, a34
v_mul_f32 v13, v13, v11
v_accvgpr_write_b32 a34, v13
v_accvgpr_read_b32 v13, a35
v_mul_f32 v13, v13, v11
v_accvgpr_write_b32 a35, v13
v_accvgpr_read_b32 v13, a40
v_mul_f32 v13, v13, v11
v_accvgpr_write_b32 a40, v13
v_accvgpr_read_b32 v13, a41
v_mul_f32 v13, v13, v11
v_accvgpr_write_b32 a41, v13
v_accvgpr_read_b32 v13, a42
v_mul_f32 v13, v13, v11
v_accvgpr_write_b32 a42, v13
v_accvgpr_read_b32 v13, a43
v_mul_f32 v13, v13, v11
v_accvgpr_write_b32 a43, v13
v_accvgpr_read_b32 v13, a48
v_mul_f32 v13, v13, v11
v_accvgpr_write_b32 a48, v13
v_accvgpr_read_b32 v13, a49
v_mul_f32 v13, v13, v11
v_accvgpr_write_b32 a49, v13
v_accvgpr_read_b32 v13, a50
v_mul_f32 v13, v13, v11
v_accvgpr_write_b32 a50, v13
v_accvgpr_read_b32 v13, a51
v_mul_f32 v13, v13, v11
v_accvgpr_write_b32 a51, v13
v_accvgpr_read_b32 v13, a56
v_mul_f32 v13, v13, v11
v_accvgpr_write_b32 a56, v13
v_accvgpr_read_b32 v13, a57
v_mul_f32 v13, v13, v11
v_accvgpr_write_b32 a57, v13
v_accvgpr_read_b32 v13, a58
v_mul_f32 v13, v13, v11
v_accvgpr_write_b32 a58, v13
v_accvgpr_read_b32 v13, a59
v_mul_f32 v13, v13, v11
v_accvgpr_write_b32 a59, v13
v_accvgpr_read_b32 v13, a64
v_mul_f32 v13, v13, v11
v_accvgpr_write_b32 a64, v13
v_accvgpr_read_b32 v13, a65
v_mul_f32 v13, v13, v11
v_accvgpr_write_b32 a65, v13
v_accvgpr_read_b32 v13, a66
v_mul_f32 v13, v13, v11
v_accvgpr_write_b32 a66, v13
v_accvgpr_read_b32 v13, a67
v_mul_f32 v13, v13, v11
v_accvgpr_write_b32 a67, v13
v_accvgpr_read_b32 v13, a72
v_mul_f32 v13, v13, v11
v_accvgpr_write_b32 a72, v13
v_accvgpr_read_b32 v13, a73
v_mul_f32 v13, v13, v11
v_accvgpr_write_b32 a73, v13
v_accvgpr_read_b32 v13, a74
v_mul_f32 v13, v13, v11
v_accvgpr_write_b32 a74, v13
v_accvgpr_read_b32 v13, a75
v_mul_f32 v13, v13, v11
v_accvgpr_write_b32 a75, v13
v_accvgpr_read_b32 v13, a80
v_mul_f32 v13, v13, v11
v_accvgpr_write_b32 a80, v13
v_accvgpr_read_b32 v13, a81
v_mul_f32 v13, v13, v11
v_accvgpr_write_b32 a81, v13
v_accvgpr_read_b32 v13, a82
v_mul_f32 v13, v13, v11
v_accvgpr_write_b32 a82, v13
v_accvgpr_read_b32 v13, a83
v_mul_f32 v13, v13, v11
v_accvgpr_write_b32 a83, v13
v_accvgpr_read_b32 v13, a88
v_mul_f32 v13, v13, v11
v_accvgpr_write_b32 a88, v13
v_accvgpr_read_b32 v13, a89
v_mul_f32 v13, v13, v11
v_accvgpr_write_b32 a89, v13
v_accvgpr_read_b32 v13, a90
v_mul_f32 v13, v13, v11
v_accvgpr_write_b32 a90, v13
v_accvgpr_read_b32 v13, a91
v_mul_f32 v13, v13, v11
v_accvgpr_write_b32 a91, v13
v_accvgpr_read_b32 v13, a96
v_mul_f32 v13, v13, v11
v_accvgpr_write_b32 a96, v13
v_accvgpr_read_b32 v13, a97
v_mul_f32 v13, v13, v11
v_accvgpr_write_b32 a97, v13
v_accvgpr_read_b32 v13, a98
v_mul_f32 v13, v13, v11
v_accvgpr_write_b32 a98, v13
v_accvgpr_read_b32 v13, a99
v_mul_f32 v13, v13, v11
v_accvgpr_write_b32 a99, v13
v_accvgpr_read_b32 v13, a104
v_mul_f32 v13, v13, v11
v_accvgpr_write_b32 a104, v13
v_accvgpr_read_b32 v13, a105
v_mul_f32 v13, v13, v11
v_accvgpr_write_b32 a105, v13
v_accvgpr_read_b32 v13, a106
v_mul_f32 v13, v13, v11
v_accvgpr_write_b32 a106, v13
v_accvgpr_read_b32 v13, a107
v_mul_f32 v13, v13, v11
v_accvgpr_write_b32 a107, v13
v_accvgpr_read_b32 v13, a112
v_mul_f32 v13, v13, v11
v_accvgpr_write_b32 a112, v13
v_accvgpr_read_b32 v13, a113
v_mul_f32 v13, v13, v11
v_accvgpr_write_b32 a113, v13
v_accvgpr_read_b32 v13, a114
v_mul_f32 v13, v13, v11
v_accvgpr_write_b32 a114, v13
v_accvgpr_read_b32 v13, a115
v_mul_f32 v13, v13, v11
v_accvgpr_write_b32 a115, v13
v_accvgpr_read_b32 v13, a120
v_mul_f32 v13, v13, v11
v_accvgpr_write_b32 a120, v13
v_accvgpr_read_b32 v13, a121
v_mul_f32 v13, v13, v11
v_accvgpr_write_b32 a121, v13
v_accvgpr_read_b32 v13, a122
v_mul_f32 v13, v13, v11
v_accvgpr_write_b32 a122, v13
v_accvgpr_read_b32 v13, a123
v_mul_f32 v13, v13, v11
v_accvgpr_write_b32 a123, v13
v_mul_f32 v29, v29, v12
v_sub_f32 v36, v36, v10
v_sub_f32 v37, v37, v10
v_sub_f32 v38, v38, v10
v_sub_f32 v39, v39, v10
v_sub_f32 v76, v76, v10
v_sub_f32 v92, v92, v10
v_sub_f32 v77, v77, v10
v_sub_f32 v93, v93, v10
v_sub_f32 v78, v78, v10
v_sub_f32 v94, v94, v10
v_sub_f32 v79, v79, v10
v_sub_f32 v95, v95, v10
v_sub_f32 v84, v84, v10
v_sub_f32 v100, v100, v10
v_sub_f32 v85, v85, v10
v_sub_f32 v101, v101, v10
v_sub_f32 v86, v86, v10
v_sub_f32 v102, v102, v10
v_sub_f32 v87, v87, v10
v_sub_f32 v103, v103, v10
v_accvgpr_read_b32 v13, a4
v_mul_f32 v13, v13, v12
v_accvgpr_write_b32 a4, v13
v_accvgpr_read_b32 v13, a5
v_mul_f32 v13, v13, v12
v_accvgpr_write_b32 a5, v13
v_accvgpr_read_b32 v13, a6
v_mul_f32 v13, v13, v12
v_accvgpr_write_b32 a6, v13
v_accvgpr_read_b32 v13, a7
v_mul_f32 v13, v13, v12
v_accvgpr_write_b32 a7, v13
v_accvgpr_read_b32 v13, a12
v_mul_f32 v13, v13, v12
v_accvgpr_write_b32 a12, v13
v_accvgpr_read_b32 v13, a13
v_mul_f32 v13, v13, v12
v_accvgpr_write_b32 a13, v13
v_accvgpr_read_b32 v13, a14
v_mul_f32 v13, v13, v12
v_accvgpr_write_b32 a14, v13
v_accvgpr_read_b32 v13, a15
v_mul_f32 v13, v13, v12
v_accvgpr_write_b32 a15, v13
v_accvgpr_read_b32 v13, a20
v_mul_f32 v13, v13, v12
v_accvgpr_write_b32 a20, v13
v_accvgpr_read_b32 v13, a21
v_mul_f32 v13, v13, v12
v_accvgpr_write_b32 a21, v13
v_accvgpr_read_b32 v13, a22
v_mul_f32 v13, v13, v12
v_accvgpr_write_b32 a22, v13
v_accvgpr_read_b32 v13, a23
v_mul_f32 v13, v13, v12
v_accvgpr_write_b32 a23, v13
v_accvgpr_read_b32 v13, a28
v_mul_f32 v13, v13, v12
v_accvgpr_write_b32 a28, v13
v_accvgpr_read_b32 v13, a29
v_mul_f32 v13, v13, v12
v_accvgpr_write_b32 a29, v13
v_accvgpr_read_b32 v13, a30
v_mul_f32 v13, v13, v12
v_accvgpr_write_b32 a30, v13
v_accvgpr_read_b32 v13, a31
v_mul_f32 v13, v13, v12
v_accvgpr_write_b32 a31, v13
v_accvgpr_read_b32 v13, a36
v_mul_f32 v13, v13, v12
v_accvgpr_write_b32 a36, v13
v_accvgpr_read_b32 v13, a37
v_mul_f32 v13, v13, v12
v_accvgpr_write_b32 a37, v13
v_accvgpr_read_b32 v13, a38
v_mul_f32 v13, v13, v12
v_accvgpr_write_b32 a38, v13
v_accvgpr_read_b32 v13, a39
v_mul_f32 v13, v13, v12
v_accvgpr_write_b32 a39, v13
v_accvgpr_read_b32 v13, a44
v_mul_f32 v13, v13, v12
v_accvgpr_write_b32 a44, v13
v_accvgpr_read_b32 v13, a45
v_mul_f32 v13, v13, v12
v_accvgpr_write_b32 a45, v13
v_accvgpr_read_b32 v13, a46
v_mul_f32 v13, v13, v12
v_accvgpr_write_b32 a46, v13
v_accvgpr_read_b32 v13, a47
v_mul_f32 v13, v13, v12
v_accvgpr_write_b32 a47, v13
v_accvgpr_read_b32 v13, a52
v_mul_f32 v13, v13, v12
v_accvgpr_write_b32 a52, v13
v_accvgpr_read_b32 v13, a53
v_mul_f32 v13, v13, v12
v_accvgpr_write_b32 a53, v13
v_accvgpr_read_b32 v13, a54
v_mul_f32 v13, v13, v12
v_accvgpr_write_b32 a54, v13
v_accvgpr_read_b32 v13, a55
v_mul_f32 v13, v13, v12
v_accvgpr_write_b32 a55, v13
v_accvgpr_read_b32 v13, a60
v_mul_f32 v13, v13, v12
v_accvgpr_write_b32 a60, v13
v_accvgpr_read_b32 v13, a61
v_mul_f32 v13, v13, v12
v_accvgpr_write_b32 a61, v13
v_accvgpr_read_b32 v13, a62
v_mul_f32 v13, v13, v12
v_accvgpr_write_b32 a62, v13
v_accvgpr_read_b32 v13, a63
v_mul_f32 v13, v13, v12
v_accvgpr_write_b32 a63, v13
v_accvgpr_read_b32 v13, a68
v_mul_f32 v13, v13, v12
v_accvgpr_write_b32 a68, v13
v_accvgpr_read_b32 v13, a69
v_mul_f32 v13, v13, v12
v_accvgpr_write_b32 a69, v13
v_accvgpr_read_b32 v13, a70
v_mul_f32 v13, v13, v12
v_accvgpr_write_b32 a70, v13
v_accvgpr_read_b32 v13, a71
v_mul_f32 v13, v13, v12
v_accvgpr_write_b32 a71, v13
v_accvgpr_read_b32 v13, a76
v_mul_f32 v13, v13, v12
v_accvgpr_write_b32 a76, v13
v_accvgpr_read_b32 v13, a77
v_mul_f32 v13, v13, v12
v_accvgpr_write_b32 a77, v13
v_accvgpr_read_b32 v13, a78
v_mul_f32 v13, v13, v12
v_accvgpr_write_b32 a78, v13
v_accvgpr_read_b32 v13, a79
v_mul_f32 v13, v13, v12
v_accvgpr_write_b32 a79, v13
v_accvgpr_read_b32 v13, a84
v_mul_f32 v13, v13, v12
v_accvgpr_write_b32 a84, v13
v_accvgpr_read_b32 v13, a85
v_mul_f32 v13, v13, v12
v_accvgpr_write_b32 a85, v13
v_accvgpr_read_b32 v13, a86
v_mul_f32 v13, v13, v12
v_accvgpr_write_b32 a86, v13
v_accvgpr_read_b32 v13, a87
v_mul_f32 v13, v13, v12
v_accvgpr_write_b32 a87, v13
v_accvgpr_read_b32 v13, a92
v_mul_f32 v13, v13, v12
v_accvgpr_write_b32 a92, v13
v_accvgpr_read_b32 v13, a93
v_mul_f32 v13, v13, v12
v_accvgpr_write_b32 a93, v13
v_accvgpr_read_b32 v13, a94
v_mul_f32 v13, v13, v12
v_accvgpr_write_b32 a94, v13
v_accvgpr_read_b32 v13, a95
v_mul_f32 v13, v13, v12
v_accvgpr_write_b32 a95, v13
v_accvgpr_read_b32 v13, a100
v_mul_f32 v13, v13, v12
v_accvgpr_write_b32 a100, v13
v_accvgpr_read_b32 v13, a101
v_mul_f32 v13, v13, v12
v_accvgpr_write_b32 a101, v13
v_accvgpr_read_b32 v13, a102
v_mul_f32 v13, v13, v12
v_accvgpr_write_b32 a102, v13
v_accvgpr_read_b32 v13, a103
v_mul_f32 v13, v13, v12
v_accvgpr_write_b32 a103, v13
v_accvgpr_read_b32 v13, a108
v_mul_f32 v13, v13, v12
v_accvgpr_write_b32 a108, v13
v_accvgpr_read_b32 v13, a109
v_mul_f32 v13, v13, v12
v_accvgpr_write_b32 a109, v13
v_accvgpr_read_b32 v13, a110
v_mul_f32 v13, v13, v12
v_accvgpr_write_b32 a110, v13
v_accvgpr_read_b32 v13, a111
v_mul_f32 v13, v13, v12
v_accvgpr_write_b32 a111, v13
v_accvgpr_read_b32 v13, a116
v_mul_f32 v13, v13, v12
v_accvgpr_write_b32 a116, v13
v_accvgpr_read_b32 v13, a117
v_mul_f32 v13, v13, v12
v_accvgpr_write_b32 a117, v13
v_accvgpr_read_b32 v13, a118
v_mul_f32 v13, v13, v12
v_accvgpr_write_b32 a118, v13
v_accvgpr_read_b32 v13, a119
v_mul_f32 v13, v13, v12
v_accvgpr_write_b32 a119, v13
v_accvgpr_read_b32 v13, a124
v_mul_f32 v13, v13, v12
v_accvgpr_write_b32 a124, v13
v_accvgpr_read_b32 v13, a125
v_mul_f32 v13, v13, v12
v_accvgpr_write_b32 a125, v13
v_accvgpr_read_b32 v13, a126
v_mul_f32 v13, v13, v12
v_accvgpr_write_b32 a126, v13
v_accvgpr_read_b32 v13, a127
v_mul_f32 v13, v13, v12
v_accvgpr_write_b32 a127, v13
v_exp_f32 v104, v72
v_exp_f32 v105, v73
v_exp_f32 v106, v74
v_exp_f32 v107, v75
v_exp_f32 v112, v80
v_exp_f32 v113, v81
v_exp_f32 v114, v82
v_exp_f32 v115, v83
v_exp_f32 v108, v76
v_exp_f32 v109, v77
v_exp_f32 v110, v78
v_exp_f32 v111, v79
v_exp_f32 v116, v84
v_exp_f32 v117, v85
v_exp_f32 v118, v86
v_exp_f32 v119, v87
s_nop 0
v_cvt_pk_bf16_f32 v120, v104, v105
v_add_f32 v200, v104, v105
v_cvt_pk_bf16_f32 v121, v106, v107
v_add_f32 v201, v106, v107
v_add_f32 v200, v200, v201
v_cvt_pk_bf16_f32 v122, v112, v113
v_add_f32 v201, v112, v113
v_cvt_pk_bf16_f32 v123, v114, v115
v_add_f32 v200, v200, v201
v_add_f32 v201, v114, v115
v_add_f32 v30, v200, v201
v_cvt_pk_bf16_f32 v124, v108, v109
v_add_f32 v202, v108, v109
v_cvt_pk_bf16_f32 v125, v110, v111
v_add_f32 v203, v110, v111
v_add_f32 v202, v202, v203
v_cvt_pk_bf16_f32 v126, v116, v117
v_add_f32 v203, v116, v117
v_cvt_pk_bf16_f32 v127, v118, v119
v_add_f32 v202, v202, v203
v_add_f32 v203, v118, v119
v_add_f32 v31, v202, v203
s_nop 1
s_branch K2A_BACK2
K2A_SLOW3:
s_nop 7
s_nop 7
v_max3_f32 v9, v88, v89, v90
v_max3_f32 v9, v9, v91, v96
v_max3_f32 v9, v9, v97, v98
v_max_f32 v9, v9, v99
v_max3_f32 v10, v92, v93, v94
v_max3_f32 v10, v10, v95, v100
v_max3_f32 v10, v10, v101, v102
v_max_f32 v10, v10, v103
ds_bpermute_b32 v11, v4, v9
ds_bpermute_b32 v12, v4, v10
s_waitcnt lgkmcnt(0)
v_max_f32 v9, v9, v11
v_max_f32 v10, v10, v12
ds_bpermute_b32 v11, v5, v9
ds_bpermute_b32 v12, v5, v10
s_waitcnt lgkmcnt(0)
v_max_f32 v9, v9, v11
v_max_f32 v10, v10, v12
v_max_f32 v9, 0, v9
v_sub_f32 v11, 0, v9
v_exp_f32 v11, v11
v_max_f32 v10, 0, v10
v_sub_f32 v12, 0, v10
v_exp_f32 v12, v12
s_nop 0
v_mul_f32 v28, v28, v11
v_sub_f32 v32, v32, v9
v_sub_f32 v33, v33, v9
v_sub_f32 v34, v34, v9
v_sub_f32 v35, v35, v9
v_sub_f32 v88, v88, v9
v_sub_f32 v72, v72, v9
v_sub_f32 v89, v89, v9
v_sub_f32 v73, v73, v9
v_sub_f32 v90, v90, v9
v_sub_f32 v74, v74, v9
v_sub_f32 v91, v91, v9
v_sub_f32 v75, v75, v9
v_sub_f32 v96, v96, v9
v_sub_f32 v80, v80, v9
v_sub_f32 v97, v97, v9
v_sub_f32 v81, v81, v9
v_sub_f32 v98, v98, v9
v_sub_f32 v82, v82, v9
v_sub_f32 v99, v99, v9
v_sub_f32 v83, v83, v9
v_accvgpr_read_b32 v13, a0
v_mul_f32 v13, v13, v11
v_accvgpr_write_b32 a0, v13
v_accvgpr_read_b32 v13, a1
v_mul_f32 v13, v13, v11
v_accvgpr_write_b32 a1, v13
v_accvgpr_read_b32 v13, a2
v_mul_f32 v13, v13, v11
v_accvgpr_write_b32 a2, v13
v_accvgpr_read_b32 v13, a3
v_mul_f32 v13, v13, v11
v_accvgpr_write_b32 a3, v13
v_accvgpr_read_b32 v13, a8
v_mul_f32 v13, v13, v11
v_accvgpr_write_b32 a8, v13
v_accvgpr_read_b32 v13, a9
v_mul_f32 v13, v13, v11
v_accvgpr_write_b32 a9, v13
v_accvgpr_read_b32 v13, a10
v_mul_f32 v13, v13, v11
v_accvgpr_write_b32 a10, v13
v_accvgpr_read_b32 v13, a11
v_mul_f32 v13, v13, v11
v_accvgpr_write_b32 a11, v13
v_accvgpr_read_b32 v13, a16
v_mul_f32 v13, v13, v11
v_accvgpr_write_b32 a16, v13
v_accvgpr_read_b32 v13, a17
v_mul_f32 v13, v13, v11
v_accvgpr_write_b32 a17, v13
v_accvgpr_read_b32 v13, a18
v_mul_f32 v13, v13, v11
v_accvgpr_write_b32 a18, v13
v_accvgpr_read_b32 v13, a19
v_mul_f32 v13, v13, v11
v_accvgpr_write_b32 a19, v13
v_accvgpr_read_b32 v13, a24
v_mul_f32 v13, v13, v11
v_accvgpr_write_b32 a24, v13
v_accvgpr_read_b32 v13, a25
v_mul_f32 v13, v13, v11
v_accvgpr_write_b32 a25, v13
v_accvgpr_read_b32 v13, a26
v_mul_f32 v13, v13, v11
v_accvgpr_write_b32 a26, v13
v_accvgpr_read_b32 v13, a27
v_mul_f32 v13, v13, v11
v_accvgpr_write_b32 a27, v13
v_accvgpr_read_b32 v13, a32
v_mul_f32 v13, v13, v11
v_accvgpr_write_b32 a32, v13
v_accvgpr_read_b32 v13, a33
v_mul_f32 v13, v13, v11
v_accvgpr_write_b32 a33, v13
v_accvgpr_read_b32 v13, a34
v_mul_f32 v13, v13, v11
v_accvgpr_write_b32 a34, v13
v_accvgpr_read_b32 v13, a35
v_mul_f32 v13, v13, v11
v_accvgpr_write_b32 a35, v13
v_accvgpr_read_b32 v13, a40
v_mul_f32 v13, v13, v11
v_accvgpr_write_b32 a40, v13
v_accvgpr_read_b32 v13, a41
v_mul_f32 v13, v13, v11
v_accvgpr_write_b32 a41, v13
v_accvgpr_read_b32 v13, a42
v_mul_f32 v13, v13, v11
v_accvgpr_write_b32 a42, v13
v_accvgpr_read_b32 v13, a43
v_mul_f32 v13, v13, v11
v_accvgpr_write_b32 a43, v13
v_accvgpr_read_b32 v13, a48
v_mul_f32 v13, v13, v11
v_accvgpr_write_b32 a48, v13
v_accvgpr_read_b32 v13, a49
v_mul_f32 v13, v13, v11
v_accvgpr_write_b32 a49, v13
v_accvgpr_read_b32 v13, a50
v_mul_f32 v13, v13, v11
v_accvgpr_write_b32 a50, v13
v_accvgpr_read_b32 v13, a51
v_mul_f32 v13, v13, v11
v_accvgpr_write_b32 a51, v13
v_accvgpr_read_b32 v13, a56
v_mul_f32 v13, v13, v11
v_accvgpr_write_b32 a56, v13
v_accvgpr_read_b32 v13, a57
v_mul_f32 v13, v13, v11
v_accvgpr_write_b32 a57, v13
v_accvgpr_read_b32 v13, a58
v_mul_f32 v13, v13, v11
v_accvgpr_write_b32 a58, v13
v_accvgpr_read_b32 v13, a59
v_mul_f32 v13, v13, v11
v_accvgpr_write_b32 a59, v13
v_accvgpr_read_b32 v13, a64
v_mul_f32 v13, v13, v11
v_accvgpr_write_b32 a64, v13
v_accvgpr_read_b32 v13, a65
v_mul_f32 v13, v13, v11
v_accvgpr_write_b32 a65, v13
v_accvgpr_read_b32 v13, a66
v_mul_f32 v13, v13, v11
v_accvgpr_write_b32 a66, v13
v_accvgpr_read_b32 v13, a67
v_mul_f32 v13, v13, v11
v_accvgpr_write_b32 a67, v13
v_accvgpr_read_b32 v13, a72
v_mul_f32 v13, v13, v11
v_accvgpr_write_b32 a72, v13
v_accvgpr_read_b32 v13, a73
v_mul_f32 v13, v13, v11
v_accvgpr_write_b32 a73, v13
v_accvgpr_read_b32 v13, a74
v_mul_f32 v13, v13, v11
v_accvgpr_write_b32 a74, v13
v_accvgpr_read_b32 v13, a75
v_mul_f32 v13, v13, v11
v_accvgpr_write_b32 a75, v13
v_accvgpr_read_b32 v13, a80
v_mul_f32 v13, v13, v11
v_accvgpr_write_b32 a80, v13
v_accvgpr_read_b32 v13, a81
v_mul_f32 v13, v13, v11
v_accvgpr_write_b32 a81, v13
v_accvgpr_read_b32 v13, a82
v_mul_f32 v13, v13, v11
v_accvgpr_write_b32 a82, v13
v_accvgpr_read_b32 v13, a83
v_mul_f32 v13, v13, v11
v_accvgpr_write_b32 a83, v13
v_accvgpr_read_b32 v13, a88
v_mul_f32 v13, v13, v11
v_accvgpr_write_b32 a88, v13
v_accvgpr_read_b32 v13, a89
v_mul_f32 v13, v13, v11
v_accvgpr_write_b32 a89, v13
v_accvgpr_read_b32 v13, a90
v_mul_f32 v13, v13, v11
v_accvgpr_write_b32 a90, v13
v_accvgpr_read_b32 v13, a91
v_mul_f32 v13, v13, v11
v_accvgpr_write_b32 a91, v13
v_accvgpr_read_b32 v13, a96
v_mul_f32 v13, v13, v11
v_accvgpr_write_b32 a96, v13
v_accvgpr_read_b32 v13, a97
v_mul_f32 v13, v13, v11
v_accvgpr_write_b32 a97, v13
v_accvgpr_read_b32 v13, a98
v_mul_f32 v13, v13, v11
v_accvgpr_write_b32 a98, v13
v_accvgpr_read_b32 v13, a99
v_mul_f32 v13, v13, v11
v_accvgpr_write_b32 a99, v13
v_accvgpr_read_b32 v13, a104
v_mul_f32 v13, v13, v11
v_accvgpr_write_b32 a104, v13
v_accvgpr_read_b32 v13, a105
v_mul_f32 v13, v13, v11
v_accvgpr_write_b32 a105, v13
v_accvgpr_read_b32 v13, a106
v_mul_f32 v13, v13, v11
v_accvgpr_write_b32 a106, v13
v_accvgpr_read_b32 v13, a107
v_mul_f32 v13, v13, v11
v_accvgpr_write_b32 a107, v13
v_accvgpr_read_b32 v13, a112
v_mul_f32 v13, v13, v11
v_accvgpr_write_b32 a112, v13
v_accvgpr_read_b32 v13, a113
v_mul_f32 v13, v13, v11
v_accvgpr_write_b32 a113, v13
v_accvgpr_read_b32 v13, a114
v_mul_f32 v13, v13, v11
v_accvgpr_write_b32 a114, v13
v_accvgpr_read_b32 v13, a115
v_mul_f32 v13, v13, v11
v_accvgpr_write_b32 a115, v13
v_accvgpr_read_b32 v13, a120
v_mul_f32 v13, v13, v11
v_accvgpr_write_b32 a120, v13
v_accvgpr_read_b32 v13, a121
v_mul_f32 v13, v13, v11
v_accvgpr_write_b32 a121, v13
v_accvgpr_read_b32 v13, a122
v_mul_f32 v13, v13, v11
v_accvgpr_write_b32 a122, v13
v_accvgpr_read_b32 v13, a123
v_mul_f32 v13, v13, v11
v_accvgpr_write_b32 a123, v13
v_mul_f32 v29, v29, v12
v_sub_f32 v36, v36, v10
v_sub_f32 v37, v37, v10
v_sub_f32 v38, v38, v10
v_sub_f32 v39, v39, v10
v_sub_f32 v92, v92, v10
v_sub_f32 v76, v76, v10
v_sub_f32 v93, v93, v10
v_sub_f32 v77, v77, v10
v_sub_f32 v94, v94, v10
v_sub_f32 v78, v78, v10
v_sub_f32 v95, v95, v10
v_sub_f32 v79, v79, v10
v_sub_f32 v100, v100, v10
v_sub_f32 v84, v84, v10
v_sub_f32 v101, v101, v10
v_sub_f32 v85, v85, v10
v_sub_f32 v102, v102, v10
v_sub_f32 v86, v86, v10
v_sub_f32 v103, v103, v10
v_sub_f32 v87, v87, v10
v_accvgpr_read_b32 v13, a4
v_mul_f32 v13, v13, v12
v_accvgpr_write_b32 a4, v13
v_accvgpr_read_b32 v13, a5
v_mul_f32 v13, v13, v12
v_accvgpr_write_b32 a5, v13
v_accvgpr_read_b32 v13, a6
v_mul_f32 v13, v13, v12
v_accvgpr_write_b32 a6, v13
v_accvgpr_read_b32 v13, a7
v_mul_f32 v13, v13, v12
v_accvgpr_write_b32 a7, v13
v_accvgpr_read_b32 v13, a12
v_mul_f32 v13, v13, v12
v_accvgpr_write_b32 a12, v13
v_accvgpr_read_b32 v13, a13
v_mul_f32 v13, v13, v12
v_accvgpr_write_b32 a13, v13
v_accvgpr_read_b32 v13, a14
v_mul_f32 v13, v13, v12
v_accvgpr_write_b32 a14, v13
v_accvgpr_read_b32 v13, a15
v_mul_f32 v13, v13, v12
v_accvgpr_write_b32 a15, v13
v_accvgpr_read_b32 v13, a20
v_mul_f32 v13, v13, v12
v_accvgpr_write_b32 a20, v13
v_accvgpr_read_b32 v13, a21
v_mul_f32 v13, v13, v12
v_accvgpr_write_b32 a21, v13
v_accvgpr_read_b32 v13, a22
v_mul_f32 v13, v13, v12
v_accvgpr_write_b32 a22, v13
v_accvgpr_read_b32 v13, a23
v_mul_f32 v13, v13, v12
v_accvgpr_write_b32 a23, v13
v_accvgpr_read_b32 v13, a28
v_mul_f32 v13, v13, v12
v_accvgpr_write_b32 a28, v13
v_accvgpr_read_b32 v13, a29
v_mul_f32 v13, v13, v12
v_accvgpr_write_b32 a29, v13
v_accvgpr_read_b32 v13, a30
v_mul_f32 v13, v13, v12
v_accvgpr_write_b32 a30, v13
v_accvgpr_read_b32 v13, a31
v_mul_f32 v13, v13, v12
v_accvgpr_write_b32 a31, v13
v_accvgpr_read_b32 v13, a36
v_mul_f32 v13, v13, v12
v_accvgpr_write_b32 a36, v13
v_accvgpr_read_b32 v13, a37
v_mul_f32 v13, v13, v12
v_accvgpr_write_b32 a37, v13
v_accvgpr_read_b32 v13, a38
v_mul_f32 v13, v13, v12
v_accvgpr_write_b32 a38, v13
v_accvgpr_read_b32 v13, a39
v_mul_f32 v13, v13, v12
v_accvgpr_write_b32 a39, v13
v_accvgpr_read_b32 v13, a44
v_mul_f32 v13, v13, v12
v_accvgpr_write_b32 a44, v13
v_accvgpr_read_b32 v13, a45
v_mul_f32 v13, v13, v12
v_accvgpr_write_b32 a45, v13
v_accvgpr_read_b32 v13, a46
v_mul_f32 v13, v13, v12
v_accvgpr_write_b32 a46, v13
v_accvgpr_read_b32 v13, a47
v_mul_f32 v13, v13, v12
v_accvgpr_write_b32 a47, v13
v_accvgpr_read_b32 v13, a52
v_mul_f32 v13, v13, v12
v_accvgpr_write_b32 a52, v13
v_accvgpr_read_b32 v13, a53
v_mul_f32 v13, v13, v12
v_accvgpr_write_b32 a53, v13
v_accvgpr_read_b32 v13, a54
v_mul_f32 v13, v13, v12
v_accvgpr_write_b32 a54, v13
v_accvgpr_read_b32 v13, a55
v_mul_f32 v13, v13, v12
v_accvgpr_write_b32 a55, v13
v_accvgpr_read_b32 v13, a60
v_mul_f32 v13, v13, v12
v_accvgpr_write_b32 a60, v13
v_accvgpr_read_b32 v13, a61
v_mul_f32 v13, v13, v12
v_accvgpr_write_b32 a61, v13
v_accvgpr_read_b32 v13, a62
v_mul_f32 v13, v13, v12
v_accvgpr_write_b32 a62, v13
v_accvgpr_read_b32 v13, a63
v_mul_f32 v13, v13, v12
v_accvgpr_write_b32 a63, v13
v_accvgpr_read_b32 v13, a68
v_mul_f32 v13, v13, v12
v_accvgpr_write_b32 a68, v13
v_accvgpr_read_b32 v13, a69
v_mul_f32 v13, v13, v12
v_accvgpr_write_b32 a69, v13
v_accvgpr_read_b32 v13, a70
v_mul_f32 v13, v13, v12
v_accvgpr_write_b32 a70, v13
v_accvgpr_read_b32 v13, a71
v_mul_f32 v13, v13, v12
v_accvgpr_write_b32 a71, v13
v_accvgpr_read_b32 v13, a76
v_mul_f32 v13, v13, v12
v_accvgpr_write_b32 a76, v13
v_accvgpr_read_b32 v13, a77
v_mul_f32 v13, v13, v12
v_accvgpr_write_b32 a77, v13
v_accvgpr_read_b32 v13, a78
v_mul_f32 v13, v13, v12
v_accvgpr_write_b32 a78, v13
v_accvgpr_read_b32 v13, a79
v_mul_f32 v13, v13, v12
v_accvgpr_write_b32 a79, v13
v_accvgpr_read_b32 v13, a84
v_mul_f32 v13, v13, v12
v_accvgpr_write_b32 a84, v13
v_accvgpr_read_b32 v13, a85
v_mul_f32 v13, v13, v12
v_accvgpr_write_b32 a85, v13
v_accvgpr_read_b32 v13, a86
v_mul_f32 v13, v13, v12
v_accvgpr_write_b32 a86, v13
v_accvgpr_read_b32 v13, a87
v_mul_f32 v13, v13, v12
v_accvgpr_write_b32 a87, v13
v_accvgpr_read_b32 v13, a92
v_mul_f32 v13, v13, v12
v_accvgpr_write_b32 a92, v13
v_accvgpr_read_b32 v13, a93
v_mul_f32 v13, v13, v12
v_accvgpr_write_b32 a93, v13
v_accvgpr_read_b32 v13, a94
v_mul_f32 v13, v13, v12
v_accvgpr_write_b32 a94, v13
v_accvgpr_read_b32 v13, a95
v_mul_f32 v13, v13, v12
v_accvgpr_write_b32 a95, v13
v_accvgpr_read_b32 v13, a100
v_mul_f32 v13, v13, v12
v_accvgpr_write_b32 a100, v13
v_accvgpr_read_b32 v13, a101
v_mul_f32 v13, v13, v12
v_accvgpr_write_b32 a101, v13
v_accvgpr_read_b32 v13, a102
v_mul_f32 v13, v13, v12
v_accvgpr_write_b32 a102, v13
v_accvgpr_read_b32 v13, a103
v_mul_f32 v13, v13, v12
v_accvgpr_write_b32 a103, v13
v_accvgpr_read_b32 v13, a108
v_mul_f32 v13, v13, v12
v_accvgpr_write_b32 a108, v13
v_accvgpr_read_b32 v13, a109
v_mul_f32 v13, v13, v12
v_accvgpr_write_b32 a109, v13
v_accvgpr_read_b32 v13, a110
v_mul_f32 v13, v13, v12
v_accvgpr_write_b32 a110, v13
v_accvgpr_read_b32 v13, a111
v_mul_f32 v13, v13, v12
v_accvgpr_write_b32 a111, v13
v_accvgpr_read_b32 v13, a116
v_mul_f32 v13, v13, v12
v_accvgpr_write_b32 a116, v13
v_accvgpr_read_b32 v13, a117
v_mul_f32 v13, v13, v12
v_accvgpr_write_b32 a117, v13
v_accvgpr_read_b32 v13, a118
v_mul_f32 v13, v13, v12
v_accvgpr_write_b32 a118, v13
v_accvgpr_read_b32 v13, a119
v_mul_f32 v13, v13, v12
v_accvgpr_write_b32 a119, v13
v_accvgpr_read_b32 v13, a124
v_mul_f32 v13, v13, v12
v_accvgpr_write_b32 a124, v13
v_accvgpr_read_b32 v13, a125
v_mul_f32 v13, v13, v12
v_accvgpr_write_b32 a125, v13
v_accvgpr_read_b32 v13, a126
v_mul_f32 v13, v13, v12
v_accvgpr_write_b32 a126, v13
v_accvgpr_read_b32 v13, a127
v_mul_f32 v13, v13, v12
v_accvgpr_write_b32 a127, v13
v_exp_f32 v104, v88
v_exp_f32 v105, v89
v_exp_f32 v106, v90
v_exp_f32 v107, v91
v_exp_f32 v112, v96
v_exp_f32 v113, v97
v_exp_f32 v114, v98
v_exp_f32 v115, v99
v_exp_f32 v108, v92
v_exp_f32 v109, v93
v_exp_f32 v110, v94
v_exp_f32 v111, v95
v_exp_f32 v116, v100
v_exp_f32 v117, v101
v_exp_f32 v118, v102
v_exp_f32 v119, v103
s_nop 0
v_cvt_pk_bf16_f32 v128, v104, v105
v_add_f32 v200, v104, v105
v_cvt_pk_bf16_f32 v129, v106, v107
v_add_f32 v201, v106, v107
v_add_f32 v200, v200, v201
v_cvt_pk_bf16_f32 v130, v112, v113
v_add_f32 v201, v112, v113
v_cvt_pk_bf16_f32 v131, v114, v115
v_add_f32 v200, v200, v201
v_add_f32 v201, v114, v115
v_add_f32 v30, v200, v201
v_cvt_pk_bf16_f32 v132, v108, v109
v_add_f32 v202, v108, v109
v_cvt_pk_bf16_f32 v133, v110, v111
v_add_f32 v203, v110, v111
v_add_f32 v202, v202, v203
v_cvt_pk_bf16_f32 v134, v116, v117
v_add_f32 v203, v116, v117
v_cvt_pk_bf16_f32 v135, v118, v119
v_add_f32 v202, v202, v203
v_add_f32 v203, v118, v119
v_add_f32 v31, v202, v203
s_nop 1
s_branch K2A_BACK3
K2A_SLOWL0:
s_nop 7
s_nop 7
v_max3_f32 v9, v72, v73, v74
v_max3_f32 v9, v9, v75, v80
v_max3_f32 v9, v9, v81, v82
v_max_f32 v9, v9, v83
v_max3_f32 v10, v76, v77, v78
v_max3_f32 v10, v10, v79, v84
v_max3_f32 v10, v10, v85, v86
v_max_f32 v10, v10, v87
ds_bpermute_b32 v11, v4, v9
ds_bpermute_b32 v12, v4, v10
s_waitcnt lgkmcnt(0)
v_max_f32 v9, v9, v11
v_max_f32 v10, v10, v12
ds_bpermute_b32 v11, v5, v9
ds_bpermute_b32 v12, v5, v10
s_waitcnt lgkmcnt(0)
v_max_f32 v9, v9, v11
v_max_f32 v10, v10, v12
v_max_f32 v9, 0, v9
v_sub_f32 v11, 0, v9
v_exp_f32 v11, v11
v_max_f32 v10, 0, v10
v_sub_f32 v12, 0, v10
v_exp_f32 v12, v12
s_nop 0
v_mul_f32 v28, v28, v11
v_sub_f32 v32, v32, v9
v_sub_f32 v33, v33, v9
v_sub_f32 v34, v34, v9
v_sub_f32 v35, v35, v9
v_sub_f32 v72, v72, v9
v_sub_f32 v73, v73, v9
v_sub_f32 v74, v74, v9
v_sub_f32 v75, v75, v9
v_sub_f32 v80, v80, v9
v_sub_f32 v81, v81, v9
v_sub_f32 v82, v82, v9
v_sub_f32 v83, v83, v9
v_accvgpr_read_b32 v13, a0
v_mul_f32 v13, v13, v11
v_accvgpr_write_b32 a0, v13
v_accvgpr_read_b32 v13, a1
v_mul_f32 v13, v13, v11
v_accvgpr_write_b32 a1, v13
v_accvgpr_read_b32 v13, a2
v_mul_f32 v13, v13, v11
v_accvgpr_write_b32 a2, v13
v_accvgpr_read_b32 v13, a3
v_mul_f32 v13, v13, v11
v_accvgpr_write_b32 a3, v13
v_accvgpr_read_b32 v13, a8
v_mul_f32 v13, v13, v11
v_accvgpr_write_b32 a8, v13
v_accvgpr_read_b32 v13, a9
v_mul_f32 v13, v13, v11
v_accvgpr_write_b32 a9, v13
v_accvgpr_read_b32 v13, a10
v_mul_f32 v13, v13, v11
v_accvgpr_write_b32 a10, v13
v_accvgpr_read_b32 v13, a11
v_mul_f32 v13, v13, v11
v_accvgpr_write_b32 a11, v13
v_accvgpr_read_b32 v13, a16
v_mul_f32 v13, v13, v11
v_accvgpr_write_b32 a16, v13
v_accvgpr_read_b32 v13, a17
v_mul_f32 v13, v13, v11
v_accvgpr_write_b32 a17, v13
v_accvgpr_read_b32 v13, a18
v_mul_f32 v13, v13, v11
v_accvgpr_write_b32 a18, v13
v_accvgpr_read_b32 v13, a19
v_mul_f32 v13, v13, v11
v_accvgpr_write_b32 a19, v13
v_accvgpr_read_b32 v13, a24
v_mul_f32 v13, v13, v11
v_accvgpr_write_b32 a24, v13
v_accvgpr_read_b32 v13, a25
v_mul_f32 v13, v13, v11
v_accvgpr_write_b32 a25, v13
v_accvgpr_read_b32 v13, a26
v_mul_f32 v13, v13, v11
v_accvgpr_write_b32 a26, v13
v_accvgpr_read_b32 v13, a27
v_mul_f32 v13, v13, v11
v_accvgpr_write_b32 a27, v13
v_accvgpr_read_b32 v13, a32
v_mul_f32 v13, v13, v11
v_accvgpr_write_b32 a32, v13
v_accvgpr_read_b32 v13, a33
v_mul_f32 v13, v13, v11
v_accvgpr_write_b32 a33, v13
v_accvgpr_read_b32 v13, a34
v_mul_f32 v13, v13, v11
v_accvgpr_write_b32 a34, v13
v_accvgpr_read_b32 v13, a35
v_mul_f32 v13, v13, v11
v_accvgpr_write_b32 a35, v13
v_accvgpr_read_b32 v13, a40
v_mul_f32 v13, v13, v11
v_accvgpr_write_b32 a40, v13
v_accvgpr_read_b32 v13, a41
v_mul_f32 v13, v13, v11
v_accvgpr_write_b32 a41, v13
v_accvgpr_read_b32 v13, a42
v_mul_f32 v13, v13, v11
v_accvgpr_write_b32 a42, v13
v_accvgpr_read_b32 v13, a43
v_mul_f32 v13, v13, v11
v_accvgpr_write_b32 a43, v13
v_accvgpr_read_b32 v13, a48
v_mul_f32 v13, v13, v11
v_accvgpr_write_b32 a48, v13
v_accvgpr_read_b32 v13, a49
v_mul_f32 v13, v13, v11
v_accvgpr_write_b32 a49, v13
v_accvgpr_read_b32 v13, a50
v_mul_f32 v13, v13, v11
v_accvgpr_write_b32 a50, v13
v_accvgpr_read_b32 v13, a51
v_mul_f32 v13, v13, v11
v_accvgpr_write_b32 a51, v13
v_accvgpr_read_b32 v13, a56
v_mul_f32 v13, v13, v11
v_accvgpr_write_b32 a56, v13
v_accvgpr_read_b32 v13, a57
v_mul_f32 v13, v13, v11
v_accvgpr_write_b32 a57, v13
v_accvgpr_read_b32 v13, a58
v_mul_f32 v13, v13, v11
v_accvgpr_write_b32 a58, v13
v_accvgpr_read_b32 v13, a59
v_mul_f32 v13, v13, v11
v_accvgpr_write_b32 a59, v13
v_accvgpr_read_b32 v13, a64
v_mul_f32 v13, v13, v11
v_accvgpr_write_b32 a64, v13
v_accvgpr_read_b32 v13, a65
v_mul_f32 v13, v13, v11
v_accvgpr_write_b32 a65, v13
v_accvgpr_read_b32 v13, a66
v_mul_f32 v13, v13, v11
v_accvgpr_write_b32 a66, v13
v_accvgpr_read_b32 v13, a67
v_mul_f32 v13, v13, v11
v_accvgpr_write_b32 a67, v13
v_accvgpr_read_b32 v13, a72
v_mul_f32 v13, v13, v11
v_accvgpr_write_b32 a72, v13
v_accvgpr_read_b32 v13, a73
v_mul_f32 v13, v13, v11
v_accvgpr_write_b32 a73, v13
v_accvgpr_read_b32 v13, a74
v_mul_f32 v13, v13, v11
v_accvgpr_write_b32 a74, v13
v_accvgpr_read_b32 v13, a75
v_mul_f32 v13, v13, v11
v_accvgpr_write_b32 a75, v13
v_accvgpr_read_b32 v13, a80
v_mul_f32 v13, v13, v11
v_accvgpr_write_b32 a80, v13
v_accvgpr_read_b32 v13, a81
v_mul_f32 v13, v13, v11
v_accvgpr_write_b32 a81, v13
v_accvgpr_read_b32 v13, a82
v_mul_f32 v13, v13, v11
v_accvgpr_write_b32 a82, v13
v_accvgpr_read_b32 v13, a83
v_mul_f32 v13, v13, v11
v_accvgpr_write_b32 a83, v13
v_accvgpr_read_b32 v13, a88
v_mul_f32 v13, v13, v11
v_accvgpr_write_b32 a88, v13
v_accvgpr_read_b32 v13, a89
v_mul_f32 v13, v13, v11
v_accvgpr_write_b32 a89, v13
v_accvgpr_read_b32 v13, a90
v_mul_f32 v13, v13, v11
v_accvgpr_write_b32 a90, v13
v_accvgpr_read_b32 v13, a91
v_mul_f32 v13, v13, v11
v_accvgpr_write_b32 a91, v13
v_accvgpr_read_b32 v13, a96
v_mul_f32 v13, v13, v11
v_accvgpr_write_b32 a96, v13
v_accvgpr_read_b32 v13, a97
v_mul_f32 v13, v13, v11
v_accvgpr_write_b32 a97, v13
v_accvgpr_read_b32 v13, a98
v_mul_f32 v13, v13, v11
v_accvgpr_write_b32 a98, v13
v_accvgpr_read_b32 v13, a99
v_mul_f32 v13, v13, v11
v_accvgpr_write_b32 a99, v13
v_accvgpr_read_b32 v13, a104
v_mul_f32 v13, v13, v11
v_accvgpr_write_b32 a104, v13
v_accvgpr_read_b32 v13, a105
v_mul_f32 v13, v13, v11
v_accvgpr_write_b32 a105, v13
v_accvgpr_read_b32 v13, a106
v_mul_f32 v13, v13, v11
v_accvgpr_write_b32 a106, v13
v_accvgpr_read_b32 v13, a107
v_mul_f32 v13, v13, v11
v_accvgpr_write_b32 a107, v13
v_accvgpr_read_b32 v13, a112
v_mul_f32 v13, v13, v11
v_accvgpr_write_b32 a112, v13
v_accvgpr_read_b32 v13, a113
v_mul_f32 v13, v13, v11
v_accvgpr_write_b32 a113, v13
v_accvgpr_read_b32 v13, a114
v_mul_f32 v13, v13, v11
v_accvgpr_write_b32 a114, v13
v_accvgpr_read_b32 v13, a115
v_mul_f32 v13, v13, v11
v_accvgpr_write_b32 a115, v13
v_accvgpr_read_b32 v13, a120
v_mul_f32 v13, v13, v11
v_accvgpr_write_b32 a120, v13
v_accvgpr_read_b32 v13, a121
v_mul_f32 v13, v13, v11
v_accvgpr_write_b32 a121, v13
v_accvgpr_read_b32 v13, a122
v_mul_f32 v13, v13, v11
v_accvgpr_write_b32 a122, v13
v_accvgpr_read_b32 v13, a123
v_mul_f32 v13, v13, v11
v_accvgpr_write_b32 a123, v13
v_mul_f32 v29, v29, v12
v_sub_f32 v36, v36, v10
v_sub_f32 v37, v37, v10
v_sub_f32 v38, v38, v10
v_sub_f32 v39, v39, v10
v_sub_f32 v76, v76, v10
v_sub_f32 v77, v77, v10
v_sub_f32 v78, v78, v10
v_sub_f32 v79, v79, v10
v_sub_f32 v84, v84, v10
v_sub_f32 v85, v85, v10
v_sub_f32 v86, v86, v10
v_sub_f32 v87, v87, v10
v_accvgpr_read_b32 v13, a4
v_mul_f32 v13, v13, v12
v_accvgpr_write_b32 a4, v13
v_accvgpr_read_b32 v13, a5
v_mul_f32 v13, v13, v12
v_accvgpr_write_b32 a5, v13
v_accvgpr_read_b32 v13, a6
v_mul_f32 v13, v13, v12
v_accvgpr_write_b32 a6, v13
v_accvgpr_read_b32 v13, a7
v_mul_f32 v13, v13, v12
v_accvgpr_write_b32 a7, v13
v_accvgpr_read_b32 v13, a12
v_mul_f32 v13, v13, v12
v_accvgpr_write_b32 a12, v13
v_accvgpr_read_b32 v13, a13
v_mul_f32 v13, v13, v12
v_accvgpr_write_b32 a13, v13
v_accvgpr_read_b32 v13, a14
v_mul_f32 v13, v13, v12
v_accvgpr_write_b32 a14, v13
v_accvgpr_read_b32 v13, a15
v_mul_f32 v13, v13, v12
v_accvgpr_write_b32 a15, v13
v_accvgpr_read_b32 v13, a20
v_mul_f32 v13, v13, v12
v_accvgpr_write_b32 a20, v13
v_accvgpr_read_b32 v13, a21
v_mul_f32 v13, v13, v12
v_accvgpr_write_b32 a21, v13
v_accvgpr_read_b32 v13, a22
v_mul_f32 v13, v13, v12
v_accvgpr_write_b32 a22, v13
v_accvgpr_read_b32 v13, a23
v_mul_f32 v13, v13, v12
v_accvgpr_write_b32 a23, v13
v_accvgpr_read_b32 v13, a28
v_mul_f32 v13, v13, v12
v_accvgpr_write_b32 a28, v13
v_accvgpr_read_b32 v13, a29
v_mul_f32 v13, v13, v12
v_accvgpr_write_b32 a29, v13
v_accvgpr_read_b32 v13, a30
v_mul_f32 v13, v13, v12
v_accvgpr_write_b32 a30, v13
v_accvgpr_read_b32 v13, a31
v_mul_f32 v13, v13, v12
v_accvgpr_write_b32 a31, v13
v_accvgpr_read_b32 v13, a36
v_mul_f32 v13, v13, v12
v_accvgpr_write_b32 a36, v13
v_accvgpr_read_b32 v13, a37
v_mul_f32 v13, v13, v12
v_accvgpr_write_b32 a37, v13
v_accvgpr_read_b32 v13, a38
v_mul_f32 v13, v13, v12
v_accvgpr_write_b32 a38, v13
v_accvgpr_read_b32 v13, a39
v_mul_f32 v13, v13, v12
v_accvgpr_write_b32 a39, v13
v_accvgpr_read_b32 v13, a44
v_mul_f32 v13, v13, v12
v_accvgpr_write_b32 a44, v13
v_accvgpr_read_b32 v13, a45
v_mul_f32 v13, v13, v12
v_accvgpr_write_b32 a45, v13
v_accvgpr_read_b32 v13, a46
v_mul_f32 v13, v13, v12
v_accvgpr_write_b32 a46, v13
v_accvgpr_read_b32 v13, a47
v_mul_f32 v13, v13, v12
v_accvgpr_write_b32 a47, v13
v_accvgpr_read_b32 v13, a52
v_mul_f32 v13, v13, v12
v_accvgpr_write_b32 a52, v13
v_accvgpr_read_b32 v13, a53
v_mul_f32 v13, v13, v12
v_accvgpr_write_b32 a53, v13
v_accvgpr_read_b32 v13, a54
v_mul_f32 v13, v13, v12
v_accvgpr_write_b32 a54, v13
v_accvgpr_read_b32 v13, a55
v_mul_f32 v13, v13, v12
v_accvgpr_write_b32 a55, v13
v_accvgpr_read_b32 v13, a60
v_mul_f32 v13, v13, v12
v_accvgpr_write_b32 a60, v13
v_accvgpr_read_b32 v13, a61
v_mul_f32 v13, v13, v12
v_accvgpr_write_b32 a61, v13
v_accvgpr_read_b32 v13, a62
v_mul_f32 v13, v13, v12
v_accvgpr_write_b32 a62, v13
v_accvgpr_read_b32 v13, a63
v_mul_f32 v13, v13, v12
v_accvgpr_write_b32 a63, v13
v_accvgpr_read_b32 v13, a68
v_mul_f32 v13, v13, v12
v_accvgpr_write_b32 a68, v13
v_accvgpr_read_b32 v13, a69
v_mul_f32 v13, v13, v12
v_accvgpr_write_b32 a69, v13
v_accvgpr_read_b32 v13, a70
v_mul_f32 v13, v13, v12
v_accvgpr_write_b32 a70, v13
v_accvgpr_read_b32 v13, a71
v_mul_f32 v13, v13, v12
v_accvgpr_write_b32 a71, v13
v_accvgpr_read_b32 v13, a76
v_mul_f32 v13, v13, v12
v_accvgpr_write_b32 a76, v13
v_accvgpr_read_b32 v13, a77
v_mul_f32 v13, v13, v12
v_accvgpr_write_b32 a77, v13
v_accvgpr_read_b32 v13, a78
v_mul_f32 v13, v13, v12
v_accvgpr_write_b32 a78, v13
v_accvgpr_read_b32 v13, a79
v_mul_f32 v13, v13, v12
v_accvgpr_write_b32 a79, v13
v_accvgpr_read_b32 v13, a84
v_mul_f32 v13, v13, v12
v_accvgpr_write_b32 a84, v13
v_accvgpr_read_b32 v13, a85
v_mul_f32 v13, v13, v12
v_accvgpr_write_b32 a85, v13
v_accvgpr_read_b32 v13, a86
v_mul_f32 v13, v13, v12
v_accvgpr_write_b32 a86, v13
v_accvgpr_read_b32 v13, a87
v_mul_f32 v13, v13, v12
v_accvgpr_write_b32 a87, v13
v_accvgpr_read_b32 v13, a92
v_mul_f32 v13, v13, v12
v_accvgpr_write_b32 a92, v13
v_accvgpr_read_b32 v13, a93
v_mul_f32 v13, v13, v12
v_accvgpr_write_b32 a93, v13
v_accvgpr_read_b32 v13, a94
v_mul_f32 v13, v13, v12
v_accvgpr_write_b32 a94, v13
v_accvgpr_read_b32 v13, a95
v_mul_f32 v13, v13, v12
v_accvgpr_write_b32 a95, v13
v_accvgpr_read_b32 v13, a100
v_mul_f32 v13, v13, v12
v_accvgpr_write_b32 a100, v13
v_accvgpr_read_b32 v13, a101
v_mul_f32 v13, v13, v12
v_accvgpr_write_b32 a101, v13
v_accvgpr_read_b32 v13, a102
v_mul_f32 v13, v13, v12
v_accvgpr_write_b32 a102, v13
v_accvgpr_read_b32 v13, a103
v_mul_f32 v13, v13, v12
v_accvgpr_write_b32 a103, v13
v_accvgpr_read_b32 v13, a108
v_mul_f32 v13, v13, v12
v_accvgpr_write_b32 a108, v13
v_accvgpr_read_b32 v13, a109
v_mul_f32 v13, v13, v12
v_accvgpr_write_b32 a109, v13
v_accvgpr_read_b32 v13, a110
v_mul_f32 v13, v13, v12
v_accvgpr_write_b32 a110, v13
v_accvgpr_read_b32 v13, a111
v_mul_f32 v13, v13, v12
v_accvgpr_write_b32 a111, v13
v_accvgpr_read_b32 v13, a116
v_mul_f32 v13, v13, v12
v_accvgpr_write_b32 a116, v13
v_accvgpr_read_b32 v13, a117
v_mul_f32 v13, v13, v12
v_accvgpr_write_b32 a117, v13
v_accvgpr_read_b32 v13, a118
v_mul_f32 v13, v13, v12
v_accvgpr_write_b32 a118, v13
v_accvgpr_read_b32 v13, a119
v_mul_f32 v13, v13, v12
v_accvgpr_write_b32 a119, v13
v_accvgpr_read_b32 v13, a124
v_mul_f32 v13, v13, v12
v_accvgpr_write_b32 a124, v13
v_accvgpr_read_b32 v13, a125
v_mul_f32 v13, v13, v12
v_accvgpr_write_b32 a125, v13
v_accvgpr_read_b32 v13, a126
v_mul_f32 v13, v13, v12
v_accvgpr_write_b32 a126, v13
v_accvgpr_read_b32 v13, a127
v_mul_f32 v13, v13, v12
v_accvgpr_write_b32 a127, v13
v_exp_f32 v104, v72
v_exp_f32 v105, v73
v_exp_f32 v106, v74
v_exp_f32 v107, v75
v_exp_f32 v112, v80
v_exp_f32 v113, v81
v_exp_f32 v114, v82
v_exp_f32 v115, v83
v_exp_f32 v108, v76
v_exp_f32 v109, v77
v_exp_f32 v110, v78
v_exp_f32 v111, v79
v_exp_f32 v116, v84
v_exp_f32 v117, v85
v_exp_f32 v118, v86
v_exp_f32 v119, v87
s_nop 0
v_cvt_pk_bf16_f32 v120, v104, v105
v_add_f32 v200, v104, v105
v_cvt_pk_bf16_f32 v121, v106, v107
v_add_f32 v201, v106, v107
v_add_f32 v200, v200, v201
v_cvt_pk_bf16_f32 v122, v112, v113
v_add_f32 v201, v112, v113
v_cvt_pk_bf16_f32 v123, v114, v115
v_add_f32 v200, v200, v201
v_add_f32 v201, v114, v115
v_add_f32 v30, v200, v201
v_cvt_pk_bf16_f32 v124, v108, v109
v_add_f32 v202, v108, v109
v_cvt_pk_bf16_f32 v125, v110, v111
v_add_f32 v203, v110, v111
v_add_f32 v202, v202, v203
v_cvt_pk_bf16_f32 v126, v116, v117
v_add_f32 v203, v116, v117
v_cvt_pk_bf16_f32 v127, v118, v119
v_add_f32 v202, v202, v203
v_add_f32 v203, v118, v119
v_add_f32 v31, v202, v203
s_nop 1
s_branch K2A_BACKL0
K2A_SLOWL1:
s_nop 7
s_nop 7
v_max3_f32 v9, v88, v89, v90
v_max3_f32 v9, v9, v91, v96
v_max3_f32 v9, v9, v97, v98
v_max_f32 v9, v9, v99
v_max3_f32 v10, v92, v93, v94
v_max3_f32 v10, v10, v95, v100
v_max3_f32 v10, v10, v101, v102
v_max_f32 v10, v10, v103
ds_bpermute_b32 v11, v4, v9
ds_bpermute_b32 v12, v4, v10
s_waitcnt lgkmcnt(0)
v_max_f32 v9, v9, v11
v_max_f32 v10, v10, v12
ds_bpermute_b32 v11, v5, v9
ds_bpermute_b32 v12, v5, v10
s_waitcnt lgkmcnt(0)
v_max_f32 v9, v9, v11
v_max_f32 v10, v10, v12
v_max_f32 v9, 0, v9
v_sub_f32 v11, 0, v9
v_exp_f32 v11, v11
v_max_f32 v10, 0, v10
v_sub_f32 v12, 0, v10
v_exp_f32 v12, v12
s_nop 0
v_mul_f32 v28, v28, v11
v_sub_f32 v32, v32, v9
v_sub_f32 v33, v33, v9
v_sub_f32 v34, v34, v9
v_sub_f32 v35, v35, v9
v_sub_f32 v88, v88, v9
v_sub_f32 v89, v89, v9
v_sub_f32 v90, v90, v9
v_sub_f32 v91, v91, v9
v_sub_f32 v96, v96, v9
v_sub_f32 v97, v97, v9
v_sub_f32 v98, v98, v9
v_sub_f32 v99, v99, v9
v_accvgpr_read_b32 v13, a0
v_mul_f32 v13, v13, v11
v_accvgpr_write_b32 a0, v13
v_accvgpr_read_b32 v13, a1
v_mul_f32 v13, v13, v11
v_accvgpr_write_b32 a1, v13
v_accvgpr_read_b32 v13, a2
v_mul_f32 v13, v13, v11
v_accvgpr_write_b32 a2, v13
v_accvgpr_read_b32 v13, a3
v_mul_f32 v13, v13, v11
v_accvgpr_write_b32 a3, v13
v_accvgpr_read_b32 v13, a8
v_mul_f32 v13, v13, v11
v_accvgpr_write_b32 a8, v13
v_accvgpr_read_b32 v13, a9
v_mul_f32 v13, v13, v11
v_accvgpr_write_b32 a9, v13
v_accvgpr_read_b32 v13, a10
v_mul_f32 v13, v13, v11
v_accvgpr_write_b32 a10, v13
v_accvgpr_read_b32 v13, a11
v_mul_f32 v13, v13, v11
v_accvgpr_write_b32 a11, v13
v_accvgpr_read_b32 v13, a16
v_mul_f32 v13, v13, v11
v_accvgpr_write_b32 a16, v13
v_accvgpr_read_b32 v13, a17
v_mul_f32 v13, v13, v11
v_accvgpr_write_b32 a17, v13
v_accvgpr_read_b32 v13, a18
v_mul_f32 v13, v13, v11
v_accvgpr_write_b32 a18, v13
v_accvgpr_read_b32 v13, a19
v_mul_f32 v13, v13, v11
v_accvgpr_write_b32 a19, v13
v_accvgpr_read_b32 v13, a24
v_mul_f32 v13, v13, v11
v_accvgpr_write_b32 a24, v13
v_accvgpr_read_b32 v13, a25
v_mul_f32 v13, v13, v11
v_accvgpr_write_b32 a25, v13
v_accvgpr_read_b32 v13, a26
v_mul_f32 v13, v13, v11
v_accvgpr_write_b32 a26, v13
v_accvgpr_read_b32 v13, a27
v_mul_f32 v13, v13, v11
v_accvgpr_write_b32 a27, v13
v_accvgpr_read_b32 v13, a32
v_mul_f32 v13, v13, v11
v_accvgpr_write_b32 a32, v13
v_accvgpr_read_b32 v13, a33
v_mul_f32 v13, v13, v11
v_accvgpr_write_b32 a33, v13
v_accvgpr_read_b32 v13, a34
v_mul_f32 v13, v13, v11
v_accvgpr_write_b32 a34, v13
v_accvgpr_read_b32 v13, a35
v_mul_f32 v13, v13, v11
v_accvgpr_write_b32 a35, v13
v_accvgpr_read_b32 v13, a40
v_mul_f32 v13, v13, v11
v_accvgpr_write_b32 a40, v13
v_accvgpr_read_b32 v13, a41
v_mul_f32 v13, v13, v11
v_accvgpr_write_b32 a41, v13
v_accvgpr_read_b32 v13, a42
v_mul_f32 v13, v13, v11
v_accvgpr_write_b32 a42, v13
v_accvgpr_read_b32 v13, a43
v_mul_f32 v13, v13, v11
v_accvgpr_write_b32 a43, v13
v_accvgpr_read_b32 v13, a48
v_mul_f32 v13, v13, v11
v_accvgpr_write_b32 a48, v13
v_accvgpr_read_b32 v13, a49
v_mul_f32 v13, v13, v11
v_accvgpr_write_b32 a49, v13
v_accvgpr_read_b32 v13, a50
v_mul_f32 v13, v13, v11
v_accvgpr_write_b32 a50, v13
v_accvgpr_read_b32 v13, a51
v_mul_f32 v13, v13, v11
v_accvgpr_write_b32 a51, v13
v_accvgpr_read_b32 v13, a56
v_mul_f32 v13, v13, v11
v_accvgpr_write_b32 a56, v13
v_accvgpr_read_b32 v13, a57
v_mul_f32 v13, v13, v11
v_accvgpr_write_b32 a57, v13
v_accvgpr_read_b32 v13, a58
v_mul_f32 v13, v13, v11
v_accvgpr_write_b32 a58, v13
v_accvgpr_read_b32 v13, a59
v_mul_f32 v13, v13, v11
v_accvgpr_write_b32 a59, v13
v_accvgpr_read_b32 v13, a64
v_mul_f32 v13, v13, v11
v_accvgpr_write_b32 a64, v13
v_accvgpr_read_b32 v13, a65
v_mul_f32 v13, v13, v11
v_accvgpr_write_b32 a65, v13
v_accvgpr_read_b32 v13, a66
v_mul_f32 v13, v13, v11
v_accvgpr_write_b32 a66, v13
v_accvgpr_read_b32 v13, a67
v_mul_f32 v13, v13, v11
v_accvgpr_write_b32 a67, v13
v_accvgpr_read_b32 v13, a72
v_mul_f32 v13, v13, v11
v_accvgpr_write_b32 a72, v13
v_accvgpr_read_b32 v13, a73
v_mul_f32 v13, v13, v11
v_accvgpr_write_b32 a73, v13
v_accvgpr_read_b32 v13, a74
v_mul_f32 v13, v13, v11
v_accvgpr_write_b32 a74, v13
v_accvgpr_read_b32 v13, a75
v_mul_f32 v13, v13, v11
v_accvgpr_write_b32 a75, v13
v_accvgpr_read_b32 v13, a80
v_mul_f32 v13, v13, v11
v_accvgpr_write_b32 a80, v13
v_accvgpr_read_b32 v13, a81
v_mul_f32 v13, v13, v11
v_accvgpr_write_b32 a81, v13
v_accvgpr_read_b32 v13, a82
v_mul_f32 v13, v13, v11
v_accvgpr_write_b32 a82, v13
v_accvgpr_read_b32 v13, a83
v_mul_f32 v13, v13, v11
v_accvgpr_write_b32 a83, v13
v_accvgpr_read_b32 v13, a88
v_mul_f32 v13, v13, v11
v_accvgpr_write_b32 a88, v13
v_accvgpr_read_b32 v13, a89
v_mul_f32 v13, v13, v11
v_accvgpr_write_b32 a89, v13
v_accvgpr_read_b32 v13, a90
v_mul_f32 v13, v13, v11
v_accvgpr_write_b32 a90, v13
v_accvgpr_read_b32 v13, a91
v_mul_f32 v13, v13, v11
v_accvgpr_write_b32 a91, v13
v_accvgpr_read_b32 v13, a96
v_mul_f32 v13, v13, v11
v_accvgpr_write_b32 a96, v13
v_accvgpr_read_b32 v13, a97
v_mul_f32 v13, v13, v11
v_accvgpr_write_b32 a97, v13
v_accvgpr_read_b32 v13, a98
v_mul_f32 v13, v13, v11
v_accvgpr_write_b32 a98, v13
v_accvgpr_read_b32 v13, a99
v_mul_f32 v13, v13, v11
v_accvgpr_write_b32 a99, v13
v_accvgpr_read_b32 v13, a104
v_mul_f32 v13, v13, v11
v_accvgpr_write_b32 a104, v13
v_accvgpr_read_b32 v13, a105
v_mul_f32 v13, v13, v11
v_accvgpr_write_b32 a105, v13
v_accvgpr_read_b32 v13, a106
v_mul_f32 v13, v13, v11
v_accvgpr_write_b32 a106, v13
v_accvgpr_read_b32 v13, a107
v_mul_f32 v13, v13, v11
v_accvgpr_write_b32 a107, v13
v_accvgpr_read_b32 v13, a112
v_mul_f32 v13, v13, v11
v_accvgpr_write_b32 a112, v13
v_accvgpr_read_b32 v13, a113
v_mul_f32 v13, v13, v11
v_accvgpr_write_b32 a113, v13
v_accvgpr_read_b32 v13, a114
v_mul_f32 v13, v13, v11
v_accvgpr_write_b32 a114, v13
v_accvgpr_read_b32 v13, a115
v_mul_f32 v13, v13, v11
v_accvgpr_write_b32 a115, v13
v_accvgpr_read_b32 v13, a120
v_mul_f32 v13, v13, v11
v_accvgpr_write_b32 a120, v13
v_accvgpr_read_b32 v13, a121
v_mul_f32 v13, v13, v11
v_accvgpr_write_b32 a121, v13
v_accvgpr_read_b32 v13, a122
v_mul_f32 v13, v13, v11
v_accvgpr_write_b32 a122, v13
v_accvgpr_read_b32 v13, a123
v_mul_f32 v13, v13, v11
v_accvgpr_write_b32 a123, v13
v_mul_f32 v29, v29, v12
v_sub_f32 v36, v36, v10
v_sub_f32 v37, v37, v10
v_sub_f32 v38, v38, v10
v_sub_f32 v39, v39, v10
v_sub_f32 v92, v92, v10
v_sub_f32 v93, v93, v10
v_sub_f32 v94, v94, v10
v_sub_f32 v95, v95, v10
v_sub_f32 v100, v100, v10
v_sub_f32 v101, v101, v10
v_sub_f32 v102, v102, v10
v_sub_f32 v103, v103, v10
v_accvgpr_read_b32 v13, a4
v_mul_f32 v13, v13, v12
v_accvgpr_write_b32 a4, v13
v_accvgpr_read_b32 v13, a5
v_mul_f32 v13, v13, v12
v_accvgpr_write_b32 a5, v13
v_accvgpr_read_b32 v13, a6
v_mul_f32 v13, v13, v12
v_accvgpr_write_b32 a6, v13
v_accvgpr_read_b32 v13, a7
v_mul_f32 v13, v13, v12
v_accvgpr_write_b32 a7, v13
v_accvgpr_read_b32 v13, a12
v_mul_f32 v13, v13, v12
v_accvgpr_write_b32 a12, v13
v_accvgpr_read_b32 v13, a13
v_mul_f32 v13, v13, v12
v_accvgpr_write_b32 a13, v13
v_accvgpr_read_b32 v13, a14
v_mul_f32 v13, v13, v12
v_accvgpr_write_b32 a14, v13
v_accvgpr_read_b32 v13, a15
v_mul_f32 v13, v13, v12
v_accvgpr_write_b32 a15, v13
v_accvgpr_read_b32 v13, a20
v_mul_f32 v13, v13, v12
v_accvgpr_write_b32 a20, v13
v_accvgpr_read_b32 v13, a21
v_mul_f32 v13, v13, v12
v_accvgpr_write_b32 a21, v13
v_accvgpr_read_b32 v13, a22
v_mul_f32 v13, v13, v12
v_accvgpr_write_b32 a22, v13
v_accvgpr_read_b32 v13, a23
v_mul_f32 v13, v13, v12
v_accvgpr_write_b32 a23, v13
v_accvgpr_read_b32 v13, a28
v_mul_f32 v13, v13, v12
v_accvgpr_write_b32 a28, v13
v_accvgpr_read_b32 v13, a29
v_mul_f32 v13, v13, v12
v_accvgpr_write_b32 a29, v13
v_accvgpr_read_b32 v13, a30
v_mul_f32 v13, v13, v12
v_accvgpr_write_b32 a30, v13
v_accvgpr_read_b32 v13, a31
v_mul_f32 v13, v13, v12
v_accvgpr_write_b32 a31, v13
v_accvgpr_read_b32 v13, a36
v_mul_f32 v13, v13, v12
v_accvgpr_write_b32 a36, v13
v_accvgpr_read_b32 v13, a37
v_mul_f32 v13, v13, v12
v_accvgpr_write_b32 a37, v13
v_accvgpr_read_b32 v13, a38
v_mul_f32 v13, v13, v12
v_accvgpr_write_b32 a38, v13
v_accvgpr_read_b32 v13, a39
v_mul_f32 v13, v13, v12
v_accvgpr_write_b32 a39, v13
v_accvgpr_read_b32 v13, a44
v_mul_f32 v13, v13, v12
v_accvgpr_write_b32 a44, v13
v_accvgpr_read_b32 v13, a45
v_mul_f32 v13, v13, v12
v_accvgpr_write_b32 a45, v13
v_accvgpr_read_b32 v13, a46
v_mul_f32 v13, v13, v12
v_accvgpr_write_b32 a46, v13
v_accvgpr_read_b32 v13, a47
v_mul_f32 v13, v13, v12
v_accvgpr_write_b32 a47, v13
v_accvgpr_read_b32 v13, a52
v_mul_f32 v13, v13, v12
v_accvgpr_write_b32 a52, v13
v_accvgpr_read_b32 v13, a53
v_mul_f32 v13, v13, v12
v_accvgpr_write_b32 a53, v13
v_accvgpr_read_b32 v13, a54
v_mul_f32 v13, v13, v12
v_accvgpr_write_b32 a54, v13
v_accvgpr_read_b32 v13, a55
v_mul_f32 v13, v13, v12
v_accvgpr_write_b32 a55, v13
v_accvgpr_read_b32 v13, a60
v_mul_f32 v13, v13, v12
v_accvgpr_write_b32 a60, v13
v_accvgpr_read_b32 v13, a61
v_mul_f32 v13, v13, v12
v_accvgpr_write_b32 a61, v13
v_accvgpr_read_b32 v13, a62
v_mul_f32 v13, v13, v12
v_accvgpr_write_b32 a62, v13
v_accvgpr_read_b32 v13, a63
v_mul_f32 v13, v13, v12
v_accvgpr_write_b32 a63, v13
v_accvgpr_read_b32 v13, a68
v_mul_f32 v13, v13, v12
v_accvgpr_write_b32 a68, v13
v_accvgpr_read_b32 v13, a69
v_mul_f32 v13, v13, v12
v_accvgpr_write_b32 a69, v13
v_accvgpr_read_b32 v13, a70
v_mul_f32 v13, v13, v12
v_accvgpr_write_b32 a70, v13
v_accvgpr_read_b32 v13, a71
v_mul_f32 v13, v13, v12
v_accvgpr_write_b32 a71, v13
v_accvgpr_read_b32 v13, a76
v_mul_f32 v13, v13, v12
v_accvgpr_write_b32 a76, v13
v_accvgpr_read_b32 v13, a77
v_mul_f32 v13, v13, v12
v_accvgpr_write_b32 a77, v13
v_accvgpr_read_b32 v13, a78
v_mul_f32 v13, v13, v12
v_accvgpr_write_b32 a78, v13
v_accvgpr_read_b32 v13, a79
v_mul_f32 v13, v13, v12
v_accvgpr_write_b32 a79, v13
v_accvgpr_read_b32 v13, a84
v_mul_f32 v13, v13, v12
v_accvgpr_write_b32 a84, v13
v_accvgpr_read_b32 v13, a85
v_mul_f32 v13, v13, v12
v_accvgpr_write_b32 a85, v13
v_accvgpr_read_b32 v13, a86
v_mul_f32 v13, v13, v12
v_accvgpr_write_b32 a86, v13
v_accvgpr_read_b32 v13, a87
v_mul_f32 v13, v13, v12
v_accvgpr_write_b32 a87, v13
v_accvgpr_read_b32 v13, a92
v_mul_f32 v13, v13, v12
v_accvgpr_write_b32 a92, v13
v_accvgpr_read_b32 v13, a93
v_mul_f32 v13, v13, v12
v_accvgpr_write_b32 a93, v13
v_accvgpr_read_b32 v13, a94
v_mul_f32 v13, v13, v12
v_accvgpr_write_b32 a94, v13
v_accvgpr_read_b32 v13, a95
v_mul_f32 v13, v13, v12
v_accvgpr_write_b32 a95, v13
v_accvgpr_read_b32 v13, a100
v_mul_f32 v13, v13, v12
v_accvgpr_write_b32 a100, v13
v_accvgpr_read_b32 v13, a101
v_mul_f32 v13, v13, v12
v_accvgpr_write_b32 a101, v13
v_accvgpr_read_b32 v13, a102
v_mul_f32 v13, v13, v12
v_accvgpr_write_b32 a102, v13
v_accvgpr_read_b32 v13, a103
v_mul_f32 v13, v13, v12
v_accvgpr_write_b32 a103, v13
v_accvgpr_read_b32 v13, a108
v_mul_f32 v13, v13, v12
v_accvgpr_write_b32 a108, v13
v_accvgpr_read_b32 v13, a109
v_mul_f32 v13, v13, v12
v_accvgpr_write_b32 a109, v13
v_accvgpr_read_b32 v13, a110
v_mul_f32 v13, v13, v12
v_accvgpr_write_b32 a110, v13
v_accvgpr_read_b32 v13, a111
v_mul_f32 v13, v13, v12
v_accvgpr_write_b32 a111, v13
v_accvgpr_read_b32 v13, a116
v_mul_f32 v13, v13, v12
v_accvgpr_write_b32 a116, v13
v_accvgpr_read_b32 v13, a117
v_mul_f32 v13, v13, v12
v_accvgpr_write_b32 a117, v13
v_accvgpr_read_b32 v13, a118
v_mul_f32 v13, v13, v12
v_accvgpr_write_b32 a118, v13
v_accvgpr_read_b32 v13, a119
v_mul_f32 v13, v13, v12
v_accvgpr_write_b32 a119, v13
v_accvgpr_read_b32 v13, a124
v_mul_f32 v13, v13, v12
v_accvgpr_write_b32 a124, v13
v_accvgpr_read_b32 v13, a125
v_mul_f32 v13, v13, v12
v_accvgpr_write_b32 a125, v13
v_accvgpr_read_b32 v13, a126
v_mul_f32 v13, v13, v12
v_accvgpr_write_b32 a126, v13
v_accvgpr_read_b32 v13, a127
v_mul_f32 v13, v13, v12
v_accvgpr_write_b32 a127, v13
v_exp_f32 v104, v88
v_exp_f32 v105, v89
v_exp_f32 v106, v90
v_exp_f32 v107, v91
v_exp_f32 v112, v96
v_exp_f32 v113, v97
v_exp_f32 v114, v98
v_exp_f32 v115, v99
v_exp_f32 v108, v92
v_exp_f32 v109, v93
v_exp_f32 v110, v94
v_exp_f32 v111, v95
v_exp_f32 v116, v100
v_exp_f32 v117, v101
v_exp_f32 v118, v102
v_exp_f32 v119, v103
s_nop 0
v_cvt_pk_bf16_f32 v128, v104, v105
v_add_f32 v200, v104, v105
v_cvt_pk_bf16_f32 v129, v106, v107
v_add_f32 v201, v106, v107
v_add_f32 v200, v200, v201
v_cvt_pk_bf16_f32 v130, v112, v113
v_add_f32 v201, v112, v113
v_cvt_pk_bf16_f32 v131, v114, v115
v_add_f32 v200, v200, v201
v_add_f32 v201, v114, v115
v_add_f32 v30, v200, v201
v_cvt_pk_bf16_f32 v132, v108, v109
v_add_f32 v202, v108, v109
v_cvt_pk_bf16_f32 v133, v110, v111
v_add_f32 v203, v110, v111
v_add_f32 v202, v202, v203
v_cvt_pk_bf16_f32 v134, v116, v117
v_add_f32 v203, v116, v117
v_cvt_pk_bf16_f32 v135, v118, v119
v_add_f32 v202, v202, v203
v_add_f32 v203, v118, v119
v_add_f32 v31, v202, v203
s_nop 1
s_branch K2A_BACKL1
K2A_SLOWL2:
s_nop 7
s_nop 7
v_max3_f32 v9, v72, v73, v74
v_max3_f32 v9, v9, v75, v80
v_max3_f32 v9, v9, v81, v82
v_max_f32 v9, v9, v83
v_max3_f32 v10, v76, v77, v78
v_max3_f32 v10, v10, v79, v84
v_max3_f32 v10, v10, v85, v86
v_max_f32 v10, v10, v87
ds_bpermute_b32 v11, v4, v9
ds_bpermute_b32 v12, v4, v10
s_waitcnt lgkmcnt(0)
v_max_f32 v9, v9, v11
v_max_f32 v10, v10, v12
ds_bpermute_b32 v11, v5, v9
ds_bpermute_b32 v12, v5, v10
s_waitcnt lgkmcnt(0)
v_max_f32 v9, v9, v11
v_max_f32 v10, v10, v12
v_max_f32 v9, 0, v9
v_sub_f32 v11, 0, v9
v_exp_f32 v11, v11
v_max_f32 v10, 0, v10
v_sub_f32 v12, 0, v10
v_exp_f32 v12, v12
s_nop 0
v_mul_f32 v28, v28, v11
v_sub_f32 v32, v32, v9
v_sub_f32 v33, v33, v9
v_sub_f32 v34, v34, v9
v_sub_f32 v35, v35, v9
v_sub_f32 v72, v72, v9
v_sub_f32 v73, v73, v9
v_sub_f32 v74, v74, v9
v_sub_f32 v75, v75, v9
v_sub_f32 v80, v80, v9
v_sub_f32 v81, v81, v9
v_sub_f32 v82, v82, v9
v_sub_f32 v83, v83, v9
v_accvgpr_read_b32 v13, a0
v_mul_f32 v13, v13, v11
v_accvgpr_write_b32 a0, v13
v_accvgpr_read_b32 v13, a1
v_mul_f32 v13, v13, v11
v_accvgpr_write_b32 a1, v13
v_accvgpr_read_b32 v13, a2
v_mul_f32 v13, v13, v11
v_accvgpr_write_b32 a2, v13
v_accvgpr_read_b32 v13, a3
v_mul_f32 v13, v13, v11
v_accvgpr_write_b32 a3, v13
v_accvgpr_read_b32 v13, a8
v_mul_f32 v13, v13, v11
v_accvgpr_write_b32 a8, v13
v_accvgpr_read_b32 v13, a9
v_mul_f32 v13, v13, v11
v_accvgpr_write_b32 a9, v13
v_accvgpr_read_b32 v13, a10
v_mul_f32 v13, v13, v11
v_accvgpr_write_b32 a10, v13
v_accvgpr_read_b32 v13, a11
v_mul_f32 v13, v13, v11
v_accvgpr_write_b32 a11, v13
v_accvgpr_read_b32 v13, a16
v_mul_f32 v13, v13, v11
v_accvgpr_write_b32 a16, v13
v_accvgpr_read_b32 v13, a17
v_mul_f32 v13, v13, v11
v_accvgpr_write_b32 a17, v13
v_accvgpr_read_b32 v13, a18
v_mul_f32 v13, v13, v11
v_accvgpr_write_b32 a18, v13
v_accvgpr_read_b32 v13, a19
v_mul_f32 v13, v13, v11
v_accvgpr_write_b32 a19, v13
v_accvgpr_read_b32 v13, a24
v_mul_f32 v13, v13, v11
v_accvgpr_write_b32 a24, v13
v_accvgpr_read_b32 v13, a25
v_mul_f32 v13, v13, v11
v_accvgpr_write_b32 a25, v13
v_accvgpr_read_b32 v13, a26
v_mul_f32 v13, v13, v11
v_accvgpr_write_b32 a26, v13
v_accvgpr_read_b32 v13, a27
v_mul_f32 v13, v13, v11
v_accvgpr_write_b32 a27, v13
v_accvgpr_read_b32 v13, a32
v_mul_f32 v13, v13, v11
v_accvgpr_write_b32 a32, v13
v_accvgpr_read_b32 v13, a33
v_mul_f32 v13, v13, v11
v_accvgpr_write_b32 a33, v13
v_accvgpr_read_b32 v13, a34
v_mul_f32 v13, v13, v11
v_accvgpr_write_b32 a34, v13
v_accvgpr_read_b32 v13, a35
v_mul_f32 v13, v13, v11
v_accvgpr_write_b32 a35, v13
v_accvgpr_read_b32 v13, a40
v_mul_f32 v13, v13, v11
v_accvgpr_write_b32 a40, v13
v_accvgpr_read_b32 v13, a41
v_mul_f32 v13, v13, v11
v_accvgpr_write_b32 a41, v13
v_accvgpr_read_b32 v13, a42
v_mul_f32 v13, v13, v11
v_accvgpr_write_b32 a42, v13
v_accvgpr_read_b32 v13, a43
v_mul_f32 v13, v13, v11
v_accvgpr_write_b32 a43, v13
v_accvgpr_read_b32 v13, a48
v_mul_f32 v13, v13, v11
v_accvgpr_write_b32 a48, v13
v_accvgpr_read_b32 v13, a49
v_mul_f32 v13, v13, v11
v_accvgpr_write_b32 a49, v13
v_accvgpr_read_b32 v13, a50
v_mul_f32 v13, v13, v11
v_accvgpr_write_b32 a50, v13
v_accvgpr_read_b32 v13, a51
v_mul_f32 v13, v13, v11
v_accvgpr_write_b32 a51, v13
v_accvgpr_read_b32 v13, a56
v_mul_f32 v13, v13, v11
v_accvgpr_write_b32 a56, v13
v_accvgpr_read_b32 v13, a57
v_mul_f32 v13, v13, v11
v_accvgpr_write_b32 a57, v13
v_accvgpr_read_b32 v13, a58
v_mul_f32 v13, v13, v11
v_accvgpr_write_b32 a58, v13
v_accvgpr_read_b32 v13, a59
v_mul_f32 v13, v13, v11
v_accvgpr_write_b32 a59, v13
v_accvgpr_read_b32 v13, a64
v_mul_f32 v13, v13, v11
v_accvgpr_write_b32 a64, v13
v_accvgpr_read_b32 v13, a65
v_mul_f32 v13, v13, v11
v_accvgpr_write_b32 a65, v13
v_accvgpr_read_b32 v13, a66
v_mul_f32 v13, v13, v11
v_accvgpr_write_b32 a66, v13
v_accvgpr_read_b32 v13, a67
v_mul_f32 v13, v13, v11
v_accvgpr_write_b32 a67, v13
v_accvgpr_read_b32 v13, a72
v_mul_f32 v13, v13, v11
v_accvgpr_write_b32 a72, v13
v_accvgpr_read_b32 v13, a73
v_mul_f32 v13, v13, v11
v_accvgpr_write_b32 a73, v13
v_accvgpr_read_b32 v13, a74
v_mul_f32 v13, v13, v11
v_accvgpr_write_b32 a74, v13
v_accvgpr_read_b32 v13, a75
v_mul_f32 v13, v13, v11
v_accvgpr_write_b32 a75, v13
v_accvgpr_read_b32 v13, a80
v_mul_f32 v13, v13, v11
v_accvgpr_write_b32 a80, v13
v_accvgpr_read_b32 v13, a81
v_mul_f32 v13, v13, v11
v_accvgpr_write_b32 a81, v13
v_accvgpr_read_b32 v13, a82
v_mul_f32 v13, v13, v11
v_accvgpr_write_b32 a82, v13
v_accvgpr_read_b32 v13, a83
v_mul_f32 v13, v13, v11
v_accvgpr_write_b32 a83, v13
v_accvgpr_read_b32 v13, a88
v_mul_f32 v13, v13, v11
v_accvgpr_write_b32 a88, v13
v_accvgpr_read_b32 v13, a89
v_mul_f32 v13, v13, v11
v_accvgpr_write_b32 a89, v13
v_accvgpr_read_b32 v13, a90
v_mul_f32 v13, v13, v11
v_accvgpr_write_b32 a90, v13
v_accvgpr_read_b32 v13, a91
v_mul_f32 v13, v13, v11
v_accvgpr_write_b32 a91, v13
v_accvgpr_read_b32 v13, a96
v_mul_f32 v13, v13, v11
v_accvgpr_write_b32 a96, v13
v_accvgpr_read_b32 v13, a97
v_mul_f32 v13, v13, v11
v_accvgpr_write_b32 a97, v13
v_accvgpr_read_b32 v13, a98
v_mul_f32 v13, v13, v11
v_accvgpr_write_b32 a98, v13
v_accvgpr_read_b32 v13, a99
v_mul_f32 v13, v13, v11
v_accvgpr_write_b32 a99, v13
v_accvgpr_read_b32 v13, a104
v_mul_f32 v13, v13, v11
v_accvgpr_write_b32 a104, v13
v_accvgpr_read_b32 v13, a105
v_mul_f32 v13, v13, v11
v_accvgpr_write_b32 a105, v13
v_accvgpr_read_b32 v13, a106
v_mul_f32 v13, v13, v11
v_accvgpr_write_b32 a106, v13
v_accvgpr_read_b32 v13, a107
v_mul_f32 v13, v13, v11
v_accvgpr_write_b32 a107, v13
v_accvgpr_read_b32 v13, a112
v_mul_f32 v13, v13, v11
v_accvgpr_write_b32 a112, v13
v_accvgpr_read_b32 v13, a113
v_mul_f32 v13, v13, v11
v_accvgpr_write_b32 a113, v13
v_accvgpr_read_b32 v13, a114
v_mul_f32 v13, v13, v11
v_accvgpr_write_b32 a114, v13
v_accvgpr_read_b32 v13, a115
v_mul_f32 v13, v13, v11
v_accvgpr_write_b32 a115, v13
v_accvgpr_read_b32 v13, a120
v_mul_f32 v13, v13, v11
v_accvgpr_write_b32 a120, v13
v_accvgpr_read_b32 v13, a121
v_mul_f32 v13, v13, v11
v_accvgpr_write_b32 a121, v13
v_accvgpr_read_b32 v13, a122
v_mul_f32 v13, v13, v11
v_accvgpr_write_b32 a122, v13
v_accvgpr_read_b32 v13, a123
v_mul_f32 v13, v13, v11
v_accvgpr_write_b32 a123, v13
v_mul_f32 v29, v29, v12
v_sub_f32 v36, v36, v10
v_sub_f32 v37, v37, v10
v_sub_f32 v38, v38, v10
v_sub_f32 v39, v39, v10
v_sub_f32 v76, v76, v10
v_sub_f32 v77, v77, v10
v_sub_f32 v78, v78, v10
v_sub_f32 v79, v79, v10
v_sub_f32 v84, v84, v10
v_sub_f32 v85, v85, v10
v_sub_f32 v86, v86, v10
v_sub_f32 v87, v87, v10
v_accvgpr_read_b32 v13, a4
v_mul_f32 v13, v13, v12
v_accvgpr_write_b32 a4, v13
v_accvgpr_read_b32 v13, a5
v_mul_f32 v13, v13, v12
v_accvgpr_write_b32 a5, v13
v_accvgpr_read_b32 v13, a6
v_mul_f32 v13, v13, v12
v_accvgpr_write_b32 a6, v13
v_accvgpr_read_b32 v13, a7
v_mul_f32 v13, v13, v12
v_accvgpr_write_b32 a7, v13
v_accvgpr_read_b32 v13, a12
v_mul_f32 v13, v13, v12
v_accvgpr_write_b32 a12, v13
v_accvgpr_read_b32 v13, a13
v_mul_f32 v13, v13, v12
v_accvgpr_write_b32 a13, v13
v_accvgpr_read_b32 v13, a14
v_mul_f32 v13, v13, v12
v_accvgpr_write_b32 a14, v13
v_accvgpr_read_b32 v13, a15
v_mul_f32 v13, v13, v12
v_accvgpr_write_b32 a15, v13
v_accvgpr_read_b32 v13, a20
v_mul_f32 v13, v13, v12
v_accvgpr_write_b32 a20, v13
v_accvgpr_read_b32 v13, a21
v_mul_f32 v13, v13, v12
v_accvgpr_write_b32 a21, v13
v_accvgpr_read_b32 v13, a22
v_mul_f32 v13, v13, v12
v_accvgpr_write_b32 a22, v13
v_accvgpr_read_b32 v13, a23
v_mul_f32 v13, v13, v12
v_accvgpr_write_b32 a23, v13
v_accvgpr_read_b32 v13, a28
v_mul_f32 v13, v13, v12
v_accvgpr_write_b32 a28, v13
v_accvgpr_read_b32 v13, a29
v_mul_f32 v13, v13, v12
v_accvgpr_write_b32 a29, v13
v_accvgpr_read_b32 v13, a30
v_mul_f32 v13, v13, v12
v_accvgpr_write_b32 a30, v13
v_accvgpr_read_b32 v13, a31
v_mul_f32 v13, v13, v12
v_accvgpr_write_b32 a31, v13
v_accvgpr_read_b32 v13, a36
v_mul_f32 v13, v13, v12
v_accvgpr_write_b32 a36, v13
v_accvgpr_read_b32 v13, a37
v_mul_f32 v13, v13, v12
v_accvgpr_write_b32 a37, v13
v_accvgpr_read_b32 v13, a38
v_mul_f32 v13, v13, v12
v_accvgpr_write_b32 a38, v13
v_accvgpr_read_b32 v13, a39
v_mul_f32 v13, v13, v12
v_accvgpr_write_b32 a39, v13
v_accvgpr_read_b32 v13, a44
v_mul_f32 v13, v13, v12
v_accvgpr_write_b32 a44, v13
v_accvgpr_read_b32 v13, a45
v_mul_f32 v13, v13, v12
v_accvgpr_write_b32 a45, v13
v_accvgpr_read_b32 v13, a46
v_mul_f32 v13, v13, v12
v_accvgpr_write_b32 a46, v13
v_accvgpr_read_b32 v13, a47
v_mul_f32 v13, v13, v12
v_accvgpr_write_b32 a47, v13
v_accvgpr_read_b32 v13, a52
v_mul_f32 v13, v13, v12
v_accvgpr_write_b32 a52, v13
v_accvgpr_read_b32 v13, a53
v_mul_f32 v13, v13, v12
v_accvgpr_write_b32 a53, v13
v_accvgpr_read_b32 v13, a54
v_mul_f32 v13, v13, v12
v_accvgpr_write_b32 a54, v13
v_accvgpr_read_b32 v13, a55
v_mul_f32 v13, v13, v12
v_accvgpr_write_b32 a55, v13
v_accvgpr_read_b32 v13, a60
v_mul_f32 v13, v13, v12
v_accvgpr_write_b32 a60, v13
v_accvgpr_read_b32 v13, a61
v_mul_f32 v13, v13, v12
v_accvgpr_write_b32 a61, v13
v_accvgpr_read_b32 v13, a62
v_mul_f32 v13, v13, v12
v_accvgpr_write_b32 a62, v13
v_accvgpr_read_b32 v13, a63
v_mul_f32 v13, v13, v12
v_accvgpr_write_b32 a63, v13
v_accvgpr_read_b32 v13, a68
v_mul_f32 v13, v13, v12
v_accvgpr_write_b32 a68, v13
v_accvgpr_read_b32 v13, a69
v_mul_f32 v13, v13, v12
v_accvgpr_write_b32 a69, v13
v_accvgpr_read_b32 v13, a70
v_mul_f32 v13, v13, v12
v_accvgpr_write_b32 a70, v13
v_accvgpr_read_b32 v13, a71
v_mul_f32 v13, v13, v12
v_accvgpr_write_b32 a71, v13
v_accvgpr_read_b32 v13, a76
v_mul_f32 v13, v13, v12
v_accvgpr_write_b32 a76, v13
v_accvgpr_read_b32 v13, a77
v_mul_f32 v13, v13, v12
v_accvgpr_write_b32 a77, v13
v_accvgpr_read_b32 v13, a78
v_mul_f32 v13, v13, v12
v_accvgpr_write_b32 a78, v13
v_accvgpr_read_b32 v13, a79
v_mul_f32 v13, v13, v12
v_accvgpr_write_b32 a79, v13
v_accvgpr_read_b32 v13, a84
v_mul_f32 v13, v13, v12
v_accvgpr_write_b32 a84, v13
v_accvgpr_read_b32 v13, a85
v_mul_f32 v13, v13, v12
v_accvgpr_write_b32 a85, v13
v_accvgpr_read_b32 v13, a86
v_mul_f32 v13, v13, v12
v_accvgpr_write_b32 a86, v13
v_accvgpr_read_b32 v13, a87
v_mul_f32 v13, v13, v12
v_accvgpr_write_b32 a87, v13
v_accvgpr_read_b32 v13, a92
v_mul_f32 v13, v13, v12
v_accvgpr_write_b32 a92, v13
v_accvgpr_read_b32 v13, a93
v_mul_f32 v13, v13, v12
v_accvgpr_write_b32 a93, v13
v_accvgpr_read_b32 v13, a94
v_mul_f32 v13, v13, v12
v_accvgpr_write_b32 a94, v13
v_accvgpr_read_b32 v13, a95
v_mul_f32 v13, v13, v12
v_accvgpr_write_b32 a95, v13
v_accvgpr_read_b32 v13, a100
v_mul_f32 v13, v13, v12
v_accvgpr_write_b32 a100, v13
v_accvgpr_read_b32 v13, a101
v_mul_f32 v13, v13, v12
v_accvgpr_write_b32 a101, v13
v_accvgpr_read_b32 v13, a102
v_mul_f32 v13, v13, v12
v_accvgpr_write_b32 a102, v13
v_accvgpr_read_b32 v13, a103
v_mul_f32 v13, v13, v12
v_accvgpr_write_b32 a103, v13
v_accvgpr_read_b32 v13, a108
v_mul_f32 v13, v13, v12
v_accvgpr_write_b32 a108, v13
v_accvgpr_read_b32 v13, a109
v_mul_f32 v13, v13, v12
v_accvgpr_write_b32 a109, v13
v_accvgpr_read_b32 v13, a110
v_mul_f32 v13, v13, v12
v_accvgpr_write_b32 a110, v13
v_accvgpr_read_b32 v13, a111
v_mul_f32 v13, v13, v12
v_accvgpr_write_b32 a111, v13
v_accvgpr_read_b32 v13, a116
v_mul_f32 v13, v13, v12
v_accvgpr_write_b32 a116, v13
v_accvgpr_read_b32 v13, a117
v_mul_f32 v13, v13, v12
v_accvgpr_write_b32 a117, v13
v_accvgpr_read_b32 v13, a118
v_mul_f32 v13, v13, v12
v_accvgpr_write_b32 a118, v13
v_accvgpr_read_b32 v13, a119
v_mul_f32 v13, v13, v12
v_accvgpr_write_b32 a119, v13
v_accvgpr_read_b32 v13, a124
v_mul_f32 v13, v13, v12
v_accvgpr_write_b32 a124, v13
v_accvgpr_read_b32 v13, a125
v_mul_f32 v13, v13, v12
v_accvgpr_write_b32 a125, v13
v_accvgpr_read_b32 v13, a126
v_mul_f32 v13, v13, v12
v_accvgpr_write_b32 a126, v13
v_accvgpr_read_b32 v13, a127
v_mul_f32 v13, v13, v12
v_accvgpr_write_b32 a127, v13
v_exp_f32 v104, v72
v_exp_f32 v105, v73
v_exp_f32 v106, v74
v_exp_f32 v107, v75
v_exp_f32 v112, v80
v_exp_f32 v113, v81
v_exp_f32 v114, v82
v_exp_f32 v115, v83
v_exp_f32 v108, v76
v_exp_f32 v109, v77
v_exp_f32 v110, v78
v_exp_f32 v111, v79
v_exp_f32 v116, v84
v_exp_f32 v117, v85
v_exp_f32 v118, v86
v_exp_f32 v119, v87
s_nop 0
v_cvt_pk_bf16_f32 v120, v104, v105
v_add_f32 v200, v104, v105
v_cvt_pk_bf16_f32 v121, v106, v107
v_add_f32 v201, v106, v107
v_add_f32 v200, v200, v201
v_cvt_pk_bf16_f32 v122, v112, v113
v_add_f32 v201, v112, v113
v_cvt_pk_bf16_f32 v123, v114, v115
v_add_f32 v200, v200, v201
v_add_f32 v201, v114, v115
v_add_f32 v30, v200, v201
v_cvt_pk_bf16_f32 v124, v108, v109
v_add_f32 v202, v108, v109
v_cvt_pk_bf16_f32 v125, v110, v111
v_add_f32 v203, v110, v111
v_add_f32 v202, v202, v203
v_cvt_pk_bf16_f32 v126, v116, v117
v_add_f32 v203, v116, v117
v_cvt_pk_bf16_f32 v127, v118, v119
v_add_f32 v202, v202, v203
v_add_f32 v203, v118, v119
v_add_f32 v31, v202, v203
s_nop 1
s_branch K2A_BACKL2
K2A_SLOWL3:
s_nop 7
s_nop 7
v_max3_f32 v9, v88, v89, v90
v_max3_f32 v9, v9, v91, v96
v_max3_f32 v9, v9, v97, v98
v_max_f32 v9, v9, v99
v_max3_f32 v10, v92, v93, v94
v_max3_f32 v10, v10, v95, v100
v_max3_f32 v10, v10, v101, v102
v_max_f32 v10, v10, v103
ds_bpermute_b32 v11, v4, v9
ds_bpermute_b32 v12, v4, v10
s_waitcnt lgkmcnt(0)
v_max_f32 v9, v9, v11
v_max_f32 v10, v10, v12
ds_bpermute_b32 v11, v5, v9
ds_bpermute_b32 v12, v5, v10
s_waitcnt lgkmcnt(0)
v_max_f32 v9, v9, v11
v_max_f32 v10, v10, v12
v_max_f32 v9, 0, v9
v_sub_f32 v11, 0, v9
v_exp_f32 v11, v11
v_max_f32 v10, 0, v10
v_sub_f32 v12, 0, v10
v_exp_f32 v12, v12
s_nop 0
v_mul_f32 v28, v28, v11
v_sub_f32 v32, v32, v9
v_sub_f32 v33, v33, v9
v_sub_f32 v34, v34, v9
v_sub_f32 v35, v35, v9
v_sub_f32 v88, v88, v9
v_sub_f32 v89, v89, v9
v_sub_f32 v90, v90, v9
v_sub_f32 v91, v91, v9
v_sub_f32 v96, v96, v9
v_sub_f32 v97, v97, v9
v_sub_f32 v98, v98, v9
v_sub_f32 v99, v99, v9
v_accvgpr_read_b32 v13, a0
v_mul_f32 v13, v13, v11
v_accvgpr_write_b32 a0, v13
v_accvgpr_read_b32 v13, a1
v_mul_f32 v13, v13, v11
v_accvgpr_write_b32 a1, v13
v_accvgpr_read_b32 v13, a2
v_mul_f32 v13, v13, v11
v_accvgpr_write_b32 a2, v13
v_accvgpr_read_b32 v13, a3
v_mul_f32 v13, v13, v11
v_accvgpr_write_b32 a3, v13
v_accvgpr_read_b32 v13, a8
v_mul_f32 v13, v13, v11
v_accvgpr_write_b32 a8, v13
v_accvgpr_read_b32 v13, a9
v_mul_f32 v13, v13, v11
v_accvgpr_write_b32 a9, v13
v_accvgpr_read_b32 v13, a10
v_mul_f32 v13, v13, v11
v_accvgpr_write_b32 a10, v13
v_accvgpr_read_b32 v13, a11
v_mul_f32 v13, v13, v11
v_accvgpr_write_b32 a11, v13
v_accvgpr_read_b32 v13, a16
v_mul_f32 v13, v13, v11
v_accvgpr_write_b32 a16, v13
v_accvgpr_read_b32 v13, a17
v_mul_f32 v13, v13, v11
v_accvgpr_write_b32 a17, v13
v_accvgpr_read_b32 v13, a18
v_mul_f32 v13, v13, v11
v_accvgpr_write_b32 a18, v13
v_accvgpr_read_b32 v13, a19
v_mul_f32 v13, v13, v11
v_accvgpr_write_b32 a19, v13
v_accvgpr_read_b32 v13, a24
v_mul_f32 v13, v13, v11
v_accvgpr_write_b32 a24, v13
v_accvgpr_read_b32 v13, a25
v_mul_f32 v13, v13, v11
v_accvgpr_write_b32 a25, v13
v_accvgpr_read_b32 v13, a26
v_mul_f32 v13, v13, v11
v_accvgpr_write_b32 a26, v13
v_accvgpr_read_b32 v13, a27
v_mul_f32 v13, v13, v11
v_accvgpr_write_b32 a27, v13
v_accvgpr_read_b32 v13, a32
v_mul_f32 v13, v13, v11
v_accvgpr_write_b32 a32, v13
v_accvgpr_read_b32 v13, a33
v_mul_f32 v13, v13, v11
v_accvgpr_write_b32 a33, v13
v_accvgpr_read_b32 v13, a34
v_mul_f32 v13, v13, v11
v_accvgpr_write_b32 a34, v13
v_accvgpr_read_b32 v13, a35
v_mul_f32 v13, v13, v11
v_accvgpr_write_b32 a35, v13
v_accvgpr_read_b32 v13, a40
v_mul_f32 v13, v13, v11
v_accvgpr_write_b32 a40, v13
v_accvgpr_read_b32 v13, a41
v_mul_f32 v13, v13, v11
v_accvgpr_write_b32 a41, v13
v_accvgpr_read_b32 v13, a42
v_mul_f32 v13, v13, v11
v_accvgpr_write_b32 a42, v13
v_accvgpr_read_b32 v13, a43
v_mul_f32 v13, v13, v11
v_accvgpr_write_b32 a43, v13
v_accvgpr_read_b32 v13, a48
v_mul_f32 v13, v13, v11
v_accvgpr_write_b32 a48, v13
v_accvgpr_read_b32 v13, a49
v_mul_f32 v13, v13, v11
v_accvgpr_write_b32 a49, v13
v_accvgpr_read_b32 v13, a50
v_mul_f32 v13, v13, v11
v_accvgpr_write_b32 a50, v13
v_accvgpr_read_b32 v13, a51
v_mul_f32 v13, v13, v11
v_accvgpr_write_b32 a51, v13
v_accvgpr_read_b32 v13, a56
v_mul_f32 v13, v13, v11
v_accvgpr_write_b32 a56, v13
v_accvgpr_read_b32 v13, a57
v_mul_f32 v13, v13, v11
v_accvgpr_write_b32 a57, v13
v_accvgpr_read_b32 v13, a58
v_mul_f32 v13, v13, v11
v_accvgpr_write_b32 a58, v13
v_accvgpr_read_b32 v13, a59
v_mul_f32 v13, v13, v11
v_accvgpr_write_b32 a59, v13
v_accvgpr_read_b32 v13, a64
v_mul_f32 v13, v13, v11
v_accvgpr_write_b32 a64, v13
v_accvgpr_read_b32 v13, a65
v_mul_f32 v13, v13, v11
v_accvgpr_write_b32 a65, v13
v_accvgpr_read_b32 v13, a66
v_mul_f32 v13, v13, v11
v_accvgpr_write_b32 a66, v13
v_accvgpr_read_b32 v13, a67
v_mul_f32 v13, v13, v11
v_accvgpr_write_b32 a67, v13
v_accvgpr_read_b32 v13, a72
v_mul_f32 v13, v13, v11
v_accvgpr_write_b32 a72, v13
v_accvgpr_read_b32 v13, a73
v_mul_f32 v13, v13, v11
v_accvgpr_write_b32 a73, v13
v_accvgpr_read_b32 v13, a74
v_mul_f32 v13, v13, v11
v_accvgpr_write_b32 a74, v13
v_accvgpr_read_b32 v13, a75
v_mul_f32 v13, v13, v11
v_accvgpr_write_b32 a75, v13
v_accvgpr_read_b32 v13, a80
v_mul_f32 v13, v13, v11
v_accvgpr_write_b32 a80, v13
v_accvgpr_read_b32 v13, a81
v_mul_f32 v13, v13, v11
v_accvgpr_write_b32 a81, v13
v_accvgpr_read_b32 v13, a82
v_mul_f32 v13, v13, v11
v_accvgpr_write_b32 a82, v13
v_accvgpr_read_b32 v13, a83
v_mul_f32 v13, v13, v11
v_accvgpr_write_b32 a83, v13
v_accvgpr_read_b32 v13, a88
v_mul_f32 v13, v13, v11
v_accvgpr_write_b32 a88, v13
v_accvgpr_read_b32 v13, a89
v_mul_f32 v13, v13, v11
v_accvgpr_write_b32 a89, v13
v_accvgpr_read_b32 v13, a90
v_mul_f32 v13, v13, v11
v_accvgpr_write_b32 a90, v13
v_accvgpr_read_b32 v13, a91
v_mul_f32 v13, v13, v11
v_accvgpr_write_b32 a91, v13
v_accvgpr_read_b32 v13, a96
v_mul_f32 v13, v13, v11
v_accvgpr_write_b32 a96, v13
v_accvgpr_read_b32 v13, a97
v_mul_f32 v13, v13, v11
v_accvgpr_write_b32 a97, v13
v_accvgpr_read_b32 v13, a98
v_mul_f32 v13, v13, v11
v_accvgpr_write_b32 a98, v13
v_accvgpr_read_b32 v13, a99
v_mul_f32 v13, v13, v11
v_accvgpr_write_b32 a99, v13
v_accvgpr_read_b32 v13, a104
v_mul_f32 v13, v13, v11
v_accvgpr_write_b32 a104, v13
v_accvgpr_read_b32 v13, a105
v_mul_f32 v13, v13, v11
v_accvgpr_write_b32 a105, v13
v_accvgpr_read_b32 v13, a106
v_mul_f32 v13, v13, v11
v_accvgpr_write_b32 a106, v13
v_accvgpr_read_b32 v13, a107
v_mul_f32 v13, v13, v11
v_accvgpr_write_b32 a107, v13
v_accvgpr_read_b32 v13, a112
v_mul_f32 v13, v13, v11
v_accvgpr_write_b32 a112, v13
v_accvgpr_read_b32 v13, a113
v_mul_f32 v13, v13, v11
v_accvgpr_write_b32 a113, v13
v_accvgpr_read_b32 v13, a114
v_mul_f32 v13, v13, v11
v_accvgpr_write_b32 a114, v13
v_accvgpr_read_b32 v13, a115
v_mul_f32 v13, v13, v11
v_accvgpr_write_b32 a115, v13
v_accvgpr_read_b32 v13, a120
v_mul_f32 v13, v13, v11
v_accvgpr_write_b32 a120, v13
v_accvgpr_read_b32 v13, a121
v_mul_f32 v13, v13, v11
v_accvgpr_write_b32 a121, v13
v_accvgpr_read_b32 v13, a122
v_mul_f32 v13, v13, v11
v_accvgpr_write_b32 a122, v13
v_accvgpr_read_b32 v13, a123
v_mul_f32 v13, v13, v11
v_accvgpr_write_b32 a123, v13
v_mul_f32 v29, v29, v12
v_sub_f32 v36, v36, v10
v_sub_f32 v37, v37, v10
v_sub_f32 v38, v38, v10
v_sub_f32 v39, v39, v10
v_sub_f32 v92, v92, v10
v_sub_f32 v93, v93, v10
v_sub_f32 v94, v94, v10
v_sub_f32 v95, v95, v10
v_sub_f32 v100, v100, v10
v_sub_f32 v101, v101, v10
v_sub_f32 v102, v102, v10
v_sub_f32 v103, v103, v10
v_accvgpr_read_b32 v13, a4
v_mul_f32 v13, v13, v12
v_accvgpr_write_b32 a4, v13
v_accvgpr_read_b32 v13, a5
v_mul_f32 v13, v13, v12
v_accvgpr_write_b32 a5, v13
v_accvgpr_read_b32 v13, a6
v_mul_f32 v13, v13, v12
v_accvgpr_write_b32 a6, v13
v_accvgpr_read_b32 v13, a7
v_mul_f32 v13, v13, v12
v_accvgpr_write_b32 a7, v13
v_accvgpr_read_b32 v13, a12
v_mul_f32 v13, v13, v12
v_accvgpr_write_b32 a12, v13
v_accvgpr_read_b32 v13, a13
v_mul_f32 v13, v13, v12
v_accvgpr_write_b32 a13, v13
v_accvgpr_read_b32 v13, a14
v_mul_f32 v13, v13, v12
v_accvgpr_write_b32 a14, v13
v_accvgpr_read_b32 v13, a15
v_mul_f32 v13, v13, v12
v_accvgpr_write_b32 a15, v13
v_accvgpr_read_b32 v13, a20
v_mul_f32 v13, v13, v12
v_accvgpr_write_b32 a20, v13
v_accvgpr_read_b32 v13, a21
v_mul_f32 v13, v13, v12
v_accvgpr_write_b32 a21, v13
v_accvgpr_read_b32 v13, a22
v_mul_f32 v13, v13, v12
v_accvgpr_write_b32 a22, v13
v_accvgpr_read_b32 v13, a23
v_mul_f32 v13, v13, v12
v_accvgpr_write_b32 a23, v13
v_accvgpr_read_b32 v13, a28
v_mul_f32 v13, v13, v12
v_accvgpr_write_b32 a28, v13
v_accvgpr_read_b32 v13, a29
v_mul_f32 v13, v13, v12
v_accvgpr_write_b32 a29, v13
v_accvgpr_read_b32 v13, a30
v_mul_f32 v13, v13, v12
v_accvgpr_write_b32 a30, v13
v_accvgpr_read_b32 v13, a31
v_mul_f32 v13, v13, v12
v_accvgpr_write_b32 a31, v13
v_accvgpr_read_b32 v13, a36
v_mul_f32 v13, v13, v12
v_accvgpr_write_b32 a36, v13
v_accvgpr_read_b32 v13, a37
v_mul_f32 v13, v13, v12
v_accvgpr_write_b32 a37, v13
v_accvgpr_read_b32 v13, a38
v_mul_f32 v13, v13, v12
v_accvgpr_write_b32 a38, v13
v_accvgpr_read_b32 v13, a39
v_mul_f32 v13, v13, v12
v_accvgpr_write_b32 a39, v13
v_accvgpr_read_b32 v13, a44
v_mul_f32 v13, v13, v12
v_accvgpr_write_b32 a44, v13
v_accvgpr_read_b32 v13, a45
v_mul_f32 v13, v13, v12
v_accvgpr_write_b32 a45, v13
v_accvgpr_read_b32 v13, a46
v_mul_f32 v13, v13, v12
v_accvgpr_write_b32 a46, v13
v_accvgpr_read_b32 v13, a47
v_mul_f32 v13, v13, v12
v_accvgpr_write_b32 a47, v13
v_accvgpr_read_b32 v13, a52
v_mul_f32 v13, v13, v12
v_accvgpr_write_b32 a52, v13
v_accvgpr_read_b32 v13, a53
v_mul_f32 v13, v13, v12
v_accvgpr_write_b32 a53, v13
v_accvgpr_read_b32 v13, a54
v_mul_f32 v13, v13, v12
v_accvgpr_write_b32 a54, v13
v_accvgpr_read_b32 v13, a55
v_mul_f32 v13, v13, v12
v_accvgpr_write_b32 a55, v13
v_accvgpr_read_b32 v13, a60
v_mul_f32 v13, v13, v12
v_accvgpr_write_b32 a60, v13
v_accvgpr_read_b32 v13, a61
v_mul_f32 v13, v13, v12
v_accvgpr_write_b32 a61, v13
v_accvgpr_read_b32 v13, a62
v_mul_f32 v13, v13, v12
v_accvgpr_write_b32 a62, v13
v_accvgpr_read_b32 v13, a63
v_mul_f32 v13, v13, v12
v_accvgpr_write_b32 a63, v13
v_accvgpr_read_b32 v13, a68
v_mul_f32 v13, v13, v12
v_accvgpr_write_b32 a68, v13
v_accvgpr_read_b32 v13, a69
v_mul_f32 v13, v13, v12
v_accvgpr_write_b32 a69, v13
v_accvgpr_read_b32 v13, a70
v_mul_f32 v13, v13, v12
v_accvgpr_write_b32 a70, v13
v_accvgpr_read_b32 v13, a71
v_mul_f32 v13, v13, v12
v_accvgpr_write_b32 a71, v13
v_accvgpr_read_b32 v13, a76
v_mul_f32 v13, v13, v12
v_accvgpr_write_b32 a76, v13
v_accvgpr_read_b32 v13, a77
v_mul_f32 v13, v13, v12
v_accvgpr_write_b32 a77, v13
v_accvgpr_read_b32 v13, a78
v_mul_f32 v13, v13, v12
v_accvgpr_write_b32 a78, v13
v_accvgpr_read_b32 v13, a79
v_mul_f32 v13, v13, v12
v_accvgpr_write_b32 a79, v13
v_accvgpr_read_b32 v13, a84
v_mul_f32 v13, v13, v12
v_accvgpr_write_b32 a84, v13
v_accvgpr_read_b32 v13, a85
v_mul_f32 v13, v13, v12
v_accvgpr_write_b32 a85, v13
v_accvgpr_read_b32 v13, a86
v_mul_f32 v13, v13, v12
v_accvgpr_write_b32 a86, v13
v_accvgpr_read_b32 v13, a87
v_mul_f32 v13, v13, v12
v_accvgpr_write_b32 a87, v13
v_accvgpr_read_b32 v13, a92
v_mul_f32 v13, v13, v12
v_accvgpr_write_b32 a92, v13
v_accvgpr_read_b32 v13, a93
v_mul_f32 v13, v13, v12
v_accvgpr_write_b32 a93, v13
v_accvgpr_read_b32 v13, a94
v_mul_f32 v13, v13, v12
v_accvgpr_write_b32 a94, v13
v_accvgpr_read_b32 v13, a95
v_mul_f32 v13, v13, v12
v_accvgpr_write_b32 a95, v13
v_accvgpr_read_b32 v13, a100
v_mul_f32 v13, v13, v12
v_accvgpr_write_b32 a100, v13
v_accvgpr_read_b32 v13, a101
v_mul_f32 v13, v13, v12
v_accvgpr_write_b32 a101, v13
v_accvgpr_read_b32 v13, a102
v_mul_f32 v13, v13, v12
v_accvgpr_write_b32 a102, v13
v_accvgpr_read_b32 v13, a103
v_mul_f32 v13, v13, v12
v_accvgpr_write_b32 a103, v13
v_accvgpr_read_b32 v13, a108
v_mul_f32 v13, v13, v12
v_accvgpr_write_b32 a108, v13
v_accvgpr_read_b32 v13, a109
v_mul_f32 v13, v13, v12
v_accvgpr_write_b32 a109, v13
v_accvgpr_read_b32 v13, a110
v_mul_f32 v13, v13, v12
v_accvgpr_write_b32 a110, v13
v_accvgpr_read_b32 v13, a111
v_mul_f32 v13, v13, v12
v_accvgpr_write_b32 a111, v13
v_accvgpr_read_b32 v13, a116
v_mul_f32 v13, v13, v12
v_accvgpr_write_b32 a116, v13
v_accvgpr_read_b32 v13, a117
v_mul_f32 v13, v13, v12
v_accvgpr_write_b32 a117, v13
v_accvgpr_read_b32 v13, a118
v_mul_f32 v13, v13, v12
v_accvgpr_write_b32 a118, v13
v_accvgpr_read_b32 v13, a119
v_mul_f32 v13, v13, v12
v_accvgpr_write_b32 a119, v13
v_accvgpr_read_b32 v13, a124
v_mul_f32 v13, v13, v12
v_accvgpr_write_b32 a124, v13
v_accvgpr_read_b32 v13, a125
v_mul_f32 v13, v13, v12
v_accvgpr_write_b32 a125, v13
v_accvgpr_read_b32 v13, a126
v_mul_f32 v13, v13, v12
v_accvgpr_write_b32 a126, v13
v_accvgpr_read_b32 v13, a127
v_mul_f32 v13, v13, v12
v_accvgpr_write_b32 a127, v13
v_exp_f32 v104, v88
v_exp_f32 v105, v89
v_exp_f32 v106, v90
v_exp_f32 v107, v91
v_exp_f32 v112, v96
v_exp_f32 v113, v97
v_exp_f32 v114, v98
v_exp_f32 v115, v99
v_exp_f32 v108, v92
v_exp_f32 v109, v93
v_exp_f32 v110, v94
v_exp_f32 v111, v95
v_exp_f32 v116, v100
v_exp_f32 v117, v101
v_exp_f32 v118, v102
v_exp_f32 v119, v103
s_nop 0
v_cvt_pk_bf16_f32 v128, v104, v105
v_add_f32 v200, v104, v105
v_cvt_pk_bf16_f32 v129, v106, v107
v_add_f32 v201, v106, v107
v_add_f32 v200, v200, v201
v_cvt_pk_bf16_f32 v130, v112, v113
v_add_f32 v201, v112, v113
v_cvt_pk_bf16_f32 v131, v114, v115
v_add_f32 v200, v200, v201
v_add_f32 v201, v114, v115
v_add_f32 v30, v200, v201
v_cvt_pk_bf16_f32 v132, v108, v109
v_add_f32 v202, v108, v109
v_cvt_pk_bf16_f32 v133, v110, v111
v_add_f32 v203, v110, v111
v_add_f32 v202, v202, v203
v_cvt_pk_bf16_f32 v134, v116, v117
v_add_f32 v203, v116, v117
v_cvt_pk_bf16_f32 v135, v118, v119
v_add_f32 v202, v202, v203
v_add_f32 v203, v118, v119
v_add_f32 v31, v202, v203
s_nop 1
s_branch K2A_BACKL3
K2A_DONE:
s_cmp_eq_u32 s61, 1
s_cbranch_scc1 K2_BLO
s_cmp_eq_u32 s61, 2
s_cbranch_scc1 K2_MERGE
s_cmp_eq_u32 s65, 0
s_cselect_b32 s82, 0, 1605632
s_cselect_b32 s86, 0, 1605632
s_lshr_b32 s51, s66, 4
s_and_b32 s35, s66, 15
s_lshl_b32 s52, s35, 3
s_lshl_b32 s33, s30, 1
s_add_u32 s52, s52, s33
s_mul_i32 s60, s52, 14336
s_mul_i32 s53, s30, 57344
s_lshl_b32 s33, s51, 8
s_add_u32 s53, s53, s33
s_add_u32 s47, s53, 0
s_add_u32 m0, s40, 0
s_nop 0
buffer_load_dwordx4 v204, s[80:83], s47 offen offset:0 lds
buffer_load_dwordx4 v205, s[80:83], s47 offen offset:1024 lds
buffer_load_dwordx4 v206, s[80:83], s47 offen offset:2048 lds
buffer_load_dwordx4 v207, s[80:83], s47 offen offset:3072 lds
s_add_u32 s47, s53, 0
s_add_u32 m0, s40, 16384
s_nop 0
buffer_load_dwordx4 v204, s[84:87], s47 offen offset:0 lds
buffer_load_dwordx4 v205, s[84:87], s47 offen offset:1024 lds
buffer_load_dwordx4 v206, s[84:87], s47 offen offset:2048 lds
buffer_load_dwordx4 v207, s[84:87], s47 offen offset:3072 lds
s_add_u32 s47, s60, 0
s_nop 0
buffer_load_dwordx4 v[72:75], v3, s[4:7], s47 offen offset:0 sc1
buffer_load_dwordx4 v[80:83], v3, s[4:7], s47 offen offset:1024 sc1
s_add_u32 s47, s60, 14336
s_nop 0
buffer_load_dwordx4 v[76:79], v3, s[4:7], s47 offen offset:0 sc1
buffer_load_dwordx4 v[84:87], v3, s[4:7], s47 offen offset:1024 sc1
s_add_u32 s47, s53, 229376
s_add_u32 m0, s40, 32768
s_nop 0
buffer_load_dwordx4 v204, s[80:83], s47 offen offset:0 lds
buffer_load_dwordx4 v205, s[80:83], s47 offen offset:1024 lds
buffer_load_dwordx4 v206, s[80:83], s47 offen offset:2048 lds
buffer_load_dwordx4 v207, s[80:83], s47 offen offset:3072 lds
s_add_u32 s47, s53, 229376
s_add_u32 m0, s40, 49152
s_nop 0
buffer_load_dwordx4 v204, s[84:87], s47 offen offset:0 lds
buffer_load_dwordx4 v205, s[84:87], s47 offen offset:1024 lds
buffer_load_dwordx4 v206, s[84:87], s47 offen offset:2048 lds
buffer_load_dwordx4 v207, s[84:87], s47 offen offset:3072 lds
s_add_u32 s47, s60, 2048
s_nop 0
buffer_load_dwordx4 v[88:91], v3, s[4:7], s47 offen offset:0 sc1
buffer_load_dwordx4 v[96:99], v3, s[4:7], s47 offen offset:1024 sc1
s_add_u32 s47, s60, 16384
s_nop 0
buffer_load_dwordx4 v[92:95], v3, s[4:7], s47 offen offset:0 sc1
buffer_load_dwordx4 v[100:103], v3, s[4:7], s47 offen offset:1024 sc1
s_nop 7
ds_bpermute_b32 v11, v4, v28
ds_bpermute_b32 v12, v4, v29
s_waitcnt lgkmcnt(0)
v_add_f32 v28, v28, v11
v_add_f32 v29, v29, v12
ds_bpermute_b32 v11, v5, v28
ds_bpermute_b32 v12, v5, v29
s_waitcnt lgkmcnt(0)
v_add_f32 v28, v28, v11
v_add_f32 v29, v29, v12
v_rcp_f32 v9, v28
v_rcp_f32 v10, v29
s_lshl_b32 s33, s62, 16
s_lshl_b32 s34, s30, 14
s_add_u32 s33, s33, s34
s_add_u32 s33, s33, 8388608
v_accvgpr_read_b32 v208, a0
v_accvgpr_read_b32 v209, a1
v_accvgpr_read_b32 v210, a2
v_accvgpr_read_b32 v211, a3
v_accvgpr_read_b32 v212, a8
v_accvgpr_read_b32 v213, a9
v_accvgpr_read_b32 v214, a10
v_accvgpr_read_b32 v215, a11
v_mul_f32 v208, v208, v9
v_mul_f32 v209, v209, v9
v_mul_f32 v210, v210, v9
v_mul_f32 v211, v211, v9
v_mul_f32 v212, v212, v9
v_mul_f32 v213, v213, v9
v_mul_f32 v214, v214, v9
v_mul_f32 v215, v215, v9
v_cvt_pk_bf16_f32 v216, v208, v209
v_cvt_pk_bf16_f32 v217, v210, v211
v_cvt_pk_bf16_f32 v218, v212, v213
v_cvt_pk_bf16_f32 v219, v214, v215
buffer_store_dwordx4 v[216:219], v3, s[68:71], s33 offen offset:0 sc1
v_accvgpr_read_b32 v220, a16
v_accvgpr_read_b32 v221, a17
v_accvgpr_read_b32 v222, a18
v_accvgpr_read_b32 v223, a19
v_accvgpr_read_b32 v224, a24
v_accvgpr_read_b32 v225, a25
v_accvgpr_read_b32 v226, a26
v_accvgpr_read_b32 v227, a27
v_mul_f32 v220, v220, v9
v_mul_f32 v221, v221, v9
v_mul_f32 v222, v222, v9
v_mul_f32 v223, v223, v9
v_mul_f32 v224, v224, v9
v_mul_f32 v225, v225, v9
v_mul_f32 v226, v226, v9
v_mul_f32 v227, v227, v9
v_cvt_pk_bf16_f32 v228, v220, v221
v_cvt_pk_bf16_f32 v229, v222, v223
v_cvt_pk_bf16_f32 v230, v224, v225
v_cvt_pk_bf16_f32 v231, v226, v227
buffer_store_dwordx4 v[228:231], v3, s[68:71], s33 offen offset:1024 sc1
v_accvgpr_read_b32 v232, a32
v_accvgpr_read_b32 v233, a33
v_accvgpr_read_b32 v234, a34
v_accvgpr_read_b32 v235, a35
v_accvgpr_read_b32 v236, a40
v_accvgpr_read_b32 v237, a41
v_accvgpr_read_b32 v238, a42
v_accvgpr_read_b32 v239, a43
v_mul_f32 v232, v232, v9
v_mul_f32 v233, v233, v9
v_mul_f32 v234, v234, v9
v_mul_f32 v235, v235, v9
v_mul_f32 v236, v236, v9
v_mul_f32 v237, v237, v9
v_mul_f32 v238, v238, v9
v_mul_f32 v239, v239, v9
v_cvt_pk_bf16_f32 v240, v232, v233
v_cvt_pk_bf16_f32 v241, v234, v235
v_cvt_pk_bf16_f32 v242, v236, v237
v_cvt_pk_bf16_f32 v243, v238, v239
buffer_store_dwordx4 v[240:243], v3, s[68:71], s33 offen offset:2048 sc1
v_accvgpr_read_b32 v244, a48
v_accvgpr_read_b32 v245, a49
v_accvgpr_read_b32 v246, a50
v_accvgpr_read_b32 v247, a51
v_accvgpr_read_b32 v248, a56
v_accvgpr_read_b32 v249, a57
v_accvgpr_read_b32 v250, a58
v_accvgpr_read_b32 v251, a59
v_mul_f32 v244, v244, v9
v_mul_f32 v245, v245, v9
v_mul_f32 v246, v246, v9
v_mul_f32 v247, v247, v9
v_mul_f32 v248, v248, v9
v_mul_f32 v249, v249, v9
v_mul_f32 v250, v250, v9
v_mul_f32 v251, v251, v9
v_cvt_pk_bf16_f32 v252, v244, v245
v_cvt_pk_bf16_f32 v253, v246, v247
v_cvt_pk_bf16_f32 v254, v248, v249
v_cvt_pk_bf16_f32 v255, v250, v251
buffer_store_dwordx4 v[252:255], v3, s[68:71], s33 offen offset:3072 sc1
v_accvgpr_read_b32 v208, a64
v_accvgpr_read_b32 v209, a65
v_accvgpr_read_b32 v210, a66
v_accvgpr_read_b32 v211, a67
v_accvgpr_read_b32 v212, a72
v_accvgpr_read_b32 v213, a73
v_accvgpr_read_b32 v214, a74
v_accvgpr_read_b32 v215, a75
v_mul_f32 v208, v208, v9
v_mul_f32 v209, v209, v9
v_mul_f32 v210, v210, v9
v_mul_f32 v211, v211, v9
v_mul_f32 v212, v212, v9
v_mul_f32 v213, v213, v9
v_mul_f32 v214, v214, v9
v_mul_f32 v215, v215, v9
v_cvt_pk_bf16_f32 v216, v208, v209
v_cvt_pk_bf16_f32 v217, v210, v211
v_cvt_pk_bf16_f32 v218, v212, v213
v_cvt_pk_bf16_f32 v219, v214, v215
s_add_u32 s33, s33, 4096
buffer_store_dwordx4 v[216:219], v3, s[68:71], s33 offen offset:0 sc1
v_accvgpr_read_b32 v220, a80
v_accvgpr_read_b32 v221, a81
v_accvgpr_read_b32 v222, a82
v_accvgpr_read_b32 v223, a83
v_accvgpr_read_b32 v224, a88
v_accvgpr_read_b32 v225, a89
v_accvgpr_read_b32 v226, a90
v_accvgpr_read_b32 v227, a91
v_mul_f32 v220, v220, v9
v_mul_f32 v221, v221, v9
v_mul_f32 v222, v222, v9
v_mul_f32 v223, v223, v9
v_mul_f32 v224, v224, v9
v_mul_f32 v225, v225, v9
v_mul_f32 v226, v226, v9
v_mul_f32 v227, v227, v9
v_cvt_pk_bf16_f32 v228, v220, v221
v_cvt_pk_bf16_f32 v229, v222, v223
v_cvt_pk_bf16_f32 v230, v224, v225
v_cvt_pk_bf16_f32 v231, v226, v227
buffer_store_dwordx4 v[228:231], v3, s[68:71], s33 offen offset:1024 sc1
v_accvgpr_read_b32 v232, a96
v_accvgpr_read_b32 v233, a97
v_accvgpr_read_b32 v234, a98
v_accvgpr_read_b32 v235, a99
v_accvgpr_read_b32 v236, a104
v_accvgpr_read_b32 v237, a105
v_accvgpr_read_b32 v238, a106
v_accvgpr_read_b32 v239, a107
v_mul_f32 v232, v232, v9
v_mul_f32 v233, v233, v9
v_mul_f32 v234, v234, v9
v_mul_f32 v235, v235, v9
v_mul_f32 v236, v236, v9
v_mul_f32 v237, v237, v9
v_mul_f32 v238, v238, v9
v_mul_f32 v239, v239, v9
v_cvt_pk_bf16_f32 v240, v232, v233
v_cvt_pk_bf16_f32 v241, v234, v235
v_cvt_pk_bf16_f32 v242, v236, v237
v_cvt_pk_bf16_f32 v243, v238, v239
buffer_store_dwordx4 v[240:243], v3, s[68:71], s33 offen offset:2048 sc1
v_accvgpr_read_b32 v244, a112
v_accvgpr_read_b32 v245, a113
v_accvgpr_read_b32 v246, a114
v_accvgpr_read_b32 v247, a115
v_accvgpr_read_b32 v248, a120
v_accvgpr_read_b32 v249, a121
v_accvgpr_read_b32 v250, a122
v_accvgpr_read_b32 v251, a123
v_mul_f32 v244, v244, v9
v_mul_f32 v245, v245, v9
v_mul_f32 v246, v246, v9
v_mul_f32 v247, v247, v9
v_mul_f32 v248, v248, v9
v_mul_f32 v249, v249, v9
v_mul_f32 v250, v250, v9
v_mul_f32 v251, v251, v9
v_cvt_pk_bf16_f32 v252, v244, v245
v_cvt_pk_bf16_f32 v253, v246, v247
v_cvt_pk_bf16_f32 v254, v248, v249
v_cvt_pk_bf16_f32 v255, v250, v251
buffer_store_dwordx4 v[252:255], v3, s[68:71], s33 offen offset:3072 sc1
s_add_u32 s33, s33, 4096
v_accvgpr_read_b32 v208, a4
v_accvgpr_read_b32 v209, a5
v_accvgpr_read_b32 v210, a6
v_accvgpr_read_b32 v211, a7
v_accvgpr_read_b32 v212, a12
v_accvgpr_read_b32 v213, a13
v_accvgpr_read_b32 v214, a14
v_accvgpr_read_b32 v215, a15
v_mul_f32 v208, v208, v10
v_mul_f32 v209, v209, v10
v_mul_f32 v210, v210, v10
v_mul_f32 v211, v211, v10
v_mul_f32 v212, v212, v10
v_mul_f32 v213, v213, v10
v_mul_f32 v214, v214, v10
v_mul_f32 v215, v215, v10
v_cvt_pk_bf16_f32 v216, v208, v209
v_cvt_pk_bf16_f32 v217, v210, v211
v_cvt_pk_bf16_f32 v218, v212, v213
v_cvt_pk_bf16_f32 v219, v214, v215
buffer_store_dwordx4 v[216:219], v3, s[68:71], s33 offen offset:0 sc1
v_accvgpr_read_b32 v220, a20
v_accvgpr_read_b32 v221, a21
v_accvgpr_read_b32 v222, a22
v_accvgpr_read_b32 v223, a23
v_accvgpr_read_b32 v224, a28
v_accvgpr_read_b32 v225, a29
v_accvgpr_read_b32 v226, a30
v_accvgpr_read_b32 v227, a31
v_mul_f32 v220, v220, v10
v_mul_f32 v221, v221, v10
v_mul_f32 v222, v222, v10
v_mul_f32 v223, v223, v10
v_mul_f32 v224, v224, v10
v_mul_f32 v225, v225, v10
v_mul_f32 v226, v226, v10
v_mul_f32 v227, v227, v10
v_cvt_pk_bf16_f32 v228, v220, v221
v_cvt_pk_bf16_f32 v229, v222, v223
v_cvt_pk_bf16_f32 v230, v224, v225
v_cvt_pk_bf16_f32 v231, v226, v227
buffer_store_dwordx4 v[228:231], v3, s[68:71], s33 offen offset:1024 sc1
v_accvgpr_read_b32 v232, a36
v_accvgpr_read_b32 v233, a37
v_accvgpr_read_b32 v234, a38
v_accvgpr_read_b32 v235, a39
v_accvgpr_read_b32 v236, a44
v_accvgpr_read_b32 v237, a45
v_accvgpr_read_b32 v238, a46
v_accvgpr_read_b32 v239, a47
v_mul_f32 v232, v232, v10
v_mul_f32 v233, v233, v10
v_mul_f32 v234, v234, v10
v_mul_f32 v235, v235, v10
v_mul_f32 v236, v236, v10
v_mul_f32 v237, v237, v10
v_mul_f32 v238, v238, v10
v_mul_f32 v239, v239, v10
v_cvt_pk_bf16_f32 v240, v232, v233
v_cvt_pk_bf16_f32 v241, v234, v235
v_cvt_pk_bf16_f32 v242, v236, v237
v_cvt_pk_bf16_f32 v243, v238, v239
buffer_store_dwordx4 v[240:243], v3, s[68:71], s33 offen offset:2048 sc1
v_accvgpr_read_b32 v244, a52
v_accvgpr_read_b32 v245, a53
v_accvgpr_read_b32 v246, a54
v_accvgpr_read_b32 v247, a55
v_accvgpr_read_b32 v248, a60
v_accvgpr_read_b32 v249, a61
v_accvgpr_read_b32 v250, a62
v_accvgpr_read_b32 v251, a63
v_mul_f32 v244, v244, v10
v_mul_f32 v245, v245, v10
v_mul_f32 v246, v246, v10
v_mul_f32 v247, v247, v10
v_mul_f32 v248, v248, v10
v_mul_f32 v249, v249, v10
v_mul_f32 v250, v250, v10
v_mul_f32 v251, v251, v10
v_cvt_pk_bf16_f32 v252, v244, v245
v_cvt_pk_bf16_f32 v253, v246, v247
v_cvt_pk_bf16_f32 v254, v248, v249
v_cvt_pk_bf16_f32 v255, v250, v251
buffer_store_dwordx4 v[252:255], v3, s[68:71], s33 offen offset:3072 sc1
v_accvgpr_read_b32 v208, a68
v_accvgpr_read_b32 v209, a69
v_accvgpr_read_b32 v210, a70
v_accvgpr_read_b32 v211, a71
v_accvgpr_read_b32 v212, a76
v_accvgpr_read_b32 v213, a77
v_accvgpr_read_b32 v214, a78
v_accvgpr_read_b32 v215, a79
v_mul_f32 v208, v208, v10
v_mul_f32 v209, v209, v10
v_mul_f32 v210, v210, v10
v_mul_f32 v211, v211, v10
v_mul_f32 v212, v212, v10
v_mul_f32 v213, v213, v10
v_mul_f32 v214, v214, v10
v_mul_f32 v215, v215, v10
v_cvt_pk_bf16_f32 v216, v208, v209
v_cvt_pk_bf16_f32 v217, v210, v211
v_cvt_pk_bf16_f32 v218, v212, v213
v_cvt_pk_bf16_f32 v219, v214, v215
s_add_u32 s33, s33, 4096
buffer_store_dwordx4 v[216:219], v3, s[68:71], s33 offen offset:0 sc1
v_accvgpr_read_b32 v220, a84
v_accvgpr_read_b32 v221, a85
v_accvgpr_read_b32 v222, a86
v_accvgpr_read_b32 v223, a87
v_accvgpr_read_b32 v224, a92
v_accvgpr_read_b32 v225, a93
v_accvgpr_read_b32 v226, a94
v_accvgpr_read_b32 v227, a95
v_mul_f32 v220, v220, v10
v_mul_f32 v221, v221, v10
v_mul_f32 v222, v222, v10
v_mul_f32 v223, v223, v10
v_mul_f32 v224, v224, v10
v_mul_f32 v225, v225, v10
v_mul_f32 v226, v226, v10
v_mul_f32 v227, v227, v10
v_cvt_pk_bf16_f32 v228, v220, v221
v_cvt_pk_bf16_f32 v229, v222, v223
v_cvt_pk_bf16_f32 v230, v224, v225
v_cvt_pk_bf16_f32 v231, v226, v227
buffer_store_dwordx4 v[228:231], v3, s[68:71], s33 offen offset:1024 sc1
v_accvgpr_read_b32 v232, a100
v_accvgpr_read_b32 v233, a101
v_accvgpr_read_b32 v234, a102
v_accvgpr_read_b32 v235, a103
v_accvgpr_read_b32 v236, a108
v_accvgpr_read_b32 v237, a109
v_accvgpr_read_b32 v238, a110
v_accvgpr_read_b32 v239, a111
v_mul_f32 v232, v232, v10
v_mul_f32 v233, v233, v10
v_mul_f32 v234, v234, v10
v_mul_f32 v235, v235, v10
v_mul_f32 v236, v236, v10
v_mul_f32 v237, v237, v10
v_mul_f32 v238, v238, v10
v_mul_f32 v239, v239, v10
v_cvt_pk_bf16_f32 v240, v232, v233
v_cvt_pk_bf16_f32 v241, v234, v235
v_cvt_pk_bf16_f32 v242, v236, v237
v_cvt_pk_bf16_f32 v243, v238, v239
buffer_store_dwordx4 v[240:243], v3, s[68:71], s33 offen offset:2048 sc1
v_accvgpr_read_b32 v244, a116
v_accvgpr_read_b32 v245, a117
v_accvgpr_read_b32 v246, a118
v_accvgpr_read_b32 v247, a119
v_accvgpr_read_b32 v248, a124
v_accvgpr_read_b32 v249, a125
v_accvgpr_read_b32 v250, a126
v_accvgpr_read_b32 v251, a127
v_mul_f32 v244, v244, v10
v_mul_f32 v245, v245, v10
v_mul_f32 v246, v246, v10
v_mul_f32 v247, v247, v10
v_mul_f32 v248, v248, v10
v_mul_f32 v249, v249, v10
v_mul_f32 v250, v250, v10
v_mul_f32 v251, v251, v10
v_cvt_pk_bf16_f32 v252, v244, v245
v_cvt_pk_bf16_f32 v253, v246, v247
v_cvt_pk_bf16_f32 v254, v248, v249
v_cvt_pk_bf16_f32 v255, v250, v251
buffer_store_dwordx4 v[252:255], v3, s[68:71], s33 offen offset:3072 sc1
s_add_u32 s33, s33, 4096
v_mov_b32 v208, v32
v_mov_b32 v209, v36
v_mov_b32 v210, v28
v_mov_b32 v211, v29
s_lshl_b32 s33, s62, 12
s_lshl_b32 s34, s30, 10
s_add_u32 s33, s33, s34
s_add_u32 s33, s33, 16777216
buffer_store_dwordx4 v[208:211], v3, s[68:71], s33 offen sc1
s_mov_b32 s50, 1
K2_GU:
s_mov_b32 s67, s51
s_mov_b32 s49, s52
s_mov_b32 s45, s53
s_mov_b32 s48, s60
s_sub_u32 s65, s65, 1
s_add_u32 s66, s66, 16
s_add_u32 s47, s45, 458752
s_add_u32 m0, s40, 65536
s_nop 0
buffer_load_dwordx4 v204, s[80:83], s47 offen offset:0 lds
buffer_load_dwordx4 v205, s[80:83], s47 offen offset:1024 lds
buffer_load_dwordx4 v206, s[80:83], s47 offen offset:2048 lds
buffer_load_dwordx4 v207, s[80:83], s47 offen offset:3072 lds
s_add_u32 s47, s45, 458752
s_add_u32 m0, s40, 81920
s_nop 0
buffer_load_dwordx4 v204, s[84:87], s47 offen offset:0 lds
buffer_load_dwordx4 v205, s[84:87], s47 offen offset:1024 lds
buffer_load_dwordx4 v206, s[84:87], s47 offen offset:2048 lds
buffer_load_dwordx4 v207, s[84:87], s47 offen offset:3072 lds
s_add_u32 s47, s48, 4096
s_nop 0
buffer_load_dwordx4 v[104:107], v3, s[4:7], s47 offen offset:0 sc1
buffer_load_dwordx4 v[112:115], v3, s[4:7], s47 offen offset:1024 sc1
s_add_u32 s47, s48, 18432
s_nop 0
buffer_load_dwordx4 v[108:111], v3, s[4:7], s47 offen offset:0 sc1
buffer_load_dwordx4 v[116:119], v3, s[4:7], s47 offen offset:1024 sc1
s_waitcnt vmcnt(32)
s_barrier
ds_read_b64_tr_b16 v[40:41], v20 offset:0
ds_read_b64_tr_b16 v[42:43], v20 offset:1024
ds_read_b64_tr_b16 v[44:45], v21 offset:0
ds_read_b64_tr_b16 v[46:47], v21 offset:1024
ds_read_b64_tr_b16 v[48:49], v22 offset:0
ds_read_b64_tr_b16 v[50:51], v22 offset:1024
ds_read_b64_tr_b16 v[52:53], v23 offset:0
ds_read_b64_tr_b16 v[54:55], v23 offset:1024
ds_read_b64_tr_b16 v[56:57], v24 offset:0
ds_read_b64_tr_b16 v[58:59], v24 offset:1024
ds_read_b64_tr_b16 v[60:61], v25 offset:0
ds_read_b64_tr_b16 v[62:63], v25 offset:1024
s_cmp_eq_u32 s50, 1
s_cbranch_scc0 K2_W8
s_waitcnt vmcnt(29)
s_branch K2_W9
K2_W8:
s_waitcnt vmcnt(20)
K2_W9:
s_barrier
s_waitcnt lgkmcnt(10)
v_mfma_f32_16x16x32_bf16 a[0:3], v[40:43], v[72:75], 0
s_waitcnt lgkmcnt(8)
ds_read_b64_tr_b16 v[64:65], v26 offset:0
ds_read_b64_tr_b16 v[66:67], v26 offset:1024
v_mfma_f32_16x16x32_bf16 a[4:7], v[40:43], v[76:79], 0
s_add_u32 s47, s45, 688128
s_add_u32 m0, s40, 98304
v_mfma_f32_16x16x32_bf16 a[8:11], v[44:47], v[72:75], 0
s_waitcnt lgkmcnt(8)
ds_read_b64_tr_b16 v[68:69], v27 offset:0
ds_read_b64_tr_b16 v[70:71], v27 offset:1024
v_mfma_f32_16x16x32_bf16 a[12:15], v[44:47], v[76:79], 0
buffer_load_dwordx4 v204, s[80:83], s47 offen offset:0 lds
v_mfma_f32_16x16x32_bf16 a[16:19], v[48:51], v[72:75], 0
s_waitcnt lgkmcnt(8)
ds_read_b64_tr_b16 v[40:41], v20 offset:16384
ds_read_b64_tr_b16 v[42:43], v20 offset:17408
v_mfma_f32_16x16x32_bf16 a[20:23], v[48:51], v[76:79], 0
v_mfma_f32_16x16x32_bf16 a[24:27], v[52:55], v[72:75], 0
s_waitcnt lgkmcnt(8)
ds_read_b64_tr_b16 v[44:45], v21 offset:16384
ds_read_b64_tr_b16 v[46:47], v21 offset:17408
v_mfma_f32_16x16x32_bf16 a[28:31], v[52:55], v[76:79], 0
buffer_load_dwordx4 v205, s[80:83], s47 offen offset:1024 lds
v_mfma_f32_16x16x32_bf16 a[32:35], v[56:59], v[72:75], 0
s_waitcnt lgkmcnt(8)
ds_read_b64_tr_b16 v[48:49], v22 offset:16384
ds_read_b64_tr_b16 v[50:51], v22 offset:17408
v_mfma_f32_16x16x32_bf16 a[36:39], v[56:59], v[76:79], 0
v_mfma_f32_16x16x32_bf16 a[40:43], v[60:63], v[72:75], 0
s_waitcnt lgkmcnt(8)
ds_read_b64_tr_b16 v[52:53], v23 offset:16384
ds_read_b64_tr_b16 v[54:55], v23 offset:17408
v_mfma_f32_16x16x32_bf16 a[44:47], v[60:63], v[76:79], 0
v_mfma_f32_16x16x32_bf16 a[48:51], v[64:67], v[72:75], 0
s_waitcnt lgkmcnt(8)
ds_read_b64_tr_b16 v[56:57], v24 offset:16384
ds_read_b64_tr_b16 v[58:59], v24 offset:17408
v_mfma_f32_16x16x32_bf16 a[52:55], v[64:67], v[76:79], 0
buffer_load_dwordx4 v206, s[80:83], s47 offen offset:2048 lds
v_mfma_f32_16x16x32_bf16 a[56:59], v[68:71], v[72:75], 0
s_waitcnt lgkmcnt(8)
ds_read_b64_tr_b16 v[60:61], v25 offset:16384
ds_read_b64_tr_b16 v[62:63], v25 offset:17408
v_mfma_f32_16x16x32_bf16 a[60:63], v[68:71], v[76:79], 0
v_mfma_f32_16x16x32_bf16 a[64:67], v[40:43], v[72:75], 0
s_waitcnt lgkmcnt(8)
ds_read_b64_tr_b16 v[64:65], v26 offset:16384
ds_read_b64_tr_b16 v[66:67], v26 offset:17408
v_mfma_f32_16x16x32_bf16 a[68:71], v[40:43], v[76:79], 0
buffer_load_dwordx4 v207, s[80:83], s47 offen offset:3072 lds
v_mfma_f32_16x16x32_bf16 a[72:75], v[44:47], v[72:75], 0
s_waitcnt lgkmcnt(8)
ds_read_b64_tr_b16 v[68:69], v27 offset:16384
ds_read_b64_tr_b16 v[70:71], v27 offset:17408
v_mfma_f32_16x16x32_bf16 a[76:79], v[44:47], v[76:79], 0
v_mfma_f32_16x16x32_bf16 a[80:83], v[48:51], v[72:75], 0
s_waitcnt lgkmcnt(8)
ds_read_b64_tr_b16 v[40:41], v20 offset:8192
ds_read_b64_tr_b16 v[42:43], v20 offset:9216
v_mfma_f32_16x16x32_bf16 a[84:87], v[48:51], v[76:79], 0
s_add_u32 s47, s45, 688128
s_add_u32 m0, s40, 114688
v_mfma_f32_16x16x32_bf16 a[88:91], v[52:55], v[72:75], 0
s_waitcnt lgkmcnt(8)
ds_read_b64_tr_b16 v[44:45], v21 offset:8192
ds_read_b64_tr_b16 v[46:47], v21 offset:9216
v_mfma_f32_16x16x32_bf16 a[92:95], v[52:55], v[76:79], 0
buffer_load_dwordx4 v204, s[84:87], s47 offen offset:0 lds
v_mfma_f32_16x16x32_bf16 a[96:99], v[56:59], v[72:75], 0
s_waitcnt lgkmcnt(8)
ds_read_b64_tr_b16 v[48:49], v22 offset:8192
ds_read_b64_tr_b16 v[50:51], v22 offset:9216
v_mfma_f32_16x16x32_bf16 a[100:103], v[56:59], v[76:79], 0
v_mfma_f32_16x16x32_bf16 a[104:107], v[60:63], v[72:75], 0
s_waitcnt lgkmcnt(8)
ds_read_b64_tr_b16 v[52:53], v23 offset:8192
ds_read_b64_tr_b16 v[54:55], v23 offset:9216
v_mfma_f32_16x16x32_bf16 a[108:111], v[60:63], v[76:79], 0
v_mfma_f32_16x16x32_bf16 a[112:115], v[64:67], v[72:75], 0
s_waitcnt lgkmcnt(8)
ds_read_b64_tr_b16 v[56:57], v24 offset:8192
ds_read_b64_tr_b16 v[58:59], v24 offset:9216
v_mfma_f32_16x16x32_bf16 a[116:119], v[64:67], v[76:79], 0
buffer_load_dwordx4 v205, s[84:87], s47 offen offset:1024 lds
v_mfma_f32_16x16x32_bf16 a[120:123], v[68:71], v[72:75], 0
s_waitcnt lgkmcnt(8)
ds_read_b64_tr_b16 v[60:61], v25 offset:8192
ds_read_b64_tr_b16 v[62:63], v25 offset:9216
v_mfma_f32_16x16x32_bf16 a[124:127], v[68:71], v[76:79], 0
v_mfma_f32_16x16x32_bf16 a[0:3], v[40:43], v[80:83], a[0:3]
s_waitcnt lgkmcnt(8)
ds_read_b64_tr_b16 v[64:65], v26 offset:8192
ds_read_b64_tr_b16 v[66:67], v26 offset:9216
v_mfma_f32_16x16x32_bf16 a[4:7], v[40:43], v[84:87], a[4:7]
buffer_load_dwordx4 v206, s[84:87], s47 offen offset:2048 lds
v_mfma_f32_16x16x32_bf16 a[8:11], v[44:47], v[80:83], a[8:11]
s_waitcnt lgkmcnt(8)
ds_read_b64_tr_b16 v[68:69], v27 offset:8192
ds_read_b64_tr_b16 v[70:71], v27 offset:9216
v_mfma_f32_16x16x32_bf16 a[12:15], v[44:47], v[84:87], a[12:15]
v_mfma_f32_16x16x32_bf16 a[16:19], v[48:51], v[80:83], a[16:19]
s_waitcnt lgkmcnt(8)
ds_read_b64_tr_b16 v[40:41], v20 offset:24576
ds_read_b64_tr_b16 v[42:43], v20 offset:25600
v_mfma_f32_16x16x32_bf16 a[20:23], v[48:51], v[84:87], a[20:23]
v_mfma_f32_16x16x32_bf16 a[24:27], v[52:55], v[80:83], a[24:27]
s_waitcnt lgkmcnt(8)
ds_read_b64_tr_b16 v[44:45], v21 offset:24576
ds_read_b64_tr_b16 v[46:47], v21 offset:25600
v_mfma_f32_16x16x32_bf16 a[28:31], v[52:55], v[84:87], a[28:31]
buffer_load_dwordx4 v207, s[84:87], s47 offen offset:3072 lds
v_mfma_f32_16x16x32_bf16 a[32:35], v[56:59], v[80:83], a[32:35]
s_waitcnt lgkmcnt(8)
ds_read_b64_tr_b16 v[48:49], v22 offset:24576
ds_read_b64_tr_b16 v[50:51], v22 offset:25600
v_mfma_f32_16x16x32_bf16 a[36:39], v[56:59], v[84:87], a[36:39]
v_mfma_f32_16x16x32_bf16 a[40:43], v[60:63], v[80:83], a[40:43]
s_waitcnt lgkmcnt(8)
ds_read_b64_tr_b16 v[52:53], v23 offset:24576
ds_read_b64_tr_b16 v[54:55], v23 offset:25600
v_mfma_f32_16x16x32_bf16 a[44:47], v[60:63], v[84:87], a[44:47]
s_add_u32 s47, s48, 6144
v_mfma_f32_16x16x32_bf16 a[48:51], v[64:67], v[80:83], a[48:51]
s_waitcnt lgkmcnt(8)
ds_read_b64_tr_b16 v[56:57], v24 offset:24576
ds_read_b64_tr_b16 v[58:59], v24 offset:25600
v_mfma_f32_16x16x32_bf16 a[52:55], v[64:67], v[84:87], a[52:55]
buffer_load_dwordx4 v[120:123], v3, s[4:7], s47 offen offset:0 sc1
v_mfma_f32_16x16x32_bf16 a[56:59], v[68:71], v[80:83], a[56:59]
s_waitcnt lgkmcnt(8)
ds_read_b64_tr_b16 v[60:61], v25 offset:24576
ds_read_b64_tr_b16 v[62:63], v25 offset:25600
v_mfma_f32_16x16x32_bf16 a[60:63], v[68:71], v[84:87], a[60:63]
v_mfma_f32_16x16x32_bf16 a[64:67], v[40:43], v[80:83], a[64:67]
s_waitcnt lgkmcnt(8)
ds_read_b64_tr_b16 v[64:65], v26 offset:24576
ds_read_b64_tr_b16 v[66:67], v26 offset:25600
v_mfma_f32_16x16x32_bf16 a[68:71], v[40:43], v[84:87], a[68:71]
buffer_load_dwordx4 v[128:131], v3, s[4:7], s47 offen offset:1024 sc1
v_mfma_f32_16x16x32_bf16 a[72:75], v[44:47], v[80:83], a[72:75]
s_waitcnt lgkmcnt(8)
ds_read_b64_tr_b16 v[68:69], v27 offset:24576
ds_read_b64_tr_b16 v[70:71], v27 offset:25600
v_mfma_f32_16x16x32_bf16 a[76:79], v[44:47], v[84:87], a[76:79]
v_mfma_f32_16x16x32_bf16 a[80:83], v[48:51], v[80:83], a[80:83]
s_waitcnt lgkmcnt(8)
ds_read_b64_tr_b16 v[40:41], v20 offset:32768
ds_read_b64_tr_b16 v[42:43], v20 offset:33792
v_mfma_f32_16x16x32_bf16 a[84:87], v[48:51], v[84:87], a[84:87]
s_add_u32 s47, s48, 20480
v_mfma_f32_16x16x32_bf16 a[88:91], v[52:55], v[80:83], a[88:91]
s_waitcnt lgkmcnt(8)
ds_read_b64_tr_b16 v[44:45], v21 offset:32768
ds_read_b64_tr_b16 v[46:47], v21 offset:33792
v_mfma_f32_16x16x32_bf16 a[92:95], v[52:55], v[84:87], a[92:95]
buffer_load_dwordx4 v[124:127], v3, s[4:7], s47 offen offset:0 sc1
v_mfma_f32_16x16x32_bf16 a[96:99], v[56:59], v[80:83], a[96:99]
s_waitcnt lgkmcnt(8)
ds_read_b64_tr_b16 v[48:49], v22 offset:32768
ds_read_b64_tr_b16 v[50:51], v22 offset:33792
v_mfma_f32_16x16x32_bf16 a[100:103], v[56:59], v[84:87], a[100:103]
v_mfma_f32_16x16x32_bf16 a[104:107], v[60:63], v[80:83], a[104:107]
s_waitcnt lgkmcnt(8)
ds_read_b64_tr_b16 v[52:53], v23 offset:32768
ds_read_b64_tr_b16 v[54:55], v23 offset:33792
v_mfma_f32_16x16x32_bf16 a[108:111], v[60:63], v[84:87], a[108:111]
v_mfma_f32_16x16x32_bf16 a[112:115], v[64:67], v[80:83], a[112:115]
s_waitcnt lgkmcnt(8)
ds_read_b64_tr_b16 v[56:57], v24 offset:32768
ds_read_b64_tr_b16 v[58:59], v24 offset:33792
v_mfma_f32_16x16x32_bf16 a[116:119], v[64:67], v[84:87], a[116:119]
buffer_load_dwordx4 v[132:135], v3, s[4:7], s47 offen offset:1024 sc1
v_mfma_f32_16x16x32_bf16 a[120:123], v[68:71], v[80:83], a[120:123]
s_waitcnt lgkmcnt(8)
ds_read_b64_tr_b16 v[60:61], v25 offset:32768
ds_read_b64_tr_b16 v[62:63], v25 offset:33792
v_mfma_f32_16x16x32_bf16 a[124:127], v[68:71], v[84:87], a[124:127]
s_waitcnt vmcnt(12)
s_barrier
s_cmp_eq_u32 s50, 0
s_cbranch_scc1 PH_10957
s_cmp_eq_u32 s50, 1
s_cbranch_scc0 PH_10957B
s_cmp_eq_u32 s30, 0
s_cbranch_scc0 FS_10961
s_lshl_b32 s33, s62, 9
s_add_u32 s33, s33, 256
v_mov_b32 v9, s33
v_mov_b32 v10, 1
v_cmp_eq_u32 s[78:79], 0, v2
s_and_saveexec_b64 s[76:77], s[78:79]
s_cbranch_execz FS_10961X
buffer_store_dword v10, v9, s[72:75], 0 offen sc1
FS_10961X:
s_mov_b64 exec, s[76:77]
FS_10961:
s_branch PH_10957C
PH_10957B:
s_cmp_eq_u32 s30, 0
s_cbranch_scc0 AR_10976
v_mov_b32 v9, s88
v_mov_b32 v10, 1
v_cmp_eq_u32 s[78:79], 0, v2
s_and_saveexec_b64 s[76:77], s[78:79]
s_cbranch_execz AR_10976X
buffer_atomic_add v10, v9, s[72:75], 0 offen
AR_10976X:
s_mov_b64 exec, s[76:77]
AR_10976:
PH_10957C:
s_mov_b32 s50, 0
PH_10957:
s_waitcnt lgkmcnt(10)
v_mfma_f32_16x16x32_bf16 a[0:3], v[40:43], v[88:91], a[0:3]
s_waitcnt lgkmcnt(8)
ds_read_b64_tr_b16 v[64:65], v26 offset:32768
ds_read_b64_tr_b16 v[66:67], v26 offset:33792
v_mfma_f32_16x16x32_bf16 a[4:7], v[40:43], v[92:95], a[4:7]
s_add_u32 s47, s45, 917504
s_add_u32 m0, s40, 0
v_mfma_f32_16x16x32_bf16 a[8:11], v[44:47], v[88:91], a[8:11]
s_waitcnt lgkmcnt(8)
ds_read_b64_tr_b16 v[68:69], v27 offset:32768
ds_read_b64_tr_b16 v[70:71], v27 offset:33792
v_mfma_f32_16x16x32_bf16 a[12:15], v[44:47], v[92:95], a[12:15]
buffer_load_dwordx4 v204, s[80:83], s47 offen offset:0 lds
v_mfma_f32_16x16x32_bf16 a[16:19], v[48:51], v[88:91], a[16:19]
s_waitcnt lgkmcnt(8)
ds_read_b64_tr_b16 v[40:41], v20 offset:49152
ds_read_b64_tr_b16 v[42:43], v20 offset:50176
v_mfma_f32_16x16x32_bf16 a[20:23], v[48:51], v[92:95], a[20:23]
v_mfma_f32_16x16x32_bf16 a[24:27], v[52:55], v[88:91], a[24:27]
s_waitcnt lgkmcnt(8)
ds_read_b64_tr_b16 v[44:45], v21 offset:49152
ds_read_b64_tr_b16 v[46:47], v21 offset:50176
v_mfma_f32_16x16x32_bf16 a[28:31], v[52:55], v[92:95], a[28:31]
buffer_load_dwordx4 v205, s[80:83], s47 offen offset:1024 lds
v_mfma_f32_16x16x32_bf16 a[32:35], v[56:59], v[88:91], a[32:35]
s_waitcnt lgkmcnt(8)
ds_read_b64_tr_b16 v[48:49], v22 offset:49152
ds_read_b64_tr_b16 v[50:51], v22 offset:50176
v_mfma_f32_16x16x32_bf16 a[36:39], v[56:59], v[92:95], a[36:39]
v_mfma_f32_16x16x32_bf16 a[40:43], v[60:63], v[88:91], a[40:43]
s_waitcnt lgkmcnt(8)
ds_read_b64_tr_b16 v[52:53], v23 offset:49152
ds_read_b64_tr_b16 v[54:55], v23 offset:50176
v_mfma_f32_16x16x32_bf16 a[44:47], v[60:63], v[92:95], a[44:47]
v_mfma_f32_16x16x32_bf16 a[48:51], v[64:67], v[88:91], a[48:51]
s_waitcnt lgkmcnt(8)
ds_read_b64_tr_b16 v[56:57], v24 offset:49152
ds_read_b64_tr_b16 v[58:59], v24 offset:50176
v_mfma_f32_16x16x32_bf16 a[52:55], v[64:67], v[92:95], a[52:55]
buffer_load_dwordx4 v206, s[80:83], s47 offen offset:2048 lds
v_mfma_f32_16x16x32_bf16 a[56:59], v[68:71], v[88:91], a[56:59]
s_waitcnt lgkmcnt(8)
ds_read_b64_tr_b16 v[60:61], v25 offset:49152
ds_read_b64_tr_b16 v[62:63], v25 offset:50176
v_mfma_f32_16x16x32_bf16 a[60:63], v[68:71], v[92:95], a[60:63]
v_mfma_f32_16x16x32_bf16 a[64:67], v[40:43], v[88:91], a[64:67]
s_waitcnt lgkmcnt(8)
ds_read_b64_tr_b16 v[64:65], v26 offset:49152
ds_read_b64_tr_b16 v[66:67], v26 offset:50176
v_mfma_f32_16x16x32_bf16 a[68:71], v[40:43], v[92:95], a[68:71]
buffer_load_dwordx4 v207, s[80:83], s47 offen offset:3072 lds
v_mfma_f32_16x16x32_bf16 a[72:75], v[44:47], v[88:91], a[72:75]
s_waitcnt lgkmcnt(8)
ds_read_b64_tr_b16 v[68:69], v27 offset:49152
ds_read_b64_tr_b16 v[70:71], v27 offset:50176
v_mfma_f32_16x16x32_bf16 a[76:79], v[44:47], v[92:95], a[76:79]
v_mfma_f32_16x16x32_bf16 a[80:83], v[48:51], v[88:91], a[80:83]
s_waitcnt lgkmcnt(8)
ds_read_b64_tr_b16 v[40:41], v20 offset:40960
ds_read_b64_tr_b16 v[42:43], v20 offset:41984
v_mfma_f32_16x16x32_bf16 a[84:87], v[48:51], v[92:95], a[84:87]
s_add_u32 s47, s45, 917504
s_add_u32 m0, s40, 16384
v_mfma_f32_16x16x32_bf16 a[88:91], v[52:55], v[88:91], a[88:91]
s_waitcnt lgkmcnt(8)
ds_read_b64_tr_b16 v[44:45], v21 offset:40960
ds_read_b64_tr_b16 v[46:47], v21 offset:41984
v_mfma_f32_16x16x32_bf16 a[92:95], v[52:55], v[92:95], a[92:95]
buffer_load_dwordx4 v204, s[84:87], s47 offen offset:0 lds
v_mfma_f32_16x16x32_bf16 a[96:99], v[56:59], v[88:91], a[96:99]
s_waitcnt lgkmcnt(8)
ds_read_b64_tr_b16 v[48:49], v22 offset:40960
ds_read_b64_tr_b16 v[50:51], v22 offset:41984
v_mfma_f32_16x16x32_bf16 a[100:103], v[56:59], v[92:95], a[100:103]
v_mfma_f32_16x16x32_bf16 a[104:107], v[60:63], v[88:91], a[104:107]
s_waitcnt lgkmcnt(8)
ds_read_b64_tr_b16 v[52:53], v23 offset:40960
ds_read_b64_tr_b16 v[54:55], v23 offset:41984
v_mfma_f32_16x16x32_bf16 a[108:111], v[60:63], v[92:95], a[108:111]
buffer_load_dwordx4 v205, s[84:87], s47 offen offset:1024 lds
v_mfma_f32_16x16x32_bf16 a[112:115], v[64:67], v[88:91], a[112:115]
s_waitcnt lgkmcnt(8)
ds_read_b64_tr_b16 v[56:57], v24 offset:40960
ds_read_b64_tr_b16 v[58:59], v24 offset:41984
v_mfma_f32_16x16x32_bf16 a[116:119], v[64:67], v[92:95], a[116:119]
v_mfma_f32_16x16x32_bf16 a[120:123], v[68:71], v[88:91], a[120:123]
s_waitcnt lgkmcnt(8)
ds_read_b64_tr_b16 v[60:61], v25 offset:40960
ds_read_b64_tr_b16 v[62:63], v25 offset:41984
v_mfma_f32_16x16x32_bf16 a[124:127], v[68:71], v[92:95], a[124:127]
v_mfma_f32_16x16x32_bf16 a[0:3], v[40:43], v[96:99], a[0:3]
s_waitcnt lgkmcnt(8)
ds_read_b64_tr_b16 v[64:65], v26 offset:40960
ds_read_b64_tr_b16 v[66:67], v26 offset:41984
v_mfma_f32_16x16x32_bf16 a[4:7], v[40:43], v[100:103], a[4:7]
buffer_load_dwordx4 v206, s[84:87], s47 offen offset:2048 lds
v_mfma_f32_16x16x32_bf16 a[8:11], v[44:47], v[96:99], a[8:11]
s_waitcnt lgkmcnt(8)
ds_read_b64_tr_b16 v[68:69], v27 offset:40960
ds_read_b64_tr_b16 v[70:71], v27 offset:41984
v_mfma_f32_16x16x32_bf16 a[12:15], v[44:47], v[100:103], a[12:15]
v_mfma_f32_16x16x32_bf16 a[16:19], v[48:51], v[96:99], a[16:19]
s_waitcnt lgkmcnt(8)
ds_read_b64_tr_b16 v[40:41], v20 offset:57344
ds_read_b64_tr_b16 v[42:43], v20 offset:58368
v_mfma_f32_16x16x32_bf16 a[20:23], v[48:51], v[100:103], a[20:23]
buffer_load_dwordx4 v207, s[84:87], s47 offen offset:3072 lds
v_mfma_f32_16x16x32_bf16 a[24:27], v[52:55], v[96:99], a[24:27]
s_waitcnt lgkmcnt(8)
ds_read_b64_tr_b16 v[44:45], v21 offset:57344
ds_read_b64_tr_b16 v[46:47], v21 offset:58368
v_mfma_f32_16x16x32_bf16 a[28:31], v[52:55], v[100:103], a[28:31]
v_mfma_f32_16x16x32_bf16 a[32:35], v[56:59], v[96:99], a[32:35]
s_waitcnt lgkmcnt(8)
ds_read_b64_tr_b16 v[48:49], v22 offset:57344
ds_read_b64_tr_b16 v[50:51], v22 offset:58368
v_mfma_f32_16x16x32_bf16 a[36:39], v[56:59], v[100:103], a[36:39]
s_add_u32 s47, s48, 8192
v_mfma_f32_16x16x32_bf16 a[40:43], v[60:63], v[96:99], a[40:43]
s_waitcnt lgkmcnt(8)
ds_read_b64_tr_b16 v[52:53], v23 offset:57344
ds_read_b64_tr_b16 v[54:55], v23 offset:58368
v_mfma_f32_16x16x32_bf16 a[44:47], v[60:63], v[100:103], a[44:47]
buffer_load_dwordx4 v[136:139], v3, s[4:7], s47 offen offset:0 sc1
v_mfma_f32_16x16x32_bf16 a[48:51], v[64:67], v[96:99], a[48:51]
s_waitcnt lgkmcnt(8)
ds_read_b64_tr_b16 v[56:57], v24 offset:57344
ds_read_b64_tr_b16 v[58:59], v24 offset:58368
v_mfma_f32_16x16x32_bf16 a[52:55], v[64:67], v[100:103], a[52:55]
v_mfma_f32_16x16x32_bf16 a[56:59], v[68:71], v[96:99], a[56:59]
s_waitcnt lgkmcnt(8)
ds_read_b64_tr_b16 v[60:61], v25 offset:57344
ds_read_b64_tr_b16 v[62:63], v25 offset:58368
v_mfma_f32_16x16x32_bf16 a[60:63], v[68:71], v[100:103], a[60:63]
buffer_load_dwordx4 v[144:147], v3, s[4:7], s47 offen offset:1024 sc1
v_mfma_f32_16x16x32_bf16 a[64:67], v[40:43], v[96:99], a[64:67]
s_waitcnt lgkmcnt(8)
ds_read_b64_tr_b16 v[64:65], v26 offset:57344
ds_read_b64_tr_b16 v[66:67], v26 offset:58368
v_mfma_f32_16x16x32_bf16 a[68:71], v[40:43], v[100:103], a[68:71]
v_mfma_f32_16x16x32_bf16 a[72:75], v[44:47], v[96:99], a[72:75]
s_waitcnt lgkmcnt(8)
ds_read_b64_tr_b16 v[68:69], v27 offset:57344
ds_read_b64_tr_b16 v[70:71], v27 offset:58368
v_mfma_f32_16x16x32_bf16 a[76:79], v[44:47], v[100:103], a[76:79]
v_add_u32 v20, 65536, v20
v_add_u32 v21, 65536, v21
v_add_u32 v22, 65536, v22
v_add_u32 v23, 65536, v23
v_add_u32 v24, 65536, v24
v_add_u32 v25, 65536, v25
v_add_u32 v26, 65536, v26
v_add_u32 v27, 65536, v27
v_mfma_f32_16x16x32_bf16 a[80:83], v[48:51], v[96:99], a[80:83]
s_waitcnt lgkmcnt(8)
ds_read_b64_tr_b16 v[40:41], v20 offset:0
ds_read_b64_tr_b16 v[42:43], v20 offset:1024
v_mfma_f32_16x16x32_bf16 a[84:87], v[48:51], v[100:103], a[84:87]
s_add_u32 s47, s48, 22528
v_mfma_f32_16x16x32_bf16 a[88:91], v[52:55], v[96:99], a[88:91]
s_waitcnt lgkmcnt(8)
ds_read_b64_tr_b16 v[44:45], v21 offset:0
ds_read_b64_tr_b16 v[46:47], v21 offset:1024
v_mfma_f32_16x16x32_bf16 a[92:95], v[52:55], v[100:103], a[92:95]
buffer_load_dwordx4 v[140:143], v3, s[4:7], s47 offen offset:0 sc1
v_mfma_f32_16x16x32_bf16 a[96:99], v[56:59], v[96:99], a[96:99]
s_waitcnt lgkmcnt(8)
ds_read_b64_tr_b16 v[48:49], v22 offset:0
ds_read_b64_tr_b16 v[50:51], v22 offset:1024
v_mfma_f32_16x16x32_bf16 a[100:103], v[56:59], v[100:103], a[100:103]
v_mfma_f32_16x16x32_bf16 a[104:107], v[60:63], v[96:99], a[104:107]
s_waitcnt lgkmcnt(8)
ds_read_b64_tr_b16 v[52:53], v23 offset:0
ds_read_b64_tr_b16 v[54:55], v23 offset:1024
v_mfma_f32_16x16x32_bf16 a[108:111], v[60:63], v[100:103], a[108:111]
v_mfma_f32_16x16x32_bf16 a[112:115], v[64:67], v[96:99], a[112:115]
s_waitcnt lgkmcnt(8)
ds_read_b64_tr_b16 v[56:57], v24 offset:0
ds_read_b64_tr_b16 v[58:59], v24 offset:1024
v_mfma_f32_16x16x32_bf16 a[116:119], v[64:67], v[100:103], a[116:119]
buffer_load_dwordx4 v[148:151], v3, s[4:7], s47 offen offset:1024 sc1
v_mfma_f32_16x16x32_bf16 a[120:123], v[68:71], v[96:99], a[120:123]
s_waitcnt lgkmcnt(8)
ds_read_b64_tr_b16 v[60:61], v25 offset:0
ds_read_b64_tr_b16 v[62:63], v25 offset:1024
v_mfma_f32_16x16x32_bf16 a[124:127], v[68:71], v[100:103], a[124:127]
s_waitcnt vmcnt(12)
s_barrier
s_waitcnt lgkmcnt(10)
v_mfma_f32_16x16x32_bf16 a[0:3], v[40:43], v[104:107], a[0:3]
s_waitcnt lgkmcnt(8)
ds_read_b64_tr_b16 v[64:65], v26 offset:0
ds_read_b64_tr_b16 v[66:67], v26 offset:1024
v_mfma_f32_16x16x32_bf16 a[4:7], v[40:43], v[108:111], a[4:7]
s_add_u32 s47, s45, 1146880
s_add_u32 m0, s40, 32768
v_mfma_f32_16x16x32_bf16 a[8:11], v[44:47], v[104:107], a[8:11]
s_waitcnt lgkmcnt(8)
ds_read_b64_tr_b16 v[68:69], v27 offset:0
ds_read_b64_tr_b16 v[70:71], v27 offset:1024
v_mfma_f32_16x16x32_bf16 a[12:15], v[44:47], v[108:111], a[12:15]
buffer_load_dwordx4 v204, s[80:83], s47 offen offset:0 lds
v_mfma_f32_16x16x32_bf16 a[16:19], v[48:51], v[104:107], a[16:19]
s_waitcnt lgkmcnt(8)
ds_read_b64_tr_b16 v[40:41], v20 offset:16384
ds_read_b64_tr_b16 v[42:43], v20 offset:17408
v_mfma_f32_16x16x32_bf16 a[20:23], v[48:51], v[108:111], a[20:23]
v_mfma_f32_16x16x32_bf16 a[24:27], v[52:55], v[104:107], a[24:27]
s_waitcnt lgkmcnt(8)
ds_read_b64_tr_b16 v[44:45], v21 offset:16384
ds_read_b64_tr_b16 v[46:47], v21 offset:17408
v_mfma_f32_16x16x32_bf16 a[28:31], v[52:55], v[108:111], a[28:31]
buffer_load_dwordx4 v205, s[80:83], s47 offen offset:1024 lds
v_mfma_f32_16x16x32_bf16 a[32:35], v[56:59], v[104:107], a[32:35]
s_waitcnt lgkmcnt(8)
ds_read_b64_tr_b16 v[48:49], v22 offset:16384
ds_read_b64_tr_b16 v[50:51], v22 offset:17408
v_mfma_f32_16x16x32_bf16 a[36:39], v[56:59], v[108:111], a[36:39]
v_mfma_f32_16x16x32_bf16 a[40:43], v[60:63], v[104:107], a[40:43]
s_waitcnt lgkmcnt(8)
ds_read_b64_tr_b16 v[52:53], v23 offset:16384
ds_read_b64_tr_b16 v[54:55], v23 offset:17408
v_mfma_f32_16x16x32_bf16 a[44:47], v[60:63], v[108:111], a[44:47]
v_mfma_f32_16x16x32_bf16 a[48:51], v[64:67], v[104:107], a[48:51]
s_waitcnt lgkmcnt(8)
ds_read_b64_tr_b16 v[56:57], v24 offset:16384
ds_read_b64_tr_b16 v[58:59], v24 offset:17408
v_mfma_f32_16x16x32_bf16 a[52:55], v[64:67], v[108:111], a[52:55]
buffer_load_dwordx4 v206, s[80:83], s47 offen offset:2048 lds
v_mfma_f32_16x16x32_bf16 a[56:59], v[68:71], v[104:107], a[56:59]
s_waitcnt lgkmcnt(8)
ds_read_b64_tr_b16 v[60:61], v25 offset:16384
ds_read_b64_tr_b16 v[62:63], v25 offset:17408
v_mfma_f32_16x16x32_bf16 a[60:63], v[68:71], v[108:111], a[60:63]
v_mfma_f32_16x16x32_bf16 a[64:67], v[40:43], v[104:107], a[64:67]
s_waitcnt lgkmcnt(8)
ds_read_b64_tr_b16 v[64:65], v26 offset:16384
ds_read_b64_tr_b16 v[66:67], v26 offset:17408
v_mfma_f32_16x16x32_bf16 a[68:71], v[40:43], v[108:111], a[68:71]
buffer_load_dwordx4 v207, s[80:83], s47 offen offset:3072 lds
v_mfma_f32_16x16x32_bf16 a[72:75], v[44:47], v[104:107], a[72:75]
s_waitcnt lgkmcnt(8)
ds_read_b64_tr_b16 v[68:69], v27 offset:16384
ds_read_b64_tr_b16 v[70:71], v27 offset:17408
v_mfma_f32_16x16x32_bf16 a[76:79], v[44:47], v[108:111], a[76:79]
v_mfma_f32_16x16x32_bf16 a[80:83], v[48:51], v[104:107], a[80:83]
s_waitcnt lgkmcnt(8)
ds_read_b64_tr_b16 v[40:41], v20 offset:8192
ds_read_b64_tr_b16 v[42:43], v20 offset:9216
v_mfma_f32_16x16x32_bf16 a[84:87], v[48:51], v[108:111], a[84:87]
s_add_u32 s47, s45, 1146880
s_add_u32 m0, s40, 49152
v_mfma_f32_16x16x32_bf16 a[88:91], v[52:55], v[104:107], a[88:91]
s_waitcnt lgkmcnt(8)
ds_read_b64_tr_b16 v[44:45], v21 offset:8192
ds_read_b64_tr_b16 v[46:47], v21 offset:9216
v_mfma_f32_16x16x32_bf16 a[92:95], v[52:55], v[108:111], a[92:95]
buffer_load_dwordx4 v204, s[84:87], s47 offen offset:0 lds
v_mfma_f32_16x16x32_bf16 a[96:99], v[56:59], v[104:107], a[96:99]
s_waitcnt lgkmcnt(8)
ds_read_b64_tr_b16 v[48:49], v22 offset:8192
ds_read_b64_tr_b16 v[50:51], v22 offset:9216
v_mfma_f32_16x16x32_bf16 a[100:103], v[56:59], v[108:111], a[100:103]
v_mfma_f32_16x16x32_bf16 a[104:107], v[60:63], v[104:107], a[104:107]
s_waitcnt lgkmcnt(8)
ds_read_b64_tr_b16 v[52:53], v23 offset:8192
ds_read_b64_tr_b16 v[54:55], v23 offset:9216
v_mfma_f32_16x16x32_bf16 a[108:111], v[60:63], v[108:111], a[108:111]
v_mfma_f32_16x16x32_bf16 a[112:115], v[64:67], v[104:107], a[112:115]
s_waitcnt lgkmcnt(8)
ds_read_b64_tr_b16 v[56:57], v24 offset:8192
ds_read_b64_tr_b16 v[58:59], v24 offset:9216
v_mfma_f32_16x16x32_bf16 a[116:119], v[64:67], v[108:111], a[116:119]
buffer_load_dwordx4 v205, s[84:87], s47 offen offset:1024 lds
v_mfma_f32_16x16x32_bf16 a[120:123], v[68:71], v[104:107], a[120:123]
s_waitcnt lgkmcnt(8)
ds_read_b64_tr_b16 v[60:61], v25 offset:8192
ds_read_b64_tr_b16 v[62:63], v25 offset:9216
v_mfma_f32_16x16x32_bf16 a[124:127], v[68:71], v[108:111], a[124:127]
v_mfma_f32_16x16x32_bf16 a[0:3], v[40:43], v[112:115], a[0:3]
s_waitcnt lgkmcnt(8)
ds_read_b64_tr_b16 v[64:65], v26 offset:8192
ds_read_b64_tr_b16 v[66:67], v26 offset:9216
v_mfma_f32_16x16x32_bf16 a[4:7], v[40:43], v[116:119], a[4:7]
buffer_load_dwordx4 v206, s[84:87], s47 offen offset:2048 lds
v_mfma_f32_16x16x32_bf16 a[8:11], v[44:47], v[112:115], a[8:11]
s_waitcnt lgkmcnt(8)
ds_read_b64_tr_b16 v[68:69], v27 offset:8192
ds_read_b64_tr_b16 v[70:71], v27 offset:9216
v_mfma_f32_16x16x32_bf16 a[12:15], v[44:47], v[116:119], a[12:15]
v_mfma_f32_16x16x32_bf16 a[16:19], v[48:51], v[112:115], a[16:19]
s_waitcnt lgkmcnt(8)
ds_read_b64_tr_b16 v[40:41], v20 offset:24576
ds_read_b64_tr_b16 v[42:43], v20 offset:25600
v_mfma_f32_16x16x32_bf16 a[20:23], v[48:51], v[116:119], a[20:23]
v_mfma_f32_16x16x32_bf16 a[24:27], v[52:55], v[112:115], a[24:27]
s_waitcnt lgkmcnt(8)
ds_read_b64_tr_b16 v[44:45], v21 offset:24576
ds_read_b64_tr_b16 v[46:47], v21 offset:25600
v_mfma_f32_16x16x32_bf16 a[28:31], v[52:55], v[116:119], a[28:31]
buffer_load_dwordx4 v207, s[84:87], s47 offen offset:3072 lds
v_mfma_f32_16x16x32_bf16 a[32:35], v[56:59], v[112:115], a[32:35]
s_waitcnt lgkmcnt(8)
ds_read_b64_tr_b16 v[48:49], v22 offset:24576
ds_read_b64_tr_b16 v[50:51], v22 offset:25600
v_mfma_f32_16x16x32_bf16 a[36:39], v[56:59], v[116:119], a[36:39]
v_mfma_f32_16x16x32_bf16 a[40:43], v[60:63], v[112:115], a[40:43]
s_waitcnt lgkmcnt(8)
ds_read_b64_tr_b16 v[52:53], v23 offset:24576
ds_read_b64_tr_b16 v[54:55], v23 offset:25600
v_mfma_f32_16x16x32_bf16 a[44:47], v[60:63], v[116:119], a[44:47]
s_add_u32 s47, s48, 10240
v_mfma_f32_16x16x32_bf16 a[48:51], v[64:67], v[112:115], a[48:51]
s_waitcnt lgkmcnt(8)
ds_read_b64_tr_b16 v[56:57], v24 offset:24576
ds_read_b64_tr_b16 v[58:59], v24 offset:25600
v_mfma_f32_16x16x32_bf16 a[52:55], v[64:67], v[116:119], a[52:55]
buffer_load_dwordx4 v[152:155], v3, s[4:7], s47 offen offset:0 sc1
v_mfma_f32_16x16x32_bf16 a[56:59], v[68:71], v[112:115], a[56:59]
s_waitcnt lgkmcnt(8)
ds_read_b64_tr_b16 v[60:61], v25 offset:24576
ds_read_b64_tr_b16 v[62:63], v25 offset:25600
v_mfma_f32_16x16x32_bf16 a[60:63], v[68:71], v[116:119], a[60:63]
v_mfma_f32_16x16x32_bf16 a[64:67], v[40:43], v[112:115], a[64:67]
s_waitcnt lgkmcnt(8)
ds_read_b64_tr_b16 v[64:65], v26 offset:24576
ds_read_b64_tr_b16 v[66:67], v26 offset:25600
v_mfma_f32_16x16x32_bf16 a[68:71], v[40:43], v[116:119], a[68:71]
buffer_load_dwordx4 v[160:163], v3, s[4:7], s47 offen offset:1024 sc1
v_mfma_f32_16x16x32_bf16 a[72:75], v[44:47], v[112:115], a[72:75]
s_waitcnt lgkmcnt(8)
ds_read_b64_tr_b16 v[68:69], v27 offset:24576
ds_read_b64_tr_b16 v[70:71], v27 offset:25600
v_mfma_f32_16x16x32_bf16 a[76:79], v[44:47], v[116:119], a[76:79]
v_mfma_f32_16x16x32_bf16 a[80:83], v[48:51], v[112:115], a[80:83]
s_waitcnt lgkmcnt(8)
ds_read_b64_tr_b16 v[40:41], v20 offset:32768
ds_read_b64_tr_b16 v[42:43], v20 offset:33792
v_mfma_f32_16x16x32_bf16 a[84:87], v[48:51], v[116:119], a[84:87]
s_add_u32 s47, s48, 24576
v_mfma_f32_16x16x32_bf16 a[88:91], v[52:55], v[112:115], a[88:91]
s_waitcnt lgkmcnt(8)
ds_read_b64_tr_b16 v[44:45], v21 offset:32768
ds_read_b64_tr_b16 v[46:47], v21 offset:33792
v_mfma_f32_16x16x32_bf16 a[92:95], v[52:55], v[116:119], a[92:95]
buffer_load_dwordx4 v[156:159], v3, s[4:7], s47 offen offset:0 sc1
v_mfma_f32_16x16x32_bf16 a[96:99], v[56:59], v[112:115], a[96:99]
s_waitcnt lgkmcnt(8)
ds_read_b64_tr_b16 v[48:49], v22 offset:32768
ds_read_b64_tr_b16 v[50:51], v22 offset:33792
v_mfma_f32_16x16x32_bf16 a[100:103], v[56:59], v[116:119], a[100:103]
v_mfma_f32_16x16x32_bf16 a[104:107], v[60:63], v[112:115], a[104:107]
s_waitcnt lgkmcnt(8)
ds_read_b64_tr_b16 v[52:53], v23 offset:32768
ds_read_b64_tr_b16 v[54:55], v23 offset:33792
v_mfma_f32_16x16x32_bf16 a[108:111], v[60:63], v[116:119], a[108:111]
v_mfma_f32_16x16x32_bf16 a[112:115], v[64:67], v[112:115], a[112:115]
s_waitcnt lgkmcnt(8)
ds_read_b64_tr_b16 v[56:57], v24 offset:32768
ds_read_b64_tr_b16 v[58:59], v24 offset:33792
v_mfma_f32_16x16x32_bf16 a[116:119], v[64:67], v[116:119], a[116:119]
buffer_load_dwordx4 v[164:167], v3, s[4:7], s47 offen offset:1024 sc1
v_mfma_f32_16x16x32_bf16 a[120:123], v[68:71], v[112:115], a[120:123]
s_waitcnt lgkmcnt(8)
ds_read_b64_tr_b16 v[60:61], v25 offset:32768
ds_read_b64_tr_b16 v[62:63], v25 offset:33792
v_mfma_f32_16x16x32_bf16 a[124:127], v[68:71], v[116:119], a[124:127]
s_waitcnt vmcnt(12)
s_barrier
s_waitcnt lgkmcnt(10)
v_mfma_f32_16x16x32_bf16 a[0:3], v[40:43], v[120:123], a[0:3]
s_waitcnt lgkmcnt(8)
ds_read_b64_tr_b16 v[64:65], v26 offset:32768
ds_read_b64_tr_b16 v[66:67], v26 offset:33792
v_mfma_f32_16x16x32_bf16 a[4:7], v[40:43], v[124:127], a[4:7]
s_add_u32 s47, s45, 1376256
s_add_u32 m0, s40, 65536
v_mfma_f32_16x16x32_bf16 a[8:11], v[44:47], v[120:123], a[8:11]
s_waitcnt lgkmcnt(8)
ds_read_b64_tr_b16 v[68:69], v27 offset:32768
ds_read_b64_tr_b16 v[70:71], v27 offset:33792
v_mfma_f32_16x16x32_bf16 a[12:15], v[44:47], v[124:127], a[12:15]
buffer_load_dwordx4 v204, s[80:83], s47 offen offset:0 lds
v_mfma_f32_16x16x32_bf16 a[16:19], v[48:51], v[120:123], a[16:19]
s_waitcnt lgkmcnt(8)
ds_read_b64_tr_b16 v[40:41], v20 offset:49152
ds_read_b64_tr_b16 v[42:43], v20 offset:50176
v_mfma_f32_16x16x32_bf16 a[20:23], v[48:51], v[124:127], a[20:23]
v_mfma_f32_16x16x32_bf16 a[24:27], v[52:55], v[120:123], a[24:27]
s_waitcnt lgkmcnt(8)
ds_read_b64_tr_b16 v[44:45], v21 offset:49152
ds_read_b64_tr_b16 v[46:47], v21 offset:50176
v_mfma_f32_16x16x32_bf16 a[28:31], v[52:55], v[124:127], a[28:31]
buffer_load_dwordx4 v205, s[80:83], s47 offen offset:1024 lds
v_mfma_f32_16x16x32_bf16 a[32:35], v[56:59], v[120:123], a[32:35]
s_waitcnt lgkmcnt(8)
ds_read_b64_tr_b16 v[48:49], v22 offset:49152
ds_read_b64_tr_b16 v[50:51], v22 offset:50176
v_mfma_f32_16x16x32_bf16 a[36:39], v[56:59], v[124:127], a[36:39]
v_mfma_f32_16x16x32_bf16 a[40:43], v[60:63], v[120:123], a[40:43]
s_waitcnt lgkmcnt(8)
ds_read_b64_tr_b16 v[52:53], v23 offset:49152
ds_read_b64_tr_b16 v[54:55], v23 offset:50176
v_mfma_f32_16x16x32_bf16 a[44:47], v[60:63], v[124:127], a[44:47]
v_mfma_f32_16x16x32_bf16 a[48:51], v[64:67], v[120:123], a[48:51]
s_waitcnt lgkmcnt(8)
ds_read_b64_tr_b16 v[56:57], v24 offset:49152
ds_read_b64_tr_b16 v[58:59], v24 offset:50176
v_mfma_f32_16x16x32_bf16 a[52:55], v[64:67], v[124:127], a[52:55]
buffer_load_dwordx4 v206, s[80:83], s47 offen offset:2048 lds
v_mfma_f32_16x16x32_bf16 a[56:59], v[68:71], v[120:123], a[56:59]
s_waitcnt lgkmcnt(8)
ds_read_b64_tr_b16 v[60:61], v25 offset:49152
ds_read_b64_tr_b16 v[62:63], v25 offset:50176
v_mfma_f32_16x16x32_bf16 a[60:63], v[68:71], v[124:127], a[60:63]
v_mfma_f32_16x16x32_bf16 a[64:67], v[40:43], v[120:123], a[64:67]
s_waitcnt lgkmcnt(8)
ds_read_b64_tr_b16 v[64:65], v26 offset:49152
ds_read_b64_tr_b16 v[66:67], v26 offset:50176
v_mfma_f32_16x16x32_bf16 a[68:71], v[40:43], v[124:127], a[68:71]
buffer_load_dwordx4 v207, s[80:83], s47 offen offset:3072 lds
v_mfma_f32_16x16x32_bf16 a[72:75], v[44:47], v[120:123], a[72:75]
s_waitcnt lgkmcnt(8)
ds_read_b64_tr_b16 v[68:69], v27 offset:49152
ds_read_b64_tr_b16 v[70:71], v27 offset:50176
v_mfma_f32_16x16x32_bf16 a[76:79], v[44:47], v[124:127], a[76:79]
v_mfma_f32_16x16x32_bf16 a[80:83], v[48:51], v[120:123], a[80:83]
s_waitcnt lgkmcnt(8)
ds_read_b64_tr_b16 v[40:41], v20 offset:40960
ds_read_b64_tr_b16 v[42:43], v20 offset:41984
v_mfma_f32_16x16x32_bf16 a[84:87], v[48:51], v[124:127], a[84:87]
s_add_u32 s47, s45, 1376256
s_add_u32 m0, s40, 81920
v_mfma_f32_16x16x32_bf16 a[88:91], v[52:55], v[120:123], a[88:91]
s_waitcnt lgkmcnt(8)
ds_read_b64_tr_b16 v[44:45], v21 offset:40960
ds_read_b64_tr_b16 v[46:47], v21 offset:41984
v_mfma_f32_16x16x32_bf16 a[92:95], v[52:55], v[124:127], a[92:95]
buffer_load_dwordx4 v204, s[84:87], s47 offen offset:0 lds
v_mfma_f32_16x16x32_bf16 a[96:99], v[56:59], v[120:123], a[96:99]
s_waitcnt lgkmcnt(8)
ds_read_b64_tr_b16 v[48:49], v22 offset:40960
ds_read_b64_tr_b16 v[50:51], v22 offset:41984
v_mfma_f32_16x16x32_bf16 a[100:103], v[56:59], v[124:127], a[100:103]
v_mfma_f32_16x16x32_bf16 a[104:107], v[60:63], v[120:123], a[104:107]
s_waitcnt lgkmcnt(8)
ds_read_b64_tr_b16 v[52:53], v23 offset:40960
ds_read_b64_tr_b16 v[54:55], v23 offset:41984
v_mfma_f32_16x16x32_bf16 a[108:111], v[60:63], v[124:127], a[108:111]
buffer_load_dwordx4 v205, s[84:87], s47 offen offset:1024 lds
v_mfma_f32_16x16x32_bf16 a[112:115], v[64:67], v[120:123], a[112:115]
s_waitcnt lgkmcnt(8)
ds_read_b64_tr_b16 v[56:57], v24 offset:40960
ds_read_b64_tr_b16 v[58:59], v24 offset:41984
v_mfma_f32_16x16x32_bf16 a[116:119], v[64:67], v[124:127], a[116:119]
v_mfma_f32_16x16x32_bf16 a[120:123], v[68:71], v[120:123], a[120:123]
s_waitcnt lgkmcnt(8)
ds_read_b64_tr_b16 v[60:61], v25 offset:40960
ds_read_b64_tr_b16 v[62:63], v25 offset:41984
v_mfma_f32_16x16x32_bf16 a[124:127], v[68:71], v[124:127], a[124:127]
v_mfma_f32_16x16x32_bf16 a[0:3], v[40:43], v[128:131], a[0:3]
s_waitcnt lgkmcnt(8)
ds_read_b64_tr_b16 v[64:65], v26 offset:40960
ds_read_b64_tr_b16 v[66:67], v26 offset:41984
v_mfma_f32_16x16x32_bf16 a[4:7], v[40:43], v[132:135], a[4:7]
buffer_load_dwordx4 v206, s[84:87], s47 offen offset:2048 lds
v_mfma_f32_16x16x32_bf16 a[8:11], v[44:47], v[128:131], a[8:11]
s_waitcnt lgkmcnt(8)
ds_read_b64_tr_b16 v[68:69], v27 offset:40960
ds_read_b64_tr_b16 v[70:71], v27 offset:41984
v_mfma_f32_16x16x32_bf16 a[12:15], v[44:47], v[132:135], a[12:15]
v_mfma_f32_16x16x32_bf16 a[16:19], v[48:51], v[128:131], a[16:19]
s_waitcnt lgkmcnt(8)
ds_read_b64_tr_b16 v[40:41], v20 offset:57344
ds_read_b64_tr_b16 v[42:43], v20 offset:58368
v_mfma_f32_16x16x32_bf16 a[20:23], v[48:51], v[132:135], a[20:23]
buffer_load_dwordx4 v207, s[84:87], s47 offen offset:3072 lds
v_mfma_f32_16x16x32_bf16 a[24:27], v[52:55], v[128:131], a[24:27]
s_waitcnt lgkmcnt(8)
ds_read_b64_tr_b16 v[44:45], v21 offset:57344
ds_read_b64_tr_b16 v[46:47], v21 offset:58368
v_mfma_f32_16x16x32_bf16 a[28:31], v[52:55], v[132:135], a[28:31]
v_mfma_f32_16x16x32_bf16 a[32:35], v[56:59], v[128:131], a[32:35]
s_waitcnt lgkmcnt(8)
ds_read_b64_tr_b16 v[48:49], v22 offset:57344
ds_read_b64_tr_b16 v[50:51], v22 offset:58368
v_mfma_f32_16x16x32_bf16 a[36:39], v[56:59], v[132:135], a[36:39]
s_add_u32 s47, s48, 12288
v_mfma_f32_16x16x32_bf16 a[40:43], v[60:63], v[128:131], a[40:43]
s_waitcnt lgkmcnt(8)
ds_read_b64_tr_b16 v[52:53], v23 offset:57344
ds_read_b64_tr_b16 v[54:55], v23 offset:58368
v_mfma_f32_16x16x32_bf16 a[44:47], v[60:63], v[132:135], a[44:47]
buffer_load_dwordx4 v[168:171], v3, s[4:7], s47 offen offset:0 sc1
v_mfma_f32_16x16x32_bf16 a[48:51], v[64:67], v[128:131], a[48:51]
s_waitcnt lgkmcnt(8)
ds_read_b64_tr_b16 v[56:57], v24 offset:57344
ds_read_b64_tr_b16 v[58:59], v24 offset:58368
v_mfma_f32_16x16x32_bf16 a[52:55], v[64:67], v[132:135], a[52:55]
v_mfma_f32_16x16x32_bf16 a[56:59], v[68:71], v[128:131], a[56:59]
s_waitcnt lgkmcnt(8)
ds_read_b64_tr_b16 v[60:61], v25 offset:57344
ds_read_b64_tr_b16 v[62:63], v25 offset:58368
v_mfma_f32_16x16x32_bf16 a[60:63], v[68:71], v[132:135], a[60:63]
buffer_load_dwordx4 v[176:179], v3, s[4:7], s47 offen offset:1024 sc1
v_mfma_f32_16x16x32_bf16 a[64:67], v[40:43], v[128:131], a[64:67]
s_waitcnt lgkmcnt(8)
ds_read_b64_tr_b16 v[64:65], v26 offset:57344
ds_read_b64_tr_b16 v[66:67], v26 offset:58368
v_mfma_f32_16x16x32_bf16 a[68:71], v[40:43], v[132:135], a[68:71]
v_mfma_f32_16x16x32_bf16 a[72:75], v[44:47], v[128:131], a[72:75]
s_waitcnt lgkmcnt(8)
ds_read_b64_tr_b16 v[68:69], v27 offset:57344
ds_read_b64_tr_b16 v[70:71], v27 offset:58368
v_mfma_f32_16x16x32_bf16 a[76:79], v[44:47], v[132:135], a[76:79]
v_add_u32 v20, 4294901760, v20
v_add_u32 v21, 4294901760, v21
v_add_u32 v22, 4294901760, v22
v_add_u32 v23, 4294901760, v23
v_add_u32 v24, 4294901760, v24
v_add_u32 v25, 4294901760, v25
v_add_u32 v26, 4294901760, v26
v_add_u32 v27, 4294901760, v27
v_mfma_f32_16x16x32_bf16 a[80:83], v[48:51], v[128:131], a[80:83]
s_waitcnt lgkmcnt(8)
ds_read_b64_tr_b16 v[40:41], v20 offset:0
ds_read_b64_tr_b16 v[42:43], v20 offset:1024
v_mfma_f32_16x16x32_bf16 a[84:87], v[48:51], v[132:135], a[84:87]
s_add_u32 s47, s48, 26624
v_mfma_f32_16x16x32_bf16 a[88:91], v[52:55], v[128:131], a[88:91]
s_waitcnt lgkmcnt(8)
ds_read_b64_tr_b16 v[44:45], v21 offset:0
ds_read_b64_tr_b16 v[46:47], v21 offset:1024
v_mfma_f32_16x16x32_bf16 a[92:95], v[52:55], v[132:135], a[92:95]
buffer_load_dwordx4 v[172:175], v3, s[4:7], s47 offen offset:0 sc1
v_mfma_f32_16x16x32_bf16 a[96:99], v[56:59], v[128:131], a[96:99]
s_waitcnt lgkmcnt(8)
ds_read_b64_tr_b16 v[48:49], v22 offset:0
ds_read_b64_tr_b16 v[50:51], v22 offset:1024
v_mfma_f32_16x16x32_bf16 a[100:103], v[56:59], v[132:135], a[100:103]
v_mfma_f32_16x16x32_bf16 a[104:107], v[60:63], v[128:131], a[104:107]
s_waitcnt lgkmcnt(8)
ds_read_b64_tr_b16 v[52:53], v23 offset:0
ds_read_b64_tr_b16 v[54:55], v23 offset:1024
v_mfma_f32_16x16x32_bf16 a[108:111], v[60:63], v[132:135], a[108:111]
v_mfma_f32_16x16x32_bf16 a[112:115], v[64:67], v[128:131], a[112:115]
s_waitcnt lgkmcnt(8)
ds_read_b64_tr_b16 v[56:57], v24 offset:0
ds_read_b64_tr_b16 v[58:59], v24 offset:1024
v_mfma_f32_16x16x32_bf16 a[116:119], v[64:67], v[132:135], a[116:119]
buffer_load_dwordx4 v[180:183], v3, s[4:7], s47 offen offset:1024 sc1
v_mfma_f32_16x16x32_bf16 a[120:123], v[68:71], v[128:131], a[120:123]
s_waitcnt lgkmcnt(8)
ds_read_b64_tr_b16 v[60:61], v25 offset:0
ds_read_b64_tr_b16 v[62:63], v25 offset:1024
v_mfma_f32_16x16x32_bf16 a[124:127], v[68:71], v[132:135], a[124:127]
s_waitcnt vmcnt(12)
s_barrier
s_cmp_eq_u32 s65, 0
s_cselect_b32 s82, 0, 1605632
s_cselect_b32 s86, 0, 1605632
s_lshr_b32 s51, s66, 4
s_and_b32 s35, s66, 15
s_lshl_b32 s52, s35, 3
s_lshl_b32 s33, s30, 1
s_add_u32 s52, s52, s33
s_mul_i32 s60, s52, 14336
s_mul_i32 s53, s30, 57344
s_lshl_b32 s33, s51, 8
s_add_u32 s53, s53, s33
s_cmp_eq_u32 s65, 0
s_cselect_b32 s6, 0, 1835008
s_waitcnt lgkmcnt(10)
v_mfma_f32_16x16x32_bf16 a[0:3], v[40:43], v[136:139], a[0:3]
s_waitcnt lgkmcnt(8)
ds_read_b64_tr_b16 v[64:65], v26 offset:0
ds_read_b64_tr_b16 v[66:67], v26 offset:1024
v_mfma_f32_16x16x32_bf16 a[4:7], v[40:43], v[140:143], a[4:7]
v_mfma_f32_16x16x32_bf16 a[8:11], v[44:47], v[136:139], a[8:11]
s_waitcnt lgkmcnt(8)
ds_read_b64_tr_b16 v[68:69], v27 offset:0
ds_read_b64_tr_b16 v[70:71], v27 offset:1024
v_mfma_f32_16x16x32_bf16 a[12:15], v[44:47], v[140:143], a[12:15]
v_mfma_f32_16x16x32_bf16 a[16:19], v[48:51], v[136:139], a[16:19]
s_waitcnt lgkmcnt(8)
ds_read_b64_tr_b16 v[40:41], v20 offset:16384
ds_read_b64_tr_b16 v[42:43], v20 offset:17408
v_mfma_f32_16x16x32_bf16 a[20:23], v[48:51], v[140:143], a[20:23]
v_mfma_f32_16x16x32_bf16 a[24:27], v[52:55], v[136:139], a[24:27]
s_waitcnt lgkmcnt(8)
ds_read_b64_tr_b16 v[44:45], v21 offset:16384
ds_read_b64_tr_b16 v[46:47], v21 offset:17408
v_mfma_f32_16x16x32_bf16 a[28:31], v[52:55], v[140:143], a[28:31]
v_mfma_f32_16x16x32_bf16 a[32:35], v[56:59], v[136:139], a[32:35]
s_waitcnt lgkmcnt(8)
ds_read_b64_tr_b16 v[48:49], v22 offset:16384
ds_read_b64_tr_b16 v[50:51], v22 offset:17408
v_mfma_f32_16x16x32_bf16 a[36:39], v[56:59], v[140:143], a[36:39]
v_mfma_f32_16x16x32_bf16 a[40:43], v[60:63], v[136:139], a[40:43]
s_waitcnt lgkmcnt(8)
ds_read_b64_tr_b16 v[52:53], v23 offset:16384
ds_read_b64_tr_b16 v[54:55], v23 offset:17408
v_mfma_f32_16x16x32_bf16 a[44:47], v[60:63], v[140:143], a[44:47]
v_mfma_f32_16x16x32_bf16 a[48:51], v[64:67], v[136:139], a[48:51]
s_waitcnt lgkmcnt(8)
ds_read_b64_tr_b16 v[56:57], v24 offset:16384
ds_read_b64_tr_b16 v[58:59], v24 offset:17408
v_mfma_f32_16x16x32_bf16 a[52:55], v[64:67], v[140:143], a[52:55]
v_mfma_f32_16x16x32_bf16 a[56:59], v[68:71], v[136:139], a[56:59]
s_waitcnt lgkmcnt(8)
ds_read_b64_tr_b16 v[60:61], v25 offset:16384
ds_read_b64_tr_b16 v[62:63], v25 offset:17408
v_mfma_f32_16x16x32_bf16 a[60:63], v[68:71], v[140:143], a[60:63]
v_mfma_f32_16x16x32_bf16 a[64:67], v[40:43], v[136:139], a[64:67]
s_waitcnt lgkmcnt(8)
ds_read_b64_tr_b16 v[64:65], v26 offset:16384
ds_read_b64_tr_b16 v[66:67], v26 offset:17408
v_mfma_f32_16x16x32_bf16 a[68:71], v[40:43], v[140:143], a[68:71]
v_mfma_f32_16x16x32_bf16 a[72:75], v[44:47], v[136:139], a[72:75]
s_waitcnt lgkmcnt(8)
ds_read_b64_tr_b16 v[68:69], v27 offset:16384
ds_read_b64_tr_b16 v[70:71], v27 offset:17408
v_mfma_f32_16x16x32_bf16 a[76:79], v[44:47], v[140:143], a[76:79]
v_mfma_f32_16x16x32_bf16 a[80:83], v[48:51], v[136:139], a[80:83]
s_waitcnt lgkmcnt(8)
ds_read_b64_tr_b16 v[40:41], v20 offset:8192
ds_read_b64_tr_b16 v[42:43], v20 offset:9216
v_mfma_f32_16x16x32_bf16 a[84:87], v[48:51], v[140:143], a[84:87]
v_mfma_f32_16x16x32_bf16 a[88:91], v[52:55], v[136:139], a[88:91]
s_waitcnt lgkmcnt(8)
ds_read_b64_tr_b16 v[44:45], v21 offset:8192
ds_read_b64_tr_b16 v[46:47], v21 offset:9216
v_mfma_f32_16x16x32_bf16 a[92:95], v[52:55], v[140:143], a[92:95]
v_mfma_f32_16x16x32_bf16 a[96:99], v[56:59], v[136:139], a[96:99]
s_waitcnt lgkmcnt(8)
ds_read_b64_tr_b16 v[48:49], v22 offset:8192
ds_read_b64_tr_b16 v[50:51], v22 offset:9216
v_mfma_f32_16x16x32_bf16 a[100:103], v[56:59], v[140:143], a[100:103]
v_mfma_f32_16x16x32_bf16 a[104:107], v[60:63], v[136:139], a[104:107]
s_waitcnt lgkmcnt(8)
ds_read_b64_tr_b16 v[52:53], v23 offset:8192
ds_read_b64_tr_b16 v[54:55], v23 offset:9216
v_mfma_f32_16x16x32_bf16 a[108:111], v[60:63], v[140:143], a[108:111]
v_mfma_f32_16x16x32_bf16 a[112:115], v[64:67], v[136:139], a[112:115]
s_waitcnt lgkmcnt(8)
ds_read_b64_tr_b16 v[56:57], v24 offset:8192
ds_read_b64_tr_b16 v[58:59], v24 offset:9216
v_mfma_f32_16x16x32_bf16 a[116:119], v[64:67], v[140:143], a[116:119]
v_mfma_f32_16x16x32_bf16 a[120:123], v[68:71], v[136:139], a[120:123]
s_waitcnt lgkmcnt(8)
ds_read_b64_tr_b16 v[60:61], v25 offset:8192
ds_read_b64_tr_b16 v[62:63], v25 offset:9216
v_mfma_f32_16x16x32_bf16 a[124:127], v[68:71], v[140:143], a[124:127]
v_mfma_f32_16x16x32_bf16 a[0:3], v[40:43], v[144:147], a[0:3]
s_waitcnt lgkmcnt(8)
ds_read_b64_tr_b16 v[64:65], v26 offset:8192
ds_read_b64_tr_b16 v[66:67], v26 offset:9216
v_mfma_f32_16x16x32_bf16 a[4:7], v[40:43], v[148:151], a[4:7]
v_mfma_f32_16x16x32_bf16 a[8:11], v[44:47], v[144:147], a[8:11]
s_waitcnt lgkmcnt(8)
ds_read_b64_tr_b16 v[68:69], v27 offset:8192
ds_read_b64_tr_b16 v[70:71], v27 offset:9216
v_mfma_f32_16x16x32_bf16 a[12:15], v[44:47], v[148:151], a[12:15]
v_mfma_f32_16x16x32_bf16 a[16:19], v[48:51], v[144:147], a[16:19]
s_waitcnt lgkmcnt(8)
ds_read_b64_tr_b16 v[40:41], v20 offset:24576
ds_read_b64_tr_b16 v[42:43], v20 offset:25600
v_mfma_f32_16x16x32_bf16 a[20:23], v[48:51], v[148:151], a[20:23]
v_mfma_f32_16x16x32_bf16 a[24:27], v[52:55], v[144:147], a[24:27]
s_waitcnt lgkmcnt(8)
ds_read_b64_tr_b16 v[44:45], v21 offset:24576
ds_read_b64_tr_b16 v[46:47], v21 offset:25600
v_mfma_f32_16x16x32_bf16 a[28:31], v[52:55], v[148:151], a[28:31]
v_mfma_f32_16x16x32_bf16 a[32:35], v[56:59], v[144:147], a[32:35]
s_waitcnt lgkmcnt(8)
ds_read_b64_tr_b16 v[48:49], v22 offset:24576
ds_read_b64_tr_b16 v[50:51], v22 offset:25600
v_mfma_f32_16x16x32_bf16 a[36:39], v[56:59], v[148:151], a[36:39]
v_mfma_f32_16x16x32_bf16 a[40:43], v[60:63], v[144:147], a[40:43]
s_waitcnt lgkmcnt(8)
ds_read_b64_tr_b16 v[52:53], v23 offset:24576
ds_read_b64_tr_b16 v[54:55], v23 offset:25600
v_mfma_f32_16x16x32_bf16 a[44:47], v[60:63], v[148:151], a[44:47]
v_mfma_f32_16x16x32_bf16 a[48:51], v[64:67], v[144:147], a[48:51]
s_waitcnt lgkmcnt(8)
ds_read_b64_tr_b16 v[56:57], v24 offset:24576
ds_read_b64_tr_b16 v[58:59], v24 offset:25600
v_mfma_f32_16x16x32_bf16 a[52:55], v[64:67], v[148:151], a[52:55]
v_mfma_f32_16x16x32_bf16 a[56:59], v[68:71], v[144:147], a[56:59]
s_waitcnt lgkmcnt(8)
ds_read_b64_tr_b16 v[60:61], v25 offset:24576
ds_read_b64_tr_b16 v[62:63], v25 offset:25600
v_mfma_f32_16x16x32_bf16 a[60:63], v[68:71], v[148:151], a[60:63]
v_mfma_f32_16x16x32_bf16 a[64:67], v[40:43], v[144:147], a[64:67]
s_waitcnt lgkmcnt(8)
ds_read_b64_tr_b16 v[64:65], v26 offset:24576
ds_read_b64_tr_b16 v[66:67], v26 offset:25600
v_mfma_f32_16x16x32_bf16 a[68:71], v[40:43], v[148:151], a[68:71]
v_mfma_f32_16x16x32_bf16 a[72:75], v[44:47], v[144:147], a[72:75]
s_waitcnt lgkmcnt(8)
ds_read_b64_tr_b16 v[68:69], v27 offset:24576
ds_read_b64_tr_b16 v[70:71], v27 offset:25600
v_mfma_f32_16x16x32_bf16 a[76:79], v[44:47], v[148:151], a[76:79]
v_mfma_f32_16x16x32_bf16 a[80:83], v[48:51], v[144:147], a[80:83]
s_waitcnt lgkmcnt(8)
ds_read_b64_tr_b16 v[40:41], v20 offset:32768
ds_read_b64_tr_b16 v[42:43], v20 offset:33792
v_mfma_f32_16x16x32_bf16 a[84:87], v[48:51], v[148:151], a[84:87]
v_mfma_f32_16x16x32_bf16 a[88:91], v[52:55], v[144:147], a[88:91]
s_waitcnt lgkmcnt(8)
ds_read_b64_tr_b16 v[44:45], v21 offset:32768
ds_read_b64_tr_b16 v[46:47], v21 offset:33792
v_mfma_f32_16x16x32_bf16 a[92:95], v[52:55], v[148:151], a[92:95]
v_mfma_f32_16x16x32_bf16 a[96:99], v[56:59], v[144:147], a[96:99]
s_waitcnt lgkmcnt(8)
ds_read_b64_tr_b16 v[48:49], v22 offset:32768
ds_read_b64_tr_b16 v[50:51], v22 offset:33792
v_mfma_f32_16x16x32_bf16 a[100:103], v[56:59], v[148:151], a[100:103]
v_mfma_f32_16x16x32_bf16 a[104:107], v[60:63], v[144:147], a[104:107]
s_waitcnt lgkmcnt(8)
ds_read_b64_tr_b16 v[52:53], v23 offset:32768
ds_read_b64_tr_b16 v[54:55], v23 offset:33792
v_mfma_f32_16x16x32_bf16 a[108:111], v[60:63], v[148:151], a[108:111]
v_mfma_f32_16x16x32_bf16 a[112:115], v[64:67], v[144:147], a[112:115]
s_waitcnt lgkmcnt(8)
ds_read_b64_tr_b16 v[56:57], v24 offset:32768
ds_read_b64_tr_b16 v[58:59], v24 offset:33792
v_mfma_f32_16x16x32_bf16 a[116:119], v[64:67], v[148:151], a[116:119]
v_mfma_f32_16x16x32_bf16 a[120:123], v[68:71], v[144:147], a[120:123]
s_waitcnt lgkmcnt(8)
ds_read_b64_tr_b16 v[60:61], v25 offset:32768
ds_read_b64_tr_b16 v[62:63], v25 offset:33792
v_mfma_f32_16x16x32_bf16 a[124:127], v[68:71], v[148:151], a[124:127]
s_waitcnt vmcnt(0)
s_barrier
s_waitcnt lgkmcnt(10)
v_mfma_f32_16x16x32_bf16 a[0:3], v[40:43], v[152:155], a[0:3]
s_waitcnt lgkmcnt(8)
ds_read_b64_tr_b16 v[64:65], v26 offset:32768
ds_read_b64_tr_b16 v[66:67], v26 offset:33792
v_mfma_f32_16x16x32_bf16 a[4:7], v[40:43], v[156:159], a[4:7]
s_add_u32 s47, s53, 0
s_add_u32 m0, s40, 0
v_mfma_f32_16x16x32_bf16 a[8:11], v[44:47], v[152:155], a[8:11]
s_waitcnt lgkmcnt(8)
ds_read_b64_tr_b16 v[68:69], v27 offset:32768
ds_read_b64_tr_b16 v[70:71], v27 offset:33792
v_mfma_f32_16x16x32_bf16 a[12:15], v[44:47], v[156:159], a[12:15]
buffer_load_dwordx4 v204, s[80:83], s47 offen offset:0 lds
v_mfma_f32_16x16x32_bf16 a[16:19], v[48:51], v[152:155], a[16:19]
s_waitcnt lgkmcnt(8)
ds_read_b64_tr_b16 v[40:41], v20 offset:49152
ds_read_b64_tr_b16 v[42:43], v20 offset:50176
v_mfma_f32_16x16x32_bf16 a[20:23], v[48:51], v[156:159], a[20:23]
v_mfma_f32_16x16x32_bf16 a[24:27], v[52:55], v[152:155], a[24:27]
s_waitcnt lgkmcnt(8)
ds_read_b64_tr_b16 v[44:45], v21 offset:49152
ds_read_b64_tr_b16 v[46:47], v21 offset:50176
v_mfma_f32_16x16x32_bf16 a[28:31], v[52:55], v[156:159], a[28:31]
buffer_load_dwordx4 v205, s[80:83], s47 offen offset:1024 lds
v_mfma_f32_16x16x32_bf16 a[32:35], v[56:59], v[152:155], a[32:35]
s_waitcnt lgkmcnt(8)
ds_read_b64_tr_b16 v[48:49], v22 offset:49152
ds_read_b64_tr_b16 v[50:51], v22 offset:50176
v_mfma_f32_16x16x32_bf16 a[36:39], v[56:59], v[156:159], a[36:39]
v_mfma_f32_16x16x32_bf16 a[40:43], v[60:63], v[152:155], a[40:43]
s_waitcnt lgkmcnt(8)
ds_read_b64_tr_b16 v[52:53], v23 offset:49152
ds_read_b64_tr_b16 v[54:55], v23 offset:50176
v_mfma_f32_16x16x32_bf16 a[44:47], v[60:63], v[156:159], a[44:47]
v_mfma_f32_16x16x32_bf16 a[48:51], v[64:67], v[152:155], a[48:51]
s_waitcnt lgkmcnt(8)
ds_read_b64_tr_b16 v[56:57], v24 offset:49152
ds_read_b64_tr_b16 v[58:59], v24 offset:50176
v_mfma_f32_16x16x32_bf16 a[52:55], v[64:67], v[156:159], a[52:55]
buffer_load_dwordx4 v206, s[80:83], s47 offen offset:2048 lds
v_mfma_f32_16x16x32_bf16 a[56:59], v[68:71], v[152:155], a[56:59]
s_waitcnt lgkmcnt(8)
ds_read_b64_tr_b16 v[60:61], v25 offset:49152
ds_read_b64_tr_b16 v[62:63], v25 offset:50176
v_mfma_f32_16x16x32_bf16 a[60:63], v[68:71], v[156:159], a[60:63]
v_mfma_f32_16x16x32_bf16 a[64:67], v[40:43], v[152:155], a[64:67]
s_waitcnt lgkmcnt(8)
ds_read_b64_tr_b16 v[64:65], v26 offset:49152
ds_read_b64_tr_b16 v[66:67], v26 offset:50176
v_mfma_f32_16x16x32_bf16 a[68:71], v[40:43], v[156:159], a[68:71]
buffer_load_dwordx4 v207, s[80:83], s47 offen offset:3072 lds
v_mfma_f32_16x16x32_bf16 a[72:75], v[44:47], v[152:155], a[72:75]
s_waitcnt lgkmcnt(8)
ds_read_b64_tr_b16 v[68:69], v27 offset:49152
ds_read_b64_tr_b16 v[70:71], v27 offset:50176
v_mfma_f32_16x16x32_bf16 a[76:79], v[44:47], v[156:159], a[76:79]
v_mfma_f32_16x16x32_bf16 a[80:83], v[48:51], v[152:155], a[80:83]
s_waitcnt lgkmcnt(8)
ds_read_b64_tr_b16 v[40:41], v20 offset:40960
ds_read_b64_tr_b16 v[42:43], v20 offset:41984
v_mfma_f32_16x16x32_bf16 a[84:87], v[48:51], v[156:159], a[84:87]
s_add_u32 s47, s53, 0
s_add_u32 m0, s40, 16384
v_mfma_f32_16x16x32_bf16 a[88:91], v[52:55], v[152:155], a[88:91]
s_waitcnt lgkmcnt(8)
ds_read_b64_tr_b16 v[44:45], v21 offset:40960
ds_read_b64_tr_b16 v[46:47], v21 offset:41984
v_mfma_f32_16x16x32_bf16 a[92:95], v[52:55], v[156:159], a[92:95]
buffer_load_dwordx4 v204, s[84:87], s47 offen offset:0 lds
v_mfma_f32_16x16x32_bf16 a[96:99], v[56:59], v[152:155], a[96:99]
s_waitcnt lgkmcnt(8)
ds_read_b64_tr_b16 v[48:49], v22 offset:40960
ds_read_b64_tr_b16 v[50:51], v22 offset:41984
v_mfma_f32_16x16x32_bf16 a[100:103], v[56:59], v[156:159], a[100:103]
v_mfma_f32_16x16x32_bf16 a[104:107], v[60:63], v[152:155], a[104:107]
s_waitcnt lgkmcnt(8)
ds_read_b64_tr_b16 v[52:53], v23 offset:40960
ds_read_b64_tr_b16 v[54:55], v23 offset:41984
v_mfma_f32_16x16x32_bf16 a[108:111], v[60:63], v[156:159], a[108:111]
buffer_load_dwordx4 v205, s[84:87], s47 offen offset:1024 lds
v_mfma_f32_16x16x32_bf16 a[112:115], v[64:67], v[152:155], a[112:115]
s_waitcnt lgkmcnt(8)
ds_read_b64_tr_b16 v[56:57], v24 offset:40960
ds_read_b64_tr_b16 v[58:59], v24 offset:41984
v_mfma_f32_16x16x32_bf16 a[116:119], v[64:67], v[156:159], a[116:119]
v_mfma_f32_16x16x32_bf16 a[120:123], v[68:71], v[152:155], a[120:123]
s_waitcnt lgkmcnt(8)
ds_read_b64_tr_b16 v[60:61], v25 offset:40960
ds_read_b64_tr_b16 v[62:63], v25 offset:41984
v_mfma_f32_16x16x32_bf16 a[124:127], v[68:71], v[156:159], a[124:127]
v_mfma_f32_16x16x32_bf16 a[0:3], v[40:43], v[160:163], a[0:3]
s_waitcnt lgkmcnt(8)
ds_read_b64_tr_b16 v[64:65], v26 offset:40960
ds_read_b64_tr_b16 v[66:67], v26 offset:41984
v_mfma_f32_16x16x32_bf16 a[4:7], v[40:43], v[164:167], a[4:7]
buffer_load_dwordx4 v206, s[84:87], s47 offen offset:2048 lds
v_mfma_f32_16x16x32_bf16 a[8:11], v[44:47], v[160:163], a[8:11]
s_waitcnt lgkmcnt(8)
ds_read_b64_tr_b16 v[68:69], v27 offset:40960
ds_read_b64_tr_b16 v[70:71], v27 offset:41984
v_mfma_f32_16x16x32_bf16 a[12:15], v[44:47], v[164:167], a[12:15]
v_mfma_f32_16x16x32_bf16 a[16:19], v[48:51], v[160:163], a[16:19]
s_waitcnt lgkmcnt(8)
ds_read_b64_tr_b16 v[40:41], v20 offset:57344
ds_read_b64_tr_b16 v[42:43], v20 offset:58368
v_mfma_f32_16x16x32_bf16 a[20:23], v[48:51], v[164:167], a[20:23]
buffer_load_dwordx4 v207, s[84:87], s47 offen offset:3072 lds
v_mfma_f32_16x16x32_bf16 a[24:27], v[52:55], v[160:163], a[24:27]
s_waitcnt lgkmcnt(8)
ds_read_b64_tr_b16 v[44:45], v21 offset:57344
ds_read_b64_tr_b16 v[46:47], v21 offset:58368
v_mfma_f32_16x16x32_bf16 a[28:31], v[52:55], v[164:167], a[28:31]
v_mfma_f32_16x16x32_bf16 a[32:35], v[56:59], v[160:163], a[32:35]
s_waitcnt lgkmcnt(8)
ds_read_b64_tr_b16 v[48:49], v22 offset:57344
ds_read_b64_tr_b16 v[50:51], v22 offset:58368
v_mfma_f32_16x16x32_bf16 a[36:39], v[56:59], v[164:167], a[36:39]
s_add_u32 s47, s60, 0
v_mfma_f32_16x16x32_bf16 a[40:43], v[60:63], v[160:163], a[40:43]
s_waitcnt lgkmcnt(8)
ds_read_b64_tr_b16 v[52:53], v23 offset:57344
ds_read_b64_tr_b16 v[54:55], v23 offset:58368
v_mfma_f32_16x16x32_bf16 a[44:47], v[60:63], v[164:167], a[44:47]
buffer_load_dwordx4 v[72:75], v3, s[4:7], s47 offen offset:0 sc1
v_mfma_f32_16x16x32_bf16 a[48:51], v[64:67], v[160:163], a[48:51]
s_waitcnt lgkmcnt(8)
ds_read_b64_tr_b16 v[56:57], v24 offset:57344
ds_read_b64_tr_b16 v[58:59], v24 offset:58368
v_mfma_f32_16x16x32_bf16 a[52:55], v[64:67], v[164:167], a[52:55]
v_mfma_f32_16x16x32_bf16 a[56:59], v[68:71], v[160:163], a[56:59]
s_waitcnt lgkmcnt(8)
ds_read_b64_tr_b16 v[60:61], v25 offset:57344
ds_read_b64_tr_b16 v[62:63], v25 offset:58368
v_mfma_f32_16x16x32_bf16 a[60:63], v[68:71], v[164:167], a[60:63]
buffer_load_dwordx4 v[80:83], v3, s[4:7], s47 offen offset:1024 sc1
v_mfma_f32_16x16x32_bf16 a[64:67], v[40:43], v[160:163], a[64:67]
s_waitcnt lgkmcnt(8)
ds_read_b64_tr_b16 v[64:65], v26 offset:57344
ds_read_b64_tr_b16 v[66:67], v26 offset:58368
v_mfma_f32_16x16x32_bf16 a[68:71], v[40:43], v[164:167], a[68:71]
v_mfma_f32_16x16x32_bf16 a[72:75], v[44:47], v[160:163], a[72:75]
s_waitcnt lgkmcnt(8)
ds_read_b64_tr_b16 v[68:69], v27 offset:57344
ds_read_b64_tr_b16 v[70:71], v27 offset:58368
v_mfma_f32_16x16x32_bf16 a[76:79], v[44:47], v[164:167], a[76:79]
v_add_u32 v20, 65536, v20
v_add_u32 v21, 65536, v21
v_add_u32 v22, 65536, v22
v_add_u32 v23, 65536, v23
v_add_u32 v24, 65536, v24
v_add_u32 v25, 65536, v25
v_add_u32 v26, 65536, v26
v_add_u32 v27, 65536, v27
v_mfma_f32_16x16x32_bf16 a[80:83], v[48:51], v[160:163], a[80:83]
s_waitcnt lgkmcnt(8)
ds_read_b64_tr_b16 v[40:41], v20 offset:0
ds_read_b64_tr_b16 v[42:43], v20 offset:1024
v_mfma_f32_16x16x32_bf16 a[84:87], v[48:51], v[164:167], a[84:87]
s_add_u32 s47, s60, 14336
v_mfma_f32_16x16x32_bf16 a[88:91], v[52:55], v[160:163], a[88:91]
s_waitcnt lgkmcnt(8)
ds_read_b64_tr_b16 v[44:45], v21 offset:0
ds_read_b64_tr_b16 v[46:47], v21 offset:1024
v_mfma_f32_16x16x32_bf16 a[92:95], v[52:55], v[164:167], a[92:95]
buffer_load_dwordx4 v[76:79], v3, s[4:7], s47 offen offset:0 sc1
v_mfma_f32_16x16x32_bf16 a[96:99], v[56:59], v[160:163], a[96:99]
s_waitcnt lgkmcnt(8)
ds_read_b64_tr_b16 v[48:49], v22 offset:0
ds_read_b64_tr_b16 v[50:51], v22 offset:1024
v_mfma_f32_16x16x32_bf16 a[100:103], v[56:59], v[164:167], a[100:103]
v_mfma_f32_16x16x32_bf16 a[104:107], v[60:63], v[160:163], a[104:107]
s_waitcnt lgkmcnt(8)
ds_read_b64_tr_b16 v[52:53], v23 offset:0
ds_read_b64_tr_b16 v[54:55], v23 offset:1024
v_mfma_f32_16x16x32_bf16 a[108:111], v[60:63], v[164:167], a[108:111]
v_mfma_f32_16x16x32_bf16 a[112:115], v[64:67], v[160:163], a[112:115]
s_waitcnt lgkmcnt(8)
ds_read_b64_tr_b16 v[56:57], v24 offset:0
ds_read_b64_tr_b16 v[58:59], v24 offset:1024
v_mfma_f32_16x16x32_bf16 a[116:119], v[64:67], v[164:167], a[116:119]
buffer_load_dwordx4 v[84:87], v3, s[4:7], s47 offen offset:1024 sc1
v_mfma_f32_16x16x32_bf16 a[120:123], v[68:71], v[160:163], a[120:123]
s_waitcnt lgkmcnt(8)
ds_read_b64_tr_b16 v[60:61], v25 offset:0
ds_read_b64_tr_b16 v[62:63], v25 offset:1024
v_mfma_f32_16x16x32_bf16 a[124:127], v[68:71], v[164:167], a[124:127]
s_barrier
s_waitcnt lgkmcnt(10)
v_mfma_f32_16x16x32_bf16 a[0:3], v[40:43], v[168:171], a[0:3]
s_waitcnt lgkmcnt(8)
ds_read_b64_tr_b16 v[64:65], v26 offset:0
ds_read_b64_tr_b16 v[66:67], v26 offset:1024
v_mfma_f32_16x16x32_bf16 a[4:7], v[40:43], v[172:175], a[4:7]
s_add_u32 s47, s53, 229376
s_add_u32 m0, s40, 32768
v_mfma_f32_16x16x32_bf16 a[8:11], v[44:47], v[168:171], a[8:11]
s_waitcnt lgkmcnt(8)
ds_read_b64_tr_b16 v[68:69], v27 offset:0
ds_read_b64_tr_b16 v[70:71], v27 offset:1024
v_mfma_f32_16x16x32_bf16 a[12:15], v[44:47], v[172:175], a[12:15]
buffer_load_dwordx4 v204, s[80:83], s47 offen offset:0 lds
v_mfma_f32_16x16x32_bf16 a[16:19], v[48:51], v[168:171], a[16:19]
s_waitcnt lgkmcnt(8)
ds_read_b64_tr_b16 v[40:41], v20 offset:16384
ds_read_b64_tr_b16 v[42:43], v20 offset:17408
v_mfma_f32_16x16x32_bf16 a[20:23], v[48:51], v[172:175], a[20:23]
v_mfma_f32_16x16x32_bf16 a[24:27], v[52:55], v[168:171], a[24:27]
s_waitcnt lgkmcnt(8)
ds_read_b64_tr_b16 v[44:45], v21 offset:16384
ds_read_b64_tr_b16 v[46:47], v21 offset:17408
v_mfma_f32_16x16x32_bf16 a[28:31], v[52:55], v[172:175], a[28:31]
buffer_load_dwordx4 v205, s[80:83], s47 offen offset:1024 lds
v_mfma_f32_16x16x32_bf16 a[32:35], v[56:59], v[168:171], a[32:35]
s_waitcnt lgkmcnt(8)
ds_read_b64_tr_b16 v[48:49], v22 offset:16384
ds_read_b64_tr_b16 v[50:51], v22 offset:17408
v_mfma_f32_16x16x32_bf16 a[36:39], v[56:59], v[172:175], a[36:39]
v_mfma_f32_16x16x32_bf16 a[40:43], v[60:63], v[168:171], a[40:43]
s_waitcnt lgkmcnt(8)
ds_read_b64_tr_b16 v[52:53], v23 offset:16384
ds_read_b64_tr_b16 v[54:55], v23 offset:17408
v_mfma_f32_16x16x32_bf16 a[44:47], v[60:63], v[172:175], a[44:47]
v_mfma_f32_16x16x32_bf16 a[48:51], v[64:67], v[168:171], a[48:51]
s_waitcnt lgkmcnt(8)
ds_read_b64_tr_b16 v[56:57], v24 offset:16384
ds_read_b64_tr_b16 v[58:59], v24 offset:17408
v_mfma_f32_16x16x32_bf16 a[52:55], v[64:67], v[172:175], a[52:55]
buffer_load_dwordx4 v206, s[80:83], s47 offen offset:2048 lds
v_mfma_f32_16x16x32_bf16 a[56:59], v[68:71], v[168:171], a[56:59]
s_waitcnt lgkmcnt(8)
ds_read_b64_tr_b16 v[60:61], v25 offset:16384
ds_read_b64_tr_b16 v[62:63], v25 offset:17408
v_mfma_f32_16x16x32_bf16 a[60:63], v[68:71], v[172:175], a[60:63]
v_mfma_f32_16x16x32_bf16 a[64:67], v[40:43], v[168:171], a[64:67]
s_waitcnt lgkmcnt(8)
ds_read_b64_tr_b16 v[64:65], v26 offset:16384
ds_read_b64_tr_b16 v[66:67], v26 offset:17408
v_mfma_f32_16x16x32_bf16 a[68:71], v[40:43], v[172:175], a[68:71]
buffer_load_dwordx4 v207, s[80:83], s47 offen offset:3072 lds
v_mfma_f32_16x16x32_bf16 a[72:75], v[44:47], v[168:171], a[72:75]
s_waitcnt lgkmcnt(8)
ds_read_b64_tr_b16 v[68:69], v27 offset:16384
ds_read_b64_tr_b16 v[70:71], v27 offset:17408
v_mfma_f32_16x16x32_bf16 a[76:79], v[44:47], v[172:175], a[76:79]
v_mfma_f32_16x16x32_bf16 a[80:83], v[48:51], v[168:171], a[80:83]
s_waitcnt lgkmcnt(8)
ds_read_b64_tr_b16 v[40:41], v20 offset:8192
ds_read_b64_tr_b16 v[42:43], v20 offset:9216
v_mfma_f32_16x16x32_bf16 a[84:87], v[48:51], v[172:175], a[84:87]
s_add_u32 s47, s53, 229376
s_add_u32 m0, s40, 49152
v_mfma_f32_16x16x32_bf16 a[88:91], v[52:55], v[168:171], a[88:91]
s_waitcnt lgkmcnt(8)
ds_read_b64_tr_b16 v[44:45], v21 offset:8192
ds_read_b64_tr_b16 v[46:47], v21 offset:9216
v_mfma_f32_16x16x32_bf16 a[92:95], v[52:55], v[172:175], a[92:95]
buffer_load_dwordx4 v204, s[84:87], s47 offen offset:0 lds
v_mfma_f32_16x16x32_bf16 a[96:99], v[56:59], v[168:171], a[96:99]
s_waitcnt lgkmcnt(8)
ds_read_b64_tr_b16 v[48:49], v22 offset:8192
ds_read_b64_tr_b16 v[50:51], v22 offset:9216
v_mfma_f32_16x16x32_bf16 a[100:103], v[56:59], v[172:175], a[100:103]
v_mfma_f32_16x16x32_bf16 a[104:107], v[60:63], v[168:171], a[104:107]
s_waitcnt lgkmcnt(8)
ds_read_b64_tr_b16 v[52:53], v23 offset:8192
ds_read_b64_tr_b16 v[54:55], v23 offset:9216
v_mfma_f32_16x16x32_bf16 a[108:111], v[60:63], v[172:175], a[108:111]
v_mfma_f32_16x16x32_bf16 a[112:115], v[64:67], v[168:171], a[112:115]
s_waitcnt lgkmcnt(8)
ds_read_b64_tr_b16 v[56:57], v24 offset:8192
ds_read_b64_tr_b16 v[58:59], v24 offset:9216
v_mfma_f32_16x16x32_bf16 a[116:119], v[64:67], v[172:175], a[116:119]
buffer_load_dwordx4 v205, s[84:87], s47 offen offset:1024 lds
v_mfma_f32_16x16x32_bf16 a[120:123], v[68:71], v[168:171], a[120:123]
s_waitcnt lgkmcnt(8)
ds_read_b64_tr_b16 v[60:61], v25 offset:8192
ds_read_b64_tr_b16 v[62:63], v25 offset:9216
v_mfma_f32_16x16x32_bf16 a[124:127], v[68:71], v[172:175], a[124:127]
v_mfma_f32_16x16x32_bf16 a[0:3], v[40:43], v[176:179], a[0:3]
s_waitcnt lgkmcnt(8)
ds_read_b64_tr_b16 v[64:65], v26 offset:8192
ds_read_b64_tr_b16 v[66:67], v26 offset:9216
v_mfma_f32_16x16x32_bf16 a[4:7], v[40:43], v[180:183], a[4:7]
buffer_load_dwordx4 v206, s[84:87], s47 offen offset:2048 lds
v_mfma_f32_16x16x32_bf16 a[8:11], v[44:47], v[176:179], a[8:11]
s_waitcnt lgkmcnt(8)
ds_read_b64_tr_b16 v[68:69], v27 offset:8192
ds_read_b64_tr_b16 v[70:71], v27 offset:9216
v_mfma_f32_16x16x32_bf16 a[12:15], v[44:47], v[180:183], a[12:15]
v_mfma_f32_16x16x32_bf16 a[16:19], v[48:51], v[176:179], a[16:19]
s_waitcnt lgkmcnt(8)
ds_read_b64_tr_b16 v[40:41], v20 offset:24576
ds_read_b64_tr_b16 v[42:43], v20 offset:25600
v_mfma_f32_16x16x32_bf16 a[20:23], v[48:51], v[180:183], a[20:23]
v_mfma_f32_16x16x32_bf16 a[24:27], v[52:55], v[176:179], a[24:27]
s_waitcnt lgkmcnt(8)
ds_read_b64_tr_b16 v[44:45], v21 offset:24576
ds_read_b64_tr_b16 v[46:47], v21 offset:25600
v_mfma_f32_16x16x32_bf16 a[28:31], v[52:55], v[180:183], a[28:31]
buffer_load_dwordx4 v207, s[84:87], s47 offen offset:3072 lds
v_mfma_f32_16x16x32_bf16 a[32:35], v[56:59], v[176:179], a[32:35]
s_waitcnt lgkmcnt(8)
ds_read_b64_tr_b16 v[48:49], v22 offset:24576
ds_read_b64_tr_b16 v[50:51], v22 offset:25600
v_mfma_f32_16x16x32_bf16 a[36:39], v[56:59], v[180:183], a[36:39]
v_mfma_f32_16x16x32_bf16 a[40:43], v[60:63], v[176:179], a[40:43]
s_waitcnt lgkmcnt(8)
ds_read_b64_tr_b16 v[52:53], v23 offset:24576
ds_read_b64_tr_b16 v[54:55], v23 offset:25600
v_mfma_f32_16x16x32_bf16 a[44:47], v[60:63], v[180:183], a[44:47]
s_add_u32 s47, s60, 2048
v_mfma_f32_16x16x32_bf16 a[48:51], v[64:67], v[176:179], a[48:51]
s_waitcnt lgkmcnt(8)
ds_read_b64_tr_b16 v[56:57], v24 offset:24576
ds_read_b64_tr_b16 v[58:59], v24 offset:25600
v_mfma_f32_16x16x32_bf16 a[52:55], v[64:67], v[180:183], a[52:55]
buffer_load_dwordx4 v[88:91], v3, s[4:7], s47 offen offset:0 sc1
v_mfma_f32_16x16x32_bf16 a[56:59], v[68:71], v[176:179], a[56:59]
s_waitcnt lgkmcnt(8)
ds_read_b64_tr_b16 v[60:61], v25 offset:24576
ds_read_b64_tr_b16 v[62:63], v25 offset:25600
v_mfma_f32_16x16x32_bf16 a[60:63], v[68:71], v[180:183], a[60:63]
v_mfma_f32_16x16x32_bf16 a[64:67], v[40:43], v[176:179], a[64:67]
s_waitcnt lgkmcnt(8)
ds_read_b64_tr_b16 v[64:65], v26 offset:24576
ds_read_b64_tr_b16 v[66:67], v26 offset:25600
v_mfma_f32_16x16x32_bf16 a[68:71], v[40:43], v[180:183], a[68:71]
buffer_load_dwordx4 v[96:99], v3, s[4:7], s47 offen offset:1024 sc1
v_mfma_f32_16x16x32_bf16 a[72:75], v[44:47], v[176:179], a[72:75]
s_waitcnt lgkmcnt(8)
ds_read_b64_tr_b16 v[68:69], v27 offset:24576
ds_read_b64_tr_b16 v[70:71], v27 offset:25600
v_mfma_f32_16x16x32_bf16 a[76:79], v[44:47], v[180:183], a[76:79]
v_mfma_f32_16x16x32_bf16 a[80:83], v[48:51], v[176:179], a[80:83]
s_waitcnt lgkmcnt(8)
v_mfma_f32_16x16x32_bf16 a[84:87], v[48:51], v[180:183], a[84:87]
s_add_u32 s47, s60, 16384
v_mfma_f32_16x16x32_bf16 a[88:91], v[52:55], v[176:179], a[88:91]
s_waitcnt lgkmcnt(6)
v_mfma_f32_16x16x32_bf16 a[92:95], v[52:55], v[180:183], a[92:95]
buffer_load_dwordx4 v[92:95], v3, s[4:7], s47 offen offset:0 sc1
v_mfma_f32_16x16x32_bf16 a[96:99], v[56:59], v[176:179], a[96:99]
s_waitcnt lgkmcnt(4)
v_mfma_f32_16x16x32_bf16 a[100:103], v[56:59], v[180:183], a[100:103]
v_mfma_f32_16x16x32_bf16 a[104:107], v[60:63], v[176:179], a[104:107]
s_waitcnt lgkmcnt(2)
v_mfma_f32_16x16x32_bf16 a[108:111], v[60:63], v[180:183], a[108:111]
v_mfma_f32_16x16x32_bf16 a[112:115], v[64:67], v[176:179], a[112:115]
s_waitcnt lgkmcnt(0)
v_mfma_f32_16x16x32_bf16 a[116:119], v[64:67], v[180:183], a[116:119]
buffer_load_dwordx4 v[100:103], v3, s[4:7], s47 offen offset:1024 sc1
v_mfma_f32_16x16x32_bf16 a[120:123], v[68:71], v[176:179], a[120:123]
v_mfma_f32_16x16x32_bf16 a[124:127], v[68:71], v[180:183], a[124:127]
v_subrev_u32 v20, 65536, v20
v_subrev_u32 v21, 65536, v21
v_subrev_u32 v22, 65536, v22
v_subrev_u32 v23, 65536, v23
v_subrev_u32 v24, 65536, v24
v_subrev_u32 v25, 65536, v25
v_subrev_u32 v26, 65536, v26
v_subrev_u32 v27, 65536, v27
s_mul_i32 s33, s49, 188416
s_lshl_b32 s34, s67, 12
s_add_u32 s33, s33, s34
s_add_u32 s33, s33, 131072
v_accvgpr_read_b32 v208, a0
v_accvgpr_read_b32 v216, a64
v_accvgpr_read_b32 v209, a1
v_accvgpr_read_b32 v217, a65
v_accvgpr_read_b32 v210, a2
v_accvgpr_read_b32 v218, a66
v_accvgpr_read_b32 v211, a3
v_accvgpr_read_b32 v219, a67
v_accvgpr_read_b32 v212, a8
v_accvgpr_read_b32 v220, a72
v_accvgpr_read_b32 v213, a9
v_accvgpr_read_b32 v221, a73
v_accvgpr_read_b32 v214, a10
v_accvgpr_read_b32 v222, a74
v_accvgpr_read_b32 v215, a11
v_accvgpr_read_b32 v223, a75
v_mul_f32 v208, v208, v216
v_mul_f32 v209, v209, v217
v_mul_f32 v210, v210, v218
v_mul_f32 v211, v211, v219
v_mul_f32 v212, v212, v220
v_mul_f32 v213, v213, v221
v_mul_f32 v214, v214, v222
v_mul_f32 v215, v215, v223
v_cvt_pk_bf16_f32 v224, v208, v209
v_cvt_pk_bf16_f32 v225, v210, v211
v_cvt_pk_bf16_f32 v226, v212, v213
v_cvt_pk_bf16_f32 v227, v214, v215
buffer_store_dwordx4 v[224:227], v3, s[24:27], s33 offen offset:0 sc1
v_accvgpr_read_b32 v232, a16
v_accvgpr_read_b32 v240, a80
v_accvgpr_read_b32 v233, a17
v_accvgpr_read_b32 v241, a81
v_accvgpr_read_b32 v234, a18
v_accvgpr_read_b32 v242, a82
v_accvgpr_read_b32 v235, a19
v_accvgpr_read_b32 v243, a83
v_accvgpr_read_b32 v236, a24
v_accvgpr_read_b32 v244, a88
v_accvgpr_read_b32 v237, a25
v_accvgpr_read_b32 v245, a89
v_accvgpr_read_b32 v238, a26
v_accvgpr_read_b32 v246, a90
v_accvgpr_read_b32 v239, a27
v_accvgpr_read_b32 v247, a91
v_mul_f32 v232, v232, v240
v_mul_f32 v233, v233, v241
v_mul_f32 v234, v234, v242
v_mul_f32 v235, v235, v243
v_mul_f32 v236, v236, v244
v_mul_f32 v237, v237, v245
v_mul_f32 v238, v238, v246
v_mul_f32 v239, v239, v247
v_cvt_pk_bf16_f32 v248, v232, v233
v_cvt_pk_bf16_f32 v249, v234, v235
v_cvt_pk_bf16_f32 v250, v236, v237
v_cvt_pk_bf16_f32 v251, v238, v239
buffer_store_dwordx4 v[248:251], v3, s[24:27], s33 offen offset:1024 sc1
v_accvgpr_read_b32 v208, a32
v_accvgpr_read_b32 v216, a96
v_accvgpr_read_b32 v209, a33
v_accvgpr_read_b32 v217, a97
v_accvgpr_read_b32 v210, a34
v_accvgpr_read_b32 v218, a98
v_accvgpr_read_b32 v211, a35
v_accvgpr_read_b32 v219, a99
v_accvgpr_read_b32 v212, a40
v_accvgpr_read_b32 v220, a104
v_accvgpr_read_b32 v213, a41
v_accvgpr_read_b32 v221, a105
v_accvgpr_read_b32 v214, a42
v_accvgpr_read_b32 v222, a106
v_accvgpr_read_b32 v215, a43
v_accvgpr_read_b32 v223, a107
v_mul_f32 v208, v208, v216
v_mul_f32 v209, v209, v217
v_mul_f32 v210, v210, v218
v_mul_f32 v211, v211, v219
v_mul_f32 v212, v212, v220
v_mul_f32 v213, v213, v221
v_mul_f32 v214, v214, v222
v_mul_f32 v215, v215, v223
v_cvt_pk_bf16_f32 v224, v208, v209
v_cvt_pk_bf16_f32 v225, v210, v211
v_cvt_pk_bf16_f32 v226, v212, v213
v_cvt_pk_bf16_f32 v227, v214, v215
buffer_store_dwordx4 v[224:227], v3, s[24:27], s33 offen offset:2048 sc1
v_accvgpr_read_b32 v232, a48
v_accvgpr_read_b32 v240, a112
v_accvgpr_read_b32 v233, a49
v_accvgpr_read_b32 v241, a113
v_accvgpr_read_b32 v234, a50
v_accvgpr_read_b32 v242, a114
v_accvgpr_read_b32 v235, a51
v_accvgpr_read_b32 v243, a115
v_accvgpr_read_b32 v236, a56
v_accvgpr_read_b32 v244, a120
v_accvgpr_read_b32 v237, a57
v_accvgpr_read_b32 v245, a121
v_accvgpr_read_b32 v238, a58
v_accvgpr_read_b32 v246, a122
v_accvgpr_read_b32 v239, a59
v_accvgpr_read_b32 v247, a123
v_mul_f32 v232, v232, v240
v_mul_f32 v233, v233, v241
v_mul_f32 v234, v234, v242
v_mul_f32 v235, v235, v243
v_mul_f32 v236, v236, v244
v_mul_f32 v237, v237, v245
v_mul_f32 v238, v238, v246
v_mul_f32 v239, v239, v247
v_cvt_pk_bf16_f32 v248, v232, v233
v_cvt_pk_bf16_f32 v249, v234, v235
v_cvt_pk_bf16_f32 v250, v236, v237
v_cvt_pk_bf16_f32 v251, v238, v239
buffer_store_dwordx4 v[248:251], v3, s[24:27], s33 offen offset:3072 sc1
s_add_u32 s33, s33, 188416
v_accvgpr_read_b32 v208, a4
v_accvgpr_read_b32 v216, a68
v_accvgpr_read_b32 v209, a5
v_accvgpr_read_b32 v217, a69
v_accvgpr_read_b32 v210, a6
v_accvgpr_read_b32 v218, a70
v_accvgpr_read_b32 v211, a7
v_accvgpr_read_b32 v219, a71
v_accvgpr_read_b32 v212, a12
v_accvgpr_read_b32 v220, a76
v_accvgpr_read_b32 v213, a13
v_accvgpr_read_b32 v221, a77
v_accvgpr_read_b32 v214, a14
v_accvgpr_read_b32 v222, a78
v_accvgpr_read_b32 v215, a15
v_accvgpr_read_b32 v223, a79
v_mul_f32 v208, v208, v216
v_mul_f32 v209, v209, v217
v_mul_f32 v210, v210, v218
v_mul_f32 v211, v211, v219
v_mul_f32 v212, v212, v220
v_mul_f32 v213, v213, v221
v_mul_f32 v214, v214, v222
v_mul_f32 v215, v215, v223
v_cvt_pk_bf16_f32 v224, v208, v209
v_cvt_pk_bf16_f32 v225, v210, v211
v_cvt_pk_bf16_f32 v226, v212, v213
v_cvt_pk_bf16_f32 v227, v214, v215
buffer_store_dwordx4 v[224:227], v3, s[24:27], s33 offen offset:0 sc1
v_accvgpr_read_b32 v232, a20
v_accvgpr_read_b32 v240, a84
v_accvgpr_read_b32 v233, a21
v_accvgpr_read_b32 v241, a85
v_accvgpr_read_b32 v234, a22
v_accvgpr_read_b32 v242, a86
v_accvgpr_read_b32 v235, a23
v_accvgpr_read_b32 v243, a87
v_accvgpr_read_b32 v236, a28
v_accvgpr_read_b32 v244, a92
v_accvgpr_read_b32 v237, a29
v_accvgpr_read_b32 v245, a93
v_accvgpr_read_b32 v238, a30
v_accvgpr_read_b32 v246, a94
v_accvgpr_read_b32 v239, a31
v_accvgpr_read_b32 v247, a95
v_mul_f32 v232, v232, v240
v_mul_f32 v233, v233, v241
v_mul_f32 v234, v234, v242
v_mul_f32 v235, v235, v243
v_mul_f32 v236, v236, v244
v_mul_f32 v237, v237, v245
v_mul_f32 v238, v238, v246
v_mul_f32 v239, v239, v247
v_cvt_pk_bf16_f32 v248, v232, v233
v_cvt_pk_bf16_f32 v249, v234, v235
v_cvt_pk_bf16_f32 v250, v236, v237
v_cvt_pk_bf16_f32 v251, v238, v239
buffer_store_dwordx4 v[248:251], v3, s[24:27], s33 offen offset:1024 sc1
v_accvgpr_read_b32 v208, a36
v_accvgpr_read_b32 v216, a100
v_accvgpr_read_b32 v209, a37
v_accvgpr_read_b32 v217, a101
v_accvgpr_read_b32 v210, a38
v_accvgpr_read_b32 v218, a102
v_accvgpr_read_b32 v211, a39
v_accvgpr_read_b32 v219, a103
v_accvgpr_read_b32 v212, a44
v_accvgpr_read_b32 v220, a108
v_accvgpr_read_b32 v213, a45
v_accvgpr_read_b32 v221, a109
v_accvgpr_read_b32 v214, a46
v_accvgpr_read_b32 v222, a110
v_accvgpr_read_b32 v215, a47
v_accvgpr_read_b32 v223, a111
v_mul_f32 v208, v208, v216
v_mul_f32 v209, v209, v217
v_mul_f32 v210, v210, v218
v_mul_f32 v211, v211, v219
v_mul_f32 v212, v212, v220
v_mul_f32 v213, v213, v221
v_mul_f32 v214, v214, v222
v_mul_f32 v215, v215, v223
v_cvt_pk_bf16_f32 v224, v208, v209
v_cvt_pk_bf16_f32 v225, v210, v211
v_cvt_pk_bf16_f32 v226, v212, v213
v_cvt_pk_bf16_f32 v227, v214, v215
buffer_store_dwordx4 v[224:227], v3, s[24:27], s33 offen offset:2048 sc1
v_accvgpr_read_b32 v232, a52
v_accvgpr_read_b32 v240, a116
v_accvgpr_read_b32 v233, a53
v_accvgpr_read_b32 v241, a117
v_accvgpr_read_b32 v234, a54
v_accvgpr_read_b32 v242, a118
v_accvgpr_read_b32 v235, a55
v_accvgpr_read_b32 v243, a119
v_accvgpr_read_b32 v236, a60
v_accvgpr_read_b32 v244, a124
v_accvgpr_read_b32 v237, a61
v_accvgpr_read_b32 v245, a125
v_accvgpr_read_b32 v238, a62
v_accvgpr_read_b32 v246, a126
v_accvgpr_read_b32 v239, a63
v_accvgpr_read_b32 v247, a127
v_mul_f32 v232, v232, v240
v_mul_f32 v233, v233, v241
v_mul_f32 v234, v234, v242
v_mul_f32 v235, v235, v243
v_mul_f32 v236, v236, v244
v_mul_f32 v237, v237, v245
v_mul_f32 v238, v238, v246
v_mul_f32 v239, v239, v247
v_cvt_pk_bf16_f32 v248, v232, v233
v_cvt_pk_bf16_f32 v249, v234, v235
v_cvt_pk_bf16_f32 v250, v236, v237
v_cvt_pk_bf16_f32 v251, v238, v239
buffer_store_dwordx4 v[248:251], v3, s[24:27], s33 offen offset:3072 sc1
s_add_u32 s33, s33, 188416
s_lshr_b32 s88, s49, 3
s_lshl_b32 s88, s88, 2
s_add_u32 s88, s88, 2
s_cmp_ge_u32 s67, 3
s_addc_u32 s88, s88, 0
s_lshl_b32 s88, s88, 8
s_add_u32 s88, s88, 86016
s_mov_b32 s50, 2
s_cmp_eq_u32 s65, 0
s_cbranch_scc0 K2_GU
s_branch K2_FIN
K2_BLO:
s_mov_b32 s47, s49
s_mov_b32 s61, 2
s_sub_u32 s32, 15, s63
s_mov_b32 s41, s64
s_lshl_b32 s42, s32, 2
s_add_u32 s42, s42, 4
s_mov_b32 s48, s49
s_lshl_b32 s33, s32, 2
s_add_u32 s33, s33, s30
s_sub_u32 s34, s42, 1
s_min_u32 s35, s33, s34
s_sub_u32 s38, s34, s35
s_sub_u32 s36, s35, s41
s_cmp_eq_u32 s35, s33
s_cselect_b32 s37, 1, -1
s_lshl_b32 s33, s31, 6
s_add_u32 s34, s33, s42
s_lshl_b32 s18, s34, 14
s_add_u32 s22, s18, 16384
s_add_u32 s39, s33, s41
s_lshl_b32 s39, s39, 14
s_add_u32 s39, s39, s40
s_lshl_b32 s33, s62, 9
v_mov_b32 v13, s33
buffer_load_dword v255, v13, s[72:75], 0 offen sc1
s_add_u32 m0, s40, 0
s_add_u32 s47, s39, 0
s_nop 0
buffer_load_dwordx4 v3, s[16:19], s47 offen offset:0 sc1 lds
buffer_load_dwordx4 v3, s[16:19], s47 offen offset:1024 sc1 lds
buffer_load_dwordx4 v3, s[16:19], s47 offen offset:2048 sc1 lds
buffer_load_dwordx4 v3, s[16:19], s47 offen offset:3072 sc1 lds
s_add_u32 m0, s40, 16384
s_add_u32 s47, s39, 16384
s_nop 0
buffer_load_dwordx4 v3, s[16:19], s47 offen offset:0 sc1 lds
buffer_load_dwordx4 v3, s[16:19], s47 offen offset:1024 sc1 lds
buffer_load_dwordx4 v3, s[16:19], s47 offen offset:2048 sc1 lds
buffer_load_dwordx4 v3, s[16:19], s47 offen offset:3072 sc1 lds
ds_bpermute_b32 v11, v4, v28
ds_bpermute_b32 v12, v4, v29
s_waitcnt lgkmcnt(0)
v_add_f32 v28, v28, v11
v_add_f32 v29, v29, v12
ds_bpermute_b32 v11, v5, v28
ds_bpermute_b32 v12, v5, v29
s_waitcnt lgkmcnt(0)
v_add_f32 v28, v28, v11
v_add_f32 v29, v29, v12
v_rcp_f32 v9, v28
v_rcp_f32 v10, v29
s_mov_b32 s35, 0x10000
s_waitcnt vmcnt(8)
K2_QP:
v_readfirstlane_b32 s33, v255
s_cmp_eq_u32 s33, 1
s_cbranch_scc1 K2_QPOK
s_sub_u32 s35, s35, 1
s_cmp_eq_u32 s35, 0
s_cbranch_scc1 K2_QPOK
s_sleep 4
buffer_load_dword v255, v13, s[72:75], 0 offen sc1
s_waitcnt vmcnt(0)
s_branch K2_QP
K2_QPOK:
s_lshl_b32 s33, s62, 16
s_lshl_b32 s34, s30, 14
s_add_u32 s33, s33, s34
buffer_load_dwordx4 v[136:139], v3, s[68:71], s33 offen offset:0 sc1
buffer_load_dwordx4 v[140:143], v3, s[68:71], s33 offen offset:1024 sc1
buffer_load_dwordx4 v[144:147], v3, s[68:71], s33 offen offset:2048 sc1
buffer_load_dwordx4 v[148:151], v3, s[68:71], s33 offen offset:3072 sc1
s_add_u32 s33, s33, 4096
buffer_load_dwordx4 v[152:155], v3, s[68:71], s33 offen offset:0 sc1
buffer_load_dwordx4 v[156:159], v3, s[68:71], s33 offen offset:1024 sc1
buffer_load_dwordx4 v[160:163], v3, s[68:71], s33 offen offset:2048 sc1
buffer_load_dwordx4 v[164:167], v3, s[68:71], s33 offen offset:3072 sc1
s_add_u32 s33, s33, 4096
buffer_load_dwordx4 v[168:171], v3, s[68:71], s33 offen offset:0 sc1
buffer_load_dwordx4 v[172:175], v3, s[68:71], s33 offen offset:1024 sc1
buffer_load_dwordx4 v[176:179], v3, s[68:71], s33 offen offset:2048 sc1
buffer_load_dwordx4 v[180:183], v3, s[68:71], s33 offen offset:3072 sc1
s_add_u32 s33, s33, 4096
buffer_load_dwordx4 v[184:187], v3, s[68:71], s33 offen offset:0 sc1
buffer_load_dwordx4 v[188:191], v3, s[68:71], s33 offen offset:1024 sc1
buffer_load_dwordx4 v[192:195], v3, s[68:71], s33 offen offset:2048 sc1
buffer_load_dwordx4 v[196:199], v3, s[68:71], s33 offen offset:3072 sc1
s_mov_b32 s47, s49
s_mov_b32 s49, s48
s_mul_i32 s33, s49, 188416
s_lshl_b32 s34, s31, 13
s_add_u32 s33, s33, s34
v_accvgpr_read_b32 v208, a0
v_accvgpr_read_b32 v209, a1
v_accvgpr_read_b32 v210, a2
v_accvgpr_read_b32 v211, a3
v_accvgpr_read_b32 v212, a8
v_accvgpr_read_b32 v213, a9
v_accvgpr_read_b32 v214, a10
v_accvgpr_read_b32 v215, a11
v_mul_f32 v208, v208, v9
v_mul_f32 v209, v209, v9
v_mul_f32 v210, v210, v9
v_mul_f32 v211, v211, v9
v_mul_f32 v212, v212, v9
v_mul_f32 v213, v213, v9
v_mul_f32 v214, v214, v9
v_mul_f32 v215, v215, v9
v_cvt_pk_bf16_f32 v216, v208, v209
v_cvt_pk_bf16_f32 v217, v210, v211
v_cvt_pk_bf16_f32 v218, v212, v213
v_cvt_pk_bf16_f32 v219, v214, v215
buffer_store_dwordx4 v[216:219], v3, s[24:27], s33 offen offset:0 sc1
v_accvgpr_read_b32 v220, a16
v_accvgpr_read_b32 v221, a17
v_accvgpr_read_b32 v222, a18
v_accvgpr_read_b32 v223, a19
v_accvgpr_read_b32 v224, a24
v_accvgpr_read_b32 v225, a25
v_accvgpr_read_b32 v226, a26
v_accvgpr_read_b32 v227, a27
v_mul_f32 v220, v220, v9
v_mul_f32 v221, v221, v9
v_mul_f32 v222, v222, v9
v_mul_f32 v223, v223, v9
v_mul_f32 v224, v224, v9
v_mul_f32 v225, v225, v9
v_mul_f32 v226, v226, v9
v_mul_f32 v227, v227, v9
v_cvt_pk_bf16_f32 v228, v220, v221
v_cvt_pk_bf16_f32 v229, v222, v223
v_cvt_pk_bf16_f32 v230, v224, v225
v_cvt_pk_bf16_f32 v231, v226, v227
buffer_store_dwordx4 v[228:231], v3, s[24:27], s33 offen offset:1024 sc1
v_accvgpr_read_b32 v232, a32
v_accvgpr_read_b32 v233, a33
v_accvgpr_read_b32 v234, a34
v_accvgpr_read_b32 v235, a35
v_accvgpr_read_b32 v236, a40
v_accvgpr_read_b32 v237, a41
v_accvgpr_read_b32 v238, a42
v_accvgpr_read_b32 v239, a43
v_mul_f32 v232, v232, v9
v_mul_f32 v233, v233, v9
v_mul_f32 v234, v234, v9
v_mul_f32 v235, v235, v9
v_mul_f32 v236, v236, v9
v_mul_f32 v237, v237, v9
v_mul_f32 v238, v238, v9
v_mul_f32 v239, v239, v9
v_cvt_pk_bf16_f32 v240, v232, v233
v_cvt_pk_bf16_f32 v241, v234, v235
v_cvt_pk_bf16_f32 v242, v236, v237
v_cvt_pk_bf16_f32 v243, v238, v239
buffer_store_dwordx4 v[240:243], v3, s[24:27], s33 offen offset:2048 sc1
v_accvgpr_read_b32 v244, a48
v_accvgpr_read_b32 v245, a49
v_accvgpr_read_b32 v246, a50
v_accvgpr_read_b32 v247, a51
v_accvgpr_read_b32 v248, a56
v_accvgpr_read_b32 v249, a57
v_accvgpr_read_b32 v250, a58
v_accvgpr_read_b32 v251, a59
v_mul_f32 v244, v244, v9
v_mul_f32 v245, v245, v9
v_mul_f32 v246, v246, v9
v_mul_f32 v247, v247, v9
v_mul_f32 v248, v248, v9
v_mul_f32 v249, v249, v9
v_mul_f32 v250, v250, v9
v_mul_f32 v251, v251, v9
v_cvt_pk_bf16_f32 v252, v244, v245
v_cvt_pk_bf16_f32 v253, v246, v247
v_cvt_pk_bf16_f32 v254, v248, v249
v_cvt_pk_bf16_f32 v255, v250, v251
buffer_store_dwordx4 v[252:255], v3, s[24:27], s33 offen offset:3072 sc1
v_accvgpr_read_b32 v208, a64
v_accvgpr_read_b32 v209, a65
v_accvgpr_read_b32 v210, a66
v_accvgpr_read_b32 v211, a67
v_accvgpr_read_b32 v212, a72
v_accvgpr_read_b32 v213, a73
v_accvgpr_read_b32 v214, a74
v_accvgpr_read_b32 v215, a75
v_mul_f32 v208, v208, v9
v_mul_f32 v209, v209, v9
v_mul_f32 v210, v210, v9
v_mul_f32 v211, v211, v9
v_mul_f32 v212, v212, v9
v_mul_f32 v213, v213, v9
v_mul_f32 v214, v214, v9
v_mul_f32 v215, v215, v9
v_cvt_pk_bf16_f32 v216, v208, v209
v_cvt_pk_bf16_f32 v217, v210, v211
v_cvt_pk_bf16_f32 v218, v212, v213
v_cvt_pk_bf16_f32 v219, v214, v215
s_add_u32 s33, s33, 4096
buffer_store_dwordx4 v[216:219], v3, s[24:27], s33 offen offset:0 sc1
v_accvgpr_read_b32 v220, a80
v_accvgpr_read_b32 v221, a81
v_accvgpr_read_b32 v222, a82
v_accvgpr_read_b32 v223, a83
v_accvgpr_read_b32 v224, a88
v_accvgpr_read_b32 v225, a89
v_accvgpr_read_b32 v226, a90
v_accvgpr_read_b32 v227, a91
v_mul_f32 v220, v220, v9
v_mul_f32 v221, v221, v9
v_mul_f32 v222, v222, v9
v_mul_f32 v223, v223, v9
v_mul_f32 v224, v224, v9
v_mul_f32 v225, v225, v9
v_mul_f32 v226, v226, v9
v_mul_f32 v227, v227, v9
v_cvt_pk_bf16_f32 v228, v220, v221
v_cvt_pk_bf16_f32 v229, v222, v223
v_cvt_pk_bf16_f32 v230, v224, v225
v_cvt_pk_bf16_f32 v231, v226, v227
buffer_store_dwordx4 v[228:231], v3, s[24:27], s33 offen offset:1024 sc1
v_accvgpr_read_b32 v232, a96
v_accvgpr_read_b32 v233, a97
v_accvgpr_read_b32 v234, a98
v_accvgpr_read_b32 v235, a99
v_accvgpr_read_b32 v236, a104
v_accvgpr_read_b32 v237, a105
v_accvgpr_read_b32 v238, a106
v_accvgpr_read_b32 v239, a107
v_mul_f32 v232, v232, v9
v_mul_f32 v233, v233, v9
v_mul_f32 v234, v234, v9
v_mul_f32 v235, v235, v9
v_mul_f32 v236, v236, v9
v_mul_f32 v237, v237, v9
v_mul_f32 v238, v238, v9
v_mul_f32 v239, v239, v9
v_cvt_pk_bf16_f32 v240, v232, v233
v_cvt_pk_bf16_f32 v241, v234, v235
v_cvt_pk_bf16_f32 v242, v236, v237
v_cvt_pk_bf16_f32 v243, v238, v239
buffer_store_dwordx4 v[240:243], v3, s[24:27], s33 offen offset:2048 sc1
v_accvgpr_read_b32 v244, a112
v_accvgpr_read_b32 v245, a113
v_accvgpr_read_b32 v246, a114
v_accvgpr_read_b32 v247, a115
v_accvgpr_read_b32 v248, a120
v_accvgpr_read_b32 v249, a121
v_accvgpr_read_b32 v250, a122
v_accvgpr_read_b32 v251, a123
v_mul_f32 v244, v244, v9
v_mul_f32 v245, v245, v9
v_mul_f32 v246, v246, v9
v_mul_f32 v247, v247, v9
v_mul_f32 v248, v248, v9
v_mul_f32 v249, v249, v9
v_mul_f32 v250, v250, v9
v_mul_f32 v251, v251, v9
v_cvt_pk_bf16_f32 v252, v244, v245
v_cvt_pk_bf16_f32 v253, v246, v247
v_cvt_pk_bf16_f32 v254, v248, v249
v_cvt_pk_bf16_f32 v255, v250, v251
buffer_store_dwordx4 v[252:255], v3, s[24:27], s33 offen offset:3072 sc1
s_add_u32 s33, s33, 184320
v_accvgpr_read_b32 v208, a4
v_accvgpr_read_b32 v209, a5
v_accvgpr_read_b32 v210, a6
v_accvgpr_read_b32 v211, a7
v_accvgpr_read_b32 v212, a12
v_accvgpr_read_b32 v213, a13
v_accvgpr_read_b32 v214, a14
v_accvgpr_read_b32 v215, a15
v_mul_f32 v208, v208, v10
v_mul_f32 v209, v209, v10
v_mul_f32 v210, v210, v10
v_mul_f32 v211, v211, v10
v_mul_f32 v212, v212, v10
v_mul_f32 v213, v213, v10
v_mul_f32 v214, v214, v10
v_mul_f32 v215, v215, v10
v_cvt_pk_bf16_f32 v216, v208, v209
v_cvt_pk_bf16_f32 v217, v210, v211
v_cvt_pk_bf16_f32 v218, v212, v213
v_cvt_pk_bf16_f32 v219, v214, v215
buffer_store_dwordx4 v[216:219], v3, s[24:27], s33 offen offset:0 sc1
v_accvgpr_read_b32 v220, a20
v_accvgpr_read_b32 v221, a21
v_accvgpr_read_b32 v222, a22
v_accvgpr_read_b32 v223, a23
v_accvgpr_read_b32 v224, a28
v_accvgpr_read_b32 v225, a29
v_accvgpr_read_b32 v226, a30
v_accvgpr_read_b32 v227, a31
v_mul_f32 v220, v220, v10
v_mul_f32 v221, v221, v10
v_mul_f32 v222, v222, v10
v_mul_f32 v223, v223, v10
v_mul_f32 v224, v224, v10
v_mul_f32 v225, v225, v10
v_mul_f32 v226, v226, v10
v_mul_f32 v227, v227, v10
v_cvt_pk_bf16_f32 v228, v220, v221
v_cvt_pk_bf16_f32 v229, v222, v223
v_cvt_pk_bf16_f32 v230, v224, v225
v_cvt_pk_bf16_f32 v231, v226, v227
buffer_store_dwordx4 v[228:231], v3, s[24:27], s33 offen offset:1024 sc1
v_accvgpr_read_b32 v232, a36
v_accvgpr_read_b32 v233, a37
v_accvgpr_read_b32 v234, a38
v_accvgpr_read_b32 v235, a39
v_accvgpr_read_b32 v236, a44
v_accvgpr_read_b32 v237, a45
v_accvgpr_read_b32 v238, a46
v_accvgpr_read_b32 v239, a47
v_mul_f32 v232, v232, v10
v_mul_f32 v233, v233, v10
v_mul_f32 v234, v234, v10
v_mul_f32 v235, v235, v10
v_mul_f32 v236, v236, v10
v_mul_f32 v237, v237, v10
v_mul_f32 v238, v238, v10
v_mul_f32 v239, v239, v10
v_cvt_pk_bf16_f32 v240, v232, v233
v_cvt_pk_bf16_f32 v241, v234, v235
v_cvt_pk_bf16_f32 v242, v236, v237
v_cvt_pk_bf16_f32 v243, v238, v239
buffer_store_dwordx4 v[240:243], v3, s[24:27], s33 offen offset:2048 sc1
v_accvgpr_read_b32 v244, a52
v_accvgpr_read_b32 v245, a53
v_accvgpr_read_b32 v246, a54
v_accvgpr_read_b32 v247, a55
v_accvgpr_read_b32 v248, a60
v_accvgpr_read_b32 v249, a61
v_accvgpr_read_b32 v250, a62
v_accvgpr_read_b32 v251, a63
v_mul_f32 v244, v244, v10
v_mul_f32 v245, v245, v10
v_mul_f32 v246, v246, v10
v_mul_f32 v247, v247, v10
v_mul_f32 v248, v248, v10
v_mul_f32 v249, v249, v10
v_mul_f32 v250, v250, v10
v_mul_f32 v251, v251, v10
v_cvt_pk_bf16_f32 v252, v244, v245
v_cvt_pk_bf16_f32 v253, v246, v247
v_cvt_pk_bf16_f32 v254, v248, v249
v_cvt_pk_bf16_f32 v255, v250, v251
buffer_store_dwordx4 v[252:255], v3, s[24:27], s33 offen offset:3072 sc1
v_accvgpr_read_b32 v208, a68
v_accvgpr_read_b32 v209, a69
v_accvgpr_read_b32 v210, a70
v_accvgpr_read_b32 v211, a71
v_accvgpr_read_b32 v212, a76
v_accvgpr_read_b32 v213, a77
v_accvgpr_read_b32 v214, a78
v_accvgpr_read_b32 v215, a79
v_mul_f32 v208, v208, v10
v_mul_f32 v209, v209, v10
v_mul_f32 v210, v210, v10
v_mul_f32 v211, v211, v10
v_mul_f32 v212, v212, v10
v_mul_f32 v213, v213, v10
v_mul_f32 v214, v214, v10
v_mul_f32 v215, v215, v10
v_cvt_pk_bf16_f32 v216, v208, v209
v_cvt_pk_bf16_f32 v217, v210, v211
v_cvt_pk_bf16_f32 v218, v212, v213
v_cvt_pk_bf16_f32 v219, v214, v215
s_add_u32 s33, s33, 4096
buffer_store_dwordx4 v[216:219], v3, s[24:27], s33 offen offset:0 sc1
v_accvgpr_read_b32 v220, a84
v_accvgpr_read_b32 v221, a85
v_accvgpr_read_b32 v222, a86
v_accvgpr_read_b32 v223, a87
v_accvgpr_read_b32 v224, a92
v_accvgpr_read_b32 v225, a93
v_accvgpr_read_b32 v226, a94
v_accvgpr_read_b32 v227, a95
v_mul_f32 v220, v220, v10
v_mul_f32 v221, v221, v10
v_mul_f32 v222, v222, v10
v_mul_f32 v223, v223, v10
v_mul_f32 v224, v224, v10
v_mul_f32 v225, v225, v10
v_mul_f32 v226, v226, v10
v_mul_f32 v227, v227, v10
v_cvt_pk_bf16_f32 v228, v220, v221
v_cvt_pk_bf16_f32 v229, v222, v223
v_cvt_pk_bf16_f32 v230, v224, v225
v_cvt_pk_bf16_f32 v231, v226, v227
buffer_store_dwordx4 v[228:231], v3, s[24:27], s33 offen offset:1024 sc1
v_accvgpr_read_b32 v232, a100
v_accvgpr_read_b32 v233, a101
v_accvgpr_read_b32 v234, a102
v_accvgpr_read_b32 v235, a103
v_accvgpr_read_b32 v236, a108
v_accvgpr_read_b32 v237, a109
v_accvgpr_read_b32 v238, a110
v_accvgpr_read_b32 v239, a111
v_mul_f32 v232, v232, v10
v_mul_f32 v233, v233, v10
v_mul_f32 v234, v234, v10
v_mul_f32 v235, v235, v10
v_mul_f32 v236, v236, v10
v_mul_f32 v237, v237, v10
v_mul_f32 v238, v238, v10
v_mul_f32 v239, v239, v10
v_cvt_pk_bf16_f32 v240, v232, v233
v_cvt_pk_bf16_f32 v241, v234, v235
v_cvt_pk_bf16_f32 v242, v236, v237
v_cvt_pk_bf16_f32 v243, v238, v239
buffer_store_dwordx4 v[240:243], v3, s[24:27], s33 offen offset:2048 sc1
v_accvgpr_read_b32 v244, a116
v_accvgpr_read_b32 v245, a117
v_accvgpr_read_b32 v246, a118
v_accvgpr_read_b32 v247, a119
v_accvgpr_read_b32 v248, a124
v_accvgpr_read_b32 v249, a125
v_accvgpr_read_b32 v250, a126
v_accvgpr_read_b32 v251, a127
v_mul_f32 v244, v244, v10
v_mul_f32 v245, v245, v10
v_mul_f32 v246, v246, v10
v_mul_f32 v247, v247, v10
v_mul_f32 v248, v248, v10
v_mul_f32 v249, v249, v10
v_mul_f32 v250, v250, v10
v_mul_f32 v251, v251, v10
v_cvt_pk_bf16_f32 v252, v244, v245
v_cvt_pk_bf16_f32 v253, v246, v247
v_cvt_pk_bf16_f32 v254, v248, v249
v_cvt_pk_bf16_f32 v255, v250, v251
buffer_store_dwordx4 v[252:255], v3, s[24:27], s33 offen offset:3072 sc1
s_add_u32 s33, s33, 184320
s_lshl_b32 s49, s32, 3
s_lshl_b32 s33, s30, 1
s_add_u32 s49, s49, s33
s_mov_b32 s44, s36
v_accvgpr_write_b32 a0, 0
v_accvgpr_write_b32 a1, 0
v_accvgpr_write_b32 a2, 0
v_accvgpr_write_b32 a3, 0
v_accvgpr_write_b32 a4, 0
v_accvgpr_write_b32 a5, 0
v_accvgpr_write_b32 a6, 0
v_accvgpr_write_b32 a7, 0
v_accvgpr_write_b32 a8, 0
v_accvgpr_write_b32 a9, 0
v_accvgpr_write_b32 a10, 0
v_accvgpr_write_b32 a11, 0
v_accvgpr_write_b32 a12, 0
v_accvgpr_write_b32 a13, 0
v_accvgpr_write_b32 a14, 0
v_accvgpr_write_b32 a15, 0
v_accvgpr_write_b32 a16, 0
v_accvgpr_write_b32 a17, 0
v_accvgpr_write_b32 a18, 0
v_accvgpr_write_b32 a19, 0
v_accvgpr_write_b32 a20, 0
v_accvgpr_write_b32 a21, 0
v_accvgpr_write_b32 a22, 0
v_accvgpr_write_b32 a23, 0
v_accvgpr_write_b32 a24, 0
v_accvgpr_write_b32 a25, 0
v_accvgpr_write_b32 a26, 0
v_accvgpr_write_b32 a27, 0
v_accvgpr_write_b32 a28, 0
v_accvgpr_write_b32 a29, 0
v_accvgpr_write_b32 a30, 0
v_accvgpr_write_b32 a31, 0
v_accvgpr_write_b32 a32, 0
v_accvgpr_write_b32 a33, 0
v_accvgpr_write_b32 a34, 0
v_accvgpr_write_b32 a35, 0
v_accvgpr_write_b32 a36, 0
v_accvgpr_write_b32 a37, 0
v_accvgpr_write_b32 a38, 0
v_accvgpr_write_b32 a39, 0
v_accvgpr_write_b32 a40, 0
v_accvgpr_write_b32 a41, 0
v_accvgpr_write_b32 a42, 0
v_accvgpr_write_b32 a43, 0
v_accvgpr_write_b32 a44, 0
v_accvgpr_write_b32 a45, 0
v_accvgpr_write_b32 a46, 0
v_accvgpr_write_b32 a47, 0
v_accvgpr_write_b32 a48, 0
v_accvgpr_write_b32 a49, 0
v_accvgpr_write_b32 a50, 0
v_accvgpr_write_b32 a51, 0
v_accvgpr_write_b32 a52, 0
v_accvgpr_write_b32 a53, 0
v_accvgpr_write_b32 a54, 0
v_accvgpr_write_b32 a55, 0
v_accvgpr_write_b32 a56, 0
v_accvgpr_write_b32 a57, 0
v_accvgpr_write_b32 a58, 0
v_accvgpr_write_b32 a59, 0
v_accvgpr_write_b32 a60, 0
v_accvgpr_write_b32 a61, 0
v_accvgpr_write_b32 a62, 0
v_accvgpr_write_b32 a63, 0
v_accvgpr_write_b32 a64, 0
v_accvgpr_write_b32 a65, 0
v_accvgpr_write_b32 a66, 0
v_accvgpr_write_b32 a67, 0
v_accvgpr_write_b32 a68, 0
v_accvgpr_write_b32 a69, 0
v_accvgpr_write_b32 a70, 0
v_accvgpr_write_b32 a71, 0
v_accvgpr_write_b32 a72, 0
v_accvgpr_write_b32 a73, 0
v_accvgpr_write_b32 a74, 0
v_accvgpr_write_b32 a75, 0
v_accvgpr_write_b32 a76, 0
v_accvgpr_write_b32 a77, 0
v_accvgpr_write_b32 a78, 0
v_accvgpr_write_b32 a79, 0
v_accvgpr_write_b32 a80, 0
v_accvgpr_write_b32 a81, 0
v_accvgpr_write_b32 a82, 0
v_accvgpr_write_b32 a83, 0
v_accvgpr_write_b32 a84, 0
v_accvgpr_write_b32 a85, 0
v_accvgpr_write_b32 a86, 0
v_accvgpr_write_b32 a87, 0
v_accvgpr_write_b32 a88, 0
v_accvgpr_write_b32 a89, 0
v_accvgpr_write_b32 a90, 0
v_accvgpr_write_b32 a91, 0
v_accvgpr_write_b32 a92, 0
v_accvgpr_write_b32 a93, 0
v_accvgpr_write_b32 a94, 0
v_accvgpr_write_b32 a95, 0
v_accvgpr_write_b32 a96, 0
v_accvgpr_write_b32 a97, 0
v_accvgpr_write_b32 a98, 0
v_accvgpr_write_b32 a99, 0
v_accvgpr_write_b32 a100, 0
v_accvgpr_write_b32 a101, 0
v_accvgpr_write_b32 a102, 0
v_accvgpr_write_b32 a103, 0
v_accvgpr_write_b32 a104, 0
v_accvgpr_write_b32 a105, 0
v_accvgpr_write_b32 a106, 0
v_accvgpr_write_b32 a107, 0
v_accvgpr_write_b32 a108, 0
v_accvgpr_write_b32 a109, 0
v_accvgpr_write_b32 a110, 0
v_accvgpr_write_b32 a111, 0
v_accvgpr_write_b32 a112, 0
v_accvgpr_write_b32 a113, 0
v_accvgpr_write_b32 a114, 0
v_accvgpr_write_b32 a115, 0
v_accvgpr_write_b32 a116, 0
v_accvgpr_write_b32 a117, 0
v_accvgpr_write_b32 a118, 0
v_accvgpr_write_b32 a119, 0
v_accvgpr_write_b32 a120, 0
v_accvgpr_write_b32 a121, 0
v_accvgpr_write_b32 a122, 0
v_accvgpr_write_b32 a123, 0
v_accvgpr_write_b32 a124, 0
v_accvgpr_write_b32 a125, 0
v_accvgpr_write_b32 a126, 0
v_accvgpr_write_b32 a127, 0
s_waitcnt vmcnt(16)
s_branch K2_GO
K2_MERGE:
s_nop 7
ds_bpermute_b32 v11, v4, v28
ds_bpermute_b32 v12, v4, v29
s_waitcnt lgkmcnt(0)
v_add_f32 v28, v28, v11
v_add_f32 v29, v29, v12
ds_bpermute_b32 v11, v5, v28
ds_bpermute_b32 v12, v5, v29
s_waitcnt lgkmcnt(0)
v_add_f32 v28, v28, v11
v_add_f32 v29, v29, v12
s_cmp_eq_u32 s54, 3
s_cbranch_scc1 K2_MRDY
s_lshl_b32 s33, s62, 9
s_add_u32 s33, s33, 256
v_mov_b32 v9, s33
s_mov_b32 s35, 0x10000
K2_MP:
buffer_load_dword v10, v9, s[72:75], 0 offen sc1
s_waitcnt vmcnt(0)
v_readfirstlane_b32 s33, v10
s_cmp_eq_u32 s33, 1
s_cbranch_scc1 K2_MPOK
s_sub_u32 s35, s35, 1
s_cmp_eq_u32 s35, 0
s_cbranch_scc1 K2_MPOK
s_sleep 4
s_branch K2_MP
K2_MPOK:
s_lshl_b32 s33, s62, 12
s_lshl_b32 s34, s30, 10
s_add_u32 s33, s33, s34
s_add_u32 s33, s33, 16777216
buffer_load_dwordx4 v[248:251], v3, s[68:71], s33 offen sc1
s_lshl_b32 s33, s62, 16
s_lshl_b32 s34, s30, 14
s_add_u32 s33, s33, s34
s_add_u32 s33, s33, 8388608
buffer_load_dwordx4 a[128:131], v3, s[68:71], s33 offen offset:0 sc1
buffer_load_dwordx4 a[132:135], v3, s[68:71], s33 offen offset:1024 sc1
buffer_load_dwordx4 a[136:139], v3, s[68:71], s33 offen offset:2048 sc1
buffer_load_dwordx4 a[140:143], v3, s[68:71], s33 offen offset:3072 sc1
s_add_u32 s33, s33, 4096
buffer_load_dwordx4 a[144:147], v3, s[68:71], s33 offen offset:0 sc1
buffer_load_dwordx4 a[148:151], v3, s[68:71], s33 offen offset:1024 sc1
buffer_load_dwordx4 a[152:155], v3, s[68:71], s33 offen offset:2048 sc1
buffer_load_dwordx4 a[156:159], v3, s[68:71], s33 offen offset:3072 sc1
s_add_u32 s33, s33, 4096
buffer_load_dwordx4 a[160:163], v3, s[68:71], s33 offen offset:0 sc1
buffer_load_dwordx4 a[164:167], v3, s[68:71], s33 offen offset:1024 sc1
buffer_load_dwordx4 a[168:171], v3, s[68:71], s33 offen offset:2048 sc1
buffer_load_dwordx4 a[172:175], v3, s[68:71], s33 offen offset:3072 sc1
s_add_u32 s33, s33, 4096
buffer_load_dwordx4 a[176:179], v3, s[68:71], s33 offen offset:0 sc1
buffer_load_dwordx4 a[180:183], v3, s[68:71], s33 offen offset:1024 sc1
buffer_load_dwordx4 a[184:187], v3, s[68:71], s33 offen offset:2048 sc1
buffer_load_dwordx4 a[188:191], v3, s[68:71], s33 offen offset:3072 sc1
K2_MRDY:
s_waitcnt vmcnt(0)
v_min_f32 v80, v248, v32
v_sub_f32 v81, v80, v248
v_sub_f32 v82, v80, v32
v_exp_f32 v81, v81
v_exp_f32 v82, v82
s_nop 0
v_mul_f32 v81, v81, v250
v_fma_f32 v83, v82, v28, v81
v_rcp_f32 v83, v83
s_nop 0
v_mul_f32 v76, v81, v83
v_mul_f32 v78, v82, v83
v_min_f32 v80, v249, v36
v_sub_f32 v81, v80, v249
v_sub_f32 v82, v80, v36
v_exp_f32 v81, v81
v_exp_f32 v82, v82
s_nop 0
v_mul_f32 v81, v81, v251
v_fma_f32 v83, v82, v29, v81
v_rcp_f32 v83, v83
s_nop 0
v_mul_f32 v77, v81, v83
v_mul_f32 v79, v82, v83
s_mul_i32 s33, s49, 188416
s_lshl_b32 s34, s31, 13
s_add_u32 s33, s33, s34
v_accvgpr_read_b32 v84, a0
v_accvgpr_read_b32 v85, a1
v_accvgpr_read_b32 v86, a2
v_accvgpr_read_b32 v87, a3
v_accvgpr_read_b32 v88, a8
v_accvgpr_read_b32 v89, a9
v_accvgpr_read_b32 v90, a10
v_accvgpr_read_b32 v91, a11
v_accvgpr_read_b32 v104, a128
v_accvgpr_read_b32 v105, a129
v_accvgpr_read_b32 v106, a130
v_accvgpr_read_b32 v107, a131
v_mul_f32 v84, v84, v78
v_mul_f32 v85, v85, v78
v_mul_f32 v86, v86, v78
v_mul_f32 v87, v87, v78
v_mul_f32 v88, v88, v78
v_mul_f32 v89, v89, v78
v_mul_f32 v90, v90, v78
v_mul_f32 v91, v91, v78
v_lshlrev_b32 v92, 16, v104
v_and_b32 v93, 0xffff0000, v104
v_lshlrev_b32 v94, 16, v105
v_and_b32 v95, 0xffff0000, v105
v_lshlrev_b32 v96, 16, v106
v_and_b32 v97, 0xffff0000, v106
v_lshlrev_b32 v98, 16, v107
v_and_b32 v99, 0xffff0000, v107
v_fmac_f32 v84, v92, v76
v_fmac_f32 v85, v93, v76
v_fmac_f32 v86, v94, v76
v_fmac_f32 v87, v95, v76
v_fmac_f32 v88, v96, v76
v_fmac_f32 v89, v97, v76
v_fmac_f32 v90, v98, v76
v_fmac_f32 v91, v99, v76
v_cvt_pk_bf16_f32 v100, v84, v85
v_cvt_pk_bf16_f32 v101, v86, v87
v_cvt_pk_bf16_f32 v102, v88, v89
v_cvt_pk_bf16_f32 v103, v90, v91
buffer_store_dwordx4 v[100:103], v3, s[24:27], s33 offen offset:0 sc1
v_accvgpr_read_b32 v108, a16
v_accvgpr_read_b32 v109, a17
v_accvgpr_read_b32 v110, a18
v_accvgpr_read_b32 v111, a19
v_accvgpr_read_b32 v112, a24
v_accvgpr_read_b32 v113, a25
v_accvgpr_read_b32 v114, a26
v_accvgpr_read_b32 v115, a27
v_accvgpr_read_b32 v128, a132
v_accvgpr_read_b32 v129, a133
v_accvgpr_read_b32 v130, a134
v_accvgpr_read_b32 v131, a135
v_mul_f32 v108, v108, v78
v_mul_f32 v109, v109, v78
v_mul_f32 v110, v110, v78
v_mul_f32 v111, v111, v78
v_mul_f32 v112, v112, v78
v_mul_f32 v113, v113, v78
v_mul_f32 v114, v114, v78
v_mul_f32 v115, v115, v78
v_lshlrev_b32 v116, 16, v128
v_and_b32 v117, 0xffff0000, v128
v_lshlrev_b32 v118, 16, v129
v_and_b32 v119, 0xffff0000, v129
v_lshlrev_b32 v120, 16, v130
v_and_b32 v121, 0xffff0000, v130
v_lshlrev_b32 v122, 16, v131
v_and_b32 v123, 0xffff0000, v131
v_fmac_f32 v108, v116, v76
v_fmac_f32 v109, v117, v76
v_fmac_f32 v110, v118, v76
v_fmac_f32 v111, v119, v76
v_fmac_f32 v112, v120, v76
v_fmac_f32 v113, v121, v76
v_fmac_f32 v114, v122, v76
v_fmac_f32 v115, v123, v76
v_cvt_pk_bf16_f32 v124, v108, v109
v_cvt_pk_bf16_f32 v125, v110, v111
v_cvt_pk_bf16_f32 v126, v112, v113
v_cvt_pk_bf16_f32 v127, v114, v115
buffer_store_dwordx4 v[124:127], v3, s[24:27], s33 offen offset:1024 sc1
v_accvgpr_read_b32 v84, a32
v_accvgpr_read_b32 v85, a33
v_accvgpr_read_b32 v86, a34
v_accvgpr_read_b32 v87, a35
v_accvgpr_read_b32 v88, a40
v_accvgpr_read_b32 v89, a41
v_accvgpr_read_b32 v90, a42
v_accvgpr_read_b32 v91, a43
v_accvgpr_read_b32 v104, a136
v_accvgpr_read_b32 v105, a137
v_accvgpr_read_b32 v106, a138
v_accvgpr_read_b32 v107, a139
v_mul_f32 v84, v84, v78
v_mul_f32 v85, v85, v78
v_mul_f32 v86, v86, v78
v_mul_f32 v87, v87, v78
v_mul_f32 v88, v88, v78
v_mul_f32 v89, v89, v78
v_mul_f32 v90, v90, v78
v_mul_f32 v91, v91, v78
v_lshlrev_b32 v92, 16, v104
v_and_b32 v93, 0xffff0000, v104
v_lshlrev_b32 v94, 16, v105
v_and_b32 v95, 0xffff0000, v105
v_lshlrev_b32 v96, 16, v106
v_and_b32 v97, 0xffff0000, v106
v_lshlrev_b32 v98, 16, v107
v_and_b32 v99, 0xffff0000, v107
v_fmac_f32 v84, v92, v76
v_fmac_f32 v85, v93, v76
v_fmac_f32 v86, v94, v76
v_fmac_f32 v87, v95, v76
v_fmac_f32 v88, v96, v76
v_fmac_f32 v89, v97, v76
v_fmac_f32 v90, v98, v76
v_fmac_f32 v91, v99, v76
v_cvt_pk_bf16_f32 v100, v84, v85
v_cvt_pk_bf16_f32 v101, v86, v87
v_cvt_pk_bf16_f32 v102, v88, v89
v_cvt_pk_bf16_f32 v103, v90, v91
buffer_store_dwordx4 v[100:103], v3, s[24:27], s33 offen offset:2048 sc1
v_accvgpr_read_b32 v108, a48
v_accvgpr_read_b32 v109, a49
v_accvgpr_read_b32 v110, a50
v_accvgpr_read_b32 v111, a51
v_accvgpr_read_b32 v112, a56
v_accvgpr_read_b32 v113, a57
v_accvgpr_read_b32 v114, a58
v_accvgpr_read_b32 v115, a59
v_accvgpr_read_b32 v128, a140
v_accvgpr_read_b32 v129, a141
v_accvgpr_read_b32 v130, a142
v_accvgpr_read_b32 v131, a143
v_mul_f32 v108, v108, v78
v_mul_f32 v109, v109, v78
v_mul_f32 v110, v110, v78
v_mul_f32 v111, v111, v78
v_mul_f32 v112, v112, v78
v_mul_f32 v113, v113, v78
v_mul_f32 v114, v114, v78
v_mul_f32 v115, v115, v78
v_lshlrev_b32 v116, 16, v128
v_and_b32 v117, 0xffff0000, v128
v_lshlrev_b32 v118, 16, v129
v_and_b32 v119, 0xffff0000, v129
v_lshlrev_b32 v120, 16, v130
v_and_b32 v121, 0xffff0000, v130
v_lshlrev_b32 v122, 16, v131
v_and_b32 v123, 0xffff0000, v131
v_fmac_f32 v108, v116, v76
v_fmac_f32 v109, v117, v76
v_fmac_f32 v110, v118, v76
v_fmac_f32 v111, v119, v76
v_fmac_f32 v112, v120, v76
v_fmac_f32 v113, v121, v76
v_fmac_f32 v114, v122, v76
v_fmac_f32 v115, v123, v76
v_cvt_pk_bf16_f32 v124, v108, v109
v_cvt_pk_bf16_f32 v125, v110, v111
v_cvt_pk_bf16_f32 v126, v112, v113
v_cvt_pk_bf16_f32 v127, v114, v115
buffer_store_dwordx4 v[124:127], v3, s[24:27], s33 offen offset:3072 sc1
v_accvgpr_read_b32 v84, a64
v_accvgpr_read_b32 v85, a65
v_accvgpr_read_b32 v86, a66
v_accvgpr_read_b32 v87, a67
v_accvgpr_read_b32 v88, a72
v_accvgpr_read_b32 v89, a73
v_accvgpr_read_b32 v90, a74
v_accvgpr_read_b32 v91, a75
v_accvgpr_read_b32 v104, a144
v_accvgpr_read_b32 v105, a145
v_accvgpr_read_b32 v106, a146
v_accvgpr_read_b32 v107, a147
v_mul_f32 v84, v84, v78
v_mul_f32 v85, v85, v78
v_mul_f32 v86, v86, v78
v_mul_f32 v87, v87, v78
v_mul_f32 v88, v88, v78
v_mul_f32 v89, v89, v78
v_mul_f32 v90, v90, v78
v_mul_f32 v91, v91, v78
v_lshlrev_b32 v92, 16, v104
v_and_b32 v93, 0xffff0000, v104
v_lshlrev_b32 v94, 16, v105
v_and_b32 v95, 0xffff0000, v105
v_lshlrev_b32 v96, 16, v106
v_and_b32 v97, 0xffff0000, v106
v_lshlrev_b32 v98, 16, v107
v_and_b32 v99, 0xffff0000, v107
v_fmac_f32 v84, v92, v76
v_fmac_f32 v85, v93, v76
v_fmac_f32 v86, v94, v76
v_fmac_f32 v87, v95, v76
v_fmac_f32 v88, v96, v76
v_fmac_f32 v89, v97, v76
v_fmac_f32 v90, v98, v76
v_fmac_f32 v91, v99, v76
v_cvt_pk_bf16_f32 v100, v84, v85
v_cvt_pk_bf16_f32 v101, v86, v87
v_cvt_pk_bf16_f32 v102, v88, v89
v_cvt_pk_bf16_f32 v103, v90, v91
s_add_u32 s33, s33, 4096
buffer_store_dwordx4 v[100:103], v3, s[24:27], s33 offen offset:0 sc1
v_accvgpr_read_b32 v108, a80
v_accvgpr_read_b32 v109, a81
v_accvgpr_read_b32 v110, a82
v_accvgpr_read_b32 v111, a83
v_accvgpr_read_b32 v112, a88
v_accvgpr_read_b32 v113, a89
v_accvgpr_read_b32 v114, a90
v_accvgpr_read_b32 v115, a91
v_accvgpr_read_b32 v128, a148
v_accvgpr_read_b32 v129, a149
v_accvgpr_read_b32 v130, a150
v_accvgpr_read_b32 v131, a151
v_mul_f32 v108, v108, v78
v_mul_f32 v109, v109, v78
v_mul_f32 v110, v110, v78
v_mul_f32 v111, v111, v78
v_mul_f32 v112, v112, v78
v_mul_f32 v113, v113, v78
v_mul_f32 v114, v114, v78
v_mul_f32 v115, v115, v78
v_lshlrev_b32 v116, 16, v128
v_and_b32 v117, 0xffff0000, v128
v_lshlrev_b32 v118, 16, v129
v_and_b32 v119, 0xffff0000, v129
v_lshlrev_b32 v120, 16, v130
v_and_b32 v121, 0xffff0000, v130
v_lshlrev_b32 v122, 16, v131
v_and_b32 v123, 0xffff0000, v131
v_fmac_f32 v108, v116, v76
v_fmac_f32 v109, v117, v76
v_fmac_f32 v110, v118, v76
v_fmac_f32 v111, v119, v76
v_fmac_f32 v112, v120, v76
v_fmac_f32 v113, v121, v76
v_fmac_f32 v114, v122, v76
v_fmac_f32 v115, v123, v76
v_cvt_pk_bf16_f32 v124, v108, v109
v_cvt_pk_bf16_f32 v125, v110, v111
v_cvt_pk_bf16_f32 v126, v112, v113
v_cvt_pk_bf16_f32 v127, v114, v115
buffer_store_dwordx4 v[124:127], v3, s[24:27], s33 offen offset:1024 sc1
v_accvgpr_read_b32 v84, a96
v_accvgpr_read_b32 v85, a97
v_accvgpr_read_b32 v86, a98
v_accvgpr_read_b32 v87, a99
v_accvgpr_read_b32 v88, a104
v_accvgpr_read_b32 v89, a105
v_accvgpr_read_b32 v90, a106
v_accvgpr_read_b32 v91, a107
v_accvgpr_read_b32 v104, a152
v_accvgpr_read_b32 v105, a153
v_accvgpr_read_b32 v106, a154
v_accvgpr_read_b32 v107, a155
v_mul_f32 v84, v84, v78
v_mul_f32 v85, v85, v78
v_mul_f32 v86, v86, v78
v_mul_f32 v87, v87, v78
v_mul_f32 v88, v88, v78
v_mul_f32 v89, v89, v78
v_mul_f32 v90, v90, v78
v_mul_f32 v91, v91, v78
v_lshlrev_b32 v92, 16, v104
v_and_b32 v93, 0xffff0000, v104
v_lshlrev_b32 v94, 16, v105
v_and_b32 v95, 0xffff0000, v105
v_lshlrev_b32 v96, 16, v106
v_and_b32 v97, 0xffff0000, v106
v_lshlrev_b32 v98, 16, v107
v_and_b32 v99, 0xffff0000, v107
v_fmac_f32 v84, v92, v76
v_fmac_f32 v85, v93, v76
v_fmac_f32 v86, v94, v76
v_fmac_f32 v87, v95, v76
v_fmac_f32 v88, v96, v76
v_fmac_f32 v89, v97, v76
v_fmac_f32 v90, v98, v76
v_fmac_f32 v91, v99, v76
v_cvt_pk_bf16_f32 v100, v84, v85
v_cvt_pk_bf16_f32 v101, v86, v87
v_cvt_pk_bf16_f32 v102, v88, v89
v_cvt_pk_bf16_f32 v103, v90, v91
buffer_store_dwordx4 v[100:103], v3, s[24:27], s33 offen offset:2048 sc1
v_accvgpr_read_b32 v108, a112
v_accvgpr_read_b32 v109, a113
v_accvgpr_read_b32 v110, a114
v_accvgpr_read_b32 v111, a115
v_accvgpr_read_b32 v112, a120
v_accvgpr_read_b32 v113, a121
v_accvgpr_read_b32 v114, a122
v_accvgpr_read_b32 v115, a123
v_accvgpr_read_b32 v128, a156
v_accvgpr_read_b32 v129, a157
v_accvgpr_read_b32 v130, a158
v_accvgpr_read_b32 v131, a159
v_mul_f32 v108, v108, v78
v_mul_f32 v109, v109, v78
v_mul_f32 v110, v110, v78
v_mul_f32 v111, v111, v78
v_mul_f32 v112, v112, v78
v_mul_f32 v113, v113, v78
v_mul_f32 v114, v114, v78
v_mul_f32 v115, v115, v78
v_lshlrev_b32 v116, 16, v128
v_and_b32 v117, 0xffff0000, v128
v_lshlrev_b32 v118, 16, v129
v_and_b32 v119, 0xffff0000, v129
v_lshlrev_b32 v120, 16, v130
v_and_b32 v121, 0xffff0000, v130
v_lshlrev_b32 v122, 16, v131
v_and_b32 v123, 0xffff0000, v131
v_fmac_f32 v108, v116, v76
v_fmac_f32 v109, v117, v76
v_fmac_f32 v110, v118, v76
v_fmac_f32 v111, v119, v76
v_fmac_f32 v112, v120, v76
v_fmac_f32 v113, v121, v76
v_fmac_f32 v114, v122, v76
v_fmac_f32 v115, v123, v76
v_cvt_pk_bf16_f32 v124, v108, v109
v_cvt_pk_bf16_f32 v125, v110, v111
v_cvt_pk_bf16_f32 v126, v112, v113
v_cvt_pk_bf16_f32 v127, v114, v115
buffer_store_dwordx4 v[124:127], v3, s[24:27], s33 offen offset:3072 sc1
s_add_u32 s33, s33, 184320
v_accvgpr_read_b32 v84, a4
v_accvgpr_read_b32 v85, a5
v_accvgpr_read_b32 v86, a6
v_accvgpr_read_b32 v87, a7
v_accvgpr_read_b32 v88, a12
v_accvgpr_read_b32 v89, a13
v_accvgpr_read_b32 v90, a14
v_accvgpr_read_b32 v91, a15
v_accvgpr_read_b32 v104, a160
v_accvgpr_read_b32 v105, a161
v_accvgpr_read_b32 v106, a162
v_accvgpr_read_b32 v107, a163
v_mul_f32 v84, v84, v79
v_mul_f32 v85, v85, v79
v_mul_f32 v86, v86, v79
v_mul_f32 v87, v87, v79
v_mul_f32 v88, v88, v79
v_mul_f32 v89, v89, v79
v_mul_f32 v90, v90, v79
v_mul_f32 v91, v91, v79
v_lshlrev_b32 v92, 16, v104
v_and_b32 v93, 0xffff0000, v104
v_lshlrev_b32 v94, 16, v105
v_and_b32 v95, 0xffff0000, v105
v_lshlrev_b32 v96, 16, v106
v_and_b32 v97, 0xffff0000, v106
v_lshlrev_b32 v98, 16, v107
v_and_b32 v99, 0xffff0000, v107
v_fmac_f32 v84, v92, v77
v_fmac_f32 v85, v93, v77
v_fmac_f32 v86, v94, v77
v_fmac_f32 v87, v95, v77
v_fmac_f32 v88, v96, v77
v_fmac_f32 v89, v97, v77
v_fmac_f32 v90, v98, v77
v_fmac_f32 v91, v99, v77
v_cvt_pk_bf16_f32 v100, v84, v85
v_cvt_pk_bf16_f32 v101, v86, v87
v_cvt_pk_bf16_f32 v102, v88, v89
v_cvt_pk_bf16_f32 v103, v90, v91
buffer_store_dwordx4 v[100:103], v3, s[24:27], s33 offen offset:0 sc1
v_accvgpr_read_b32 v108, a20
v_accvgpr_read_b32 v109, a21
v_accvgpr_read_b32 v110, a22
v_accvgpr_read_b32 v111, a23
v_accvgpr_read_b32 v112, a28
v_accvgpr_read_b32 v113, a29
v_accvgpr_read_b32 v114, a30
v_accvgpr_read_b32 v115, a31
v_accvgpr_read_b32 v128, a164
v_accvgpr_read_b32 v129, a165
v_accvgpr_read_b32 v130, a166
v_accvgpr_read_b32 v131, a167
v_mul_f32 v108, v108, v79
v_mul_f32 v109, v109, v79
v_mul_f32 v110, v110, v79
v_mul_f32 v111, v111, v79
v_mul_f32 v112, v112, v79
v_mul_f32 v113, v113, v79
v_mul_f32 v114, v114, v79
v_mul_f32 v115, v115, v79
v_lshlrev_b32 v116, 16, v128
v_and_b32 v117, 0xffff0000, v128
v_lshlrev_b32 v118, 16, v129
v_and_b32 v119, 0xffff0000, v129
v_lshlrev_b32 v120, 16, v130
v_and_b32 v121, 0xffff0000, v130
v_lshlrev_b32 v122, 16, v131
v_and_b32 v123, 0xffff0000, v131
v_fmac_f32 v108, v116, v77
v_fmac_f32 v109, v117, v77
v_fmac_f32 v110, v118, v77
v_fmac_f32 v111, v119, v77
v_fmac_f32 v112, v120, v77
v_fmac_f32 v113, v121, v77
v_fmac_f32 v114, v122, v77
v_fmac_f32 v115, v123, v77
v_cvt_pk_bf16_f32 v124, v108, v109
v_cvt_pk_bf16_f32 v125, v110, v111
v_cvt_pk_bf16_f32 v126, v112, v113
v_cvt_pk_bf16_f32 v127, v114, v115
buffer_store_dwordx4 v[124:127], v3, s[24:27], s33 offen offset:1024 sc1
v_accvgpr_read_b32 v84, a36
v_accvgpr_read_b32 v85, a37
v_accvgpr_read_b32 v86, a38
v_accvgpr_read_b32 v87, a39
v_accvgpr_read_b32 v88, a44
v_accvgpr_read_b32 v89, a45
v_accvgpr_read_b32 v90, a46
v_accvgpr_read_b32 v91, a47
v_accvgpr_read_b32 v104, a168
v_accvgpr_read_b32 v105, a169
v_accvgpr_read_b32 v106, a170
v_accvgpr_read_b32 v107, a171
v_mul_f32 v84, v84, v79
v_mul_f32 v85, v85, v79
v_mul_f32 v86, v86, v79
v_mul_f32 v87, v87, v79
v_mul_f32 v88, v88, v79
v_mul_f32 v89, v89, v79
v_mul_f32 v90, v90, v79
v_mul_f32 v91, v91, v79
v_lshlrev_b32 v92, 16, v104
v_and_b32 v93, 0xffff0000, v104
v_lshlrev_b32 v94, 16, v105
v_and_b32 v95, 0xffff0000, v105
v_lshlrev_b32 v96, 16, v106
v_and_b32 v97, 0xffff0000, v106
v_lshlrev_b32 v98, 16, v107
v_and_b32 v99, 0xffff0000, v107
v_fmac_f32 v84, v92, v77
v_fmac_f32 v85, v93, v77
v_fmac_f32 v86, v94, v77
v_fmac_f32 v87, v95, v77
v_fmac_f32 v88, v96, v77
v_fmac_f32 v89, v97, v77
v_fmac_f32 v90, v98, v77
v_fmac_f32 v91, v99, v77
v_cvt_pk_bf16_f32 v100, v84, v85
v_cvt_pk_bf16_f32 v101, v86, v87
v_cvt_pk_bf16_f32 v102, v88, v89
v_cvt_pk_bf16_f32 v103, v90, v91
buffer_store_dwordx4 v[100:103], v3, s[24:27], s33 offen offset:2048 sc1
v_accvgpr_read_b32 v108, a52
v_accvgpr_read_b32 v109, a53
v_accvgpr_read_b32 v110, a54
v_accvgpr_read_b32 v111, a55
v_accvgpr_read_b32 v112, a60
v_accvgpr_read_b32 v113, a61
v_accvgpr_read_b32 v114, a62
v_accvgpr_read_b32 v115, a63
v_accvgpr_read_b32 v128, a172
v_accvgpr_read_b32 v129, a173
v_accvgpr_read_b32 v130, a174
v_accvgpr_read_b32 v131, a175
v_mul_f32 v108, v108, v79
v_mul_f32 v109, v109, v79
v_mul_f32 v110, v110, v79
v_mul_f32 v111, v111, v79
v_mul_f32 v112, v112, v79
v_mul_f32 v113, v113, v79
v_mul_f32 v114, v114, v79
v_mul_f32 v115, v115, v79
v_lshlrev_b32 v116, 16, v128
v_and_b32 v117, 0xffff0000, v128
v_lshlrev_b32 v118, 16, v129
v_and_b32 v119, 0xffff0000, v129
v_lshlrev_b32 v120, 16, v130
v_and_b32 v121, 0xffff0000, v130
v_lshlrev_b32 v122, 16, v131
v_and_b32 v123, 0xffff0000, v131
v_fmac_f32 v108, v116, v77
v_fmac_f32 v109, v117, v77
v_fmac_f32 v110, v118, v77
v_fmac_f32 v111, v119, v77
v_fmac_f32 v112, v120, v77
v_fmac_f32 v113, v121, v77
v_fmac_f32 v114, v122, v77
v_fmac_f32 v115, v123, v77
v_cvt_pk_bf16_f32 v124, v108, v109
v_cvt_pk_bf16_f32 v125, v110, v111
v_cvt_pk_bf16_f32 v126, v112, v113
v_cvt_pk_bf16_f32 v127, v114, v115
buffer_store_dwordx4 v[124:127], v3, s[24:27], s33 offen offset:3072 sc1
v_accvgpr_read_b32 v84, a68
v_accvgpr_read_b32 v85, a69
v_accvgpr_read_b32 v86, a70
v_accvgpr_read_b32 v87, a71
v_accvgpr_read_b32 v88, a76
v_accvgpr_read_b32 v89, a77
v_accvgpr_read_b32 v90, a78
v_accvgpr_read_b32 v91, a79
v_accvgpr_read_b32 v104, a176
v_accvgpr_read_b32 v105, a177
v_accvgpr_read_b32 v106, a178
v_accvgpr_read_b32 v107, a179
v_mul_f32 v84, v84, v79
v_mul_f32 v85, v85, v79
v_mul_f32 v86, v86, v79
v_mul_f32 v87, v87, v79
v_mul_f32 v88, v88, v79
v_mul_f32 v89, v89, v79
v_mul_f32 v90, v90, v79
v_mul_f32 v91, v91, v79
v_lshlrev_b32 v92, 16, v104
v_and_b32 v93, 0xffff0000, v104
v_lshlrev_b32 v94, 16, v105
v_and_b32 v95, 0xffff0000, v105
v_lshlrev_b32 v96, 16, v106
v_and_b32 v97, 0xffff0000, v106
v_lshlrev_b32 v98, 16, v107
v_and_b32 v99, 0xffff0000, v107
v_fmac_f32 v84, v92, v77
v_fmac_f32 v85, v93, v77
v_fmac_f32 v86, v94, v77
v_fmac_f32 v87, v95, v77
v_fmac_f32 v88, v96, v77
v_fmac_f32 v89, v97, v77
v_fmac_f32 v90, v98, v77
v_fmac_f32 v91, v99, v77
v_cvt_pk_bf16_f32 v100, v84, v85
v_cvt_pk_bf16_f32 v101, v86, v87
v_cvt_pk_bf16_f32 v102, v88, v89
v_cvt_pk_bf16_f32 v103, v90, v91
s_add_u32 s33, s33, 4096
buffer_store_dwordx4 v[100:103], v3, s[24:27], s33 offen offset:0 sc1
v_accvgpr_read_b32 v108, a84
v_accvgpr_read_b32 v109, a85
v_accvgpr_read_b32 v110, a86
v_accvgpr_read_b32 v111, a87
v_accvgpr_read_b32 v112, a92
v_accvgpr_read_b32 v113, a93
v_accvgpr_read_b32 v114, a94
v_accvgpr_read_b32 v115, a95
v_accvgpr_read_b32 v128, a180
v_accvgpr_read_b32 v129, a181
v_accvgpr_read_b32 v130, a182
v_accvgpr_read_b32 v131, a183
v_mul_f32 v108, v108, v79
v_mul_f32 v109, v109, v79
v_mul_f32 v110, v110, v79
v_mul_f32 v111, v111, v79
v_mul_f32 v112, v112, v79
v_mul_f32 v113, v113, v79
v_mul_f32 v114, v114, v79
v_mul_f32 v115, v115, v79
v_lshlrev_b32 v116, 16, v128
v_and_b32 v117, 0xffff0000, v128
v_lshlrev_b32 v118, 16, v129
v_and_b32 v119, 0xffff0000, v129
v_lshlrev_b32 v120, 16, v130
v_and_b32 v121, 0xffff0000, v130
v_lshlrev_b32 v122, 16, v131
v_and_b32 v123, 0xffff0000, v131
v_fmac_f32 v108, v116, v77
v_fmac_f32 v109, v117, v77
v_fmac_f32 v110, v118, v77
v_fmac_f32 v111, v119, v77
v_fmac_f32 v112, v120, v77
v_fmac_f32 v113, v121, v77
v_fmac_f32 v114, v122, v77
v_fmac_f32 v115, v123, v77
v_cvt_pk_bf16_f32 v124, v108, v109
v_cvt_pk_bf16_f32 v125, v110, v111
v_cvt_pk_bf16_f32 v126, v112, v113
v_cvt_pk_bf16_f32 v127, v114, v115
buffer_store_dwordx4 v[124:127], v3, s[24:27], s33 offen offset:1024 sc1
v_accvgpr_read_b32 v84, a100
v_accvgpr_read_b32 v85, a101
v_accvgpr_read_b32 v86, a102
v_accvgpr_read_b32 v87, a103
v_accvgpr_read_b32 v88, a108
v_accvgpr_read_b32 v89, a109
v_accvgpr_read_b32 v90, a110
v_accvgpr_read_b32 v91, a111
v_accvgpr_read_b32 v104, a184
v_accvgpr_read_b32 v105, a185
v_accvgpr_read_b32 v106, a186
v_accvgpr_read_b32 v107, a187
v_mul_f32 v84, v84, v79
v_mul_f32 v85, v85, v79
v_mul_f32 v86, v86, v79
v_mul_f32 v87, v87, v79
v_mul_f32 v88, v88, v79
v_mul_f32 v89, v89, v79
v_mul_f32 v90, v90, v79
v_mul_f32 v91, v91, v79
v_lshlrev_b32 v92, 16, v104
v_and_b32 v93, 0xffff0000, v104
v_lshlrev_b32 v94, 16, v105
v_and_b32 v95, 0xffff0000, v105
v_lshlrev_b32 v96, 16, v106
v_and_b32 v97, 0xffff0000, v106
v_lshlrev_b32 v98, 16, v107
v_and_b32 v99, 0xffff0000, v107
v_fmac_f32 v84, v92, v77
v_fmac_f32 v85, v93, v77
v_fmac_f32 v86, v94, v77
v_fmac_f32 v87, v95, v77
v_fmac_f32 v88, v96, v77
v_fmac_f32 v89, v97, v77
v_fmac_f32 v90, v98, v77
v_fmac_f32 v91, v99, v77
v_cvt_pk_bf16_f32 v100, v84, v85
v_cvt_pk_bf16_f32 v101, v86, v87
v_cvt_pk_bf16_f32 v102, v88, v89
v_cvt_pk_bf16_f32 v103, v90, v91
buffer_store_dwordx4 v[100:103], v3, s[24:27], s33 offen offset:2048 sc1
v_accvgpr_read_b32 v108, a116
v_accvgpr_read_b32 v109, a117
v_accvgpr_read_b32 v110, a118
v_accvgpr_read_b32 v111, a119
v_accvgpr_read_b32 v112, a124
v_accvgpr_read_b32 v113, a125
v_accvgpr_read_b32 v114, a126
v_accvgpr_read_b32 v115, a127
v_accvgpr_read_b32 v128, a188
v_accvgpr_read_b32 v129, a189
v_accvgpr_read_b32 v130, a190
v_accvgpr_read_b32 v131, a191
v_mul_f32 v108, v108, v79
v_mul_f32 v109, v109, v79
v_mul_f32 v110, v110, v79
v_mul_f32 v111, v111, v79
v_mul_f32 v112, v112, v79
v_mul_f32 v113, v113, v79
v_mul_f32 v114, v114, v79
v_mul_f32 v115, v115, v79
v_lshlrev_b32 v116, 16, v128
v_and_b32 v117, 0xffff0000, v128
v_lshlrev_b32 v118, 16, v129
v_and_b32 v119, 0xffff0000, v129
v_lshlrev_b32 v120, 16, v130
v_and_b32 v121, 0xffff0000, v130
v_lshlrev_b32 v122, 16, v131
v_and_b32 v123, 0xffff0000, v131
v_fmac_f32 v108, v116, v77
v_fmac_f32 v109, v117, v77
v_fmac_f32 v110, v118, v77
v_fmac_f32 v111, v119, v77
v_fmac_f32 v112, v120, v77
v_fmac_f32 v113, v121, v77
v_fmac_f32 v114, v122, v77
v_fmac_f32 v115, v123, v77
v_cvt_pk_bf16_f32 v124, v108, v109
v_cvt_pk_bf16_f32 v125, v110, v111
v_cvt_pk_bf16_f32 v126, v112, v113
v_cvt_pk_bf16_f32 v127, v114, v115
buffer_store_dwordx4 v[124:127], v3, s[24:27], s33 offen offset:3072 sc1
s_add_u32 s33, s33, 184320
s_lshl_b32 s88, s32, 2
s_cmp_ge_u32 s31, 6
s_addc_u32 s88, s88, 0
s_cmp_ge_u32 s31, 12
s_addc_u32 s88, s88, 0
s_lshl_b32 s88, s88, 8
s_add_u32 s88, s88, 86016
s_mov_b32 s50, 2
K2_FIN:
s_mov_b32 s89, s50
s_mov_b32 s71, s55
s_load_dwordx2 s[28:29], s[0:1], 96
s_load_dwordx2 s[46:47], s[0:1], 40
s_load_dwordx2 s[48:49], s[0:1], 72
s_load_dwordx2 s[50:51], s[0:1], 0
s_load_dwordx4 s[52:55], s[0:1], 80
v_lshrrev_b32 v1, 6, v0
v_and_b32 v2, 63, v0
v_readfirstlane_b32 s30, v1
v_lshlrev_b32 v3, 4, v2
s_and_b32 s3, s2, 7
s_lshr_b32 s34, s2, 3
s_and_b32 s31, s34, 3
s_lshr_b32 s32, s34, 2
s_lshr_b32 s35, s3, 2
s_lshl_b32 s35, s35, 3
s_add_u32 s32, s32, s35
s_and_b32 s33, s3, 3
s_lshl_b32 s42, s32, 2
s_add_u32 s42, s42, s31
s_mul_i32 s37, s33, 48
s_cmp_eq_u32 s33, 3
s_cselect_b32 s37, 140, s37
s_cmp_ge_u32 s33, 2
s_cselect_b32 s38, 11, 12
s_mul_i32 s45, s31, 224
s_and_b32 s45, s45, 0xffffffc0
s_waitcnt lgkmcnt(0)
s_add_u32 s4, s28, 35651584
s_addc_u32 s5, s29, 0
s_and_b32 s5, s5, 0xffff
s_mov_b32 s6, 24117248
s_mov_b32 s7, 0x20000
s_mov_b32 s8, s46
s_and_b32 s9, s47, 0xffff
s_mov_b32 s10, 3670016
s_mov_b32 s11, 0x20000
s_add_u32 s12, s28, 101711872
s_addc_u32 s13, s29, 0
s_and_b32 s13, s13, 0xffff
s_mov_b32 s14, 9437184
s_mov_b32 s15, 0x20000
s_mov_b32 s16, s50
s_and_b32 s17, s51, 0xffff
s_mov_b32 s18, 1835008
s_mov_b32 s19, 0x20000
s_mov_b32 s20, s52
s_and_b32 s21, s53, 0xffff
s_mov_b32 s22, 1835008
s_mov_b32 s23, 0x20000
s_add_u32 s24, s28, 100728832
s_addc_u32 s25, s29, 0
s_and_b32 s25, s25, 0xffff
s_mov_b32 s26, 65536
s_mov_b32 s27, 0x20000
v_lshrrev_b32 v4, 4, v2
v_and_b32 v5, 15, v2
v_add_u32 v6, 0, v4
v_lshlrev_b32 v6, 1, v6
v_xor_b32 v6, v6, v5
v_lshlrev_b32 v6, 4, v6
v_mul_u32_u24 v7, 896, v4
v_add_u32 v10, v6, v7
v_add_u32 v6, 4, v4
v_lshlrev_b32 v6, 1, v6
v_xor_b32 v6, v6, v5
v_lshlrev_b32 v6, 4, v6
v_mul_u32_u24 v7, 896, v4
v_add_u32 v11, v6, v7
v_add_u32 v220, 0, v10
v_add_u32 v221, 2560, v11
v_add_u32 v222, 5120, v10
v_add_u32 v223, 7680, v11
v_add_u32 v224, 14336, v10
v_add_u32 v225, 16896, v11
v_add_u32 v226, 19456, v10
v_add_u32 v227, 22016, v11
v_lshrrev_b32 v4, 4, v2
v_bfe_u32 v5, v2, 2, 2
v_lshl_add_u32 v6, v4, 2, v5
v_and_b32 v7, 7, v6
v_lshlrev_b32 v7, 1, v7
v_lshlrev_b32 v6, 8, v6
v_and_b32 v8, 1, v2
v_lshl_add_u32 v6, v8, 3, v6
v_bfe_u32 v8, v2, 1, 1
s_and_b32 s34, s31, 1
s_lshl_b32 s34, s34, 1
v_add_u32 v8, s34, v8
v_add_u32 v9, 0, v8
v_xor_b32 v9, v9, v7
v_lshl_add_u32 v13, v9, 4, v6
v_add_u32 v20, 65536, v13
v_add_u32 v9, 2, v8
v_xor_b32 v9, v9, v7
v_lshl_add_u32 v14, v9, 4, v6
v_add_u32 v21, 65536, v14
v_add_u32 v9, 4, v8
v_xor_b32 v9, v9, v7
v_lshl_add_u32 v15, v9, 4, v6
v_add_u32 v22, 65536, v15
v_add_u32 v9, 6, v8
v_xor_b32 v9, v9, v7
v_lshl_add_u32 v16, v9, 4, v6
v_add_u32 v23, 65536, v16
v_add_u32 v9, 8, v8
v_xor_b32 v9, v9, v7
v_lshl_add_u32 v17, v9, 4, v6
v_add_u32 v24, 65536, v17
v_add_u32 v9, 10, v8
v_xor_b32 v9, v9, v7
v_lshl_add_u32 v18, v9, 4, v6
v_add_u32 v25, 65536, v18
v_add_u32 v9, 12, v8
v_xor_b32 v9, v9, v7
v_lshl_add_u32 v19, v9, 4, v6
v_add_u32 v26, 65536, v19
s_lshl_b32 s40, s32, 3
s_lshl_b32 s34, s30, 1
s_add_u32 s40, s40, s34
s_mul_i32 s40, s40, 188416
s_lshl_b32 s34, s37, 10
s_add_u32 s40, s40, s34
s_lshl_b32 s41, s30, 13
s_mov_b32 s44, 0
s_mov_b32 s70, 0
s_and_b32 s57, s47, 0xffff
s_and_b32 s56, s49, 0xffff
s_mov_b32 s58, 3670016
s_barrier
s_cmp_ge_u32 s44, s38
s_cselect_b32 s43, 1, 0
s_cmp_ge_u32 s37, 128
s_cselect_b32 s8, s48, s46
s_cselect_b32 s9, s56, s57
s_cselect_b32 s10, 1605632, s58
s_cselect_b32 s35, 128, 0
s_sub_u32 s34, s37, s35
s_add_u32 s34, s34, s30
s_mul_i32 s34, s34, 28672
s_add_u32 s34, s34, s45
s_cmp_eq_u32 s43, 1
s_cselect_b32 s10, 0, s10
s_add_u32 m0, s41, 0
s_nop 0
buffer_load_dwordx4 v220, s[8:11], s34 offen offset:0 lds
buffer_load_dwordx4 v221, s[8:11], s34 offen offset:1024 lds
buffer_load_dwordx4 v222, s[8:11], s34 offen offset:2048 lds
buffer_load_dwordx4 v223, s[8:11], s34 offen offset:3072 lds
s_add_u32 m0, s41, 4096
s_nop 0
buffer_load_dwordx4 v224, s[8:11], s34 offen offset:0 lds
buffer_load_dwordx4 v225, s[8:11], s34 offen offset:1024 lds
buffer_load_dwordx4 v226, s[8:11], s34 offen offset:2048 lds
buffer_load_dwordx4 v227, s[8:11], s34 offen offset:3072 lds
s_add_u32 s37, s37, 4
s_add_u32 s44, s44, 1
s_cmp_ge_u32 s44, s38
s_cselect_b32 s43, 1, 0
s_cmp_ge_u32 s37, 128
s_cselect_b32 s8, s48, s46
s_cselect_b32 s9, s56, s57
s_cselect_b32 s10, 1605632, s58
s_cselect_b32 s35, 128, 0
s_sub_u32 s34, s37, s35
s_add_u32 s34, s34, s30
s_mul_i32 s34, s34, 28672
s_add_u32 s34, s34, s45
s_cmp_eq_u32 s43, 1
s_cselect_b32 s10, 0, s10
s_add_u32 m0, s41, 32768
s_nop 0
buffer_load_dwordx4 v220, s[8:11], s34 offen offset:0 lds
buffer_load_dwordx4 v221, s[8:11], s34 offen offset:1024 lds
buffer_load_dwordx4 v222, s[8:11], s34 offen offset:2048 lds
buffer_load_dwordx4 v223, s[8:11], s34 offen offset:3072 lds
s_add_u32 m0, s41, 36864
s_nop 0
buffer_load_dwordx4 v224, s[8:11], s34 offen offset:0 lds
buffer_load_dwordx4 v225, s[8:11], s34 offen offset:1024 lds
buffer_load_dwordx4 v226, s[8:11], s34 offen offset:2048 lds
buffer_load_dwordx4 v227, s[8:11], s34 offen offset:3072 lds
s_add_u32 s37, s37, 4
s_add_u32 s44, s44, 1
s_cmp_ge_u32 s44, s38
s_cselect_b32 s43, 1, 0
s_cmp_ge_u32 s37, 128
s_cselect_b32 s8, s48, s46
s_cselect_b32 s9, s56, s57
s_cselect_b32 s10, 1605632, s58
s_cselect_b32 s35, 128, 0
s_sub_u32 s34, s37, s35
s_add_u32 s34, s34, s30
s_mul_i32 s34, s34, 28672
s_add_u32 s34, s34, s45
s_cmp_eq_u32 s43, 1
s_cselect_b32 s10, 0, s10
s_add_u32 m0, s41, 65536
s_nop 0
buffer_load_dwordx4 v220, s[8:11], s34 offen offset:0 lds
buffer_load_dwordx4 v221, s[8:11], s34 offen offset:1024 lds
buffer_load_dwordx4 v222, s[8:11], s34 offen offset:2048 lds
buffer_load_dwordx4 v223, s[8:11], s34 offen offset:3072 lds
s_add_u32 m0, s41, 69632
s_nop 0
buffer_load_dwordx4 v224, s[8:11], s34 offen offset:0 lds
buffer_load_dwordx4 v225, s[8:11], s34 offen offset:1024 lds
buffer_load_dwordx4 v226, s[8:11], s34 offen offset:2048 lds
buffer_load_dwordx4 v227, s[8:11], s34 offen offset:3072 lds
s_add_u32 s37, s37, 4
s_add_u32 s44, s44, 1
s_waitcnt vmcnt(24)
s_barrier
s_cmp_eq_u32 s89, 2
s_cbranch_scc0 K2_FA
s_cmp_eq_u32 s30, 0
s_cbranch_scc0 K2_FA
v_mov_b32 v4, s88
v_mov_b32 v5, 1
v_cmp_eq_u32 s[78:79], 0, v2
s_and_saveexec_b64 s[76:77], s[78:79]
s_cbranch_execz K2_FAX
buffer_atomic_add v5, v4, s[72:75], 0 offen
K2_FAX:
s_mov_b64 exec, s[76:77]
K2_FA:
s_cmp_eq_u32 s30, 0
s_cbranch_scc0 K3_AFOK
s_lshl_b32 s34, s32, 2
s_add_u32 s34, s34, s33
s_lshl_b32 s34, s34, 8
s_add_u32 s34, s34, 20480
v_mov_b32 v5, s34
s_cmp_ge_u32 s33, 2
s_cselect_b32 s35, 7, 6
s_cmp_eq_u32 s33, 3
s_cselect_b32 s35, 11, s35
s_mov_b32 s36, 0x10000
K3_AFP:
buffer_load_dword v4, v5, s[24:27], 0 offen sc1
s_waitcnt vmcnt(0)
v_readfirstlane_b32 s34, v4
s_cmp_ge_u32 s34, s35
s_cbranch_scc1 K3_AFOK
s_sub_u32 s36, s36, 1
s_cmp_eq_u32 s36, 0
s_cbranch_scc1 K3_AFOK
s_sleep 4
s_branch K3_AFP
K3_AFOK:
s_barrier
s_cmp_ge_u32 s70, s38
s_cselect_b32 s6, 0, 24117248
s_add_u32 s36, s40, 188416
buffer_load_dwordx4 v[60:63], v3, s[4:7], s40 offen offset:0 sc1
buffer_load_dwordx4 v[64:67], v3, s[4:7], s36 offen offset:0 sc1
buffer_load_dwordx4 v[68:71], v3, s[4:7], s40 offen offset:1024 sc1
buffer_load_dwordx4 v[72:75], v3, s[4:7], s36 offen offset:1024 sc1
buffer_load_dwordx4 v[76:79], v3, s[4:7], s40 offen offset:2048 sc1
buffer_load_dwordx4 v[80:83], v3, s[4:7], s36 offen offset:2048 sc1
buffer_load_dwordx4 v[84:87], v3, s[4:7], s40 offen offset:3072 sc1
buffer_load_dwordx4 v[88:91], v3, s[4:7], s36 offen offset:3072 sc1
s_add_u32 s40, s40, 4096
s_add_u32 s70, s70, 1
s_cmp_ge_u32 s70, s38
s_cselect_b32 s6, 0, 24117248
s_add_u32 s36, s40, 188416
buffer_load_dwordx4 v[92:95], v3, s[4:7], s40 offen offset:0 sc1
buffer_load_dwordx4 v[96:99], v3, s[4:7], s36 offen offset:0 sc1
buffer_load_dwordx4 v[100:103], v3, s[4:7], s40 offen offset:1024 sc1
buffer_load_dwordx4 v[104:107], v3, s[4:7], s36 offen offset:1024 sc1
buffer_load_dwordx4 v[108:111], v3, s[4:7], s40 offen offset:2048 sc1
buffer_load_dwordx4 v[112:115], v3, s[4:7], s36 offen offset:2048 sc1
buffer_load_dwordx4 v[116:119], v3, s[4:7], s40 offen offset:3072 sc1
buffer_load_dwordx4 v[120:123], v3, s[4:7], s36 offen offset:3072 sc1
s_add_u32 s40, s40, 4096
s_add_u32 s70, s70, 1
s_cmp_ge_u32 s70, s38
s_cselect_b32 s6, 0, 24117248
s_add_u32 s36, s40, 188416
buffer_load_dwordx4 v[124:127], v3, s[4:7], s40 offen offset:0 sc1
buffer_load_dwordx4 v[128:131], v3, s[4:7], s36 offen offset:0 sc1
buffer_load_dwordx4 v[132:135], v3, s[4:7], s40 offen offset:1024 sc1
buffer_load_dwordx4 v[136:139], v3, s[4:7], s36 offen offset:1024 sc1
buffer_load_dwordx4 v[140:143], v3, s[4:7], s40 offen offset:2048 sc1
buffer_load_dwordx4 v[144:147], v3, s[4:7], s36 offen offset:2048 sc1
buffer_load_dwordx4 v[148:151], v3, s[4:7], s40 offen offset:3072 sc1
buffer_load_dwordx4 v[152:155], v3, s[4:7], s36 offen offset:3072 sc1
s_add_u32 s40, s40, 4096
s_add_u32 s70, s70, 1
s_cmp_ge_u32 s70, s38
s_cselect_b32 s6, 0, 24117248
s_add_u32 s36, s40, 188416
buffer_load_dwordx4 v[156:159], v3, s[4:7], s40 offen offset:0 sc1
buffer_load_dwordx4 v[160:163], v3, s[4:7], s36 offen offset:0 sc1
buffer_load_dwordx4 v[164:167], v3, s[4:7], s40 offen offset:1024 sc1
buffer_load_dwordx4 v[168:171], v3, s[4:7], s36 offen offset:1024 sc1
buffer_load_dwordx4 v[172:175], v3, s[4:7], s40 offen offset:2048 sc1
buffer_load_dwordx4 v[176:179], v3, s[4:7], s36 offen offset:2048 sc1
buffer_load_dwordx4 v[180:183], v3, s[4:7], s40 offen offset:3072 sc1
buffer_load_dwordx4 v[184:187], v3, s[4:7], s36 offen offset:3072 sc1
s_add_u32 s40, s40, 4096
s_add_u32 s70, s70, 1
s_mov_b32 s39, 0
s_waitcnt vmcnt(48)
s_barrier
ds_read_b64_tr_b16 v[28:29], v13 offset:0
ds_read_b64_tr_b16 v[30:31], v13 offset:4096
ds_read_b64_tr_b16 v[32:33], v14 offset:0
ds_read_b64_tr_b16 v[34:35], v14 offset:4096
ds_read_b64_tr_b16 v[36:37], v15 offset:0
ds_read_b64_tr_b16 v[38:39], v15 offset:4096
ds_read_b64_tr_b16 v[40:41], v16 offset:0
ds_read_b64_tr_b16 v[42:43], v16 offset:4096
ds_read_b64_tr_b16 v[44:45], v17 offset:0
ds_read_b64_tr_b16 v[46:47], v17 offset:4096
s_waitcnt vmcnt(24) lgkmcnt(8)
s_barrier
v_mfma_f32_16x16x32_bf16 a[0:3], v[28:31], v[60:63], 0
s_waitcnt lgkmcnt(6)
ds_read_b64_tr_b16 v[48:49], v18 offset:0
ds_read_b64_tr_b16 v[50:51], v18 offset:4096
v_mfma_f32_16x16x32_bf16 a[28:31], v[28:31], v[64:67], 0
s_cmp_ge_u32 s44, s38
s_cselect_b32 s43, 1, 0
v_mfma_f32_16x16x32_bf16 a[4:7], v[32:35], v[60:63], 0
s_waitcnt lgkmcnt(6)
ds_read_b64_tr_b16 v[52:53], v19 offset:0
ds_read_b64_tr_b16 v[54:55], v19 offset:4096
v_mfma_f32_16x16x32_bf16 a[32:35], v[32:35], v[64:67], 0
s_cmp_ge_u32 s37, 128
s_cselect_b32 s8, s48, s46
s_cselect_b32 s9, s56, s57
v_mfma_f32_16x16x32_bf16 a[8:11], v[36:39], v[60:63], 0
s_waitcnt lgkmcnt(6)
ds_read_b64_tr_b16 v[56:57], v13 offset:8192
ds_read_b64_tr_b16 v[58:59], v13 offset:12288
v_mfma_f32_16x16x32_bf16 a[36:39], v[36:39], v[64:67], 0
s_cselect_b32 s10, 1605632, s58
s_cselect_b32 s35, 128, 0
s_sub_u32 s34, s37, s35
v_mfma_f32_16x16x32_bf16 a[12:15], v[40:43], v[60:63], 0
s_waitcnt lgkmcnt(6)
ds_read_b64_tr_b16 v[28:29], v14 offset:8192
ds_read_b64_tr_b16 v[30:31], v14 offset:12288
v_mfma_f32_16x16x32_bf16 a[40:43], v[40:43], v[64:67], 0
s_add_u32 s34, s34, s30
s_mul_i32 s34, s34, 28672
s_add_u32 s34, s34, s45
v_mfma_f32_16x16x32_bf16 a[16:19], v[44:47], v[60:63], 0
s_waitcnt lgkmcnt(6)
ds_read_b64_tr_b16 v[32:33], v15 offset:8192
ds_read_b64_tr_b16 v[34:35], v15 offset:12288
v_mfma_f32_16x16x32_bf16 a[44:47], v[44:47], v[64:67], 0
s_cmp_eq_u32 s43, 1
s_cselect_b32 s10, 0, s10
s_add_u32 m0, s41, 98304
v_mfma_f32_16x16x32_bf16 a[20:23], v[48:51], v[60:63], 0
s_waitcnt lgkmcnt(6)
ds_read_b64_tr_b16 v[36:37], v16 offset:8192
ds_read_b64_tr_b16 v[38:39], v16 offset:12288
v_mfma_f32_16x16x32_bf16 a[48:51], v[48:51], v[64:67], 0
buffer_load_dwordx4 v220, s[8:11], s34 offen offset:0 lds
v_mfma_f32_16x16x32_bf16 a[24:27], v[52:55], v[60:63], 0
s_waitcnt lgkmcnt(6)
ds_read_b64_tr_b16 v[40:41], v17 offset:8192
ds_read_b64_tr_b16 v[42:43], v17 offset:12288
v_mfma_f32_16x16x32_bf16 a[52:55], v[52:55], v[64:67], 0
buffer_load_dwordx4 v221, s[8:11], s34 offen offset:1024 lds
v_mfma_f32_16x16x32_bf16 a[0:3], v[56:59], v[68:71], a[0:3]
s_waitcnt lgkmcnt(6)
ds_read_b64_tr_b16 v[44:45], v18 offset:8192
ds_read_b64_tr_b16 v[46:47], v18 offset:12288
v_mfma_f32_16x16x32_bf16 a[28:31], v[56:59], v[72:75], a[28:31]
buffer_load_dwordx4 v222, s[8:11], s34 offen offset:2048 lds
v_mfma_f32_16x16x32_bf16 a[4:7], v[28:31], v[68:71], a[4:7]
s_waitcnt lgkmcnt(6)
ds_read_b64_tr_b16 v[48:49], v19 offset:8192
ds_read_b64_tr_b16 v[50:51], v19 offset:12288
v_mfma_f32_16x16x32_bf16 a[32:35], v[28:31], v[72:75], a[32:35]
v_mfma_f32_16x16x32_bf16 a[8:11], v[32:35], v[68:71], a[8:11]
s_waitcnt lgkmcnt(6)
ds_read_b64_tr_b16 v[52:53], v13 offset:16384
ds_read_b64_tr_b16 v[54:55], v13 offset:20480
v_mfma_f32_16x16x32_bf16 a[36:39], v[32:35], v[72:75], a[36:39]
buffer_load_dwordx4 v223, s[8:11], s34 offen offset:3072 lds
v_mfma_f32_16x16x32_bf16 a[12:15], v[36:39], v[68:71], a[12:15]
s_waitcnt lgkmcnt(6)
s_add_u32 m0, s41, 102400
ds_read_b64_tr_b16 v[56:57], v14 offset:16384
ds_read_b64_tr_b16 v[58:59], v14 offset:20480
v_mfma_f32_16x16x32_bf16 a[40:43], v[36:39], v[72:75], a[40:43]
buffer_load_dwordx4 v224, s[8:11], s34 offen offset:0 lds
v_mfma_f32_16x16x32_bf16 a[16:19], v[40:43], v[68:71], a[16:19]
s_waitcnt lgkmcnt(6)
ds_read_b64_tr_b16 v[28:29], v15 offset:16384
ds_read_b64_tr_b16 v[30:31], v15 offset:20480
v_mfma_f32_16x16x32_bf16 a[44:47], v[40:43], v[72:75], a[44:47]
v_mfma_f32_16x16x32_bf16 a[20:23], v[44:47], v[68:71], a[20:23]
s_waitcnt lgkmcnt(6)
ds_read_b64_tr_b16 v[32:33], v16 offset:16384
ds_read_b64_tr_b16 v[34:35], v16 offset:20480
v_mfma_f32_16x16x32_bf16 a[48:51], v[44:47], v[72:75], a[48:51]
buffer_load_dwordx4 v225, s[8:11], s34 offen offset:1024 lds
v_mfma_f32_16x16x32_bf16 a[24:27], v[48:51], v[68:71], a[24:27]
s_waitcnt lgkmcnt(6)
ds_read_b64_tr_b16 v[36:37], v17 offset:16384
ds_read_b64_tr_b16 v[38:39], v17 offset:20480
v_mfma_f32_16x16x32_bf16 a[52:55], v[48:51], v[72:75], a[52:55]
buffer_load_dwordx4 v226, s[8:11], s34 offen offset:2048 lds
v_mfma_f32_16x16x32_bf16 a[0:3], v[52:55], v[76:79], a[0:3]
s_waitcnt lgkmcnt(6)
ds_read_b64_tr_b16 v[40:41], v18 offset:16384
ds_read_b64_tr_b16 v[42:43], v18 offset:20480
v_mfma_f32_16x16x32_bf16 a[28:31], v[52:55], v[80:83], a[28:31]
v_mfma_f32_16x16x32_bf16 a[4:7], v[56:59], v[76:79], a[4:7]
s_waitcnt lgkmcnt(6)
ds_read_b64_tr_b16 v[44:45], v19 offset:16384
ds_read_b64_tr_b16 v[46:47], v19 offset:20480
v_mfma_f32_16x16x32_bf16 a[32:35], v[56:59], v[80:83], a[32:35]
buffer_load_dwordx4 v227, s[8:11], s34 offen offset:3072 lds
v_mfma_f32_16x16x32_bf16 a[8:11], v[28:31], v[76:79], a[8:11]
s_waitcnt lgkmcnt(6)
s_cmp_ge_u32 s70, s38
s_cselect_b32 s6, 0, 24117248
s_add_u32 s36, s40, 188416
ds_read_b64_tr_b16 v[48:49], v13 offset:24576
ds_read_b64_tr_b16 v[50:51], v13 offset:28672
v_mfma_f32_16x16x32_bf16 a[36:39], v[28:31], v[80:83], a[36:39]
buffer_load_dwordx4 v[188:191], v3, s[4:7], s40 offen offset:0 sc1
v_mfma_f32_16x16x32_bf16 a[12:15], v[32:35], v[76:79], a[12:15]
s_waitcnt lgkmcnt(6)
ds_read_b64_tr_b16 v[52:53], v14 offset:24576
ds_read_b64_tr_b16 v[54:55], v14 offset:28672
v_mfma_f32_16x16x32_bf16 a[40:43], v[32:35], v[80:83], a[40:43]
v_mfma_f32_16x16x32_bf16 a[16:19], v[36:39], v[76:79], a[16:19]
s_waitcnt lgkmcnt(6)
ds_read_b64_tr_b16 v[56:57], v15 offset:24576
ds_read_b64_tr_b16 v[58:59], v15 offset:28672
v_mfma_f32_16x16x32_bf16 a[44:47], v[36:39], v[80:83], a[44:47]
buffer_load_dwordx4 v[192:195], v3, s[4:7], s36 offen offset:0 sc1
v_mfma_f32_16x16x32_bf16 a[20:23], v[40:43], v[76:79], a[20:23]
s_waitcnt lgkmcnt(6)
ds_read_b64_tr_b16 v[28:29], v16 offset:24576
ds_read_b64_tr_b16 v[30:31], v16 offset:28672
v_mfma_f32_16x16x32_bf16 a[48:51], v[40:43], v[80:83], a[48:51]
buffer_load_dwordx4 v[196:199], v3, s[4:7], s40 offen offset:1024 sc1
v_mfma_f32_16x16x32_bf16 a[24:27], v[44:47], v[76:79], a[24:27]
s_waitcnt lgkmcnt(6)
ds_read_b64_tr_b16 v[32:33], v17 offset:24576
ds_read_b64_tr_b16 v[34:35], v17 offset:28672
v_mfma_f32_16x16x32_bf16 a[52:55], v[44:47], v[80:83], a[52:55]
v_mfma_f32_16x16x32_bf16 a[0:3], v[48:51], v[84:87], a[0:3]
s_waitcnt lgkmcnt(6)
ds_read_b64_tr_b16 v[36:37], v18 offset:24576
ds_read_b64_tr_b16 v[38:39], v18 offset:28672
v_mfma_f32_16x16x32_bf16 a[28:31], v[48:51], v[88:91], a[28:31]
buffer_load_dwordx4 v[200:203], v3, s[4:7], s36 offen offset:1024 sc1
v_mfma_f32_16x16x32_bf16 a[4:7], v[52:55], v[84:87], a[4:7]
s_waitcnt lgkmcnt(6)
ds_read_b64_tr_b16 v[40:41], v19 offset:24576
ds_read_b64_tr_b16 v[42:43], v19 offset:28672
v_mfma_f32_16x16x32_bf16 a[32:35], v[52:55], v[88:91], a[32:35]
buffer_load_dwordx4 v[204:207], v3, s[4:7], s40 offen offset:2048 sc1
v_mfma_f32_16x16x32_bf16 a[8:11], v[56:59], v[84:87], a[8:11]
s_waitcnt lgkmcnt(6)
ds_read_b64_tr_b16 v[44:45], v13 offset:32768
ds_read_b64_tr_b16 v[46:47], v13 offset:36864
v_mfma_f32_16x16x32_bf16 a[36:39], v[56:59], v[88:91], a[36:39]
v_mfma_f32_16x16x32_bf16 a[12:15], v[28:31], v[84:87], a[12:15]
s_waitcnt lgkmcnt(6)
ds_read_b64_tr_b16 v[48:49], v14 offset:32768
ds_read_b64_tr_b16 v[50:51], v14 offset:36864
v_mfma_f32_16x16x32_bf16 a[40:43], v[28:31], v[88:91], a[40:43]
buffer_load_dwordx4 v[208:211], v3, s[4:7], s36 offen offset:2048 sc1
v_mfma_f32_16x16x32_bf16 a[16:19], v[32:35], v[84:87], a[16:19]
s_waitcnt lgkmcnt(6)
ds_read_b64_tr_b16 v[52:53], v15 offset:32768
ds_read_b64_tr_b16 v[54:55], v15 offset:36864
v_mfma_f32_16x16x32_bf16 a[44:47], v[32:35], v[88:91], a[44:47]
buffer_load_dwordx4 v[212:215], v3, s[4:7], s40 offen offset:3072 sc1
v_mfma_f32_16x16x32_bf16 a[20:23], v[36:39], v[84:87], a[20:23]
s_waitcnt lgkmcnt(6)
ds_read_b64_tr_b16 v[56:57], v16 offset:32768
ds_read_b64_tr_b16 v[58:59], v16 offset:36864
v_mfma_f32_16x16x32_bf16 a[48:51], v[36:39], v[88:91], a[48:51]
v_mfma_f32_16x16x32_bf16 a[24:27], v[40:43], v[84:87], a[24:27]
s_waitcnt lgkmcnt(6)
ds_read_b64_tr_b16 v[28:29], v17 offset:32768
ds_read_b64_tr_b16 v[30:31], v17 offset:36864
v_mfma_f32_16x16x32_bf16 a[52:55], v[40:43], v[88:91], a[52:55]
buffer_load_dwordx4 v[216:219], v3, s[4:7], s36 offen offset:3072 sc1
s_add_u32 s37, s37, 4
s_add_u32 s44, s44, 1
s_add_u32 s40, s40, 4096
s_add_u32 s70, s70, 1
s_waitcnt vmcnt(32) lgkmcnt(8)
s_barrier
v_mfma_f32_16x16x32_bf16 a[0:3], v[44:47], v[92:95], a[0:3]
s_waitcnt lgkmcnt(6)
ds_read_b64_tr_b16 v[32:33], v18 offset:32768
ds_read_b64_tr_b16 v[34:35], v18 offset:36864
v_mfma_f32_16x16x32_bf16 a[28:31], v[44:47], v[96:99], a[28:31]
s_cmp_ge_u32 s44, s38
s_cselect_b32 s43, 1, 0
v_mfma_f32_16x16x32_bf16 a[4:7], v[48:51], v[92:95], a[4:7]
s_waitcnt lgkmcnt(6)
ds_read_b64_tr_b16 v[36:37], v19 offset:32768
ds_read_b64_tr_b16 v[38:39], v19 offset:36864
v_mfma_f32_16x16x32_bf16 a[32:35], v[48:51], v[96:99], a[32:35]
s_cmp_ge_u32 s37, 128
s_cselect_b32 s8, s48, s46
s_cselect_b32 s9, s56, s57
v_mfma_f32_16x16x32_bf16 a[8:11], v[52:55], v[92:95], a[8:11]
s_waitcnt lgkmcnt(6)
ds_read_b64_tr_b16 v[40:41], v13 offset:40960
ds_read_b64_tr_b16 v[42:43], v13 offset:45056
v_mfma_f32_16x16x32_bf16 a[36:39], v[52:55], v[96:99], a[36:39]
s_cselect_b32 s10, 1605632, s58
s_cselect_b32 s35, 128, 0
s_sub_u32 s34, s37, s35
v_mfma_f32_16x16x32_bf16 a[12:15], v[56:59], v[92:95], a[12:15]
s_waitcnt lgkmcnt(6)
ds_read_b64_tr_b16 v[44:45], v14 offset:40960
ds_read_b64_tr_b16 v[46:47], v14 offset:45056
v_mfma_f32_16x16x32_bf16 a[40:43], v[56:59], v[96:99], a[40:43]
s_add_u32 s34, s34, s30
s_mul_i32 s34, s34, 28672
s_add_u32 s34, s34, s45
v_mfma_f32_16x16x32_bf16 a[16:19], v[28:31], v[92:95], a[16:19]
s_waitcnt lgkmcnt(6)
ds_read_b64_tr_b16 v[48:49], v15 offset:40960
ds_read_b64_tr_b16 v[50:51], v15 offset:45056
v_mfma_f32_16x16x32_bf16 a[44:47], v[28:31], v[96:99], a[44:47]
s_cmp_eq_u32 s43, 1
s_cselect_b32 s10, 0, s10
s_add_u32 m0, s41, 0
v_mfma_f32_16x16x32_bf16 a[20:23], v[32:35], v[92:95], a[20:23]
s_waitcnt lgkmcnt(6)
ds_read_b64_tr_b16 v[52:53], v16 offset:40960
ds_read_b64_tr_b16 v[54:55], v16 offset:45056
v_mfma_f32_16x16x32_bf16 a[48:51], v[32:35], v[96:99], a[48:51]
buffer_load_dwordx4 v220, s[8:11], s34 offen offset:0 lds
v_mfma_f32_16x16x32_bf16 a[24:27], v[36:39], v[92:95], a[24:27]
s_waitcnt lgkmcnt(6)
ds_read_b64_tr_b16 v[56:57], v17 offset:40960
ds_read_b64_tr_b16 v[58:59], v17 offset:45056
v_mfma_f32_16x16x32_bf16 a[52:55], v[36:39], v[96:99], a[52:55]
buffer_load_dwordx4 v221, s[8:11], s34 offen offset:1024 lds
v_mfma_f32_16x16x32_bf16 a[0:3], v[40:43], v[100:103], a[0:3]
s_waitcnt lgkmcnt(6)
ds_read_b64_tr_b16 v[28:29], v18 offset:40960
ds_read_b64_tr_b16 v[30:31], v18 offset:45056
v_mfma_f32_16x16x32_bf16 a[28:31], v[40:43], v[104:107], a[28:31]
buffer_load_dwordx4 v222, s[8:11], s34 offen offset:2048 lds
v_mfma_f32_16x16x32_bf16 a[4:7], v[44:47], v[100:103], a[4:7]
s_waitcnt lgkmcnt(6)
ds_read_b64_tr_b16 v[32:33], v19 offset:40960
ds_read_b64_tr_b16 v[34:35], v19 offset:45056
v_mfma_f32_16x16x32_bf16 a[32:35], v[44:47], v[104:107], a[32:35]
v_mfma_f32_16x16x32_bf16 a[8:11], v[48:51], v[100:103], a[8:11]
s_waitcnt lgkmcnt(6)
ds_read_b64_tr_b16 v[36:37], v13 offset:49152
ds_read_b64_tr_b16 v[38:39], v13 offset:53248
v_mfma_f32_16x16x32_bf16 a[36:39], v[48:51], v[104:107], a[36:39]
buffer_load_dwordx4 v223, s[8:11], s34 offen offset:3072 lds
v_mfma_f32_16x16x32_bf16 a[12:15], v[52:55], v[100:103], a[12:15]
s_waitcnt lgkmcnt(6)
s_add_u32 m0, s41, 4096
ds_read_b64_tr_b16 v[40:41], v14 offset:49152
ds_read_b64_tr_b16 v[42:43], v14 offset:53248
v_mfma_f32_16x16x32_bf16 a[40:43], v[52:55], v[104:107], a[40:43]
buffer_load_dwordx4 v224, s[8:11], s34 offen offset:0 lds
v_mfma_f32_16x16x32_bf16 a[16:19], v[56:59], v[100:103], a[16:19]
s_waitcnt lgkmcnt(6)
ds_read_b64_tr_b16 v[44:45], v15 offset:49152
ds_read_b64_tr_b16 v[46:47], v15 offset:53248
v_mfma_f32_16x16x32_bf16 a[44:47], v[56:59], v[104:107], a[44:47]
v_mfma_f32_16x16x32_bf16 a[20:23], v[28:31], v[100:103], a[20:23]
s_waitcnt lgkmcnt(6)
ds_read_b64_tr_b16 v[48:49], v16 offset:49152
ds_read_b64_tr_b16 v[50:51], v16 offset:53248
v_mfma_f32_16x16x32_bf16 a[48:51], v[28:31], v[104:107], a[48:51]
buffer_load_dwordx4 v225, s[8:11], s34 offen offset:1024 lds
v_mfma_f32_16x16x32_bf16 a[24:27], v[32:35], v[100:103], a[24:27]
s_waitcnt lgkmcnt(6)
ds_read_b64_tr_b16 v[52:53], v17 offset:49152
ds_read_b64_tr_b16 v[54:55], v17 offset:53248
v_mfma_f32_16x16x32_bf16 a[52:55], v[32:35], v[104:107], a[52:55]
buffer_load_dwordx4 v226, s[8:11], s34 offen offset:2048 lds
v_mfma_f32_16x16x32_bf16 a[0:3], v[36:39], v[108:111], a[0:3]
s_waitcnt lgkmcnt(6)
ds_read_b64_tr_b16 v[56:57], v18 offset:49152
ds_read_b64_tr_b16 v[58:59], v18 offset:53248
v_mfma_f32_16x16x32_bf16 a[28:31], v[36:39], v[112:115], a[28:31]
v_mfma_f32_16x16x32_bf16 a[4:7], v[40:43], v[108:111], a[4:7]
s_waitcnt lgkmcnt(6)
ds_read_b64_tr_b16 v[28:29], v19 offset:49152
ds_read_b64_tr_b16 v[30:31], v19 offset:53248
v_mfma_f32_16x16x32_bf16 a[32:35], v[40:43], v[112:115], a[32:35]
buffer_load_dwordx4 v227, s[8:11], s34 offen offset:3072 lds
v_mfma_f32_16x16x32_bf16 a[8:11], v[44:47], v[108:111], a[8:11]
s_waitcnt lgkmcnt(6)
s_cmp_ge_u32 s70, s38
s_cselect_b32 s6, 0, 24117248
s_add_u32 s36, s40, 188416
ds_read_b64_tr_b16 v[32:33], v13 offset:57344
ds_read_b64_tr_b16 v[34:35], v13 offset:61440
v_mfma_f32_16x16x32_bf16 a[36:39], v[44:47], v[112:115], a[36:39]
buffer_load_dwordx4 v[60:63], v3, s[4:7], s40 offen offset:0 sc1
v_mfma_f32_16x16x32_bf16 a[12:15], v[48:51], v[108:111], a[12:15]
s_waitcnt lgkmcnt(6)
ds_read_b64_tr_b16 v[36:37], v14 offset:57344
ds_read_b64_tr_b16 v[38:39], v14 offset:61440
v_mfma_f32_16x16x32_bf16 a[40:43], v[48:51], v[112:115], a[40:43]
v_mfma_f32_16x16x32_bf16 a[16:19], v[52:55], v[108:111], a[16:19]
s_waitcnt lgkmcnt(6)
ds_read_b64_tr_b16 v[40:41], v15 offset:57344
ds_read_b64_tr_b16 v[42:43], v15 offset:61440
v_mfma_f32_16x16x32_bf16 a[44:47], v[52:55], v[112:115], a[44:47]
buffer_load_dwordx4 v[64:67], v3, s[4:7], s36 offen offset:0 sc1
v_mfma_f32_16x16x32_bf16 a[20:23], v[56:59], v[108:111], a[20:23]
s_waitcnt lgkmcnt(6)
ds_read_b64_tr_b16 v[44:45], v16 offset:57344
ds_read_b64_tr_b16 v[46:47], v16 offset:61440
v_mfma_f32_16x16x32_bf16 a[48:51], v[56:59], v[112:115], a[48:51]
buffer_load_dwordx4 v[68:71], v3, s[4:7], s40 offen offset:1024 sc1
v_mfma_f32_16x16x32_bf16 a[24:27], v[28:31], v[108:111], a[24:27]
s_waitcnt lgkmcnt(6)
ds_read_b64_tr_b16 v[48:49], v17 offset:57344
ds_read_b64_tr_b16 v[50:51], v17 offset:61440
v_mfma_f32_16x16x32_bf16 a[52:55], v[28:31], v[112:115], a[52:55]
v_mfma_f32_16x16x32_bf16 a[0:3], v[32:35], v[116:119], a[0:3]
s_waitcnt lgkmcnt(6)
ds_read_b64_tr_b16 v[52:53], v18 offset:57344
ds_read_b64_tr_b16 v[54:55], v18 offset:61440
v_mfma_f32_16x16x32_bf16 a[28:31], v[32:35], v[120:123], a[28:31]
buffer_load_dwordx4 v[72:75], v3, s[4:7], s36 offen offset:1024 sc1
v_mfma_f32_16x16x32_bf16 a[4:7], v[36:39], v[116:119], a[4:7]
s_waitcnt lgkmcnt(6)
ds_read_b64_tr_b16 v[56:57], v19 offset:57344
ds_read_b64_tr_b16 v[58:59], v19 offset:61440
v_mfma_f32_16x16x32_bf16 a[32:35], v[36:39], v[120:123], a[32:35]
buffer_load_dwordx4 v[76:79], v3, s[4:7], s40 offen offset:2048 sc1
v_mfma_f32_16x16x32_bf16 a[8:11], v[40:43], v[116:119], a[8:11]
s_waitcnt lgkmcnt(6)
ds_read_b64_tr_b16 v[28:29], v20 offset:0
ds_read_b64_tr_b16 v[30:31], v20 offset:4096
v_mfma_f32_16x16x32_bf16 a[36:39], v[40:43], v[120:123], a[36:39]
v_mfma_f32_16x16x32_bf16 a[12:15], v[44:47], v[116:119], a[12:15]
s_waitcnt lgkmcnt(6)
ds_read_b64_tr_b16 v[32:33], v21 offset:0
ds_read_b64_tr_b16 v[34:35], v21 offset:4096
v_mfma_f32_16x16x32_bf16 a[40:43], v[44:47], v[120:123], a[40:43]
buffer_load_dwordx4 v[80:83], v3, s[4:7], s36 offen offset:2048 sc1
v_mfma_f32_16x16x32_bf16 a[16:19], v[48:51], v[116:119], a[16:19]
s_waitcnt lgkmcnt(6)
ds_read_b64_tr_b16 v[36:37], v22 offset:0
ds_read_b64_tr_b16 v[38:39], v22 offset:4096
v_mfma_f32_16x16x32_bf16 a[44:47], v[48:51], v[120:123], a[44:47]
buffer_load_dwordx4 v[84:87], v3, s[4:7], s40 offen offset:3072 sc1
v_mfma_f32_16x16x32_bf16 a[20:23], v[52:55], v[116:119], a[20:23]
s_waitcnt lgkmcnt(6)
ds_read_b64_tr_b16 v[40:41], v23 offset:0
ds_read_b64_tr_b16 v[42:43], v23 offset:4096
v_mfma_f32_16x16x32_bf16 a[48:51], v[52:55], v[120:123], a[48:51]
v_mfma_f32_16x16x32_bf16 a[24:27], v[56:59], v[116:119], a[24:27]
s_waitcnt lgkmcnt(6)
ds_read_b64_tr_b16 v[44:45], v24 offset:0
ds_read_b64_tr_b16 v[46:47], v24 offset:4096
v_mfma_f32_16x16x32_bf16 a[52:55], v[56:59], v[120:123], a[52:55]
buffer_load_dwordx4 v[88:91], v3, s[4:7], s36 offen offset:3072 sc1
s_add_u32 s37, s37, 4
s_add_u32 s44, s44, 1
s_add_u32 s40, s40, 4096
s_add_u32 s70, s70, 1
s_waitcnt vmcnt(24) lgkmcnt(8)
s_barrier
v_mfma_f32_16x16x32_bf16 a[0:3], v[28:31], v[124:127], a[0:3]
s_waitcnt lgkmcnt(6)
ds_read_b64_tr_b16 v[48:49], v25 offset:0
ds_read_b64_tr_b16 v[50:51], v25 offset:4096
v_mfma_f32_16x16x32_bf16 a[28:31], v[28:31], v[128:131], a[28:31]
s_cmp_ge_u32 s44, s38
s_cselect_b32 s43, 1, 0
v_mfma_f32_16x16x32_bf16 a[4:7], v[32:35], v[124:127], a[4:7]
s_waitcnt lgkmcnt(6)
ds_read_b64_tr_b16 v[52:53], v26 offset:0
ds_read_b64_tr_b16 v[54:55], v26 offset:4096
v_mfma_f32_16x16x32_bf16 a[32:35], v[32:35], v[128:131], a[32:35]
s_cmp_ge_u32 s37, 128
s_cselect_b32 s8, s48, s46
s_cselect_b32 s9, s56, s57
v_mfma_f32_16x16x32_bf16 a[8:11], v[36:39], v[124:127], a[8:11]
s_waitcnt lgkmcnt(6)
ds_read_b64_tr_b16 v[56:57], v20 offset:8192
ds_read_b64_tr_b16 v[58:59], v20 offset:12288
v_mfma_f32_16x16x32_bf16 a[36:39], v[36:39], v[128:131], a[36:39]
s_cselect_b32 s10, 1605632, s58
s_cselect_b32 s35, 128, 0
s_sub_u32 s34, s37, s35
v_mfma_f32_16x16x32_bf16 a[12:15], v[40:43], v[124:127], a[12:15]
s_waitcnt lgkmcnt(6)
ds_read_b64_tr_b16 v[28:29], v21 offset:8192
ds_read_b64_tr_b16 v[30:31], v21 offset:12288
v_mfma_f32_16x16x32_bf16 a[40:43], v[40:43], v[128:131], a[40:43]
s_add_u32 s34, s34, s30
s_mul_i32 s34, s34, 28672
s_add_u32 s34, s34, s45
v_mfma_f32_16x16x32_bf16 a[16:19], v[44:47], v[124:127], a[16:19]
s_waitcnt lgkmcnt(6)
ds_read_b64_tr_b16 v[32:33], v22 offset:8192
ds_read_b64_tr_b16 v[34:35], v22 offset:12288
v_mfma_f32_16x16x32_bf16 a[44:47], v[44:47], v[128:131], a[44:47]
s_cmp_eq_u32 s43, 1
s_cselect_b32 s10, 0, s10
s_add_u32 m0, s41, 32768
v_mfma_f32_16x16x32_bf16 a[20:23], v[48:51], v[124:127], a[20:23]
s_waitcnt lgkmcnt(6)
ds_read_b64_tr_b16 v[36:37], v23 offset:8192
ds_read_b64_tr_b16 v[38:39], v23 offset:12288
v_mfma_f32_16x16x32_bf16 a[48:51], v[48:51], v[128:131], a[48:51]
buffer_load_dwordx4 v220, s[8:11], s34 offen offset:0 lds
v_mfma_f32_16x16x32_bf16 a[24:27], v[52:55], v[124:127], a[24:27]
s_waitcnt lgkmcnt(6)
ds_read_b64_tr_b16 v[40:41], v24 offset:8192
ds_read_b64_tr_b16 v[42:43], v24 offset:12288
v_mfma_f32_16x16x32_bf16 a[52:55], v[52:55], v[128:131], a[52:55]
buffer_load_dwordx4 v221, s[8:11], s34 offen offset:1024 lds
v_mfma_f32_16x16x32_bf16 a[0:3], v[56:59], v[132:135], a[0:3]
s_waitcnt lgkmcnt(6)
ds_read_b64_tr_b16 v[44:45], v25 offset:8192
ds_read_b64_tr_b16 v[46:47], v25 offset:12288
v_mfma_f32_16x16x32_bf16 a[28:31], v[56:59], v[136:139], a[28:31]
buffer_load_dwordx4 v222, s[8:11], s34 offen offset:2048 lds
v_mfma_f32_16x16x32_bf16 a[4:7], v[28:31], v[132:135], a[4:7]
s_waitcnt lgkmcnt(6)
ds_read_b64_tr_b16 v[48:49], v26 offset:8192
ds_read_b64_tr_b16 v[50:51], v26 offset:12288
v_mfma_f32_16x16x32_bf16 a[32:35], v[28:31], v[136:139], a[32:35]
v_mfma_f32_16x16x32_bf16 a[8:11], v[32:35], v[132:135], a[8:11]
s_waitcnt lgkmcnt(6)
ds_read_b64_tr_b16 v[52:53], v20 offset:16384
ds_read_b64_tr_b16 v[54:55], v20 offset:20480
v_mfma_f32_16x16x32_bf16 a[36:39], v[32:35], v[136:139], a[36:39]
buffer_load_dwordx4 v223, s[8:11], s34 offen offset:3072 lds
v_mfma_f32_16x16x32_bf16 a[12:15], v[36:39], v[132:135], a[12:15]
s_waitcnt lgkmcnt(6)
s_add_u32 m0, s41, 36864
ds_read_b64_tr_b16 v[56:57], v21 offset:16384
ds_read_b64_tr_b16 v[58:59], v21 offset:20480
v_mfma_f32_16x16x32_bf16 a[40:43], v[36:39], v[136:139], a[40:43]
buffer_load_dwordx4 v224, s[8:11], s34 offen offset:0 lds
v_mfma_f32_16x16x32_bf16 a[16:19], v[40:43], v[132:135], a[16:19]
s_waitcnt lgkmcnt(6)
ds_read_b64_tr_b16 v[28:29], v22 offset:16384
ds_read_b64_tr_b16 v[30:31], v22 offset:20480
v_mfma_f32_16x16x32_bf16 a[44:47], v[40:43], v[136:139], a[44:47]
v_mfma_f32_16x16x32_bf16 a[20:23], v[44:47], v[132:135], a[20:23]
s_waitcnt lgkmcnt(6)
ds_read_b64_tr_b16 v[32:33], v23 offset:16384
ds_read_b64_tr_b16 v[34:35], v23 offset:20480
v_mfma_f32_16x16x32_bf16 a[48:51], v[44:47], v[136:139], a[48:51]
buffer_load_dwordx4 v225, s[8:11], s34 offen offset:1024 lds
v_mfma_f32_16x16x32_bf16 a[24:27], v[48:51], v[132:135], a[24:27]
s_waitcnt lgkmcnt(6)
ds_read_b64_tr_b16 v[36:37], v24 offset:16384
ds_read_b64_tr_b16 v[38:39], v24 offset:20480
v_mfma_f32_16x16x32_bf16 a[52:55], v[48:51], v[136:139], a[52:55]
buffer_load_dwordx4 v226, s[8:11], s34 offen offset:2048 lds
v_mfma_f32_16x16x32_bf16 a[0:3], v[52:55], v[140:143], a[0:3]
s_waitcnt lgkmcnt(6)
ds_read_b64_tr_b16 v[40:41], v25 offset:16384
ds_read_b64_tr_b16 v[42:43], v25 offset:20480
v_mfma_f32_16x16x32_bf16 a[28:31], v[52:55], v[144:147], a[28:31]
v_mfma_f32_16x16x32_bf16 a[4:7], v[56:59], v[140:143], a[4:7]
s_waitcnt lgkmcnt(6)
ds_read_b64_tr_b16 v[44:45], v26 offset:16384
ds_read_b64_tr_b16 v[46:47], v26 offset:20480
v_mfma_f32_16x16x32_bf16 a[32:35], v[56:59], v[144:147], a[32:35]
buffer_load_dwordx4 v227, s[8:11], s34 offen offset:3072 lds
v_mfma_f32_16x16x32_bf16 a[8:11], v[28:31], v[140:143], a[8:11]
s_waitcnt lgkmcnt(6)
s_cmp_ge_u32 s70, s38
s_cselect_b32 s6, 0, 24117248
s_add_u32 s36, s40, 188416
ds_read_b64_tr_b16 v[48:49], v20 offset:24576
ds_read_b64_tr_b16 v[50:51], v20 offset:28672
v_mfma_f32_16x16x32_bf16 a[36:39], v[28:31], v[144:147], a[36:39]
buffer_load_dwordx4 v[92:95], v3, s[4:7], s40 offen offset:0 sc1
v_mfma_f32_16x16x32_bf16 a[12:15], v[32:35], v[140:143], a[12:15]
s_waitcnt lgkmcnt(6)
ds_read_b64_tr_b16 v[52:53], v21 offset:24576
ds_read_b64_tr_b16 v[54:55], v21 offset:28672
v_mfma_f32_16x16x32_bf16 a[40:43], v[32:35], v[144:147], a[40:43]
v_mfma_f32_16x16x32_bf16 a[16:19], v[36:39], v[140:143], a[16:19]
s_waitcnt lgkmcnt(6)
ds_read_b64_tr_b16 v[56:57], v22 offset:24576
ds_read_b64_tr_b16 v[58:59], v22 offset:28672
v_mfma_f32_16x16x32_bf16 a[44:47], v[36:39], v[144:147], a[44:47]
buffer_load_dwordx4 v[96:99], v3, s[4:7], s36 offen offset:0 sc1
v_mfma_f32_16x16x32_bf16 a[20:23], v[40:43], v[140:143], a[20:23]
s_waitcnt lgkmcnt(6)
ds_read_b64_tr_b16 v[28:29], v23 offset:24576
ds_read_b64_tr_b16 v[30:31], v23 offset:28672
v_mfma_f32_16x16x32_bf16 a[48:51], v[40:43], v[144:147], a[48:51]
buffer_load_dwordx4 v[100:103], v3, s[4:7], s40 offen offset:1024 sc1
v_mfma_f32_16x16x32_bf16 a[24:27], v[44:47], v[140:143], a[24:27]
s_waitcnt lgkmcnt(6)
ds_read_b64_tr_b16 v[32:33], v24 offset:24576
ds_read_b64_tr_b16 v[34:35], v24 offset:28672
v_mfma_f32_16x16x32_bf16 a[52:55], v[44:47], v[144:147], a[52:55]
v_mfma_f32_16x16x32_bf16 a[0:3], v[48:51], v[148:151], a[0:3]
s_waitcnt lgkmcnt(6)
ds_read_b64_tr_b16 v[36:37], v25 offset:24576
ds_read_b64_tr_b16 v[38:39], v25 offset:28672
v_mfma_f32_16x16x32_bf16 a[28:31], v[48:51], v[152:155], a[28:31]
buffer_load_dwordx4 v[104:107], v3, s[4:7], s36 offen offset:1024 sc1
v_mfma_f32_16x16x32_bf16 a[4:7], v[52:55], v[148:151], a[4:7]
s_waitcnt lgkmcnt(6)
ds_read_b64_tr_b16 v[40:41], v26 offset:24576
ds_read_b64_tr_b16 v[42:43], v26 offset:28672
v_mfma_f32_16x16x32_bf16 a[32:35], v[52:55], v[152:155], a[32:35]
buffer_load_dwordx4 v[108:111], v3, s[4:7], s40 offen offset:2048 sc1
v_mfma_f32_16x16x32_bf16 a[8:11], v[56:59], v[148:151], a[8:11]
s_waitcnt lgkmcnt(6)
ds_read_b64_tr_b16 v[44:45], v20 offset:32768
ds_read_b64_tr_b16 v[46:47], v20 offset:36864
v_mfma_f32_16x16x32_bf16 a[36:39], v[56:59], v[152:155], a[36:39]
v_mfma_f32_16x16x32_bf16 a[12:15], v[28:31], v[148:151], a[12:15]
s_waitcnt lgkmcnt(6)
ds_read_b64_tr_b16 v[48:49], v21 offset:32768
ds_read_b64_tr_b16 v[50:51], v21 offset:36864
v_mfma_f32_16x16x32_bf16 a[40:43], v[28:31], v[152:155], a[40:43]
buffer_load_dwordx4 v[112:115], v3, s[4:7], s36 offen offset:2048 sc1
v_mfma_f32_16x16x32_bf16 a[16:19], v[32:35], v[148:151], a[16:19]
s_waitcnt lgkmcnt(6)
ds_read_b64_tr_b16 v[52:53], v22 offset:32768
ds_read_b64_tr_b16 v[54:55], v22 offset:36864
v_mfma_f32_16x16x32_bf16 a[44:47], v[32:35], v[152:155], a[44:47]
buffer_load_dwordx4 v[116:119], v3, s[4:7], s40 offen offset:3072 sc1
v_mfma_f32_16x16x32_bf16 a[20:23], v[36:39], v[148:151], a[20:23]
s_waitcnt lgkmcnt(6)
ds_read_b64_tr_b16 v[56:57], v23 offset:32768
ds_read_b64_tr_b16 v[58:59], v23 offset:36864
v_mfma_f32_16x16x32_bf16 a[48:51], v[36:39], v[152:155], a[48:51]
v_mfma_f32_16x16x32_bf16 a[24:27], v[40:43], v[148:151], a[24:27]
s_waitcnt lgkmcnt(6)
ds_read_b64_tr_b16 v[28:29], v24 offset:32768
ds_read_b64_tr_b16 v[30:31], v24 offset:36864
v_mfma_f32_16x16x32_bf16 a[52:55], v[40:43], v[152:155], a[52:55]
buffer_load_dwordx4 v[120:123], v3, s[4:7], s36 offen offset:3072 sc1
s_add_u32 s37, s37, 4
s_add_u32 s44, s44, 1
s_add_u32 s40, s40, 4096
s_add_u32 s70, s70, 1
s_waitcnt vmcnt(24) lgkmcnt(8)
s_barrier
v_mfma_f32_16x16x32_bf16 a[0:3], v[44:47], v[156:159], a[0:3]
s_waitcnt lgkmcnt(6)
ds_read_b64_tr_b16 v[32:33], v25 offset:32768
ds_read_b64_tr_b16 v[34:35], v25 offset:36864
v_mfma_f32_16x16x32_bf16 a[28:31], v[44:47], v[160:163], a[28:31]
s_cmp_ge_u32 s44, s38
s_cselect_b32 s43, 1, 0
v_mfma_f32_16x16x32_bf16 a[4:7], v[48:51], v[156:159], a[4:7]
s_waitcnt lgkmcnt(6)
ds_read_b64_tr_b16 v[36:37], v26 offset:32768
ds_read_b64_tr_b16 v[38:39], v26 offset:36864
v_mfma_f32_16x16x32_bf16 a[32:35], v[48:51], v[160:163], a[32:35]
s_cmp_ge_u32 s37, 128
s_cselect_b32 s8, s48, s46
s_cselect_b32 s9, s56, s57
v_mfma_f32_16x16x32_bf16 a[8:11], v[52:55], v[156:159], a[8:11]
s_waitcnt lgkmcnt(6)
ds_read_b64_tr_b16 v[40:41], v20 offset:40960
ds_read_b64_tr_b16 v[42:43], v20 offset:45056
v_mfma_f32_16x16x32_bf16 a[36:39], v[52:55], v[160:163], a[36:39]
s_cselect_b32 s10, 1605632, s58
s_cselect_b32 s35, 128, 0
s_sub_u32 s34, s37, s35
v_mfma_f32_16x16x32_bf16 a[12:15], v[56:59], v[156:159], a[12:15]
s_waitcnt lgkmcnt(6)
ds_read_b64_tr_b16 v[44:45], v21 offset:40960
ds_read_b64_tr_b16 v[46:47], v21 offset:45056
v_mfma_f32_16x16x32_bf16 a[40:43], v[56:59], v[160:163], a[40:43]
s_add_u32 s34, s34, s30
s_mul_i32 s34, s34, 28672
s_add_u32 s34, s34, s45
v_mfma_f32_16x16x32_bf16 a[16:19], v[28:31], v[156:159], a[16:19]
s_waitcnt lgkmcnt(6)
ds_read_b64_tr_b16 v[48:49], v22 offset:40960
ds_read_b64_tr_b16 v[50:51], v22 offset:45056
v_mfma_f32_16x16x32_bf16 a[44:47], v[28:31], v[160:163], a[44:47]
s_cmp_eq_u32 s43, 1
s_cselect_b32 s10, 0, s10
s_add_u32 m0, s41, 65536
v_mfma_f32_16x16x32_bf16 a[20:23], v[32:35], v[156:159], a[20:23]
s_waitcnt lgkmcnt(6)
ds_read_b64_tr_b16 v[52:53], v23 offset:40960
ds_read_b64_tr_b16 v[54:55], v23 offset:45056
v_mfma_f32_16x16x32_bf16 a[48:51], v[32:35], v[160:163], a[48:51]
buffer_load_dwordx4 v220, s[8:11], s34 offen offset:0 lds
v_mfma_f32_16x16x32_bf16 a[24:27], v[36:39], v[156:159], a[24:27]
s_waitcnt lgkmcnt(6)
ds_read_b64_tr_b16 v[56:57], v24 offset:40960
ds_read_b64_tr_b16 v[58:59], v24 offset:45056
v_mfma_f32_16x16x32_bf16 a[52:55], v[36:39], v[160:163], a[52:55]
buffer_load_dwordx4 v221, s[8:11], s34 offen offset:1024 lds
v_mfma_f32_16x16x32_bf16 a[0:3], v[40:43], v[164:167], a[0:3]
s_waitcnt lgkmcnt(6)
ds_read_b64_tr_b16 v[28:29], v25 offset:40960
ds_read_b64_tr_b16 v[30:31], v25 offset:45056
v_mfma_f32_16x16x32_bf16 a[28:31], v[40:43], v[168:171], a[28:31]
buffer_load_dwordx4 v222, s[8:11], s34 offen offset:2048 lds
v_mfma_f32_16x16x32_bf16 a[4:7], v[44:47], v[164:167], a[4:7]
s_waitcnt lgkmcnt(6)
ds_read_b64_tr_b16 v[32:33], v26 offset:40960
ds_read_b64_tr_b16 v[34:35], v26 offset:45056
v_mfma_f32_16x16x32_bf16 a[32:35], v[44:47], v[168:171], a[32:35]
v_mfma_f32_16x16x32_bf16 a[8:11], v[48:51], v[164:167], a[8:11]
s_waitcnt lgkmcnt(6)
ds_read_b64_tr_b16 v[36:37], v20 offset:49152
ds_read_b64_tr_b16 v[38:39], v20 offset:53248
v_mfma_f32_16x16x32_bf16 a[36:39], v[48:51], v[168:171], a[36:39]
buffer_load_dwordx4 v223, s[8:11], s34 offen offset:3072 lds
v_mfma_f32_16x16x32_bf16 a[12:15], v[52:55], v[164:167], a[12:15]
s_waitcnt lgkmcnt(6)
s_add_u32 m0, s41, 69632
ds_read_b64_tr_b16 v[40:41], v21 offset:49152
ds_read_b64_tr_b16 v[42:43], v21 offset:53248
v_mfma_f32_16x16x32_bf16 a[40:43], v[52:55], v[168:171], a[40:43]
buffer_load_dwordx4 v224, s[8:11], s34 offen offset:0 lds
v_mfma_f32_16x16x32_bf16 a[16:19], v[56:59], v[164:167], a[16:19]
s_waitcnt lgkmcnt(6)
ds_read_b64_tr_b16 v[44:45], v22 offset:49152
ds_read_b64_tr_b16 v[46:47], v22 offset:53248
v_mfma_f32_16x16x32_bf16 a[44:47], v[56:59], v[168:171], a[44:47]
v_mfma_f32_16x16x32_bf16 a[20:23], v[28:31], v[164:167], a[20:23]
s_waitcnt lgkmcnt(6)
ds_read_b64_tr_b16 v[48:49], v23 offset:49152
ds_read_b64_tr_b16 v[50:51], v23 offset:53248
v_mfma_f32_16x16x32_bf16 a[48:51], v[28:31], v[168:171], a[48:51]
buffer_load_dwordx4 v225, s[8:11], s34 offen offset:1024 lds
v_mfma_f32_16x16x32_bf16 a[24:27], v[32:35], v[164:167], a[24:27]
s_waitcnt lgkmcnt(6)
ds_read_b64_tr_b16 v[52:53], v24 offset:49152
ds_read_b64_tr_b16 v[54:55], v24 offset:53248
v_mfma_f32_16x16x32_bf16 a[52:55], v[32:35], v[168:171], a[52:55]
buffer_load_dwordx4 v226, s[8:11], s34 offen offset:2048 lds
v_mfma_f32_16x16x32_bf16 a[0:3], v[36:39], v[172:175], a[0:3]
s_waitcnt lgkmcnt(6)
ds_read_b64_tr_b16 v[56:57], v25 offset:49152
ds_read_b64_tr_b16 v[58:59], v25 offset:53248
v_mfma_f32_16x16x32_bf16 a[28:31], v[36:39], v[176:179], a[28:31]
v_mfma_f32_16x16x32_bf16 a[4:7], v[40:43], v[172:175], a[4:7]
s_waitcnt lgkmcnt(6)
ds_read_b64_tr_b16 v[28:29], v26 offset:49152
ds_read_b64_tr_b16 v[30:31], v26 offset:53248
v_mfma_f32_16x16x32_bf16 a[32:35], v[40:43], v[176:179], a[32:35]
buffer_load_dwordx4 v227, s[8:11], s34 offen offset:3072 lds
v_mfma_f32_16x16x32_bf16 a[8:11], v[44:47], v[172:175], a[8:11]
s_waitcnt lgkmcnt(6)
s_cmp_ge_u32 s70, s38
s_cselect_b32 s6, 0, 24117248
s_add_u32 s36, s40, 188416
ds_read_b64_tr_b16 v[32:33], v20 offset:57344
ds_read_b64_tr_b16 v[34:35], v20 offset:61440
v_mfma_f32_16x16x32_bf16 a[36:39], v[44:47], v[176:179], a[36:39]
buffer_load_dwordx4 v[124:127], v3, s[4:7], s40 offen offset:0 sc1
v_mfma_f32_16x16x32_bf16 a[12:15], v[48:51], v[172:175], a[12:15]
s_waitcnt lgkmcnt(6)
ds_read_b64_tr_b16 v[36:37], v21 offset:57344
ds_read_b64_tr_b16 v[38:39], v21 offset:61440
v_mfma_f32_16x16x32_bf16 a[40:43], v[48:51], v[176:179], a[40:43]
v_mfma_f32_16x16x32_bf16 a[16:19], v[52:55], v[172:175], a[16:19]
s_waitcnt lgkmcnt(6)
ds_read_b64_tr_b16 v[40:41], v22 offset:57344
ds_read_b64_tr_b16 v[42:43], v22 offset:61440
v_mfma_f32_16x16x32_bf16 a[44:47], v[52:55], v[176:179], a[44:47]
buffer_load_dwordx4 v[128:131], v3, s[4:7], s36 offen offset:0 sc1
v_mfma_f32_16x16x32_bf16 a[20:23], v[56:59], v[172:175], a[20:23]
s_waitcnt lgkmcnt(6)
ds_read_b64_tr_b16 v[44:45], v23 offset:57344
ds_read_b64_tr_b16 v[46:47], v23 offset:61440
v_mfma_f32_16x16x32_bf16 a[48:51], v[56:59], v[176:179], a[48:51]
buffer_load_dwordx4 v[132:135], v3, s[4:7], s40 offen offset:1024 sc1
v_mfma_f32_16x16x32_bf16 a[24:27], v[28:31], v[172:175], a[24:27]
s_waitcnt lgkmcnt(6)
ds_read_b64_tr_b16 v[48:49], v24 offset:57344
ds_read_b64_tr_b16 v[50:51], v24 offset:61440
v_mfma_f32_16x16x32_bf16 a[52:55], v[28:31], v[176:179], a[52:55]
v_mfma_f32_16x16x32_bf16 a[0:3], v[32:35], v[180:183], a[0:3]
s_waitcnt lgkmcnt(6)
ds_read_b64_tr_b16 v[52:53], v25 offset:57344
ds_read_b64_tr_b16 v[54:55], v25 offset:61440
v_mfma_f32_16x16x32_bf16 a[28:31], v[32:35], v[184:187], a[28:31]
buffer_load_dwordx4 v[136:139], v3, s[4:7], s36 offen offset:1024 sc1
v_mfma_f32_16x16x32_bf16 a[4:7], v[36:39], v[180:183], a[4:7]
s_waitcnt lgkmcnt(6)
ds_read_b64_tr_b16 v[56:57], v26 offset:57344
ds_read_b64_tr_b16 v[58:59], v26 offset:61440
v_mfma_f32_16x16x32_bf16 a[32:35], v[36:39], v[184:187], a[32:35]
buffer_load_dwordx4 v[140:143], v3, s[4:7], s40 offen offset:2048 sc1
v_mfma_f32_16x16x32_bf16 a[8:11], v[40:43], v[180:183], a[8:11]
s_waitcnt lgkmcnt(6)
ds_read_b64_tr_b16 v[28:29], v13 offset:0
ds_read_b64_tr_b16 v[30:31], v13 offset:4096
v_mfma_f32_16x16x32_bf16 a[36:39], v[40:43], v[184:187], a[36:39]
v_mfma_f32_16x16x32_bf16 a[12:15], v[44:47], v[180:183], a[12:15]
s_waitcnt lgkmcnt(6)
ds_read_b64_tr_b16 v[32:33], v14 offset:0
ds_read_b64_tr_b16 v[34:35], v14 offset:4096
v_mfma_f32_16x16x32_bf16 a[40:43], v[44:47], v[184:187], a[40:43]
buffer_load_dwordx4 v[144:147], v3, s[4:7], s36 offen offset:2048 sc1
v_mfma_f32_16x16x32_bf16 a[16:19], v[48:51], v[180:183], a[16:19]
s_waitcnt lgkmcnt(6)
ds_read_b64_tr_b16 v[36:37], v15 offset:0
ds_read_b64_tr_b16 v[38:39], v15 offset:4096
v_mfma_f32_16x16x32_bf16 a[44:47], v[48:51], v[184:187], a[44:47]
buffer_load_dwordx4 v[148:151], v3, s[4:7], s40 offen offset:3072 sc1
v_mfma_f32_16x16x32_bf16 a[20:23], v[52:55], v[180:183], a[20:23]
s_waitcnt lgkmcnt(6)
ds_read_b64_tr_b16 v[40:41], v16 offset:0
ds_read_b64_tr_b16 v[42:43], v16 offset:4096
v_mfma_f32_16x16x32_bf16 a[48:51], v[52:55], v[184:187], a[48:51]
v_mfma_f32_16x16x32_bf16 a[24:27], v[56:59], v[180:183], a[24:27]
s_waitcnt lgkmcnt(6)
ds_read_b64_tr_b16 v[44:45], v17 offset:0
ds_read_b64_tr_b16 v[46:47], v17 offset:4096
v_mfma_f32_16x16x32_bf16 a[52:55], v[56:59], v[184:187], a[52:55]
buffer_load_dwordx4 v[152:155], v3, s[4:7], s36 offen offset:3072 sc1
s_add_u32 s37, s37, 4
s_add_u32 s44, s44, 1
s_add_u32 s40, s40, 4096
s_add_u32 s70, s70, 1
s_waitcnt vmcnt(24) lgkmcnt(8)
s_barrier
v_mfma_f32_16x16x32_bf16 a[0:3], v[28:31], v[188:191], a[0:3]
s_waitcnt lgkmcnt(6)
ds_read_b64_tr_b16 v[48:49], v18 offset:0
ds_read_b64_tr_b16 v[50:51], v18 offset:4096
v_mfma_f32_16x16x32_bf16 a[28:31], v[28:31], v[192:195], a[28:31]
s_cmp_ge_u32 s44, s38
s_cselect_b32 s43, 1, 0
v_mfma_f32_16x16x32_bf16 a[4:7], v[32:35], v[188:191], a[4:7]
s_waitcnt lgkmcnt(6)
ds_read_b64_tr_b16 v[52:53], v19 offset:0
ds_read_b64_tr_b16 v[54:55], v19 offset:4096
v_mfma_f32_16x16x32_bf16 a[32:35], v[32:35], v[192:195], a[32:35]
s_cmp_ge_u32 s37, 128
s_cselect_b32 s8, s48, s46
s_cselect_b32 s9, s56, s57
v_mfma_f32_16x16x32_bf16 a[8:11], v[36:39], v[188:191], a[8:11]
s_waitcnt lgkmcnt(6)
ds_read_b64_tr_b16 v[56:57], v13 offset:8192
ds_read_b64_tr_b16 v[58:59], v13 offset:12288
v_mfma_f32_16x16x32_bf16 a[36:39], v[36:39], v[192:195], a[36:39]
s_cselect_b32 s10, 1605632, s58
s_cselect_b32 s35, 128, 0
s_sub_u32 s34, s37, s35
v_mfma_f32_16x16x32_bf16 a[12:15], v[40:43], v[188:191], a[12:15]
s_waitcnt lgkmcnt(6)
ds_read_b64_tr_b16 v[28:29], v14 offset:8192
ds_read_b64_tr_b16 v[30:31], v14 offset:12288
v_mfma_f32_16x16x32_bf16 a[40:43], v[40:43], v[192:195], a[40:43]
s_add_u32 s34, s34, s30
s_mul_i32 s34, s34, 28672
s_add_u32 s34, s34, s45
v_mfma_f32_16x16x32_bf16 a[16:19], v[44:47], v[188:191], a[16:19]
s_waitcnt lgkmcnt(6)
ds_read_b64_tr_b16 v[32:33], v15 offset:8192
ds_read_b64_tr_b16 v[34:35], v15 offset:12288
v_mfma_f32_16x16x32_bf16 a[44:47], v[44:47], v[192:195], a[44:47]
s_cmp_eq_u32 s43, 1
s_cselect_b32 s10, 0, s10
s_add_u32 m0, s41, 98304
v_mfma_f32_16x16x32_bf16 a[20:23], v[48:51], v[188:191], a[20:23]
s_waitcnt lgkmcnt(6)
ds_read_b64_tr_b16 v[36:37], v16 offset:8192
ds_read_b64_tr_b16 v[38:39], v16 offset:12288
v_mfma_f32_16x16x32_bf16 a[48:51], v[48:51], v[192:195], a[48:51]
buffer_load_dwordx4 v220, s[8:11], s34 offen offset:0 lds
v_mfma_f32_16x16x32_bf16 a[24:27], v[52:55], v[188:191], a[24:27]
s_waitcnt lgkmcnt(6)
ds_read_b64_tr_b16 v[40:41], v17 offset:8192
ds_read_b64_tr_b16 v[42:43], v17 offset:12288
v_mfma_f32_16x16x32_bf16 a[52:55], v[52:55], v[192:195], a[52:55]
buffer_load_dwordx4 v221, s[8:11], s34 offen offset:1024 lds
v_mfma_f32_16x16x32_bf16 a[0:3], v[56:59], v[196:199], a[0:3]
s_waitcnt lgkmcnt(6)
ds_read_b64_tr_b16 v[44:45], v18 offset:8192
ds_read_b64_tr_b16 v[46:47], v18 offset:12288
v_mfma_f32_16x16x32_bf16 a[28:31], v[56:59], v[200:203], a[28:31]
buffer_load_dwordx4 v222, s[8:11], s34 offen offset:2048 lds
v_mfma_f32_16x16x32_bf16 a[4:7], v[28:31], v[196:199], a[4:7]
s_waitcnt lgkmcnt(6)
ds_read_b64_tr_b16 v[48:49], v19 offset:8192
ds_read_b64_tr_b16 v[50:51], v19 offset:12288
v_mfma_f32_16x16x32_bf16 a[32:35], v[28:31], v[200:203], a[32:35]
v_mfma_f32_16x16x32_bf16 a[8:11], v[32:35], v[196:199], a[8:11]
s_waitcnt lgkmcnt(6)
ds_read_b64_tr_b16 v[52:53], v13 offset:16384
ds_read_b64_tr_b16 v[54:55], v13 offset:20480
v_mfma_f32_16x16x32_bf16 a[36:39], v[32:35], v[200:203], a[36:39]
buffer_load_dwordx4 v223, s[8:11], s34 offen offset:3072 lds
v_mfma_f32_16x16x32_bf16 a[12:15], v[36:39], v[196:199], a[12:15]
s_waitcnt lgkmcnt(6)
s_add_u32 m0, s41, 102400
ds_read_b64_tr_b16 v[56:57], v14 offset:16384
ds_read_b64_tr_b16 v[58:59], v14 offset:20480
v_mfma_f32_16x16x32_bf16 a[40:43], v[36:39], v[200:203], a[40:43]
buffer_load_dwordx4 v224, s[8:11], s34 offen offset:0 lds
v_mfma_f32_16x16x32_bf16 a[16:19], v[40:43], v[196:199], a[16:19]
s_waitcnt lgkmcnt(6)
ds_read_b64_tr_b16 v[28:29], v15 offset:16384
ds_read_b64_tr_b16 v[30:31], v15 offset:20480
v_mfma_f32_16x16x32_bf16 a[44:47], v[40:43], v[200:203], a[44:47]
v_mfma_f32_16x16x32_bf16 a[20:23], v[44:47], v[196:199], a[20:23]
s_waitcnt lgkmcnt(6)
ds_read_b64_tr_b16 v[32:33], v16 offset:16384
ds_read_b64_tr_b16 v[34:35], v16 offset:20480
v_mfma_f32_16x16x32_bf16 a[48:51], v[44:47], v[200:203], a[48:51]
buffer_load_dwordx4 v225, s[8:11], s34 offen offset:1024 lds
v_mfma_f32_16x16x32_bf16 a[24:27], v[48:51], v[196:199], a[24:27]
s_waitcnt lgkmcnt(6)
ds_read_b64_tr_b16 v[36:37], v17 offset:16384
ds_read_b64_tr_b16 v[38:39], v17 offset:20480
v_mfma_f32_16x16x32_bf16 a[52:55], v[48:51], v[200:203], a[52:55]
buffer_load_dwordx4 v226, s[8:11], s34 offen offset:2048 lds
v_mfma_f32_16x16x32_bf16 a[0:3], v[52:55], v[204:207], a[0:3]
s_waitcnt lgkmcnt(6)
ds_read_b64_tr_b16 v[40:41], v18 offset:16384
ds_read_b64_tr_b16 v[42:43], v18 offset:20480
v_mfma_f32_16x16x32_bf16 a[28:31], v[52:55], v[208:211], a[28:31]
v_mfma_f32_16x16x32_bf16 a[4:7], v[56:59], v[204:207], a[4:7]
s_waitcnt lgkmcnt(6)
ds_read_b64_tr_b16 v[44:45], v19 offset:16384
ds_read_b64_tr_b16 v[46:47], v19 offset:20480
v_mfma_f32_16x16x32_bf16 a[32:35], v[56:59], v[208:211], a[32:35]
buffer_load_dwordx4 v227, s[8:11], s34 offen offset:3072 lds
v_mfma_f32_16x16x32_bf16 a[8:11], v[28:31], v[204:207], a[8:11]
s_waitcnt lgkmcnt(6)
s_cmp_ge_u32 s70, s38
s_cselect_b32 s6, 0, 24117248
s_add_u32 s36, s40, 188416
ds_read_b64_tr_b16 v[48:49], v13 offset:24576
ds_read_b64_tr_b16 v[50:51], v13 offset:28672
v_mfma_f32_16x16x32_bf16 a[36:39], v[28:31], v[208:211], a[36:39]
buffer_load_dwordx4 v[156:159], v3, s[4:7], s40 offen offset:0 sc1
v_mfma_f32_16x16x32_bf16 a[12:15], v[32:35], v[204:207], a[12:15]
s_waitcnt lgkmcnt(6)
ds_read_b64_tr_b16 v[52:53], v14 offset:24576
ds_read_b64_tr_b16 v[54:55], v14 offset:28672
v_mfma_f32_16x16x32_bf16 a[40:43], v[32:35], v[208:211], a[40:43]
v_mfma_f32_16x16x32_bf16 a[16:19], v[36:39], v[204:207], a[16:19]
s_waitcnt lgkmcnt(6)
ds_read_b64_tr_b16 v[56:57], v15 offset:24576
ds_read_b64_tr_b16 v[58:59], v15 offset:28672
v_mfma_f32_16x16x32_bf16 a[44:47], v[36:39], v[208:211], a[44:47]
buffer_load_dwordx4 v[160:163], v3, s[4:7], s36 offen offset:0 sc1
v_mfma_f32_16x16x32_bf16 a[20:23], v[40:43], v[204:207], a[20:23]
s_waitcnt lgkmcnt(6)
ds_read_b64_tr_b16 v[28:29], v16 offset:24576
ds_read_b64_tr_b16 v[30:31], v16 offset:28672
v_mfma_f32_16x16x32_bf16 a[48:51], v[40:43], v[208:211], a[48:51]
buffer_load_dwordx4 v[164:167], v3, s[4:7], s40 offen offset:1024 sc1
v_mfma_f32_16x16x32_bf16 a[24:27], v[44:47], v[204:207], a[24:27]
s_waitcnt lgkmcnt(6)
ds_read_b64_tr_b16 v[32:33], v17 offset:24576
ds_read_b64_tr_b16 v[34:35], v17 offset:28672
v_mfma_f32_16x16x32_bf16 a[52:55], v[44:47], v[208:211], a[52:55]
v_mfma_f32_16x16x32_bf16 a[0:3], v[48:51], v[212:215], a[0:3]
s_waitcnt lgkmcnt(6)
ds_read_b64_tr_b16 v[36:37], v18 offset:24576
ds_read_b64_tr_b16 v[38:39], v18 offset:28672
v_mfma_f32_16x16x32_bf16 a[28:31], v[48:51], v[216:219], a[28:31]
buffer_load_dwordx4 v[168:171], v3, s[4:7], s36 offen offset:1024 sc1
v_mfma_f32_16x16x32_bf16 a[4:7], v[52:55], v[212:215], a[4:7]
s_waitcnt lgkmcnt(6)
ds_read_b64_tr_b16 v[40:41], v19 offset:24576
ds_read_b64_tr_b16 v[42:43], v19 offset:28672
v_mfma_f32_16x16x32_bf16 a[32:35], v[52:55], v[216:219], a[32:35]
buffer_load_dwordx4 v[172:175], v3, s[4:7], s40 offen offset:2048 sc1
v_mfma_f32_16x16x32_bf16 a[8:11], v[56:59], v[212:215], a[8:11]
s_waitcnt lgkmcnt(6)
ds_read_b64_tr_b16 v[44:45], v13 offset:32768
ds_read_b64_tr_b16 v[46:47], v13 offset:36864
v_mfma_f32_16x16x32_bf16 a[36:39], v[56:59], v[216:219], a[36:39]
v_mfma_f32_16x16x32_bf16 a[12:15], v[28:31], v[212:215], a[12:15]
s_waitcnt lgkmcnt(6)
ds_read_b64_tr_b16 v[48:49], v14 offset:32768
ds_read_b64_tr_b16 v[50:51], v14 offset:36864
v_mfma_f32_16x16x32_bf16 a[40:43], v[28:31], v[216:219], a[40:43]
buffer_load_dwordx4 v[176:179], v3, s[4:7], s36 offen offset:2048 sc1
v_mfma_f32_16x16x32_bf16 a[16:19], v[32:35], v[212:215], a[16:19]
s_waitcnt lgkmcnt(6)
ds_read_b64_tr_b16 v[52:53], v15 offset:32768
ds_read_b64_tr_b16 v[54:55], v15 offset:36864
v_mfma_f32_16x16x32_bf16 a[44:47], v[32:35], v[216:219], a[44:47]
buffer_load_dwordx4 v[180:183], v3, s[4:7], s40 offen offset:3072 sc1
v_mfma_f32_16x16x32_bf16 a[20:23], v[36:39], v[212:215], a[20:23]
s_waitcnt lgkmcnt(6)
ds_read_b64_tr_b16 v[56:57], v16 offset:32768
ds_read_b64_tr_b16 v[58:59], v16 offset:36864
v_mfma_f32_16x16x32_bf16 a[48:51], v[36:39], v[216:219], a[48:51]
v_mfma_f32_16x16x32_bf16 a[24:27], v[40:43], v[212:215], a[24:27]
s_waitcnt lgkmcnt(6)
ds_read_b64_tr_b16 v[28:29], v17 offset:32768
ds_read_b64_tr_b16 v[30:31], v17 offset:36864
v_mfma_f32_16x16x32_bf16 a[52:55], v[40:43], v[216:219], a[52:55]
buffer_load_dwordx4 v[184:187], v3, s[4:7], s36 offen offset:3072 sc1
s_add_u32 s37, s37, 4
s_add_u32 s44, s44, 1
s_add_u32 s40, s40, 4096
s_add_u32 s70, s70, 1
s_waitcnt vmcnt(24) lgkmcnt(8)
s_barrier
v_mfma_f32_16x16x32_bf16 a[0:3], v[44:47], v[60:63], a[0:3]
s_waitcnt lgkmcnt(6)
ds_read_b64_tr_b16 v[32:33], v18 offset:32768
ds_read_b64_tr_b16 v[34:35], v18 offset:36864
v_mfma_f32_16x16x32_bf16 a[28:31], v[44:47], v[64:67], a[28:31]
s_cmp_ge_u32 s44, s38
s_cselect_b32 s43, 1, 0
v_mfma_f32_16x16x32_bf16 a[4:7], v[48:51], v[60:63], a[4:7]
s_waitcnt lgkmcnt(6)
ds_read_b64_tr_b16 v[36:37], v19 offset:32768
ds_read_b64_tr_b16 v[38:39], v19 offset:36864
v_mfma_f32_16x16x32_bf16 a[32:35], v[48:51], v[64:67], a[32:35]
s_cmp_ge_u32 s37, 128
s_cselect_b32 s8, s48, s46
s_cselect_b32 s9, s56, s57
v_mfma_f32_16x16x32_bf16 a[8:11], v[52:55], v[60:63], a[8:11]
s_waitcnt lgkmcnt(6)
ds_read_b64_tr_b16 v[40:41], v13 offset:40960
ds_read_b64_tr_b16 v[42:43], v13 offset:45056
v_mfma_f32_16x16x32_bf16 a[36:39], v[52:55], v[64:67], a[36:39]
s_cselect_b32 s10, 1605632, s58
s_cselect_b32 s35, 128, 0
s_sub_u32 s34, s37, s35
v_mfma_f32_16x16x32_bf16 a[12:15], v[56:59], v[60:63], a[12:15]
s_waitcnt lgkmcnt(6)
ds_read_b64_tr_b16 v[44:45], v14 offset:40960
ds_read_b64_tr_b16 v[46:47], v14 offset:45056
v_mfma_f32_16x16x32_bf16 a[40:43], v[56:59], v[64:67], a[40:43]
s_add_u32 s34, s34, s30
s_mul_i32 s34, s34, 28672
s_add_u32 s34, s34, s45
v_mfma_f32_16x16x32_bf16 a[16:19], v[28:31], v[60:63], a[16:19]
s_waitcnt lgkmcnt(6)
ds_read_b64_tr_b16 v[48:49], v15 offset:40960
ds_read_b64_tr_b16 v[50:51], v15 offset:45056
v_mfma_f32_16x16x32_bf16 a[44:47], v[28:31], v[64:67], a[44:47]
s_cmp_eq_u32 s43, 1
s_cselect_b32 s10, 0, s10
s_add_u32 m0, s41, 0
v_mfma_f32_16x16x32_bf16 a[20:23], v[32:35], v[60:63], a[20:23]
s_waitcnt lgkmcnt(6)
ds_read_b64_tr_b16 v[52:53], v16 offset:40960
ds_read_b64_tr_b16 v[54:55], v16 offset:45056
v_mfma_f32_16x16x32_bf16 a[48:51], v[32:35], v[64:67], a[48:51]
buffer_load_dwordx4 v220, s[8:11], s34 offen offset:0 lds
v_mfma_f32_16x16x32_bf16 a[24:27], v[36:39], v[60:63], a[24:27]
s_waitcnt lgkmcnt(6)
ds_read_b64_tr_b16 v[56:57], v17 offset:40960
ds_read_b64_tr_b16 v[58:59], v17 offset:45056
v_mfma_f32_16x16x32_bf16 a[52:55], v[36:39], v[64:67], a[52:55]
buffer_load_dwordx4 v221, s[8:11], s34 offen offset:1024 lds
v_mfma_f32_16x16x32_bf16 a[0:3], v[40:43], v[68:71], a[0:3]
s_waitcnt lgkmcnt(6)
ds_read_b64_tr_b16 v[28:29], v18 offset:40960
ds_read_b64_tr_b16 v[30:31], v18 offset:45056
v_mfma_f32_16x16x32_bf16 a[28:31], v[40:43], v[72:75], a[28:31]
buffer_load_dwordx4 v222, s[8:11], s34 offen offset:2048 lds
v_mfma_f32_16x16x32_bf16 a[4:7], v[44:47], v[68:71], a[4:7]
s_waitcnt lgkmcnt(6)
ds_read_b64_tr_b16 v[32:33], v19 offset:40960
ds_read_b64_tr_b16 v[34:35], v19 offset:45056
v_mfma_f32_16x16x32_bf16 a[32:35], v[44:47], v[72:75], a[32:35]
v_mfma_f32_16x16x32_bf16 a[8:11], v[48:51], v[68:71], a[8:11]
s_waitcnt lgkmcnt(6)
ds_read_b64_tr_b16 v[36:37], v13 offset:49152
ds_read_b64_tr_b16 v[38:39], v13 offset:53248
v_mfma_f32_16x16x32_bf16 a[36:39], v[48:51], v[72:75], a[36:39]
buffer_load_dwordx4 v223, s[8:11], s34 offen offset:3072 lds
v_mfma_f32_16x16x32_bf16 a[12:15], v[52:55], v[68:71], a[12:15]
s_waitcnt lgkmcnt(6)
s_add_u32 m0, s41, 4096
ds_read_b64_tr_b16 v[40:41], v14 offset:49152
ds_read_b64_tr_b16 v[42:43], v14 offset:53248
v_mfma_f32_16x16x32_bf16 a[40:43], v[52:55], v[72:75], a[40:43]
buffer_load_dwordx4 v224, s[8:11], s34 offen offset:0 lds
v_mfma_f32_16x16x32_bf16 a[16:19], v[56:59], v[68:71], a[16:19]
s_waitcnt lgkmcnt(6)
ds_read_b64_tr_b16 v[44:45], v15 offset:49152
ds_read_b64_tr_b16 v[46:47], v15 offset:53248
v_mfma_f32_16x16x32_bf16 a[44:47], v[56:59], v[72:75], a[44:47]
v_mfma_f32_16x16x32_bf16 a[20:23], v[28:31], v[68:71], a[20:23]
s_waitcnt lgkmcnt(6)
ds_read_b64_tr_b16 v[48:49], v16 offset:49152
ds_read_b64_tr_b16 v[50:51], v16 offset:53248
v_mfma_f32_16x16x32_bf16 a[48:51], v[28:31], v[72:75], a[48:51]
buffer_load_dwordx4 v225, s[8:11], s34 offen offset:1024 lds
v_mfma_f32_16x16x32_bf16 a[24:27], v[32:35], v[68:71], a[24:27]
s_waitcnt lgkmcnt(6)
ds_read_b64_tr_b16 v[52:53], v17 offset:49152
ds_read_b64_tr_b16 v[54:55], v17 offset:53248
v_mfma_f32_16x16x32_bf16 a[52:55], v[32:35], v[72:75], a[52:55]
buffer_load_dwordx4 v226, s[8:11], s34 offen offset:2048 lds
v_mfma_f32_16x16x32_bf16 a[0:3], v[36:39], v[76:79], a[0:3]
s_waitcnt lgkmcnt(6)
ds_read_b64_tr_b16 v[56:57], v18 offset:49152
ds_read_b64_tr_b16 v[58:59], v18 offset:53248
v_mfma_f32_16x16x32_bf16 a[28:31], v[36:39], v[80:83], a[28:31]
v_mfma_f32_16x16x32_bf16 a[4:7], v[40:43], v[76:79], a[4:7]
s_waitcnt lgkmcnt(6)
ds_read_b64_tr_b16 v[28:29], v19 offset:49152
ds_read_b64_tr_b16 v[30:31], v19 offset:53248
v_mfma_f32_16x16x32_bf16 a[32:35], v[40:43], v[80:83], a[32:35]
buffer_load_dwordx4 v227, s[8:11], s34 offen offset:3072 lds
v_mfma_f32_16x16x32_bf16 a[8:11], v[44:47], v[76:79], a[8:11]
s_waitcnt lgkmcnt(6)
s_cmp_ge_u32 s70, s38
s_cselect_b32 s6, 0, 24117248
s_add_u32 s36, s40, 188416
ds_read_b64_tr_b16 v[32:33], v13 offset:57344
ds_read_b64_tr_b16 v[34:35], v13 offset:61440
v_mfma_f32_16x16x32_bf16 a[36:39], v[44:47], v[80:83], a[36:39]
buffer_load_dwordx4 v[188:191], v3, s[4:7], s40 offen offset:0 sc1
v_mfma_f32_16x16x32_bf16 a[12:15], v[48:51], v[76:79], a[12:15]
s_waitcnt lgkmcnt(6)
ds_read_b64_tr_b16 v[36:37], v14 offset:57344
ds_read_b64_tr_b16 v[38:39], v14 offset:61440
v_mfma_f32_16x16x32_bf16 a[40:43], v[48:51], v[80:83], a[40:43]
v_mfma_f32_16x16x32_bf16 a[16:19], v[52:55], v[76:79], a[16:19]
s_waitcnt lgkmcnt(6)
ds_read_b64_tr_b16 v[40:41], v15 offset:57344
ds_read_b64_tr_b16 v[42:43], v15 offset:61440
v_mfma_f32_16x16x32_bf16 a[44:47], v[52:55], v[80:83], a[44:47]
buffer_load_dwordx4 v[192:195], v3, s[4:7], s36 offen offset:0 sc1
v_mfma_f32_16x16x32_bf16 a[20:23], v[56:59], v[76:79], a[20:23]
s_waitcnt lgkmcnt(6)
ds_read_b64_tr_b16 v[44:45], v16 offset:57344
ds_read_b64_tr_b16 v[46:47], v16 offset:61440
v_mfma_f32_16x16x32_bf16 a[48:51], v[56:59], v[80:83], a[48:51]
buffer_load_dwordx4 v[196:199], v3, s[4:7], s40 offen offset:1024 sc1
v_mfma_f32_16x16x32_bf16 a[24:27], v[28:31], v[76:79], a[24:27]
s_waitcnt lgkmcnt(6)
ds_read_b64_tr_b16 v[48:49], v17 offset:57344
ds_read_b64_tr_b16 v[50:51], v17 offset:61440
v_mfma_f32_16x16x32_bf16 a[52:55], v[28:31], v[80:83], a[52:55]
v_mfma_f32_16x16x32_bf16 a[0:3], v[32:35], v[84:87], a[0:3]
s_waitcnt lgkmcnt(6)
ds_read_b64_tr_b16 v[52:53], v18 offset:57344
ds_read_b64_tr_b16 v[54:55], v18 offset:61440
v_mfma_f32_16x16x32_bf16 a[28:31], v[32:35], v[88:91], a[28:31]
buffer_load_dwordx4 v[200:203], v3, s[4:7], s36 offen offset:1024 sc1
v_mfma_f32_16x16x32_bf16 a[4:7], v[36:39], v[84:87], a[4:7]
s_waitcnt lgkmcnt(6)
ds_read_b64_tr_b16 v[56:57], v19 offset:57344
ds_read_b64_tr_b16 v[58:59], v19 offset:61440
v_mfma_f32_16x16x32_bf16 a[32:35], v[36:39], v[88:91], a[32:35]
buffer_load_dwordx4 v[204:207], v3, s[4:7], s40 offen offset:2048 sc1
v_mfma_f32_16x16x32_bf16 a[8:11], v[40:43], v[84:87], a[8:11]
s_waitcnt lgkmcnt(6)
ds_read_b64_tr_b16 v[28:29], v20 offset:0
ds_read_b64_tr_b16 v[30:31], v20 offset:4096
v_mfma_f32_16x16x32_bf16 a[36:39], v[40:43], v[88:91], a[36:39]
v_mfma_f32_16x16x32_bf16 a[12:15], v[44:47], v[84:87], a[12:15]
s_waitcnt lgkmcnt(6)
ds_read_b64_tr_b16 v[32:33], v21 offset:0
ds_read_b64_tr_b16 v[34:35], v21 offset:4096
v_mfma_f32_16x16x32_bf16 a[40:43], v[44:47], v[88:91], a[40:43]
buffer_load_dwordx4 v[208:211], v3, s[4:7], s36 offen offset:2048 sc1
v_mfma_f32_16x16x32_bf16 a[16:19], v[48:51], v[84:87], a[16:19]
s_waitcnt lgkmcnt(6)
ds_read_b64_tr_b16 v[36:37], v22 offset:0
ds_read_b64_tr_b16 v[38:39], v22 offset:4096
v_mfma_f32_16x16x32_bf16 a[44:47], v[48:51], v[88:91], a[44:47]
buffer_load_dwordx4 v[212:215], v3, s[4:7], s40 offen offset:3072 sc1
v_mfma_f32_16x16x32_bf16 a[20:23], v[52:55], v[84:87], a[20:23]
s_waitcnt lgkmcnt(6)
ds_read_b64_tr_b16 v[40:41], v23 offset:0
ds_read_b64_tr_b16 v[42:43], v23 offset:4096
v_mfma_f32_16x16x32_bf16 a[48:51], v[52:55], v[88:91], a[48:51]
v_mfma_f32_16x16x32_bf16 a[24:27], v[56:59], v[84:87], a[24:27]
s_waitcnt lgkmcnt(6)
ds_read_b64_tr_b16 v[44:45], v24 offset:0
ds_read_b64_tr_b16 v[46:47], v24 offset:4096
v_mfma_f32_16x16x32_bf16 a[52:55], v[56:59], v[88:91], a[52:55]
buffer_load_dwordx4 v[216:219], v3, s[4:7], s36 offen offset:3072 sc1
s_add_u32 s37, s37, 4
s_add_u32 s44, s44, 1
s_add_u32 s40, s40, 4096
s_add_u32 s70, s70, 1
s_waitcnt vmcnt(24) lgkmcnt(8)
s_barrier
v_mfma_f32_16x16x32_bf16 a[0:3], v[28:31], v[92:95], a[0:3]
s_waitcnt lgkmcnt(6)
ds_read_b64_tr_b16 v[48:49], v25 offset:0
ds_read_b64_tr_b16 v[50:51], v25 offset:4096
v_mfma_f32_16x16x32_bf16 a[28:31], v[28:31], v[96:99], a[28:31]
s_cmp_ge_u32 s44, s38
s_cselect_b32 s43, 1, 0
v_mfma_f32_16x16x32_bf16 a[4:7], v[32:35], v[92:95], a[4:7]
s_waitcnt lgkmcnt(6)
ds_read_b64_tr_b16 v[52:53], v26 offset:0
ds_read_b64_tr_b16 v[54:55], v26 offset:4096
v_mfma_f32_16x16x32_bf16 a[32:35], v[32:35], v[96:99], a[32:35]
s_cmp_ge_u32 s37, 128
s_cselect_b32 s8, s48, s46
s_cselect_b32 s9, s56, s57
v_mfma_f32_16x16x32_bf16 a[8:11], v[36:39], v[92:95], a[8:11]
s_waitcnt lgkmcnt(6)
ds_read_b64_tr_b16 v[56:57], v20 offset:8192
ds_read_b64_tr_b16 v[58:59], v20 offset:12288
v_mfma_f32_16x16x32_bf16 a[36:39], v[36:39], v[96:99], a[36:39]
s_cselect_b32 s10, 1605632, s58
s_cselect_b32 s35, 128, 0
s_sub_u32 s34, s37, s35
v_mfma_f32_16x16x32_bf16 a[12:15], v[40:43], v[92:95], a[12:15]
s_waitcnt lgkmcnt(6)
ds_read_b64_tr_b16 v[28:29], v21 offset:8192
ds_read_b64_tr_b16 v[30:31], v21 offset:12288
v_mfma_f32_16x16x32_bf16 a[40:43], v[40:43], v[96:99], a[40:43]
s_add_u32 s34, s34, s30
s_mul_i32 s34, s34, 28672
s_add_u32 s34, s34, s45
v_mfma_f32_16x16x32_bf16 a[16:19], v[44:47], v[92:95], a[16:19]
s_waitcnt lgkmcnt(6)
ds_read_b64_tr_b16 v[32:33], v22 offset:8192
ds_read_b64_tr_b16 v[34:35], v22 offset:12288
v_mfma_f32_16x16x32_bf16 a[44:47], v[44:47], v[96:99], a[44:47]
s_cmp_eq_u32 s43, 1
s_cselect_b32 s10, 0, s10
s_add_u32 m0, s41, 32768
v_mfma_f32_16x16x32_bf16 a[20:23], v[48:51], v[92:95], a[20:23]
s_waitcnt lgkmcnt(6)
ds_read_b64_tr_b16 v[36:37], v23 offset:8192
ds_read_b64_tr_b16 v[38:39], v23 offset:12288
v_mfma_f32_16x16x32_bf16 a[48:51], v[48:51], v[96:99], a[48:51]
buffer_load_dwordx4 v220, s[8:11], s34 offen offset:0 lds
v_mfma_f32_16x16x32_bf16 a[24:27], v[52:55], v[92:95], a[24:27]
s_waitcnt lgkmcnt(6)
ds_read_b64_tr_b16 v[40:41], v24 offset:8192
ds_read_b64_tr_b16 v[42:43], v24 offset:12288
v_mfma_f32_16x16x32_bf16 a[52:55], v[52:55], v[96:99], a[52:55]
buffer_load_dwordx4 v221, s[8:11], s34 offen offset:1024 lds
v_mfma_f32_16x16x32_bf16 a[0:3], v[56:59], v[100:103], a[0:3]
s_waitcnt lgkmcnt(6)
ds_read_b64_tr_b16 v[44:45], v25 offset:8192
ds_read_b64_tr_b16 v[46:47], v25 offset:12288
v_mfma_f32_16x16x32_bf16 a[28:31], v[56:59], v[104:107], a[28:31]
buffer_load_dwordx4 v222, s[8:11], s34 offen offset:2048 lds
v_mfma_f32_16x16x32_bf16 a[4:7], v[28:31], v[100:103], a[4:7]
s_waitcnt lgkmcnt(6)
ds_read_b64_tr_b16 v[48:49], v26 offset:8192
ds_read_b64_tr_b16 v[50:51], v26 offset:12288
v_mfma_f32_16x16x32_bf16 a[32:35], v[28:31], v[104:107], a[32:35]
v_mfma_f32_16x16x32_bf16 a[8:11], v[32:35], v[100:103], a[8:11]
s_waitcnt lgkmcnt(6)
ds_read_b64_tr_b16 v[52:53], v20 offset:16384
ds_read_b64_tr_b16 v[54:55], v20 offset:20480
v_mfma_f32_16x16x32_bf16 a[36:39], v[32:35], v[104:107], a[36:39]
buffer_load_dwordx4 v223, s[8:11], s34 offen offset:3072 lds
v_mfma_f32_16x16x32_bf16 a[12:15], v[36:39], v[100:103], a[12:15]
s_waitcnt lgkmcnt(6)
s_add_u32 m0, s41, 36864
ds_read_b64_tr_b16 v[56:57], v21 offset:16384
ds_read_b64_tr_b16 v[58:59], v21 offset:20480
v_mfma_f32_16x16x32_bf16 a[40:43], v[36:39], v[104:107], a[40:43]
buffer_load_dwordx4 v224, s[8:11], s34 offen offset:0 lds
v_mfma_f32_16x16x32_bf16 a[16:19], v[40:43], v[100:103], a[16:19]
s_waitcnt lgkmcnt(6)
ds_read_b64_tr_b16 v[28:29], v22 offset:16384
ds_read_b64_tr_b16 v[30:31], v22 offset:20480
v_mfma_f32_16x16x32_bf16 a[44:47], v[40:43], v[104:107], a[44:47]
v_mfma_f32_16x16x32_bf16 a[20:23], v[44:47], v[100:103], a[20:23]
s_waitcnt lgkmcnt(6)
ds_read_b64_tr_b16 v[32:33], v23 offset:16384
ds_read_b64_tr_b16 v[34:35], v23 offset:20480
v_mfma_f32_16x16x32_bf16 a[48:51], v[44:47], v[104:107], a[48:51]
buffer_load_dwordx4 v225, s[8:11], s34 offen offset:1024 lds
v_mfma_f32_16x16x32_bf16 a[24:27], v[48:51], v[100:103], a[24:27]
s_waitcnt lgkmcnt(6)
ds_read_b64_tr_b16 v[36:37], v24 offset:16384
ds_read_b64_tr_b16 v[38:39], v24 offset:20480
v_mfma_f32_16x16x32_bf16 a[52:55], v[48:51], v[104:107], a[52:55]
buffer_load_dwordx4 v226, s[8:11], s34 offen offset:2048 lds
v_mfma_f32_16x16x32_bf16 a[0:3], v[52:55], v[108:111], a[0:3]
s_waitcnt lgkmcnt(6)
ds_read_b64_tr_b16 v[40:41], v25 offset:16384
ds_read_b64_tr_b16 v[42:43], v25 offset:20480
v_mfma_f32_16x16x32_bf16 a[28:31], v[52:55], v[112:115], a[28:31]
v_mfma_f32_16x16x32_bf16 a[4:7], v[56:59], v[108:111], a[4:7]
s_waitcnt lgkmcnt(6)
ds_read_b64_tr_b16 v[44:45], v26 offset:16384
ds_read_b64_tr_b16 v[46:47], v26 offset:20480
v_mfma_f32_16x16x32_bf16 a[32:35], v[56:59], v[112:115], a[32:35]
buffer_load_dwordx4 v227, s[8:11], s34 offen offset:3072 lds
v_mfma_f32_16x16x32_bf16 a[8:11], v[28:31], v[108:111], a[8:11]
s_waitcnt lgkmcnt(6)
s_cmp_ge_u32 s70, s38
s_cselect_b32 s6, 0, 24117248
s_add_u32 s36, s40, 188416
ds_read_b64_tr_b16 v[48:49], v20 offset:24576
ds_read_b64_tr_b16 v[50:51], v20 offset:28672
v_mfma_f32_16x16x32_bf16 a[36:39], v[28:31], v[112:115], a[36:39]
buffer_load_dwordx4 v[60:63], v3, s[4:7], s40 offen offset:0 sc1
v_mfma_f32_16x16x32_bf16 a[12:15], v[32:35], v[108:111], a[12:15]
s_waitcnt lgkmcnt(6)
ds_read_b64_tr_b16 v[52:53], v21 offset:24576
ds_read_b64_tr_b16 v[54:55], v21 offset:28672
v_mfma_f32_16x16x32_bf16 a[40:43], v[32:35], v[112:115], a[40:43]
v_mfma_f32_16x16x32_bf16 a[16:19], v[36:39], v[108:111], a[16:19]
s_waitcnt lgkmcnt(6)
ds_read_b64_tr_b16 v[56:57], v22 offset:24576
ds_read_b64_tr_b16 v[58:59], v22 offset:28672
v_mfma_f32_16x16x32_bf16 a[44:47], v[36:39], v[112:115], a[44:47]
buffer_load_dwordx4 v[64:67], v3, s[4:7], s36 offen offset:0 sc1
v_mfma_f32_16x16x32_bf16 a[20:23], v[40:43], v[108:111], a[20:23]
s_waitcnt lgkmcnt(6)
ds_read_b64_tr_b16 v[28:29], v23 offset:24576
ds_read_b64_tr_b16 v[30:31], v23 offset:28672
v_mfma_f32_16x16x32_bf16 a[48:51], v[40:43], v[112:115], a[48:51]
buffer_load_dwordx4 v[68:71], v3, s[4:7], s40 offen offset:1024 sc1
v_mfma_f32_16x16x32_bf16 a[24:27], v[44:47], v[108:111], a[24:27]
s_waitcnt lgkmcnt(6)
ds_read_b64_tr_b16 v[32:33], v24 offset:24576
ds_read_b64_tr_b16 v[34:35], v24 offset:28672
v_mfma_f32_16x16x32_bf16 a[52:55], v[44:47], v[112:115], a[52:55]
v_mfma_f32_16x16x32_bf16 a[0:3], v[48:51], v[116:119], a[0:3]
s_waitcnt lgkmcnt(6)
ds_read_b64_tr_b16 v[36:37], v25 offset:24576
ds_read_b64_tr_b16 v[38:39], v25 offset:28672
v_mfma_f32_16x16x32_bf16 a[28:31], v[48:51], v[120:123], a[28:31]
buffer_load_dwordx4 v[72:75], v3, s[4:7], s36 offen offset:1024 sc1
v_mfma_f32_16x16x32_bf16 a[4:7], v[52:55], v[116:119], a[4:7]
s_waitcnt lgkmcnt(6)
ds_read_b64_tr_b16 v[40:41], v26 offset:24576
ds_read_b64_tr_b16 v[42:43], v26 offset:28672
v_mfma_f32_16x16x32_bf16 a[32:35], v[52:55], v[120:123], a[32:35]
buffer_load_dwordx4 v[76:79], v3, s[4:7], s40 offen offset:2048 sc1
v_mfma_f32_16x16x32_bf16 a[8:11], v[56:59], v[116:119], a[8:11]
s_waitcnt lgkmcnt(6)
ds_read_b64_tr_b16 v[44:45], v20 offset:32768
ds_read_b64_tr_b16 v[46:47], v20 offset:36864
v_mfma_f32_16x16x32_bf16 a[36:39], v[56:59], v[120:123], a[36:39]
v_mfma_f32_16x16x32_bf16 a[12:15], v[28:31], v[116:119], a[12:15]
s_waitcnt lgkmcnt(6)
ds_read_b64_tr_b16 v[48:49], v21 offset:32768
ds_read_b64_tr_b16 v[50:51], v21 offset:36864
v_mfma_f32_16x16x32_bf16 a[40:43], v[28:31], v[120:123], a[40:43]
buffer_load_dwordx4 v[80:83], v3, s[4:7], s36 offen offset:2048 sc1
v_mfma_f32_16x16x32_bf16 a[16:19], v[32:35], v[116:119], a[16:19]
s_waitcnt lgkmcnt(6)
ds_read_b64_tr_b16 v[52:53], v22 offset:32768
ds_read_b64_tr_b16 v[54:55], v22 offset:36864
v_mfma_f32_16x16x32_bf16 a[44:47], v[32:35], v[120:123], a[44:47]
buffer_load_dwordx4 v[84:87], v3, s[4:7], s40 offen offset:3072 sc1
v_mfma_f32_16x16x32_bf16 a[20:23], v[36:39], v[116:119], a[20:23]
s_waitcnt lgkmcnt(6)
ds_read_b64_tr_b16 v[56:57], v23 offset:32768
ds_read_b64_tr_b16 v[58:59], v23 offset:36864
v_mfma_f32_16x16x32_bf16 a[48:51], v[36:39], v[120:123], a[48:51]
v_mfma_f32_16x16x32_bf16 a[24:27], v[40:43], v[116:119], a[24:27]
s_waitcnt lgkmcnt(6)
ds_read_b64_tr_b16 v[28:29], v24 offset:32768
ds_read_b64_tr_b16 v[30:31], v24 offset:36864
v_mfma_f32_16x16x32_bf16 a[52:55], v[40:43], v[120:123], a[52:55]
buffer_load_dwordx4 v[88:91], v3, s[4:7], s36 offen offset:3072 sc1
s_add_u32 s37, s37, 4
s_add_u32 s44, s44, 1
s_add_u32 s40, s40, 4096
s_add_u32 s70, s70, 1
s_waitcnt vmcnt(24) lgkmcnt(8)
s_barrier
v_mfma_f32_16x16x32_bf16 a[0:3], v[44:47], v[124:127], a[0:3]
s_waitcnt lgkmcnt(6)
ds_read_b64_tr_b16 v[32:33], v25 offset:32768
ds_read_b64_tr_b16 v[34:35], v25 offset:36864
v_mfma_f32_16x16x32_bf16 a[28:31], v[44:47], v[128:131], a[28:31]
s_cmp_ge_u32 s44, s38
s_cselect_b32 s43, 1, 0
v_mfma_f32_16x16x32_bf16 a[4:7], v[48:51], v[124:127], a[4:7]
s_waitcnt lgkmcnt(6)
ds_read_b64_tr_b16 v[36:37], v26 offset:32768
ds_read_b64_tr_b16 v[38:39], v26 offset:36864
v_mfma_f32_16x16x32_bf16 a[32:35], v[48:51], v[128:131], a[32:35]
s_cmp_ge_u32 s37, 128
s_cselect_b32 s8, s48, s46
s_cselect_b32 s9, s56, s57
v_mfma_f32_16x16x32_bf16 a[8:11], v[52:55], v[124:127], a[8:11]
s_waitcnt lgkmcnt(6)
ds_read_b64_tr_b16 v[40:41], v20 offset:40960
ds_read_b64_tr_b16 v[42:43], v20 offset:45056
v_mfma_f32_16x16x32_bf16 a[36:39], v[52:55], v[128:131], a[36:39]
s_cselect_b32 s10, 1605632, s58
s_cselect_b32 s35, 128, 0
s_sub_u32 s34, s37, s35
v_mfma_f32_16x16x32_bf16 a[12:15], v[56:59], v[124:127], a[12:15]
s_waitcnt lgkmcnt(6)
ds_read_b64_tr_b16 v[44:45], v21 offset:40960
ds_read_b64_tr_b16 v[46:47], v21 offset:45056
v_mfma_f32_16x16x32_bf16 a[40:43], v[56:59], v[128:131], a[40:43]
s_add_u32 s34, s34, s30
s_mul_i32 s34, s34, 28672
s_add_u32 s34, s34, s45
v_mfma_f32_16x16x32_bf16 a[16:19], v[28:31], v[124:127], a[16:19]
s_waitcnt lgkmcnt(6)
ds_read_b64_tr_b16 v[48:49], v22 offset:40960
ds_read_b64_tr_b16 v[50:51], v22 offset:45056
v_mfma_f32_16x16x32_bf16 a[44:47], v[28:31], v[128:131], a[44:47]
s_cmp_eq_u32 s43, 1
s_cselect_b32 s10, 0, s10
s_add_u32 m0, s41, 65536
v_mfma_f32_16x16x32_bf16 a[20:23], v[32:35], v[124:127], a[20:23]
s_waitcnt lgkmcnt(6)
ds_read_b64_tr_b16 v[52:53], v23 offset:40960
ds_read_b64_tr_b16 v[54:55], v23 offset:45056
v_mfma_f32_16x16x32_bf16 a[48:51], v[32:35], v[128:131], a[48:51]
buffer_load_dwordx4 v220, s[8:11], s34 offen offset:0 lds
v_mfma_f32_16x16x32_bf16 a[24:27], v[36:39], v[124:127], a[24:27]
s_waitcnt lgkmcnt(6)
ds_read_b64_tr_b16 v[56:57], v24 offset:40960
ds_read_b64_tr_b16 v[58:59], v24 offset:45056
v_mfma_f32_16x16x32_bf16 a[52:55], v[36:39], v[128:131], a[52:55]
buffer_load_dwordx4 v221, s[8:11], s34 offen offset:1024 lds
v_mfma_f32_16x16x32_bf16 a[0:3], v[40:43], v[132:135], a[0:3]
s_waitcnt lgkmcnt(6)
ds_read_b64_tr_b16 v[28:29], v25 offset:40960
ds_read_b64_tr_b16 v[30:31], v25 offset:45056
v_mfma_f32_16x16x32_bf16 a[28:31], v[40:43], v[136:139], a[28:31]
buffer_load_dwordx4 v222, s[8:11], s34 offen offset:2048 lds
v_mfma_f32_16x16x32_bf16 a[4:7], v[44:47], v[132:135], a[4:7]
s_waitcnt lgkmcnt(6)
ds_read_b64_tr_b16 v[32:33], v26 offset:40960
ds_read_b64_tr_b16 v[34:35], v26 offset:45056
v_mfma_f32_16x16x32_bf16 a[32:35], v[44:47], v[136:139], a[32:35]
v_mfma_f32_16x16x32_bf16 a[8:11], v[48:51], v[132:135], a[8:11]
s_waitcnt lgkmcnt(6)
ds_read_b64_tr_b16 v[36:37], v20 offset:49152
ds_read_b64_tr_b16 v[38:39], v20 offset:53248
v_mfma_f32_16x16x32_bf16 a[36:39], v[48:51], v[136:139], a[36:39]
buffer_load_dwordx4 v223, s[8:11], s34 offen offset:3072 lds
v_mfma_f32_16x16x32_bf16 a[12:15], v[52:55], v[132:135], a[12:15]
s_waitcnt lgkmcnt(6)
s_add_u32 m0, s41, 69632
ds_read_b64_tr_b16 v[40:41], v21 offset:49152
ds_read_b64_tr_b16 v[42:43], v21 offset:53248
v_mfma_f32_16x16x32_bf16 a[40:43], v[52:55], v[136:139], a[40:43]
buffer_load_dwordx4 v224, s[8:11], s34 offen offset:0 lds
v_mfma_f32_16x16x32_bf16 a[16:19], v[56:59], v[132:135], a[16:19]
s_waitcnt lgkmcnt(6)
ds_read_b64_tr_b16 v[44:45], v22 offset:49152
ds_read_b64_tr_b16 v[46:47], v22 offset:53248
v_mfma_f32_16x16x32_bf16 a[44:47], v[56:59], v[136:139], a[44:47]
v_mfma_f32_16x16x32_bf16 a[20:23], v[28:31], v[132:135], a[20:23]
s_waitcnt lgkmcnt(6)
ds_read_b64_tr_b16 v[48:49], v23 offset:49152
ds_read_b64_tr_b16 v[50:51], v23 offset:53248
v_mfma_f32_16x16x32_bf16 a[48:51], v[28:31], v[136:139], a[48:51]
buffer_load_dwordx4 v225, s[8:11], s34 offen offset:1024 lds
v_mfma_f32_16x16x32_bf16 a[24:27], v[32:35], v[132:135], a[24:27]
s_waitcnt lgkmcnt(6)
ds_read_b64_tr_b16 v[52:53], v24 offset:49152
ds_read_b64_tr_b16 v[54:55], v24 offset:53248
v_mfma_f32_16x16x32_bf16 a[52:55], v[32:35], v[136:139], a[52:55]
buffer_load_dwordx4 v226, s[8:11], s34 offen offset:2048 lds
v_mfma_f32_16x16x32_bf16 a[0:3], v[36:39], v[140:143], a[0:3]
s_waitcnt lgkmcnt(6)
ds_read_b64_tr_b16 v[56:57], v25 offset:49152
ds_read_b64_tr_b16 v[58:59], v25 offset:53248
v_mfma_f32_16x16x32_bf16 a[28:31], v[36:39], v[144:147], a[28:31]
v_mfma_f32_16x16x32_bf16 a[4:7], v[40:43], v[140:143], a[4:7]
s_waitcnt lgkmcnt(6)
ds_read_b64_tr_b16 v[28:29], v26 offset:49152
ds_read_b64_tr_b16 v[30:31], v26 offset:53248
v_mfma_f32_16x16x32_bf16 a[32:35], v[40:43], v[144:147], a[32:35]
buffer_load_dwordx4 v227, s[8:11], s34 offen offset:3072 lds
v_mfma_f32_16x16x32_bf16 a[8:11], v[44:47], v[140:143], a[8:11]
s_waitcnt lgkmcnt(6)
s_cmp_ge_u32 s70, s38
s_cselect_b32 s6, 0, 24117248
s_add_u32 s36, s40, 188416
ds_read_b64_tr_b16 v[32:33], v20 offset:57344
ds_read_b64_tr_b16 v[34:35], v20 offset:61440
v_mfma_f32_16x16x32_bf16 a[36:39], v[44:47], v[144:147], a[36:39]
buffer_load_dwordx4 v[92:95], v3, s[4:7], s40 offen offset:0 sc1
v_mfma_f32_16x16x32_bf16 a[12:15], v[48:51], v[140:143], a[12:15]
s_waitcnt lgkmcnt(6)
ds_read_b64_tr_b16 v[36:37], v21 offset:57344
ds_read_b64_tr_b16 v[38:39], v21 offset:61440
v_mfma_f32_16x16x32_bf16 a[40:43], v[48:51], v[144:147], a[40:43]
v_mfma_f32_16x16x32_bf16 a[16:19], v[52:55], v[140:143], a[16:19]
s_waitcnt lgkmcnt(6)
ds_read_b64_tr_b16 v[40:41], v22 offset:57344
ds_read_b64_tr_b16 v[42:43], v22 offset:61440
v_mfma_f32_16x16x32_bf16 a[44:47], v[52:55], v[144:147], a[44:47]
buffer_load_dwordx4 v[96:99], v3, s[4:7], s36 offen offset:0 sc1
v_mfma_f32_16x16x32_bf16 a[20:23], v[56:59], v[140:143], a[20:23]
s_waitcnt lgkmcnt(6)
ds_read_b64_tr_b16 v[44:45], v23 offset:57344
ds_read_b64_tr_b16 v[46:47], v23 offset:61440
v_mfma_f32_16x16x32_bf16 a[48:51], v[56:59], v[144:147], a[48:51]
buffer_load_dwordx4 v[100:103], v3, s[4:7], s40 offen offset:1024 sc1
v_mfma_f32_16x16x32_bf16 a[24:27], v[28:31], v[140:143], a[24:27]
s_waitcnt lgkmcnt(6)
ds_read_b64_tr_b16 v[48:49], v24 offset:57344
ds_read_b64_tr_b16 v[50:51], v24 offset:61440
v_mfma_f32_16x16x32_bf16 a[52:55], v[28:31], v[144:147], a[52:55]
v_mfma_f32_16x16x32_bf16 a[0:3], v[32:35], v[148:151], a[0:3]
s_waitcnt lgkmcnt(6)
ds_read_b64_tr_b16 v[52:53], v25 offset:57344
ds_read_b64_tr_b16 v[54:55], v25 offset:61440
v_mfma_f32_16x16x32_bf16 a[28:31], v[32:35], v[152:155], a[28:31]
buffer_load_dwordx4 v[104:107], v3, s[4:7], s36 offen offset:1024 sc1
v_mfma_f32_16x16x32_bf16 a[4:7], v[36:39], v[148:151], a[4:7]
s_waitcnt lgkmcnt(6)
ds_read_b64_tr_b16 v[56:57], v26 offset:57344
ds_read_b64_tr_b16 v[58:59], v26 offset:61440
v_mfma_f32_16x16x32_bf16 a[32:35], v[36:39], v[152:155], a[32:35]
buffer_load_dwordx4 v[108:111], v3, s[4:7], s40 offen offset:2048 sc1
v_mfma_f32_16x16x32_bf16 a[8:11], v[40:43], v[148:151], a[8:11]
s_waitcnt lgkmcnt(6)
ds_read_b64_tr_b16 v[28:29], v13 offset:0
ds_read_b64_tr_b16 v[30:31], v13 offset:4096
v_mfma_f32_16x16x32_bf16 a[36:39], v[40:43], v[152:155], a[36:39]
v_mfma_f32_16x16x32_bf16 a[12:15], v[44:47], v[148:151], a[12:15]
s_waitcnt lgkmcnt(6)
ds_read_b64_tr_b16 v[32:33], v14 offset:0
ds_read_b64_tr_b16 v[34:35], v14 offset:4096
v_mfma_f32_16x16x32_bf16 a[40:43], v[44:47], v[152:155], a[40:43]
buffer_load_dwordx4 v[112:115], v3, s[4:7], s36 offen offset:2048 sc1
v_mfma_f32_16x16x32_bf16 a[16:19], v[48:51], v[148:151], a[16:19]
s_waitcnt lgkmcnt(6)
ds_read_b64_tr_b16 v[36:37], v15 offset:0
ds_read_b64_tr_b16 v[38:39], v15 offset:4096
v_mfma_f32_16x16x32_bf16 a[44:47], v[48:51], v[152:155], a[44:47]
buffer_load_dwordx4 v[116:119], v3, s[4:7], s40 offen offset:3072 sc1
v_mfma_f32_16x16x32_bf16 a[20:23], v[52:55], v[148:151], a[20:23]
s_waitcnt lgkmcnt(6)
ds_read_b64_tr_b16 v[40:41], v16 offset:0
ds_read_b64_tr_b16 v[42:43], v16 offset:4096
v_mfma_f32_16x16x32_bf16 a[48:51], v[52:55], v[152:155], a[48:51]
v_mfma_f32_16x16x32_bf16 a[24:27], v[56:59], v[148:151], a[24:27]
s_waitcnt lgkmcnt(6)
ds_read_b64_tr_b16 v[44:45], v17 offset:0
ds_read_b64_tr_b16 v[46:47], v17 offset:4096
v_mfma_f32_16x16x32_bf16 a[52:55], v[56:59], v[152:155], a[52:55]
buffer_load_dwordx4 v[120:123], v3, s[4:7], s36 offen offset:3072 sc1
s_add_u32 s37, s37, 4
s_add_u32 s44, s44, 1
s_add_u32 s40, s40, 4096
s_add_u32 s70, s70, 1
s_waitcnt vmcnt(24) lgkmcnt(8)
s_barrier
v_mfma_f32_16x16x32_bf16 a[0:3], v[28:31], v[156:159], a[0:3]
s_waitcnt lgkmcnt(6)
ds_read_b64_tr_b16 v[48:49], v18 offset:0
ds_read_b64_tr_b16 v[50:51], v18 offset:4096
v_mfma_f32_16x16x32_bf16 a[28:31], v[28:31], v[160:163], a[28:31]
s_cmp_ge_u32 s44, s38
s_cselect_b32 s43, 1, 0
v_mfma_f32_16x16x32_bf16 a[4:7], v[32:35], v[156:159], a[4:7]
s_waitcnt lgkmcnt(6)
ds_read_b64_tr_b16 v[52:53], v19 offset:0
ds_read_b64_tr_b16 v[54:55], v19 offset:4096
v_mfma_f32_16x16x32_bf16 a[32:35], v[32:35], v[160:163], a[32:35]
s_cmp_ge_u32 s37, 128
s_cselect_b32 s8, s48, s46
s_cselect_b32 s9, s56, s57
v_mfma_f32_16x16x32_bf16 a[8:11], v[36:39], v[156:159], a[8:11]
s_waitcnt lgkmcnt(6)
ds_read_b64_tr_b16 v[56:57], v13 offset:8192
ds_read_b64_tr_b16 v[58:59], v13 offset:12288
v_mfma_f32_16x16x32_bf16 a[36:39], v[36:39], v[160:163], a[36:39]
s_cselect_b32 s10, 1605632, s58
s_cselect_b32 s35, 128, 0
s_sub_u32 s34, s37, s35
v_mfma_f32_16x16x32_bf16 a[12:15], v[40:43], v[156:159], a[12:15]
s_waitcnt lgkmcnt(6)
ds_read_b64_tr_b16 v[28:29], v14 offset:8192
ds_read_b64_tr_b16 v[30:31], v14 offset:12288
v_mfma_f32_16x16x32_bf16 a[40:43], v[40:43], v[160:163], a[40:43]
s_add_u32 s34, s34, s30
s_mul_i32 s34, s34, 28672
s_add_u32 s34, s34, s45
v_mfma_f32_16x16x32_bf16 a[16:19], v[44:47], v[156:159], a[16:19]
s_waitcnt lgkmcnt(6)
ds_read_b64_tr_b16 v[32:33], v15 offset:8192
ds_read_b64_tr_b16 v[34:35], v15 offset:12288
v_mfma_f32_16x16x32_bf16 a[44:47], v[44:47], v[160:163], a[44:47]
s_cmp_eq_u32 s43, 1
s_cselect_b32 s10, 0, s10
s_add_u32 m0, s41, 98304
v_mfma_f32_16x16x32_bf16 a[20:23], v[48:51], v[156:159], a[20:23]
s_waitcnt lgkmcnt(6)
ds_read_b64_tr_b16 v[36:37], v16 offset:8192
ds_read_b64_tr_b16 v[38:39], v16 offset:12288
v_mfma_f32_16x16x32_bf16 a[48:51], v[48:51], v[160:163], a[48:51]
buffer_load_dwordx4 v220, s[8:11], s34 offen offset:0 lds
v_mfma_f32_16x16x32_bf16 a[24:27], v[52:55], v[156:159], a[24:27]
s_waitcnt lgkmcnt(6)
ds_read_b64_tr_b16 v[40:41], v17 offset:8192
ds_read_b64_tr_b16 v[42:43], v17 offset:12288
v_mfma_f32_16x16x32_bf16 a[52:55], v[52:55], v[160:163], a[52:55]
v_mfma_f32_16x16x32_bf16 a[0:3], v[56:59], v[164:167], a[0:3]
s_waitcnt lgkmcnt(6)
ds_read_b64_tr_b16 v[44:45], v18 offset:8192
ds_read_b64_tr_b16 v[46:47], v18 offset:12288
v_mfma_f32_16x16x32_bf16 a[28:31], v[56:59], v[168:171], a[28:31]
v_mfma_f32_16x16x32_bf16 a[4:7], v[28:31], v[164:167], a[4:7]
s_waitcnt lgkmcnt(6)
ds_read_b64_tr_b16 v[48:49], v19 offset:8192
ds_read_b64_tr_b16 v[50:51], v19 offset:12288
v_mfma_f32_16x16x32_bf16 a[32:35], v[28:31], v[168:171], a[32:35]
buffer_load_dwordx4 v221, s[8:11], s34 offen offset:1024 lds
v_mfma_f32_16x16x32_bf16 a[8:11], v[32:35], v[164:167], a[8:11]
s_waitcnt lgkmcnt(6)
ds_read_b64_tr_b16 v[52:53], v13 offset:16384
ds_read_b64_tr_b16 v[54:55], v13 offset:20480
v_mfma_f32_16x16x32_bf16 a[36:39], v[32:35], v[168:171], a[36:39]
v_mfma_f32_16x16x32_bf16 a[12:15], v[36:39], v[164:167], a[12:15]
s_waitcnt lgkmcnt(6)
ds_read_b64_tr_b16 v[56:57], v14 offset:16384
ds_read_b64_tr_b16 v[58:59], v14 offset:20480
v_mfma_f32_16x16x32_bf16 a[40:43], v[36:39], v[168:171], a[40:43]
v_mfma_f32_16x16x32_bf16 a[16:19], v[40:43], v[164:167], a[16:19]
s_waitcnt lgkmcnt(6)
ds_read_b64_tr_b16 v[28:29], v15 offset:16384
ds_read_b64_tr_b16 v[30:31], v15 offset:20480
v_mfma_f32_16x16x32_bf16 a[44:47], v[40:43], v[168:171], a[44:47]
buffer_load_dwordx4 v222, s[8:11], s34 offen offset:2048 lds
v_mfma_f32_16x16x32_bf16 a[20:23], v[44:47], v[164:167], a[20:23]
s_waitcnt lgkmcnt(6)
ds_read_b64_tr_b16 v[32:33], v16 offset:16384
ds_read_b64_tr_b16 v[34:35], v16 offset:20480
v_mfma_f32_16x16x32_bf16 a[48:51], v[44:47], v[168:171], a[48:51]
v_mfma_f32_16x16x32_bf16 a[24:27], v[48:51], v[164:167], a[24:27]
s_waitcnt lgkmcnt(6)
ds_read_b64_tr_b16 v[36:37], v17 offset:16384
ds_read_b64_tr_b16 v[38:39], v17 offset:20480
v_mfma_f32_16x16x32_bf16 a[52:55], v[48:51], v[168:171], a[52:55]
v_mfma_f32_16x16x32_bf16 a[0:3], v[52:55], v[172:175], a[0:3]
s_waitcnt lgkmcnt(6)
ds_read_b64_tr_b16 v[40:41], v18 offset:16384
ds_read_b64_tr_b16 v[42:43], v18 offset:20480
v_mfma_f32_16x16x32_bf16 a[28:31], v[52:55], v[176:179], a[28:31]
buffer_load_dwordx4 v223, s[8:11], s34 offen offset:3072 lds
v_mfma_f32_16x16x32_bf16 a[4:7], v[56:59], v[172:175], a[4:7]
s_waitcnt lgkmcnt(6)
ds_read_b64_tr_b16 v[44:45], v19 offset:16384
ds_read_b64_tr_b16 v[46:47], v19 offset:20480
v_mfma_f32_16x16x32_bf16 a[32:35], v[56:59], v[176:179], a[32:35]
v_mfma_f32_16x16x32_bf16 a[8:11], v[28:31], v[172:175], a[8:11]
s_waitcnt lgkmcnt(6)
ds_read_b64_tr_b16 v[48:49], v13 offset:24576
ds_read_b64_tr_b16 v[50:51], v13 offset:28672
v_mfma_f32_16x16x32_bf16 a[36:39], v[28:31], v[176:179], a[36:39]
v_mfma_f32_16x16x32_bf16 a[12:15], v[32:35], v[172:175], a[12:15]
s_waitcnt lgkmcnt(6)
s_add_u32 m0, s41, 102400
ds_read_b64_tr_b16 v[52:53], v14 offset:24576
ds_read_b64_tr_b16 v[54:55], v14 offset:28672
v_mfma_f32_16x16x32_bf16 a[40:43], v[32:35], v[176:179], a[40:43]
buffer_load_dwordx4 v224, s[8:11], s34 offen offset:0 lds
v_mfma_f32_16x16x32_bf16 a[16:19], v[36:39], v[172:175], a[16:19]
s_waitcnt lgkmcnt(6)
ds_read_b64_tr_b16 v[56:57], v15 offset:24576
ds_read_b64_tr_b16 v[58:59], v15 offset:28672
v_mfma_f32_16x16x32_bf16 a[44:47], v[36:39], v[176:179], a[44:47]
v_mfma_f32_16x16x32_bf16 a[20:23], v[40:43], v[172:175], a[20:23]
s_waitcnt lgkmcnt(6)
ds_read_b64_tr_b16 v[28:29], v16 offset:24576
ds_read_b64_tr_b16 v[30:31], v16 offset:28672
v_mfma_f32_16x16x32_bf16 a[48:51], v[40:43], v[176:179], a[48:51]
v_mfma_f32_16x16x32_bf16 a[24:27], v[44:47], v[172:175], a[24:27]
s_waitcnt lgkmcnt(6)
ds_read_b64_tr_b16 v[32:33], v17 offset:24576
ds_read_b64_tr_b16 v[34:35], v17 offset:28672
v_mfma_f32_16x16x32_bf16 a[52:55], v[44:47], v[176:179], a[52:55]
buffer_load_dwordx4 v225, s[8:11], s34 offen offset:1024 lds
v_mfma_f32_16x16x32_bf16 a[0:3], v[48:51], v[180:183], a[0:3]
s_waitcnt lgkmcnt(6)
ds_read_b64_tr_b16 v[36:37], v18 offset:24576
ds_read_b64_tr_b16 v[38:39], v18 offset:28672
v_mfma_f32_16x16x32_bf16 a[28:31], v[48:51], v[184:187], a[28:31]
v_mfma_f32_16x16x32_bf16 a[4:7], v[52:55], v[180:183], a[4:7]
s_waitcnt lgkmcnt(6)
ds_read_b64_tr_b16 v[40:41], v19 offset:24576
ds_read_b64_tr_b16 v[42:43], v19 offset:28672
v_mfma_f32_16x16x32_bf16 a[32:35], v[52:55], v[184:187], a[32:35]
v_mfma_f32_16x16x32_bf16 a[8:11], v[56:59], v[180:183], a[8:11]
s_waitcnt lgkmcnt(6)
ds_read_b64_tr_b16 v[44:45], v13 offset:32768
ds_read_b64_tr_b16 v[46:47], v13 offset:36864
v_mfma_f32_16x16x32_bf16 a[36:39], v[56:59], v[184:187], a[36:39]
buffer_load_dwordx4 v226, s[8:11], s34 offen offset:2048 lds
v_mfma_f32_16x16x32_bf16 a[12:15], v[28:31], v[180:183], a[12:15]
s_waitcnt lgkmcnt(6)
ds_read_b64_tr_b16 v[48:49], v14 offset:32768
ds_read_b64_tr_b16 v[50:51], v14 offset:36864
v_mfma_f32_16x16x32_bf16 a[40:43], v[28:31], v[184:187], a[40:43]
v_mfma_f32_16x16x32_bf16 a[16:19], v[32:35], v[180:183], a[16:19]
s_waitcnt lgkmcnt(6)
ds_read_b64_tr_b16 v[52:53], v15 offset:32768
ds_read_b64_tr_b16 v[54:55], v15 offset:36864
v_mfma_f32_16x16x32_bf16 a[44:47], v[32:35], v[184:187], a[44:47]
v_mfma_f32_16x16x32_bf16 a[20:23], v[36:39], v[180:183], a[20:23]
s_waitcnt lgkmcnt(6)
ds_read_b64_tr_b16 v[56:57], v16 offset:32768
ds_read_b64_tr_b16 v[58:59], v16 offset:36864
v_mfma_f32_16x16x32_bf16 a[48:51], v[36:39], v[184:187], a[48:51]
v_mfma_f32_16x16x32_bf16 a[24:27], v[40:43], v[180:183], a[24:27]
s_waitcnt lgkmcnt(6)
ds_read_b64_tr_b16 v[28:29], v17 offset:32768
ds_read_b64_tr_b16 v[30:31], v17 offset:36864
v_mfma_f32_16x16x32_bf16 a[52:55], v[40:43], v[184:187], a[52:55]
buffer_load_dwordx4 v227, s[8:11], s34 offen offset:3072 lds
s_add_u32 s37, s37, 4
s_add_u32 s44, s44, 1
s_waitcnt vmcnt(16) lgkmcnt(8)
s_barrier
v_mfma_f32_16x16x32_bf16 a[0:3], v[44:47], v[188:191], a[0:3]
s_waitcnt lgkmcnt(6)
ds_read_b64_tr_b16 v[32:33], v18 offset:32768
ds_read_b64_tr_b16 v[34:35], v18 offset:36864
v_mfma_f32_16x16x32_bf16 a[28:31], v[44:47], v[192:195], a[28:31]
v_mfma_f32_16x16x32_bf16 a[4:7], v[48:51], v[188:191], a[4:7]
s_waitcnt lgkmcnt(6)
ds_read_b64_tr_b16 v[36:37], v19 offset:32768
ds_read_b64_tr_b16 v[38:39], v19 offset:36864
v_mfma_f32_16x16x32_bf16 a[32:35], v[48:51], v[192:195], a[32:35]
v_mfma_f32_16x16x32_bf16 a[8:11], v[52:55], v[188:191], a[8:11]
s_waitcnt lgkmcnt(6)
ds_read_b64_tr_b16 v[40:41], v13 offset:40960
ds_read_b64_tr_b16 v[42:43], v13 offset:45056
v_mfma_f32_16x16x32_bf16 a[36:39], v[52:55], v[192:195], a[36:39]
v_mfma_f32_16x16x32_bf16 a[12:15], v[56:59], v[188:191], a[12:15]
s_waitcnt lgkmcnt(6)
ds_read_b64_tr_b16 v[44:45], v14 offset:40960
ds_read_b64_tr_b16 v[46:47], v14 offset:45056
v_mfma_f32_16x16x32_bf16 a[40:43], v[56:59], v[192:195], a[40:43]
v_mfma_f32_16x16x32_bf16 a[16:19], v[28:31], v[188:191], a[16:19]
s_waitcnt lgkmcnt(6)
ds_read_b64_tr_b16 v[48:49], v15 offset:40960
ds_read_b64_tr_b16 v[50:51], v15 offset:45056
v_mfma_f32_16x16x32_bf16 a[44:47], v[28:31], v[192:195], a[44:47]
v_mfma_f32_16x16x32_bf16 a[20:23], v[32:35], v[188:191], a[20:23]
s_waitcnt lgkmcnt(6)
ds_read_b64_tr_b16 v[52:53], v16 offset:40960
ds_read_b64_tr_b16 v[54:55], v16 offset:45056
v_mfma_f32_16x16x32_bf16 a[48:51], v[32:35], v[192:195], a[48:51]
v_mfma_f32_16x16x32_bf16 a[24:27], v[36:39], v[188:191], a[24:27]
s_waitcnt lgkmcnt(6)
ds_read_b64_tr_b16 v[56:57], v17 offset:40960
ds_read_b64_tr_b16 v[58:59], v17 offset:45056
v_mfma_f32_16x16x32_bf16 a[52:55], v[36:39], v[192:195], a[52:55]
v_mfma_f32_16x16x32_bf16 a[0:3], v[40:43], v[196:199], a[0:3]
s_waitcnt lgkmcnt(6)
ds_read_b64_tr_b16 v[28:29], v18 offset:40960
ds_read_b64_tr_b16 v[30:31], v18 offset:45056
v_mfma_f32_16x16x32_bf16 a[28:31], v[40:43], v[200:203], a[28:31]
v_mfma_f32_16x16x32_bf16 a[4:7], v[44:47], v[196:199], a[4:7]
s_waitcnt lgkmcnt(6)
ds_read_b64_tr_b16 v[32:33], v19 offset:40960
ds_read_b64_tr_b16 v[34:35], v19 offset:45056
v_mfma_f32_16x16x32_bf16 a[32:35], v[44:47], v[200:203], a[32:35]
v_mfma_f32_16x16x32_bf16 a[8:11], v[48:51], v[196:199], a[8:11]
s_waitcnt lgkmcnt(6)
ds_read_b64_tr_b16 v[36:37], v13 offset:49152
ds_read_b64_tr_b16 v[38:39], v13 offset:53248
v_mfma_f32_16x16x32_bf16 a[36:39], v[48:51], v[200:203], a[36:39]
v_mfma_f32_16x16x32_bf16 a[12:15], v[52:55], v[196:199], a[12:15]
s_waitcnt lgkmcnt(6)
ds_read_b64_tr_b16 v[40:41], v14 offset:49152
ds_read_b64_tr_b16 v[42:43], v14 offset:53248
v_mfma_f32_16x16x32_bf16 a[40:43], v[52:55], v[200:203], a[40:43]
v_mfma_f32_16x16x32_bf16 a[16:19], v[56:59], v[196:199], a[16:19]
s_waitcnt lgkmcnt(6)
ds_read_b64_tr_b16 v[44:45], v15 offset:49152
ds_read_b64_tr_b16 v[46:47], v15 offset:53248
v_mfma_f32_16x16x32_bf16 a[44:47], v[56:59], v[200:203], a[44:47]
v_mfma_f32_16x16x32_bf16 a[20:23], v[28:31], v[196:199], a[20:23]
s_waitcnt lgkmcnt(6)
ds_read_b64_tr_b16 v[48:49], v16 offset:49152
ds_read_b64_tr_b16 v[50:51], v16 offset:53248
v_mfma_f32_16x16x32_bf16 a[48:51], v[28:31], v[200:203], a[48:51]
v_mfma_f32_16x16x32_bf16 a[24:27], v[32:35], v[196:199], a[24:27]
s_waitcnt lgkmcnt(6)
ds_read_b64_tr_b16 v[52:53], v17 offset:49152
ds_read_b64_tr_b16 v[54:55], v17 offset:53248
v_mfma_f32_16x16x32_bf16 a[52:55], v[32:35], v[200:203], a[52:55]
v_mfma_f32_16x16x32_bf16 a[0:3], v[36:39], v[204:207], a[0:3]
s_waitcnt lgkmcnt(6)
ds_read_b64_tr_b16 v[56:57], v18 offset:49152
ds_read_b64_tr_b16 v[58:59], v18 offset:53248
v_mfma_f32_16x16x32_bf16 a[28:31], v[36:39], v[208:211], a[28:31]
v_mfma_f32_16x16x32_bf16 a[4:7], v[40:43], v[204:207], a[4:7]
s_waitcnt lgkmcnt(6)
ds_read_b64_tr_b16 v[28:29], v19 offset:49152
ds_read_b64_tr_b16 v[30:31], v19 offset:53248
v_mfma_f32_16x16x32_bf16 a[32:35], v[40:43], v[208:211], a[32:35]
v_mfma_f32_16x16x32_bf16 a[8:11], v[44:47], v[204:207], a[8:11]
s_waitcnt lgkmcnt(6)
ds_read_b64_tr_b16 v[32:33], v13 offset:57344
ds_read_b64_tr_b16 v[34:35], v13 offset:61440
v_mfma_f32_16x16x32_bf16 a[36:39], v[44:47], v[208:211], a[36:39]
v_mfma_f32_16x16x32_bf16 a[12:15], v[48:51], v[204:207], a[12:15]
s_waitcnt lgkmcnt(6)
ds_read_b64_tr_b16 v[36:37], v14 offset:57344
ds_read_b64_tr_b16 v[38:39], v14 offset:61440
v_mfma_f32_16x16x32_bf16 a[40:43], v[48:51], v[208:211], a[40:43]
v_mfma_f32_16x16x32_bf16 a[16:19], v[52:55], v[204:207], a[16:19]
s_waitcnt lgkmcnt(6)
ds_read_b64_tr_b16 v[40:41], v15 offset:57344
ds_read_b64_tr_b16 v[42:43], v15 offset:61440
v_mfma_f32_16x16x32_bf16 a[44:47], v[52:55], v[208:211], a[44:47]
v_mfma_f32_16x16x32_bf16 a[20:23], v[56:59], v[204:207], a[20:23]
s_waitcnt lgkmcnt(6)
ds_read_b64_tr_b16 v[44:45], v16 offset:57344
ds_read_b64_tr_b16 v[46:47], v16 offset:61440
v_mfma_f32_16x16x32_bf16 a[48:51], v[56:59], v[208:211], a[48:51]
v_mfma_f32_16x16x32_bf16 a[24:27], v[28:31], v[204:207], a[24:27]
s_waitcnt lgkmcnt(6)
ds_read_b64_tr_b16 v[48:49], v17 offset:57344
ds_read_b64_tr_b16 v[50:51], v17 offset:61440
v_mfma_f32_16x16x32_bf16 a[52:55], v[28:31], v[208:211], a[52:55]
v_mfma_f32_16x16x32_bf16 a[0:3], v[32:35], v[212:215], a[0:3]
s_waitcnt lgkmcnt(6)
ds_read_b64_tr_b16 v[52:53], v18 offset:57344
ds_read_b64_tr_b16 v[54:55], v18 offset:61440
v_mfma_f32_16x16x32_bf16 a[28:31], v[32:35], v[216:219], a[28:31]
v_mfma_f32_16x16x32_bf16 a[4:7], v[36:39], v[212:215], a[4:7]
s_waitcnt lgkmcnt(6)
ds_read_b64_tr_b16 v[56:57], v19 offset:57344
ds_read_b64_tr_b16 v[58:59], v19 offset:61440
v_mfma_f32_16x16x32_bf16 a[32:35], v[36:39], v[216:219], a[32:35]
v_mfma_f32_16x16x32_bf16 a[8:11], v[40:43], v[212:215], a[8:11]
s_waitcnt lgkmcnt(6)
ds_read_b64_tr_b16 v[28:29], v20 offset:0
ds_read_b64_tr_b16 v[30:31], v20 offset:4096
v_mfma_f32_16x16x32_bf16 a[36:39], v[40:43], v[216:219], a[36:39]
v_mfma_f32_16x16x32_bf16 a[12:15], v[44:47], v[212:215], a[12:15]
s_waitcnt lgkmcnt(6)
ds_read_b64_tr_b16 v[32:33], v21 offset:0
ds_read_b64_tr_b16 v[34:35], v21 offset:4096
v_mfma_f32_16x16x32_bf16 a[40:43], v[44:47], v[216:219], a[40:43]
v_mfma_f32_16x16x32_bf16 a[16:19], v[48:51], v[212:215], a[16:19]
s_waitcnt lgkmcnt(6)
ds_read_b64_tr_b16 v[36:37], v22 offset:0
ds_read_b64_tr_b16 v[38:39], v22 offset:4096
v_mfma_f32_16x16x32_bf16 a[44:47], v[48:51], v[216:219], a[44:47]
v_mfma_f32_16x16x32_bf16 a[20:23], v[52:55], v[212:215], a[20:23]
s_waitcnt lgkmcnt(6)
ds_read_b64_tr_b16 v[40:41], v23 offset:0
ds_read_b64_tr_b16 v[42:43], v23 offset:4096
v_mfma_f32_16x16x32_bf16 a[48:51], v[52:55], v[216:219], a[48:51]
v_mfma_f32_16x16x32_bf16 a[24:27], v[56:59], v[212:215], a[24:27]
s_waitcnt lgkmcnt(6)
ds_read_b64_tr_b16 v[44:45], v24 offset:0
ds_read_b64_tr_b16 v[46:47], v24 offset:4096
v_mfma_f32_16x16x32_bf16 a[52:55], v[56:59], v[216:219], a[52:55]
s_waitcnt vmcnt(0) lgkmcnt(8)
s_barrier
v_mfma_f32_16x16x32_bf16 a[0:3], v[28:31], v[60:63], a[0:3]
s_waitcnt lgkmcnt(6)
ds_read_b64_tr_b16 v[48:49], v25 offset:0
ds_read_b64_tr_b16 v[50:51], v25 offset:4096
v_mfma_f32_16x16x32_bf16 a[28:31], v[28:31], v[64:67], a[28:31]
v_mfma_f32_16x16x32_bf16 a[4:7], v[32:35], v[60:63], a[4:7]
s_waitcnt lgkmcnt(6)
ds_read_b64_tr_b16 v[52:53], v26 offset:0
ds_read_b64_tr_b16 v[54:55], v26 offset:4096
v_mfma_f32_16x16x32_bf16 a[32:35], v[32:35], v[64:67], a[32:35]
v_mfma_f32_16x16x32_bf16 a[8:11], v[36:39], v[60:63], a[8:11]
s_waitcnt lgkmcnt(6)
ds_read_b64_tr_b16 v[56:57], v20 offset:8192
ds_read_b64_tr_b16 v[58:59], v20 offset:12288
v_mfma_f32_16x16x32_bf16 a[36:39], v[36:39], v[64:67], a[36:39]
v_mfma_f32_16x16x32_bf16 a[12:15], v[40:43], v[60:63], a[12:15]
s_waitcnt lgkmcnt(6)
ds_read_b64_tr_b16 v[28:29], v21 offset:8192
ds_read_b64_tr_b16 v[30:31], v21 offset:12288
v_mfma_f32_16x16x32_bf16 a[40:43], v[40:43], v[64:67], a[40:43]
v_mfma_f32_16x16x32_bf16 a[16:19], v[44:47], v[60:63], a[16:19]
s_waitcnt lgkmcnt(6)
ds_read_b64_tr_b16 v[32:33], v22 offset:8192
ds_read_b64_tr_b16 v[34:35], v22 offset:12288
v_mfma_f32_16x16x32_bf16 a[44:47], v[44:47], v[64:67], a[44:47]
v_mfma_f32_16x16x32_bf16 a[20:23], v[48:51], v[60:63], a[20:23]
s_waitcnt lgkmcnt(6)
ds_read_b64_tr_b16 v[36:37], v23 offset:8192
ds_read_b64_tr_b16 v[38:39], v23 offset:12288
v_mfma_f32_16x16x32_bf16 a[48:51], v[48:51], v[64:67], a[48:51]
v_mfma_f32_16x16x32_bf16 a[24:27], v[52:55], v[60:63], a[24:27]
s_waitcnt lgkmcnt(6)
ds_read_b64_tr_b16 v[40:41], v24 offset:8192
ds_read_b64_tr_b16 v[42:43], v24 offset:12288
v_mfma_f32_16x16x32_bf16 a[52:55], v[52:55], v[64:67], a[52:55]
v_mfma_f32_16x16x32_bf16 a[0:3], v[56:59], v[68:71], a[0:3]
s_waitcnt lgkmcnt(6)
ds_read_b64_tr_b16 v[44:45], v25 offset:8192
ds_read_b64_tr_b16 v[46:47], v25 offset:12288
v_mfma_f32_16x16x32_bf16 a[28:31], v[56:59], v[72:75], a[28:31]
v_mfma_f32_16x16x32_bf16 a[4:7], v[28:31], v[68:71], a[4:7]
s_waitcnt lgkmcnt(6)
ds_read_b64_tr_b16 v[48:49], v26 offset:8192
ds_read_b64_tr_b16 v[50:51], v26 offset:12288
v_mfma_f32_16x16x32_bf16 a[32:35], v[28:31], v[72:75], a[32:35]
v_mfma_f32_16x16x32_bf16 a[8:11], v[32:35], v[68:71], a[8:11]
s_waitcnt lgkmcnt(6)
ds_read_b64_tr_b16 v[52:53], v20 offset:16384
ds_read_b64_tr_b16 v[54:55], v20 offset:20480
v_mfma_f32_16x16x32_bf16 a[36:39], v[32:35], v[72:75], a[36:39]
v_mfma_f32_16x16x32_bf16 a[12:15], v[36:39], v[68:71], a[12:15]
s_waitcnt lgkmcnt(6)
ds_read_b64_tr_b16 v[56:57], v21 offset:16384
ds_read_b64_tr_b16 v[58:59], v21 offset:20480
v_mfma_f32_16x16x32_bf16 a[40:43], v[36:39], v[72:75], a[40:43]
v_mfma_f32_16x16x32_bf16 a[16:19], v[40:43], v[68:71], a[16:19]
s_waitcnt lgkmcnt(6)
ds_read_b64_tr_b16 v[28:29], v22 offset:16384
ds_read_b64_tr_b16 v[30:31], v22 offset:20480
v_mfma_f32_16x16x32_bf16 a[44:47], v[40:43], v[72:75], a[44:47]
v_mfma_f32_16x16x32_bf16 a[20:23], v[44:47], v[68:71], a[20:23]
s_waitcnt lgkmcnt(6)
ds_read_b64_tr_b16 v[32:33], v23 offset:16384
ds_read_b64_tr_b16 v[34:35], v23 offset:20480
v_mfma_f32_16x16x32_bf16 a[48:51], v[44:47], v[72:75], a[48:51]
v_mfma_f32_16x16x32_bf16 a[24:27], v[48:51], v[68:71], a[24:27]
s_waitcnt lgkmcnt(6)
ds_read_b64_tr_b16 v[36:37], v24 offset:16384
ds_read_b64_tr_b16 v[38:39], v24 offset:20480
v_mfma_f32_16x16x32_bf16 a[52:55], v[48:51], v[72:75], a[52:55]
v_mfma_f32_16x16x32_bf16 a[0:3], v[52:55], v[76:79], a[0:3]
s_waitcnt lgkmcnt(6)
ds_read_b64_tr_b16 v[40:41], v25 offset:16384
ds_read_b64_tr_b16 v[42:43], v25 offset:20480
v_mfma_f32_16x16x32_bf16 a[28:31], v[52:55], v[80:83], a[28:31]
v_mfma_f32_16x16x32_bf16 a[4:7], v[56:59], v[76:79], a[4:7]
s_waitcnt lgkmcnt(6)
ds_read_b64_tr_b16 v[44:45], v26 offset:16384
ds_read_b64_tr_b16 v[46:47], v26 offset:20480
v_mfma_f32_16x16x32_bf16 a[32:35], v[56:59], v[80:83], a[32:35]
v_mfma_f32_16x16x32_bf16 a[8:11], v[28:31], v[76:79], a[8:11]
s_waitcnt lgkmcnt(6)
ds_read_b64_tr_b16 v[48:49], v20 offset:24576
ds_read_b64_tr_b16 v[50:51], v20 offset:28672
v_mfma_f32_16x16x32_bf16 a[36:39], v[28:31], v[80:83], a[36:39]
v_mfma_f32_16x16x32_bf16 a[12:15], v[32:35], v[76:79], a[12:15]
s_waitcnt lgkmcnt(6)
ds_read_b64_tr_b16 v[52:53], v21 offset:24576
ds_read_b64_tr_b16 v[54:55], v21 offset:28672
v_mfma_f32_16x16x32_bf16 a[40:43], v[32:35], v[80:83], a[40:43]
v_mfma_f32_16x16x32_bf16 a[16:19], v[36:39], v[76:79], a[16:19]
s_waitcnt lgkmcnt(6)
ds_read_b64_tr_b16 v[56:57], v22 offset:24576
ds_read_b64_tr_b16 v[58:59], v22 offset:28672
v_mfma_f32_16x16x32_bf16 a[44:47], v[36:39], v[80:83], a[44:47]
v_mfma_f32_16x16x32_bf16 a[20:23], v[40:43], v[76:79], a[20:23]
s_waitcnt lgkmcnt(6)
ds_read_b64_tr_b16 v[28:29], v23 offset:24576
ds_read_b64_tr_b16 v[30:31], v23 offset:28672
v_mfma_f32_16x16x32_bf16 a[48:51], v[40:43], v[80:83], a[48:51]
v_mfma_f32_16x16x32_bf16 a[24:27], v[44:47], v[76:79], a[24:27]
s_waitcnt lgkmcnt(6)
ds_read_b64_tr_b16 v[32:33], v24 offset:24576
ds_read_b64_tr_b16 v[34:35], v24 offset:28672
v_mfma_f32_16x16x32_bf16 a[52:55], v[44:47], v[80:83], a[52:55]
v_mfma_f32_16x16x32_bf16 a[0:3], v[48:51], v[84:87], a[0:3]
s_waitcnt lgkmcnt(6)
ds_read_b64_tr_b16 v[36:37], v25 offset:24576
ds_read_b64_tr_b16 v[38:39], v25 offset:28672
v_mfma_f32_16x16x32_bf16 a[28:31], v[48:51], v[88:91], a[28:31]
v_mfma_f32_16x16x32_bf16 a[4:7], v[52:55], v[84:87], a[4:7]
s_waitcnt lgkmcnt(6)
ds_read_b64_tr_b16 v[40:41], v26 offset:24576
ds_read_b64_tr_b16 v[42:43], v26 offset:28672
v_mfma_f32_16x16x32_bf16 a[32:35], v[52:55], v[88:91], a[32:35]
v_mfma_f32_16x16x32_bf16 a[8:11], v[56:59], v[84:87], a[8:11]
s_waitcnt lgkmcnt(6)
ds_read_b64_tr_b16 v[44:45], v20 offset:32768
ds_read_b64_tr_b16 v[46:47], v20 offset:36864
v_mfma_f32_16x16x32_bf16 a[36:39], v[56:59], v[88:91], a[36:39]
v_mfma_f32_16x16x32_bf16 a[12:15], v[28:31], v[84:87], a[12:15]
s_waitcnt lgkmcnt(6)
ds_read_b64_tr_b16 v[48:49], v21 offset:32768
ds_read_b64_tr_b16 v[50:51], v21 offset:36864
v_mfma_f32_16x16x32_bf16 a[40:43], v[28:31], v[88:91], a[40:43]
v_mfma_f32_16x16x32_bf16 a[16:19], v[32:35], v[84:87], a[16:19]
s_waitcnt lgkmcnt(6)
ds_read_b64_tr_b16 v[52:53], v22 offset:32768
ds_read_b64_tr_b16 v[54:55], v22 offset:36864
v_mfma_f32_16x16x32_bf16 a[44:47], v[32:35], v[88:91], a[44:47]
v_mfma_f32_16x16x32_bf16 a[20:23], v[36:39], v[84:87], a[20:23]
s_waitcnt lgkmcnt(6)
ds_read_b64_tr_b16 v[56:57], v23 offset:32768
ds_read_b64_tr_b16 v[58:59], v23 offset:36864
v_mfma_f32_16x16x32_bf16 a[48:51], v[36:39], v[88:91], a[48:51]
v_mfma_f32_16x16x32_bf16 a[24:27], v[40:43], v[84:87], a[24:27]
s_waitcnt lgkmcnt(6)
ds_read_b64_tr_b16 v[28:29], v24 offset:32768
ds_read_b64_tr_b16 v[30:31], v24 offset:36864
v_mfma_f32_16x16x32_bf16 a[52:55], v[40:43], v[88:91], a[52:55]
s_cmp_eq_u32 s38, 11
s_cbranch_scc1 K3_EPI
s_waitcnt vmcnt(8) lgkmcnt(8)
s_barrier
v_mfma_f32_16x16x32_bf16 a[0:3], v[44:47], v[92:95], a[0:3]
s_waitcnt lgkmcnt(6)
ds_read_b64_tr_b16 v[32:33], v25 offset:32768
ds_read_b64_tr_b16 v[34:35], v25 offset:36864
v_mfma_f32_16x16x32_bf16 a[28:31], v[44:47], v[96:99], a[28:31]
v_mfma_f32_16x16x32_bf16 a[4:7], v[48:51], v[92:95], a[4:7]
s_waitcnt lgkmcnt(6)
ds_read_b64_tr_b16 v[36:37], v26 offset:32768
ds_read_b64_tr_b16 v[38:39], v26 offset:36864
v_mfma_f32_16x16x32_bf16 a[32:35], v[48:51], v[96:99], a[32:35]
v_mfma_f32_16x16x32_bf16 a[8:11], v[52:55], v[92:95], a[8:11]
s_waitcnt lgkmcnt(6)
ds_read_b64_tr_b16 v[40:41], v20 offset:40960
ds_read_b64_tr_b16 v[42:43], v20 offset:45056
v_mfma_f32_16x16x32_bf16 a[36:39], v[52:55], v[96:99], a[36:39]
v_mfma_f32_16x16x32_bf16 a[12:15], v[56:59], v[92:95], a[12:15]
s_waitcnt lgkmcnt(6)
ds_read_b64_tr_b16 v[44:45], v21 offset:40960
ds_read_b64_tr_b16 v[46:47], v21 offset:45056
v_mfma_f32_16x16x32_bf16 a[40:43], v[56:59], v[96:99], a[40:43]
v_mfma_f32_16x16x32_bf16 a[16:19], v[28:31], v[92:95], a[16:19]
s_waitcnt lgkmcnt(6)
ds_read_b64_tr_b16 v[48:49], v22 offset:40960
ds_read_b64_tr_b16 v[50:51], v22 offset:45056
v_mfma_f32_16x16x32_bf16 a[44:47], v[28:31], v[96:99], a[44:47]
v_mfma_f32_16x16x32_bf16 a[20:23], v[32:35], v[92:95], a[20:23]
s_waitcnt lgkmcnt(6)
ds_read_b64_tr_b16 v[52:53], v23 offset:40960
ds_read_b64_tr_b16 v[54:55], v23 offset:45056
v_mfma_f32_16x16x32_bf16 a[48:51], v[32:35], v[96:99], a[48:51]
v_mfma_f32_16x16x32_bf16 a[24:27], v[36:39], v[92:95], a[24:27]
s_waitcnt lgkmcnt(6)
ds_read_b64_tr_b16 v[56:57], v24 offset:40960
ds_read_b64_tr_b16 v[58:59], v24 offset:45056
v_mfma_f32_16x16x32_bf16 a[52:55], v[36:39], v[96:99], a[52:55]
v_mfma_f32_16x16x32_bf16 a[0:3], v[40:43], v[100:103], a[0:3]
s_waitcnt lgkmcnt(6)
ds_read_b64_tr_b16 v[28:29], v25 offset:40960
ds_read_b64_tr_b16 v[30:31], v25 offset:45056
v_mfma_f32_16x16x32_bf16 a[28:31], v[40:43], v[104:107], a[28:31]
v_mfma_f32_16x16x32_bf16 a[4:7], v[44:47], v[100:103], a[4:7]
s_waitcnt lgkmcnt(6)
ds_read_b64_tr_b16 v[32:33], v26 offset:40960
ds_read_b64_tr_b16 v[34:35], v26 offset:45056
v_mfma_f32_16x16x32_bf16 a[32:35], v[44:47], v[104:107], a[32:35]
v_mfma_f32_16x16x32_bf16 a[8:11], v[48:51], v[100:103], a[8:11]
s_waitcnt lgkmcnt(6)
ds_read_b64_tr_b16 v[36:37], v20 offset:49152
ds_read_b64_tr_b16 v[38:39], v20 offset:53248
v_mfma_f32_16x16x32_bf16 a[36:39], v[48:51], v[104:107], a[36:39]
v_mfma_f32_16x16x32_bf16 a[12:15], v[52:55], v[100:103], a[12:15]
s_waitcnt lgkmcnt(6)
ds_read_b64_tr_b16 v[40:41], v21 offset:49152
ds_read_b64_tr_b16 v[42:43], v21 offset:53248
v_mfma_f32_16x16x32_bf16 a[40:43], v[52:55], v[104:107], a[40:43]
v_mfma_f32_16x16x32_bf16 a[16:19], v[56:59], v[100:103], a[16:19]
s_waitcnt lgkmcnt(6)
ds_read_b64_tr_b16 v[44:45], v22 offset:49152
ds_read_b64_tr_b16 v[46:47], v22 offset:53248
v_mfma_f32_16x16x32_bf16 a[44:47], v[56:59], v[104:107], a[44:47]
v_mfma_f32_16x16x32_bf16 a[20:23], v[28:31], v[100:103], a[20:23]
s_waitcnt lgkmcnt(6)
ds_read_b64_tr_b16 v[48:49], v23 offset:49152
ds_read_b64_tr_b16 v[50:51], v23 offset:53248
v_mfma_f32_16x16x32_bf16 a[48:51], v[28:31], v[104:107], a[48:51]
v_mfma_f32_16x16x32_bf16 a[24:27], v[32:35], v[100:103], a[24:27]
s_waitcnt lgkmcnt(6)
ds_read_b64_tr_b16 v[52:53], v24 offset:49152
ds_read_b64_tr_b16 v[54:55], v24 offset:53248
v_mfma_f32_16x16x32_bf16 a[52:55], v[32:35], v[104:107], a[52:55]
v_mfma_f32_16x16x32_bf16 a[0:3], v[36:39], v[108:111], a[0:3]
s_waitcnt lgkmcnt(6)
ds_read_b64_tr_b16 v[56:57], v25 offset:49152
ds_read_b64_tr_b16 v[58:59], v25 offset:53248
v_mfma_f32_16x16x32_bf16 a[28:31], v[36:39], v[112:115], a[28:31]
v_mfma_f32_16x16x32_bf16 a[4:7], v[40:43], v[108:111], a[4:7]
s_waitcnt lgkmcnt(6)
ds_read_b64_tr_b16 v[28:29], v26 offset:49152
ds_read_b64_tr_b16 v[30:31], v26 offset:53248
v_mfma_f32_16x16x32_bf16 a[32:35], v[40:43], v[112:115], a[32:35]
v_mfma_f32_16x16x32_bf16 a[8:11], v[44:47], v[108:111], a[8:11]
s_waitcnt lgkmcnt(6)
ds_read_b64_tr_b16 v[32:33], v20 offset:57344
ds_read_b64_tr_b16 v[34:35], v20 offset:61440
v_mfma_f32_16x16x32_bf16 a[36:39], v[44:47], v[112:115], a[36:39]
v_mfma_f32_16x16x32_bf16 a[12:15], v[48:51], v[108:111], a[12:15]
s_waitcnt lgkmcnt(6)
ds_read_b64_tr_b16 v[36:37], v21 offset:57344
ds_read_b64_tr_b16 v[38:39], v21 offset:61440
v_mfma_f32_16x16x32_bf16 a[40:43], v[48:51], v[112:115], a[40:43]
v_mfma_f32_16x16x32_bf16 a[16:19], v[52:55], v[108:111], a[16:19]
s_waitcnt lgkmcnt(6)
ds_read_b64_tr_b16 v[40:41], v22 offset:57344
ds_read_b64_tr_b16 v[42:43], v22 offset:61440
v_mfma_f32_16x16x32_bf16 a[44:47], v[52:55], v[112:115], a[44:47]
v_mfma_f32_16x16x32_bf16 a[20:23], v[56:59], v[108:111], a[20:23]
s_waitcnt lgkmcnt(6)
ds_read_b64_tr_b16 v[44:45], v23 offset:57344
ds_read_b64_tr_b16 v[46:47], v23 offset:61440
v_mfma_f32_16x16x32_bf16 a[48:51], v[56:59], v[112:115], a[48:51]
v_mfma_f32_16x16x32_bf16 a[24:27], v[28:31], v[108:111], a[24:27]
s_waitcnt lgkmcnt(6)
ds_read_b64_tr_b16 v[48:49], v24 offset:57344
ds_read_b64_tr_b16 v[50:51], v24 offset:61440
v_mfma_f32_16x16x32_bf16 a[52:55], v[28:31], v[112:115], a[52:55]
v_mfma_f32_16x16x32_bf16 a[0:3], v[32:35], v[116:119], a[0:3]
s_waitcnt lgkmcnt(6)
ds_read_b64_tr_b16 v[52:53], v25 offset:57344
ds_read_b64_tr_b16 v[54:55], v25 offset:61440
v_mfma_f32_16x16x32_bf16 a[28:31], v[32:35], v[120:123], a[28:31]
v_mfma_f32_16x16x32_bf16 a[4:7], v[36:39], v[116:119], a[4:7]
s_waitcnt lgkmcnt(6)
ds_read_b64_tr_b16 v[56:57], v26 offset:57344
ds_read_b64_tr_b16 v[58:59], v26 offset:61440
v_mfma_f32_16x16x32_bf16 a[32:35], v[36:39], v[120:123], a[32:35]
v_mfma_f32_16x16x32_bf16 a[8:11], v[40:43], v[116:119], a[8:11]
s_waitcnt lgkmcnt(6)
v_mfma_f32_16x16x32_bf16 a[36:39], v[40:43], v[120:123], a[36:39]
v_mfma_f32_16x16x32_bf16 a[12:15], v[44:47], v[116:119], a[12:15]
s_waitcnt lgkmcnt(4)
v_mfma_f32_16x16x32_bf16 a[40:43], v[44:47], v[120:123], a[40:43]
v_mfma_f32_16x16x32_bf16 a[16:19], v[48:51], v[116:119], a[16:19]
s_waitcnt lgkmcnt(2)
v_mfma_f32_16x16x32_bf16 a[44:47], v[48:51], v[120:123], a[44:47]
v_mfma_f32_16x16x32_bf16 a[20:23], v[52:55], v[116:119], a[20:23]
s_waitcnt lgkmcnt(0)
v_mfma_f32_16x16x32_bf16 a[48:51], v[52:55], v[120:123], a[48:51]
v_mfma_f32_16x16x32_bf16 a[24:27], v[56:59], v[116:119], a[24:27]
v_mfma_f32_16x16x32_bf16 a[52:55], v[56:59], v[120:123], a[52:55]
K3_EPI:
s_waitcnt vmcnt(0) lgkmcnt(0)
s_nop 7
v_mov_b32 v63, s71
v_mov_b32 v67, s71
v_mov_b32 v71, s71
v_mov_b32 v70, 0
v_mov_b32 v75, s71
v_mov_b32 v79, s71
v_mov_b32 v83, s71
v_mov_b32 v82, 0
v_mov_b32 v87, s71
v_mov_b32 v91, s71
v_mov_b32 v95, s71
v_mov_b32 v94, 0
v_mov_b32 v99, s71
v_mov_b32 v103, s71
v_mov_b32 v107, s71
v_mov_b32 v106, 0
v_accvgpr_read_b32 v28, a0
v_accvgpr_read_b32 v29, a1
v_accvgpr_read_b32 v30, a2
v_accvgpr_read_b32 v31, a3
v_cvt_pk_bf16_f32 v60, v28, v29
v_cvt_pk_bf16_f32 v61, v30, v31
v_accvgpr_read_b32 v28, a16
v_accvgpr_read_b32 v29, a17
v_accvgpr_read_b32 v30, a18
v_accvgpr_read_b32 v31, a19
v_cvt_pk_bf16_f32 v62, v28, v29
v_cvt_pk_bf16_f32 v64, v30, v31
v_accvgpr_read_b32 v28, a32
v_accvgpr_read_b32 v29, a33
v_accvgpr_read_b32 v30, a34
v_accvgpr_read_b32 v31, a35
v_cvt_pk_bf16_f32 v65, v28, v29
v_cvt_pk_bf16_f32 v66, v30, v31
v_accvgpr_read_b32 v28, a48
v_accvgpr_read_b32 v29, a49
v_accvgpr_read_b32 v30, a50
v_accvgpr_read_b32 v31, a51
v_cvt_pk_bf16_f32 v68, v28, v29
v_cvt_pk_bf16_f32 v69, v30, v31
s_cmp_eq_u32 s33, 0
s_cbranch_scc1 K3_SK0
s_sub_u32 s34, s33, 1
s_and_b32 s34, s34, 3
s_lshl_b32 s35, s42, 2
s_add_u32 s35, s35, 0
s_mul_i32 s35, s35, 3
s_add_u32 s35, s35, s34
s_lshl_b32 s35, s35, 2
s_add_u32 s35, s35, s30
s_mul_i32 s35, s35, 3072
buffer_store_dwordx4 v[60:63], v3, s[12:15], s35 offen offset:0 sc1
buffer_store_dwordx4 v[64:67], v3, s[12:15], s35 offen offset:1024 sc1
buffer_store_dwordx4 v[68:71], v3, s[12:15], s35 offen offset:2048 sc1
K3_SK0:
v_accvgpr_read_b32 v32, a4
v_accvgpr_read_b32 v33, a5
v_accvgpr_read_b32 v34, a6
v_accvgpr_read_b32 v35, a7
v_cvt_pk_bf16_f32 v72, v32, v33
v_cvt_pk_bf16_f32 v73, v34, v35
v_accvgpr_read_b32 v32, a20
v_accvgpr_read_b32 v33, a21
v_accvgpr_read_b32 v34, a22
v_accvgpr_read_b32 v35, a23
v_cvt_pk_bf16_f32 v74, v32, v33
v_cvt_pk_bf16_f32 v76, v34, v35
v_accvgpr_read_b32 v32, a36
v_accvgpr_read_b32 v33, a37
v_accvgpr_read_b32 v34, a38
v_accvgpr_read_b32 v35, a39
v_cvt_pk_bf16_f32 v77, v32, v33
v_cvt_pk_bf16_f32 v78, v34, v35
v_accvgpr_read_b32 v32, a52
v_accvgpr_read_b32 v33, a53
v_accvgpr_read_b32 v34, a54
v_accvgpr_read_b32 v35, a55
v_cvt_pk_bf16_f32 v80, v32, v33
v_cvt_pk_bf16_f32 v81, v34, v35
s_cmp_eq_u32 s33, 1
s_cbranch_scc1 K3_SK1
s_sub_u32 s34, s33, 2
s_and_b32 s34, s34, 3
s_lshl_b32 s35, s42, 2
s_add_u32 s35, s35, 1
s_mul_i32 s35, s35, 3
s_add_u32 s35, s35, s34
s_lshl_b32 s35, s35, 2
s_add_u32 s35, s35, s30
s_mul_i32 s35, s35, 3072
buffer_store_dwordx4 v[72:75], v3, s[12:15], s35 offen offset:0 sc1
buffer_store_dwordx4 v[76:79], v3, s[12:15], s35 offen offset:1024 sc1
buffer_store_dwordx4 v[80:83], v3, s[12:15], s35 offen offset:2048 sc1
K3_SK1:
v_accvgpr_read_b32 v36, a8
v_accvgpr_read_b32 v37, a9
v_accvgpr_read_b32 v38, a10
v_accvgpr_read_b32 v39, a11
v_cvt_pk_bf16_f32 v84, v36, v37
v_cvt_pk_bf16_f32 v85, v38, v39
v_accvgpr_read_b32 v36, a24
v_accvgpr_read_b32 v37, a25
v_accvgpr_read_b32 v38, a26
v_accvgpr_read_b32 v39, a27
v_cvt_pk_bf16_f32 v86, v36, v37
v_cvt_pk_bf16_f32 v88, v38, v39
v_accvgpr_read_b32 v36, a40
v_accvgpr_read_b32 v37, a41
v_accvgpr_read_b32 v38, a42
v_accvgpr_read_b32 v39, a43
v_cvt_pk_bf16_f32 v89, v36, v37
v_cvt_pk_bf16_f32 v90, v38, v39
v_mov_b32 v92, 0
v_mov_b32 v93, 0
s_cmp_eq_u32 s33, 2
s_cbranch_scc1 K3_SK2
s_sub_u32 s34, s33, 3
s_and_b32 s34, s34, 3
s_lshl_b32 s35, s42, 2
s_add_u32 s35, s35, 2
s_mul_i32 s35, s35, 3
s_add_u32 s35, s35, s34
s_lshl_b32 s35, s35, 2
s_add_u32 s35, s35, s30
s_mul_i32 s35, s35, 3072
buffer_store_dwordx4 v[84:87], v3, s[12:15], s35 offen offset:0 sc1
buffer_store_dwordx4 v[88:91], v3, s[12:15], s35 offen offset:1024 sc1
buffer_store_dwordx4 v[92:95], v3, s[12:15], s35 offen offset:2048 sc1
K3_SK2:
v_accvgpr_read_b32 v40, a12
v_accvgpr_read_b32 v41, a13
v_accvgpr_read_b32 v42, a14
v_accvgpr_read_b32 v43, a15
v_cvt_pk_bf16_f32 v96, v40, v41
v_cvt_pk_bf16_f32 v97, v42, v43
v_accvgpr_read_b32 v40, a28
v_accvgpr_read_b32 v41, a29
v_accvgpr_read_b32 v42, a30
v_accvgpr_read_b32 v43, a31
v_cvt_pk_bf16_f32 v98, v40, v41
v_cvt_pk_bf16_f32 v100, v42, v43
v_accvgpr_read_b32 v40, a44
v_accvgpr_read_b32 v41, a45
v_accvgpr_read_b32 v42, a46
v_accvgpr_read_b32 v43, a47
v_cvt_pk_bf16_f32 v101, v40, v41
v_cvt_pk_bf16_f32 v102, v42, v43
v_mov_b32 v104, 0
v_mov_b32 v105, 0
s_cmp_eq_u32 s33, 3
s_cbranch_scc1 K3_SK3
s_sub_u32 s34, s33, 4
s_and_b32 s34, s34, 3
s_lshl_b32 s35, s42, 2
s_add_u32 s35, s35, 3
s_mul_i32 s35, s35, 3
s_add_u32 s35, s35, s34
s_lshl_b32 s35, s35, 2
s_add_u32 s35, s35, s30
s_mul_i32 s35, s35, 3072
buffer_store_dwordx4 v[96:99], v3, s[12:15], s35 offen offset:0 sc1
buffer_store_dwordx4 v[100:103], v3, s[12:15], s35 offen offset:1024 sc1
buffer_store_dwordx4 v[104:107], v3, s[12:15], s35 offen offset:2048 sc1
K3_SK3:
v_and_b32 v4, 15, v2
s_lshl_b32 s34, s32, 7
s_lshl_b32 s35, s30, 5
s_add_u32 s34, s34, s35
v_add_u32 v4, s34, v4
v_mul_u32_u24 v12, 896, v4
v_lshrrev_b32 v6, 4, v2
v_lshl_add_u32 v12, v6, 3, v12
s_mul_i32 s35, s31, 224
v_add_u32 v12, s35, v12
s_add_u32 s62, s33, 0
s_cmp_ge_u32 s62, 7
s_cselect_b32 s34, 14112, 0
s_lshl_b32 s66, s62, 5
s_add_u32 s66, s66, s34
s_add_u32 s63, s33, 4
s_cmp_ge_u32 s63, 7
s_cselect_b32 s34, 14112, 0
s_lshl_b32 s67, s63, 5
s_add_u32 s67, s67, s34
s_add_u32 s64, s33, 8
s_cmp_ge_u32 s64, 7
s_cselect_b32 s34, 14112, 0
s_lshl_b32 s68, s64, 5
s_add_u32 s68, s68, s34
s_add_u32 s65, s33, 12
s_cmp_ge_u32 s65, 7
s_cselect_b32 s34, 14112, 0
s_lshl_b32 s69, s65, 5
s_add_u32 s69, s69, s34
buffer_load_dwordx2 v[120:121], v12, s[16:19], s66 offen
buffer_load_dwordx2 v[122:123], v12, s[16:19], s67 offen
buffer_load_dwordx2 v[124:125], v12, s[16:19], s68 offen
buffer_load_dwordx2 v[126:127], v12, s[16:19], s69 offen
s_cmp_eq_u32 s33, 0
s_cbranch_scc0 K3_OW0
v_accvgpr_read_b32 v128, a0
v_accvgpr_read_b32 v129, a1
v_accvgpr_read_b32 v130, a2
v_accvgpr_read_b32 v131, a3
v_accvgpr_read_b32 v132, a16
v_accvgpr_read_b32 v133, a17
v_accvgpr_read_b32 v134, a18
v_accvgpr_read_b32 v135, a19
v_accvgpr_read_b32 v136, a32
v_accvgpr_read_b32 v137, a33
v_accvgpr_read_b32 v138, a34
v_accvgpr_read_b32 v139, a35
v_accvgpr_read_b32 v140, a48
v_accvgpr_read_b32 v141, a49
v_accvgpr_read_b32 v142, a50
v_accvgpr_read_b32 v143, a51
K3_OW0:
s_cmp_eq_u32 s33, 1
s_cbranch_scc0 K3_OW1
v_accvgpr_read_b32 v128, a4
v_accvgpr_read_b32 v129, a5
v_accvgpr_read_b32 v130, a6
v_accvgpr_read_b32 v131, a7
v_accvgpr_read_b32 v132, a20
v_accvgpr_read_b32 v133, a21
v_accvgpr_read_b32 v134, a22
v_accvgpr_read_b32 v135, a23
v_accvgpr_read_b32 v136, a36
v_accvgpr_read_b32 v137, a37
v_accvgpr_read_b32 v138, a38
v_accvgpr_read_b32 v139, a39
v_accvgpr_read_b32 v140, a52
v_accvgpr_read_b32 v141, a53
v_accvgpr_read_b32 v142, a54
v_accvgpr_read_b32 v143, a55
K3_OW1:
s_cmp_eq_u32 s33, 2
s_cbranch_scc0 K3_OW2
v_accvgpr_read_b32 v128, a8
v_accvgpr_read_b32 v129, a9
v_accvgpr_read_b32 v130, a10
v_accvgpr_read_b32 v131, a11
v_accvgpr_read_b32 v132, a24
v_accvgpr_read_b32 v133, a25
v_accvgpr_read_b32 v134, a26
v_accvgpr_read_b32 v135, a27
v_accvgpr_read_b32 v136, a40
v_accvgpr_read_b32 v137, a41
v_accvgpr_read_b32 v138, a42
v_accvgpr_read_b32 v139, a43
v_mov_b32 v140, 0
v_mov_b32 v141, 0
v_mov_b32 v142, 0
v_mov_b32 v143, 0
K3_OW2:
s_cmp_eq_u32 s33, 3
s_cbranch_scc0 K3_OW3
v_accvgpr_read_b32 v128, a12
v_accvgpr_read_b32 v129, a13
v_accvgpr_read_b32 v130, a14
v_accvgpr_read_b32 v131, a15
v_accvgpr_read_b32 v132, a28
v_accvgpr_read_b32 v133, a29
v_accvgpr_read_b32 v134, a30
v_accvgpr_read_b32 v135, a31
v_accvgpr_read_b32 v136, a44
v_accvgpr_read_b32 v137, a45
v_accvgpr_read_b32 v138, a46
v_accvgpr_read_b32 v139, a47
v_mov_b32 v140, 0
v_mov_b32 v141, 0
v_mov_b32 v142, 0
v_mov_b32 v143, 0
K3_OW3:
s_lshl_b32 s34, s42, 2
s_add_u32 s34, s34, s33
s_mul_i32 s34, s34, 12
s_add_u32 s34, s34, s30
s_mul_i32 s34, s34, 3072
s_add_u32 s35, s34, 12288
s_add_u32 s36, s34, 24576
s_mov_b32 s59, 0x10000
K3_POLL:
buffer_load_dwordx4 v[150:153], v3, s[12:15], s34 offen offset:0 sc1
buffer_load_dwordx4 v[154:157], v3, s[12:15], s34 offen offset:1024 sc1
buffer_load_dwordx4 v[158:161], v3, s[12:15], s34 offen offset:2048 sc1
buffer_load_dwordx4 v[162:165], v3, s[12:15], s35 offen offset:0 sc1
buffer_load_dwordx4 v[166:169], v3, s[12:15], s35 offen offset:1024 sc1
buffer_load_dwordx4 v[170:173], v3, s[12:15], s35 offen offset:2048 sc1
buffer_load_dwordx4 v[174:177], v3, s[12:15], s36 offen offset:0 sc1
buffer_load_dwordx4 v[178:181], v3, s[12:15], s36 offen offset:1024 sc1
buffer_load_dwordx4 v[182:185], v3, s[12:15], s36 offen offset:2048 sc1
s_waitcnt vmcnt(0)
s_mov_b64 s[60:61], 0
v_cmp_ne_u32 vcc, s71, v153
s_or_b64 s[60:61], s[60:61], vcc
v_cmp_ne_u32 vcc, s71, v157
s_or_b64 s[60:61], s[60:61], vcc
v_cmp_ne_u32 vcc, s71, v161
s_or_b64 s[60:61], s[60:61], vcc
v_cmp_ne_u32 vcc, s71, v165
s_or_b64 s[60:61], s[60:61], vcc
v_cmp_ne_u32 vcc, s71, v169
s_or_b64 s[60:61], s[60:61], vcc
v_cmp_ne_u32 vcc, s71, v173
s_or_b64 s[60:61], s[60:61], vcc
v_cmp_ne_u32 vcc, s71, v177
s_or_b64 s[60:61], s[60:61], vcc
v_cmp_ne_u32 vcc, s71, v181
s_or_b64 s[60:61], s[60:61], vcc
v_cmp_ne_u32 vcc, s71, v185
s_or_b64 s[60:61], s[60:61], vcc
s_cmp_eq_u64 s[60:61], 0
s_cbranch_scc1 K3_GO
s_sub_u32 s59, s59, 1
s_cmp_eq_u32 s59, 0
s_cbranch_scc1 K3_GO
s_sleep 1
s_branch K3_POLL
K3_GO:
v_lshlrev_b32 v190, 16, v150
v_and_b32 v191, 0xffff0000, v150
v_lshlrev_b32 v192, 16, v151
v_and_b32 v193, 0xffff0000, v151
v_add_f32 v128, v128, v190
v_add_f32 v129, v129, v191
v_add_f32 v130, v130, v192
v_add_f32 v131, v131, v193
v_lshlrev_b32 v190, 16, v162
v_and_b32 v191, 0xffff0000, v162
v_lshlrev_b32 v192, 16, v163
v_and_b32 v193, 0xffff0000, v163
v_add_f32 v128, v128, v190
v_add_f32 v129, v129, v191
v_add_f32 v130, v130, v192
v_add_f32 v131, v131, v193
v_lshlrev_b32 v190, 16, v174
v_and_b32 v191, 0xffff0000, v174
v_lshlrev_b32 v192, 16, v175
v_and_b32 v193, 0xffff0000, v175
v_add_f32 v128, v128, v190
v_add_f32 v129, v129, v191
v_add_f32 v130, v130, v192
v_add_f32 v131, v131, v193
v_lshlrev_b32 v190, 16, v120
v_and_b32 v191, 0xffff0000, v120
v_lshlrev_b32 v192, 16, v121
v_and_b32 v193, 0xffff0000, v121
v_add_f32 v128, v128, v190
v_add_f32 v129, v129, v191
v_add_f32 v130, v130, v192
v_add_f32 v131, v131, v193
v_cvt_pk_bf16_f32 v194, v128, v129
v_cvt_pk_bf16_f32 v195, v130, v131
buffer_store_dwordx2 v[194:195], v12, s[20:23], s66 offen
v_lshlrev_b32 v198, 16, v152
v_and_b32 v199, 0xffff0000, v152
v_lshlrev_b32 v200, 16, v154
v_and_b32 v201, 0xffff0000, v154
v_add_f32 v132, v132, v198
v_add_f32 v133, v133, v199
v_add_f32 v134, v134, v200
v_add_f32 v135, v135, v201
v_lshlrev_b32 v198, 16, v164
v_and_b32 v199, 0xffff0000, v164
v_lshlrev_b32 v200, 16, v166
v_and_b32 v201, 0xffff0000, v166
v_add_f32 v132, v132, v198
v_add_f32 v133, v133, v199
v_add_f32 v134, v134, v200
v_add_f32 v135, v135, v201
v_lshlrev_b32 v198, 16, v176
v_and_b32 v199, 0xffff0000, v176
v_lshlrev_b32 v200, 16, v178
v_and_b32 v201, 0xffff0000, v178
v_add_f32 v132, v132, v198
v_add_f32 v133, v133, v199
v_add_f32 v134, v134, v200
v_add_f32 v135, v135, v201
v_lshlrev_b32 v198, 16, v122
v_and_b32 v199, 0xffff0000, v122
v_lshlrev_b32 v200, 16, v123
v_and_b32 v201, 0xffff0000, v123
v_add_f32 v132, v132, v198
v_add_f32 v133, v133, v199
v_add_f32 v134, v134, v200
v_add_f32 v135, v135, v201
v_cvt_pk_bf16_f32 v202, v132, v133
v_cvt_pk_bf16_f32 v203, v134, v135
buffer_store_dwordx2 v[202:203], v12, s[20:23], s67 offen
v_lshlrev_b32 v190, 16, v155
v_and_b32 v191, 0xffff0000, v155
v_lshlrev_b32 v192, 16, v156
v_and_b32 v193, 0xffff0000, v156
v_add_f32 v136, v136, v190
v_add_f32 v137, v137, v191
v_add_f32 v138, v138, v192
v_add_f32 v139, v139, v193
v_lshlrev_b32 v190, 16, v167
v_and_b32 v191, 0xffff0000, v167
v_lshlrev_b32 v192, 16, v168
v_and_b32 v193, 0xffff0000, v168
v_add_f32 v136, v136, v190
v_add_f32 v137, v137, v191
v_add_f32 v138, v138, v192
v_add_f32 v139, v139, v193
v_lshlrev_b32 v190, 16, v179
v_and_b32 v191, 0xffff0000, v179
v_lshlrev_b32 v192, 16, v180
v_and_b32 v193, 0xffff0000, v180
v_add_f32 v136, v136, v190
v_add_f32 v137, v137, v191
v_add_f32 v138, v138, v192
v_add_f32 v139, v139, v193
v_lshlrev_b32 v190, 16, v124
v_and_b32 v191, 0xffff0000, v124
v_lshlrev_b32 v192, 16, v125
v_and_b32 v193, 0xffff0000, v125
v_add_f32 v136, v136, v190
v_add_f32 v137, v137, v191
v_add_f32 v138, v138, v192
v_add_f32 v139, v139, v193
v_cvt_pk_bf16_f32 v194, v136, v137
v_cvt_pk_bf16_f32 v195, v138, v139
buffer_store_dwordx2 v[194:195], v12, s[20:23], s68 offen
s_cmp_ge_u32 s65, 14
s_cbranch_scc1 K3_FIN
v_lshlrev_b32 v198, 16, v158
v_and_b32 v199, 0xffff0000, v158
v_lshlrev_b32 v200, 16, v159
v_and_b32 v201, 0xffff0000, v159
v_add_f32 v140, v140, v198
v_add_f32 v141, v141, v199
v_add_f32 v142, v142, v200
v_add_f32 v143, v143, v201
v_lshlrev_b32 v198, 16, v170
v_and_b32 v199, 0xffff0000, v170
v_lshlrev_b32 v200, 16, v171
v_and_b32 v201, 0xffff0000, v171
v_add_f32 v140, v140, v198
v_add_f32 v141, v141, v199
v_add_f32 v142, v142, v200
v_add_f32 v143, v143, v201
v_lshlrev_b32 v198, 16, v182
v_and_b32 v199, 0xffff0000, v182
v_lshlrev_b32 v200, 16, v183
v_and_b32 v201, 0xffff0000, v183
v_add_f32 v140, v140, v198
v_add_f32 v141, v141, v199
v_add_f32 v142, v142, v200
v_add_f32 v143, v143, v201
v_lshlrev_b32 v198, 16, v126
v_and_b32 v199, 0xffff0000, v126
v_lshlrev_b32 v200, 16, v127
v_and_b32 v201, 0xffff0000, v127
v_add_f32 v140, v140, v198
v_add_f32 v141, v141, v199
v_add_f32 v142, v142, v200
v_add_f32 v143, v143, v201
v_cvt_pk_bf16_f32 v202, v140, v141
v_cvt_pk_bf16_f32 v203, v142, v143
buffer_store_dwordx2 v[202:203], v12, s[20:23], s69 offen
K3_FIN:
KF_END:
s_endpgm
.section .rodata,"a"
.p2align 6
.amdhsa_kernel parallel_sum__compressed_kv_cla__glu_gated_bilinear__prompt_kernel
  .amdhsa_next_free_vgpr 512
  .amdhsa_next_free_sgpr 102
  .amdhsa_accum_offset 256
  .amdhsa_group_segment_fixed_size 0
  .amdhsa_kernarg_size 104
  .amdhsa_user_sgpr_count 2
  .amdhsa_user_sgpr_kernarg_segment_ptr 1
  .amdhsa_system_sgpr_workgroup_id_x 1
  .amdhsa_float_denorm_mode_32 3
.end_amdhsa_kernel
```
